```python
import torch

def _softmax(x, axis=-1):
    return torch.softmax(x, dim=axis)
def _gelu(x):
    return torch.nn.functional.gelu(x, approximate="tanh")
def _silu(x):
    return torch.nn.functional.silu(x)
def _sigmoid(x):
    return torch.sigmoid(x)
def _layernorm(x, axis=-1, eps=1e-5):
    m = x.mean(dim=axis, keepdim=True)
    v = x.var(dim=axis, keepdim=True, unbiased=False)
    return (x - m) / torch.sqrt(v + eps)
def _scatter_add(tgt, idx, src, axis=0):
    return tgt.clone().index_add_(axis, idx, src)
def _segment_sum(src, seg, n):
    out = torch.zeros((n,) + src.shape[1:], dtype=src.dtype)
    return out.index_add_(0, seg, src)
def _pad(x, pw):
    flat = tuple(v for pair in reversed(pw) for v in pair)
    return torch.nn.functional.pad(x, flat)

kernel_name = 'concat_heads__mha_block_cached__gqa_block_cached__near_ridge'

def setup_inputs():

    _w = (lambda a: (lambda t: t.to(torch.bfloat16) if t.is_floating_point() else t)(torch.as_tensor(a)))
    def _A_setup():
        B, Sq, D = 16, 96, 640
        H, Sk, Dh = 32, 512, 192
        return {
            "x": _w((lambda *s: torch.randn(*s, dtype=torch.bfloat16) * 0.8)(B, Sq, D)),
            "k_cache": _w((lambda *s: torch.randn(*s, dtype=torch.bfloat16) * 0.8)(B, H, Sk, Dh)),
            "v_cache": _w((lambda *s: torch.randn(*s, dtype=torch.bfloat16) * 0.05)(B, H, Sk, Dh)),
            "wq": _w((lambda *s: torch.randn(*s, dtype=torch.bfloat16) * 0.8)(D, H * Dh) * (D ** -0.5)),
            "wo": _w((lambda *s: torch.randn(*s, dtype=torch.bfloat16) * 0.05)(H * Dh, D) * ((H * Dh) ** -0.5)),
        }
    _A_in = _A_setup()

    def _B_setup():
        B, Sq, D = 16, 96, 640
        Hq, Hkv, Sk, Dh = 32, 32, 512, 192
        assert Hq % Hkv == 0, (Hq, Hkv)
        return {
            "x": _w((lambda *s: torch.randn(*s, dtype=torch.bfloat16) * 0.8)(B, Sq, D)),
            "k_cache": _w((lambda *s: torch.randn(*s, dtype=torch.bfloat16) * 0.8)(B, Hkv, Sk, Dh)),
            "v_cache": _w((lambda *s: torch.randn(*s, dtype=torch.bfloat16) * 0.05)(B, Hkv, Sk, Dh)),
            "wq": _w((lambda *s: torch.randn(*s, dtype=torch.bfloat16) * 0.8)(D, Hq * Dh) * (D ** -0.5)),
            "wo": _w((lambda *s: torch.randn(*s, dtype=torch.bfloat16) * 0.05)(Hq * Dh, D) * ((Hq * Dh) ** -0.5)),
        }
    _B_in = _B_setup()

    return {
        "A_x": _A_in["x"],
        "A_k_cache": _A_in["k_cache"],
        "A_v_cache": _A_in["v_cache"],
        "A_wq": _A_in["wq"],
        "A_wo": _A_in["wo"],
        "B_x": _B_in["x"],
        "B_k_cache": _B_in["k_cache"],
        "B_v_cache": _B_in["v_cache"],
        "B_wq": _B_in["wq"],
        "B_wo": _B_in["wo"],
    }

def reference(A_x, A_k_cache, A_v_cache, A_wq, A_wo, B_x, B_k_cache, B_v_cache, B_wq, B_wo):
    def _A_ref(x, k_cache, v_cache, wq, wo):
        B, Sq, D = x.shape
        H, Dh = 32, 192
        q = (lambda x, *d: x.permute(*d))((x @ wq).reshape(B, Sq, H, Dh), 0, 2, 1, 3)
        scores = torch.einsum("bhqd,bhkd->bhqk", q, k_cache) * (Dh ** -0.5)
        p = _softmax(scores, axis=-1)
        o = torch.einsum("bhqk,bhkd->bhqd", p, v_cache)
        return (lambda x, *d: x.permute(*d))(o, 0, 2, 1, 3).reshape(B, Sq, H * Dh) @ wo

    def _B_ref(x, k_cache, v_cache, wq, wo):
        B, Sq, D = x.shape
        Hq, Dh = 32, 192
        Hkv = k_cache.shape[1]
        rep = Hq // Hkv
        q = (lambda x, *d: x.permute(*d))((x @ wq).reshape(B, Sq, Hq, Dh), 0, 2, 1, 3)
        k = (lambda x, n, axis: torch.repeat_interleave(x, n, dim=axis))(k_cache, rep, axis=1)
        v = (lambda x, n, axis: torch.repeat_interleave(x, n, dim=axis))(v_cache, rep, axis=1)
        scores = torch.einsum("bhqd,bhkd->bhqk", q, k) * (Dh ** -0.5)
        p = _softmax(scores, axis=-1)
        o = torch.einsum("bhqk,bhkd->bhqd", p, v)
        return (lambda x, *d: x.permute(*d))(o, 0, 2, 1, 3).reshape(B, Sq, Hq * Dh) @ wo

    a = _A_ref(A_x, A_k_cache, A_v_cache, A_wq, A_wo)
    b = _B_ref(B_x, B_k_cache, B_v_cache, B_wq, B_wo)
    return torch.concatenate([a, b], axis=-1)
```

```asm
; @launch grid=(256,1,1) block=(256,1,1) lds=155648
.amdgcn_target "amdgcn-amd-amdhsa--gfx950"
.text
.macro M a:vararg
v_mfma_f32_16x16x32_bf16 \a
.endm
.macro T a:vararg
ds_read_b64_tr_b16 \a
.endm
.macro C a:vararg
v_cvt_pk_bf16_f32 \a
.endm
.macro AW a:vararg
v_accvgpr_write_b32 \a
.endm
.macro L a:vararg
buffer_load_dwordx4 \a
.endm
.globl concat_heads__mha_block_cached__gqa_block_cached__near_ridge_kernel
.p2align 8
.type concat_heads__mha_block_cached__gqa_block_cached__near_ridge_kernel,@function
concat_heads__mha_block_cached__gqa_block_cached__near_ridge_kernel:
s_cmp_lt_u32 s2,256
s_cbranch_scc1 L_go
s_endpgm
L_go:
s_getpc_b64 s[52:53]
L_cp0:
s_sub_u32 s52,s52,L_cp0-L_go
s_subb_u32 s53,s53,0
s_and_b32 s54,s2,7
s_lshr_b32 s55,s2,3
s_lshr_b32 s56,s54,2
s_mul_i32 s56,s56,40
s_add_u32 s58,s0,s56
s_addc_u32 s59,s1,0
s_load_dwordx8 s[68:75],s[58:59],0
s_load_dwordx2 s[76:77],s[58:59],32
s_load_dwordx2 s[78:79],s[0:1],96
s_and_b32 s54,s54,3
s_lshl_b32 s54,s54,1
s_and_b32 s57,s55,1
s_or_b32 s51,s54,s57
s_lshr_b32 s55,s55,1
v_lshrrev_b32 v25,6,v0
s_nop 0
v_readfirstlane_b32 s50,v25
v_and_b32 v25,63,v0
v_lshlrev_b32 v0,4,v25
v_lshrrev_b32 v30,3,v25
v_and_b32 v31,6,v30
v_and_b32 v28,7,v25
v_xor_b32 v28,v28,v31
v_lshlrev_b32 v28,4,v28
v_mul_u32_u24 v30,0x500,v30
v_add_u32 v106,v28,v30
v_add_u32 v107,0x2400,v106
v_add_u32 v108,0x4800,v106
s_mov_b32 s35,0xaaaaaab
v_add_u32 v28,0,v25
v_mul_hi_u32 v30,v28,s35
v_and_b32 v31,6,v30
v_lshlrev_b32 v31,4,v31
v_xor_b32 v100,v0,v31
v_mul_u32_u24 v29,24,v30
v_sub_u32 v28,v28,v29
v_lshlrev_b32 v28,4,v28
v_xor_b32 v28,v28,v31
v_lshrrev_b32 v29,2,v30
v_lshl_add_u32 v30,v29,2,v30
v_mul_u32_u24 v30,0x3000,v30
v_add_u32 v28,v28,v30
v_subrev_u32 v103,0,v28
v_add_u32 v28,64,v25
v_mul_hi_u32 v30,v28,s35
v_and_b32 v31,6,v30
v_lshlrev_b32 v31,4,v31
v_xor_b32 v101,v0,v31
v_mul_u32_u24 v29,24,v30
v_sub_u32 v28,v28,v29
v_lshlrev_b32 v28,4,v28
v_xor_b32 v28,v28,v31
v_lshrrev_b32 v29,2,v30
v_lshl_add_u32 v30,v29,2,v30
v_mul_u32_u24 v30,0x3000,v30
v_add_u32 v28,v28,v30
v_subrev_u32 v104,0x400,v28
v_add_u32 v28,0x80,v25
v_mul_hi_u32 v30,v28,s35
v_and_b32 v31,6,v30
v_lshlrev_b32 v31,4,v31
v_xor_b32 v102,v0,v31
v_mul_u32_u24 v29,24,v30
v_sub_u32 v28,v28,v29
v_lshlrev_b32 v28,4,v28
v_xor_b32 v28,v28,v31
v_lshrrev_b32 v29,2,v30
v_lshl_add_u32 v30,v29,2,v30
v_mul_u32_u24 v30,0x3000,v30
v_add_u32 v28,v28,v30
v_subrev_u32 v105,0x800,v28
s_lshr_b32 s61,s50,1
s_and_b32 s62,s50,1
s_mul_i32 s28,s50,0x1800
s_lshl_b32 s57,s51,2
s_lshl_b32 s63,s61,1
s_add_u32 s63,s63,s57
s_mul_i32 s56,s55,5
s_lshr_b32 s56,s56,3
s_mul_i32 s38,s63,0x180
s_mul_i32 s35,s62,0xc000
s_add_u32 s38,s38,s35
s_add_u32 s39,s38,0x780000
s_mul_i32 s100,s56,0xc0000
s_add_u32 s31,s38,s100
s_mul_i32 s40,s55,0x60
s_mul_i32 s35,s50,24
s_add_u32 s40,s40,s35
s_mul_i32 s40,s40,0x500
s_add_u32 s41,s40,0x500
s_lshl_b32 s60,s56,7
s_mov_b32 s101,s60
s_add_u32 s33,s40,s60
s_mul_i32 s35,s50,0xc00
s_add_u32 s34,s35,0x18000
s_waitcnt lgkmcnt(0)
s_mov_b32 s20,s68
s_mov_b32 s21,s69
s_mov_b32 s22,0x1e0000
s_mov_b32 s23,0x20000
s_mov_b32 s12,s74
s_mov_b32 s13,s75
s_mov_b32 s14,0x780000
s_mov_b32 s15,0x20000
s_add_u32 m0,s34,0
s_nop 0
L v106,s[20:23],s33 offen lds
L v107,s[20:23],s33 offen offset:1024 lds
L v108,s[20:23],s33 offen offset:2048 lds
s_add_u32 s33,s33,0x80
s_cmp_eq_u32 s33,s41
s_cselect_b32 s33,s40,s33
s_add_u32 m0,s28,0
s_add_u32 s35,s31,0x30000
L v103,s[12:15],s31 offen lds
L v104,s[12:15],s31 offen offset:1024 lds
L v105,s[12:15],s31 offen offset:2048 lds
s_add_u32 m0,m0,0xc00
s_add_u32 s31,s31,0x60000
L v103,s[12:15],s35 offen lds
L v104,s[12:15],s35 offen offset:1024 lds
L v105,s[12:15],s35 offen offset:2048 lds
s_lshr_b32 s54,s2,3
s_lshl_b32 s54,s54,2
s_add_u32 s54,s54,s50
s_lshl_b32 s54,s54,4
v_and_b32 v28,15,v25
v_add_u32 v28,s54,v28
v_lshlrev_b32 v28,7,v28
v_min_u32 v28,L_code_end-L_go-4,v28
global_load_dword v35,v28,s[52:53]
s_mov_b32 s4,s70
s_mov_b32 s5,s71
s_mov_b32 s6,0x6000000
s_mov_b32 s7,0x20000
s_mov_b32 s8,s72
s_mov_b32 s9,s73
s_mov_b32 s10,0x6000000
s_mov_b32 s11,0x20000
s_mov_b32 s16,s76
s_mov_b32 s17,s77
s_mov_b32 s18,0x780000
s_mov_b32 s19,0x20000
s_mov_b32 s24,s78
s_mov_b32 s25,s79
s_mov_b32 s26,0x1a1c0000
s_mov_b32 s27,0x20000
v_and_b32 v26,15,v25
v_lshrrev_b32 v27,4,v25
s_bfe_u32 s54,s2,0x10002
s_lshl_b32 s54,s54,4
s_add_u32 s54,s54,s55
s_lshl_b32 s54,s54,7
s_add_u32 s54,s54,0x1e10000
v_and_b32 v110,7,v25
v_lshl_add_u32 v110,v110,2,s54
buffer_load_dword v109,v110,s[24:27],0 offen sc1
s_lshl_b32 s29,s55,5
s_add_u32 s29,s29,s63
s_mul_i32 s29,s29,0x30000
s_mul_i32 s36,s62,0x1800
s_add_u32 s29,s29,s36
s_mov_b32 s30,s29
s_mul_i32 s42,s57,0xc0
s_mul_i32 s43,s50,48
s_add_u32 s42,s42,s43
s_mul_i32 s42,s42,0x500
s_add_u32 s43,s42,0x500
s_add_u32 s32,s42,s60
s_mul_i32 s45,s2,0x1e000
s_mul_i32 s54,s50,0xc00
s_add_u32 s45,s45,s54
s_add_u32 s46,s45,0x1e000
s_mul_i32 s54,s56,0x3000
s_add_u32 s44,s45,s54
s_mov_b32 s37,0x3dd53b95
s_mul_i32 s54,s61,0x3000
v_and_b32 v31,6,v26
v_xor_b32 v28,v27,v31
v_lshlrev_b32 v28,4,v28
v_mul_u32_u24 v29,0x180,v26
v_add3_u32 v1,v28,v29,s54
v_xor_b32 v2,64,v1
v_add_u32 v3,0xc000,v1
v_add_u32 v4,0xc000,v2
s_add_u32 s36,s36,0x18000
v_lshlrev_b32 v29,7,v26
v_add3_u32 v17,v28,v29,s36
v_xor_b32 v18,64,v17
v_lshrrev_b32 v30,2,v25
v_and_b32 v31,6,v30
v_bfe_u32 v28,v25,1,1
v_xor_b32 v28,v28,v31
v_lshlrev_b32 v28,4,v28
v_and_b32 v29,1,v25
v_lshl_add_u32 v28,v29,3,v28
v_mul_u32_u24 v29,0x180,v30
v_add3_u32 v5,v28,v29,s54
v_xor_b32 v6,32,v5
v_xor_b32 v7,64,v5
v_xor_b32 v8,0x60,v5
v_add_u32 v9,0xc000,v5
v_add_u32 v10,0xc000,v6
v_add_u32 v11,0xc000,v7
v_add_u32 v12,0xc000,v8
v_lshl_add_u32 v13,v30,7,v28
s_lshl_b32 s54,s61,6
v_xor_b32 v13,s54,v13
v_xor_b32 v14,32,v13
v_add_u32 v15,0xc000,v13
v_add_u32 v16,0xc000,v14
v_lshrrev_b32 v28,2,v26
v_cmp_eq_u32 vcc,v28,v27
v_and_b32 v29,1,v26
v_lshlrev_b32 v29,4,v29
s_mov_b32 s54,0x3f80
v_lshlrev_b32 v29,v29,s54
v_cndmask_b32 v29,0,v29,vcc
v_and_b32 v28,2,v26
v_cmp_eq_u32 vcc,0,v28
s_nop 1
v_cndmask_b32 v30,0,v29,vcc
v_sub_u32 v31,v29,v30
AW a240,0
AW a241,0
AW a244,0
AW a245,0
AW a242,v30
AW a243,v31
v_add_u32 v111,s28,v0
s_mul_i32 s47,s50,0x4800
s_add_u32 s47,s47,0x18000
s_cmp_eq_u32 s50,3
s_cselect_b32 s47,0x12000,s47
s_mul_i32 s48,s62,0x4800
s_add_u32 s48,s48,0x18000
s_mov_b32 s49,0x21000
s_cmp_eq_u32 s62,1
s_cselect_b32 s49,0x12000,s49
s_mov_b32 s52,0x44444444
s_mov_b32 s53,0x44444444
s_lshr_b32 s36,s2,3
s_lshl_b32 s36,s36,1
s_lshr_b64 s[52:53],s[52:53],s36
s_and_b32 s36,s52,3
s_cmp_eq_u32 s36,1
s_cbranch_scc0 L_nc1
s_getpc_b64 s[52:53]
L_pc1:
s_add_u32 s52,s52,L_cls1-L_pc1
s_addc_u32 s53,s53,0
s_setpc_b64 s[52:53]
L_nc1:
L_cls0:
s_add_u32 m0,s28,0x6000
s_add_u32 s35,s31,0x30000
L v103,s[12:15],s31 offen lds
L v104,s[12:15],s31 offen offset:1024 lds
L v105,s[12:15],s31 offen offset:2048 lds
s_add_u32 m0,m0,0xc00
s_add_u32 s31,s31,0x60000
L v103,s[12:15],s35 offen lds
L v104,s[12:15],s35 offen offset:1024 lds
L v105,s[12:15],s35 offen offset:2048 lds
s_cmp_eq_u32 s31,s39
s_cselect_b32 s31,s38,s31
s_add_u32 m0,s34,0x3000
s_xor_b32 s34,s34,0x38000
L v106,s[20:23],s33 offen lds
L v107,s[20:23],s33 offen offset:1024 lds
L v108,s[20:23],s33 offen offset:2048 lds
s_add_u32 s33,s33,0x80
s_cmp_eq_u32 s33,s41
s_cselect_b32 s33,s40,s33
s_add_u32 m0,s28,0xc000
s_add_u32 s35,s31,0x30000
L v103,s[12:15],s31 offen lds
L v104,s[12:15],s31 offen offset:1024 lds
L v105,s[12:15],s31 offen offset:2048 lds
s_add_u32 m0,m0,0xc00
s_add_u32 s31,s31,0x60000
L v103,s[12:15],s35 offen lds
L v104,s[12:15],s35 offen offset:1024 lds
L v105,s[12:15],s35 offen offset:2048 lds
s_waitcnt vmcnt(17)
s_barrier
ds_read_b128 v[76:79],v17
ds_read_b128 v[80:83],v17 offset:2048
ds_read_b128 v[84:87],v17 offset:4096
T a[216:217],v5
T a[218:219],v5 offset:6144
T a[220:221],v6
T a[222:223],v6 offset:6144
T a[224:225],v7
T a[226:227],v7 offset:6144
T a[228:229],v8
T a[230:231],v8 offset:6144
T a[232:233],v5 offset:128
T a[234:235],v5 offset:6272
s_waitcnt lgkmcnt(4)
M v[112:115],a[216:219],v[76:79],0
T a[236:237],v6 offset:128
s_add_u32 m0,s28,0x12000
M v[116:119],a[216:219],v[80:83],0
T a[238:239],v6 offset:6272
M v[120:123],a[216:219],v[84:87],0
s_add_u32 s35,s31,0x30000
M v[132:135],a[220:223],v[84:87],0
T a[216:217],v7 offset:128
L v103,s[12:15],s31 offen lds
M v[128:131],a[220:223],v[80:83],0
T a[218:219],v7 offset:6272
M v[124:127],a[220:223],v[76:79],0
L v104,s[12:15],s31 offen offset:1024 lds
M v[136:139],a[224:227],v[76:79],0
T a[220:221],v8 offset:128
L v105,s[12:15],s31 offen offset:2048 lds
M v[140:143],a[224:227],v[80:83],0
T a[222:223],v8 offset:6272
M v[144:147],a[224:227],v[84:87],0
s_add_u32 m0,m0,0xc00
s_waitcnt lgkmcnt(4)
M v[156:159],a[228:231],v[84:87],0
T a[224:225],v5 offset:256
M v[152:155],a[228:231],v[80:83],0
T a[226:227],v5 offset:6400
s_add_u32 s31,s31,0x60000
M v[148:151],a[228:231],v[76:79],0
L v103,s[12:15],s35 offen lds
M v[160:163],a[232:235],v[76:79],0
T a[228:229],v6 offset:256
M v[164:167],a[232:235],v[80:83],0
T a[230:231],v6 offset:6400
L v104,s[12:15],s35 offen offset:1024 lds
M v[168:171],a[232:235],v[84:87],0
L v105,s[12:15],s35 offen offset:2048 lds
M v[180:183],a[236:239],v[84:87],0
T a[232:233],v7 offset:256
M v[176:179],a[236:239],v[80:83],0
T a[234:235],v7 offset:6400
M v[172:175],a[236:239],v[76:79],0
s_waitcnt lgkmcnt(4)
M v[184:187],a[216:219],v[76:79],0
T a[236:237],v8 offset:256
M v[188:191],a[216:219],v[80:83],0
T a[238:239],v8 offset:6400
M v[192:195],a[216:219],v[84:87],0
s_cmp_eq_u32 s31,s39
s_cselect_b32 s31,s38,s31
M v[204:207],a[220:223],v[84:87],0
s_add_u32 m0,s34,0
s_nop 0
L v106,s[20:23],s33 offen lds
M v[200:203],a[220:223],v[80:83],0
L v107,s[20:23],s33 offen offset:1024 lds
M v[196:199],a[220:223],v[76:79],0
L v108,s[20:23],s33 offen offset:2048 lds
M v[208:211],a[224:227],v[76:79],0
s_add_u32 s33,s33,0x80
M v[212:215],a[224:227],v[80:83],0
M v[216:219],a[224:227],v[84:87],0
s_waitcnt vmcnt(18) lgkmcnt(0)
s_barrier
M v[228:231],a[228:231],v[84:87],0
T a[216:217],v5 offset:24576
T a[218:219],v5 offset:30720
M v[224:227],a[228:231],v[80:83],0
ds_read_b128 v[88:91],v18
T a[220:221],v6 offset:24576
M v[220:223],a[228:231],v[76:79],0
T a[222:223],v6 offset:30720
ds_read_b128 v[92:95],v18 offset:2048
M v[232:235],a[232:235],v[76:79],0
ds_read_b128 v[96:99],v18 offset:4096
T a[224:225],v7 offset:24576
M v[236:239],a[232:235],v[80:83],0
T a[226:227],v7 offset:30720
T a[228:229],v8 offset:24576
M v[240:243],a[232:235],v[84:87],0
T a[230:231],v8 offset:30720
T a[232:233],v5 offset:24704
M v[252:255],a[236:239],v[84:87],0
T a[234:235],v5 offset:30848
M v[248:251],a[236:239],v[80:83],0
s_cmp_eq_u32 s33,s41
s_cselect_b32 s33,s40,s33
M v[244:247],a[236:239],v[76:79],0
s_mov_b32 s36,3
.p2align 3
C0_loop1:
s_waitcnt lgkmcnt(4)
M v[112:115],a[216:219],v[88:91],v[112:115]
T a[236:237],v6 offset:24704
s_add_u32 m0,s28,0
M v[116:119],a[216:219],v[92:95],v[116:119]
T a[238:239],v6 offset:30848
M v[120:123],a[216:219],v[96:99],v[120:123]
s_add_u32 s35,s31,0x30000
M v[132:135],a[220:223],v[96:99],v[132:135]
T a[216:217],v7 offset:24704
L v103,s[12:15],s31 offen lds
M v[128:131],a[220:223],v[92:95],v[128:131]
T a[218:219],v7 offset:30848
M v[124:127],a[220:223],v[88:91],v[124:127]
L v104,s[12:15],s31 offen offset:1024 lds
M v[136:139],a[224:227],v[88:91],v[136:139]
T a[220:221],v8 offset:24704
L v105,s[12:15],s31 offen offset:2048 lds
M v[140:143],a[224:227],v[92:95],v[140:143]
T a[222:223],v8 offset:30848
M v[144:147],a[224:227],v[96:99],v[144:147]
s_waitcnt lgkmcnt(4)
M v[156:159],a[228:231],v[96:99],v[156:159]
T a[224:225],v5 offset:24832
s_add_u32 m0,m0,0xc00
M v[152:155],a[228:231],v[92:95],v[152:155]
T a[226:227],v5 offset:30976
M v[148:151],a[228:231],v[88:91],v[148:151]
s_add_u32 s31,s31,0x60000
M v[160:163],a[232:235],v[88:91],v[160:163]
T a[228:229],v6 offset:24832
L v103,s[12:15],s35 offen lds
M v[164:167],a[232:235],v[92:95],v[164:167]
T a[230:231],v6 offset:30976
M v[168:171],a[232:235],v[96:99],v[168:171]
L v104,s[12:15],s35 offen offset:1024 lds
M v[180:183],a[236:239],v[96:99],v[180:183]
T a[232:233],v7 offset:24832
L v105,s[12:15],s35 offen offset:2048 lds
M v[176:179],a[236:239],v[92:95],v[176:179]
T a[234:235],v7 offset:30976
M v[172:175],a[236:239],v[88:91],v[172:175]
s_waitcnt lgkmcnt(4)
M v[184:187],a[216:219],v[88:91],v[184:187]
T a[236:237],v8 offset:24832
s_add_u32 m0,s34,0x3000
M v[188:191],a[216:219],v[92:95],v[188:191]
T a[238:239],v8 offset:30976
M v[192:195],a[216:219],v[96:99],v[192:195]
s_xor_b32 s34,s34,0x38000
M v[204:207],a[220:223],v[96:99],v[204:207]
L v106,s[20:23],s33 offen lds
M v[200:203],a[220:223],v[92:95],v[200:203]
L v107,s[20:23],s33 offen offset:1024 lds
M v[196:199],a[220:223],v[88:91],v[196:199]
L v108,s[20:23],s33 offen offset:2048 lds
M v[208:211],a[224:227],v[88:91],v[208:211]
s_add_u32 s33,s33,0x80
M v[212:215],a[224:227],v[92:95],v[212:215]
M v[216:219],a[224:227],v[96:99],v[216:219]
s_waitcnt vmcnt(18) lgkmcnt(0)
s_barrier
M v[228:231],a[228:231],v[96:99],v[228:231]
T a[216:217],v9
T a[218:219],v9 offset:6144
M v[224:227],a[228:231],v[92:95],v[224:227]
ds_read_b128 v[76:79],v17 offset:12288
T a[220:221],v10
M v[220:223],a[228:231],v[88:91],v[220:223]
T a[222:223],v10 offset:6144
ds_read_b128 v[80:83],v17 offset:14336
M v[232:235],a[232:235],v[88:91],v[232:235]
ds_read_b128 v[84:87],v17 offset:16384
T a[224:225],v11
M v[236:239],a[232:235],v[92:95],v[236:239]
T a[226:227],v11 offset:6144
T a[228:229],v12
M v[240:243],a[232:235],v[96:99],v[240:243]
T a[230:231],v12 offset:6144
T a[232:233],v9 offset:128
M v[252:255],a[236:239],v[96:99],v[252:255]
T a[234:235],v9 offset:6272
M v[248:251],a[236:239],v[92:95],v[248:251]
s_cmp_eq_u32 s33,s41
s_cselect_b32 s33,s40,s33
M v[244:247],a[236:239],v[88:91],v[244:247]
s_waitcnt lgkmcnt(4)
M v[112:115],a[216:219],v[76:79],v[112:115]
T a[236:237],v10 offset:128
s_add_u32 m0,s28,0x6000
M v[116:119],a[216:219],v[80:83],v[116:119]
T a[238:239],v10 offset:6272
M v[120:123],a[216:219],v[84:87],v[120:123]
s_add_u32 s35,s31,0x30000
M v[132:135],a[220:223],v[84:87],v[132:135]
T a[216:217],v11 offset:128
M v[128:131],a[220:223],v[80:83],v[128:131]
T a[218:219],v11 offset:6272
M v[124:127],a[220:223],v[76:79],v[124:127]
L v103,s[12:15],s31 offen lds
M v[136:139],a[224:227],v[76:79],v[136:139]
T a[220:221],v12 offset:128
M v[140:143],a[224:227],v[80:83],v[140:143]
T a[222:223],v12 offset:6272
L v104,s[12:15],s31 offen offset:1024 lds
M v[144:147],a[224:227],v[84:87],v[144:147]
s_waitcnt lgkmcnt(4)
M v[156:159],a[228:231],v[84:87],v[156:159]
T a[224:225],v9 offset:256
M v[152:155],a[228:231],v[80:83],v[152:155]
T a[226:227],v9 offset:6400
M v[148:151],a[228:231],v[76:79],v[148:151]
L v105,s[12:15],s31 offen offset:2048 lds
M v[160:163],a[232:235],v[76:79],v[160:163]
T a[228:229],v10 offset:256
M v[164:167],a[232:235],v[80:83],v[164:167]
T a[230:231],v10 offset:6400
s_add_u32 m0,m0,0xc00
M v[168:171],a[232:235],v[84:87],v[168:171]
M v[180:183],a[236:239],v[84:87],v[180:183]
T a[232:233],v11 offset:256
s_add_u32 s31,s31,0x60000
M v[176:179],a[236:239],v[80:83],v[176:179]
T a[234:235],v11 offset:6400
M v[172:175],a[236:239],v[76:79],v[172:175]
s_waitcnt lgkmcnt(4)
M v[184:187],a[216:219],v[76:79],v[184:187]
T a[236:237],v12 offset:256
M v[188:191],a[216:219],v[80:83],v[188:191]
T a[238:239],v12 offset:6400
L v103,s[12:15],s35 offen lds
M v[192:195],a[216:219],v[84:87],v[192:195]
M v[204:207],a[220:223],v[84:87],v[204:207]
L v104,s[12:15],s35 offen offset:1024 lds
M v[200:203],a[220:223],v[80:83],v[200:203]
L v105,s[12:15],s35 offen offset:2048 lds
M v[196:199],a[220:223],v[76:79],v[196:199]
M v[208:211],a[224:227],v[76:79],v[208:211]
M v[212:215],a[224:227],v[80:83],v[212:215]
M v[216:219],a[224:227],v[84:87],v[216:219]
s_waitcnt vmcnt(18) lgkmcnt(0)
s_barrier
M v[228:231],a[228:231],v[84:87],v[228:231]
T a[216:217],v9 offset:24576
T a[218:219],v9 offset:30720
M v[224:227],a[228:231],v[80:83],v[224:227]
ds_read_b128 v[88:91],v18 offset:12288
T a[220:221],v10 offset:24576
M v[220:223],a[228:231],v[76:79],v[220:223]
T a[222:223],v10 offset:30720
ds_read_b128 v[92:95],v18 offset:14336
M v[232:235],a[232:235],v[76:79],v[232:235]
ds_read_b128 v[96:99],v18 offset:16384
T a[224:225],v11 offset:24576
M v[236:239],a[232:235],v[80:83],v[236:239]
T a[226:227],v11 offset:30720
T a[228:229],v12 offset:24576
M v[240:243],a[232:235],v[84:87],v[240:243]
T a[230:231],v12 offset:30720
T a[232:233],v9 offset:24704
M v[252:255],a[236:239],v[84:87],v[252:255]
T a[234:235],v9 offset:30848
M v[248:251],a[236:239],v[80:83],v[248:251]
s_cmp_eq_u32 s31,s39
s_cselect_b32 s31,s38,s31
M v[244:247],a[236:239],v[76:79],v[244:247]
s_waitcnt lgkmcnt(4)
M v[112:115],a[216:219],v[88:91],v[112:115]
T a[236:237],v10 offset:24704
s_add_u32 m0,s28,0xc000
M v[116:119],a[216:219],v[92:95],v[116:119]
T a[238:239],v10 offset:30848
M v[120:123],a[216:219],v[96:99],v[120:123]
s_add_u32 s35,s31,0x30000
M v[132:135],a[220:223],v[96:99],v[132:135]
T a[216:217],v11 offset:24704
M v[128:131],a[220:223],v[92:95],v[128:131]
T a[218:219],v11 offset:30848
M v[124:127],a[220:223],v[88:91],v[124:127]
L v103,s[12:15],s31 offen lds
M v[136:139],a[224:227],v[88:91],v[136:139]
T a[220:221],v12 offset:24704
M v[140:143],a[224:227],v[92:95],v[140:143]
T a[222:223],v12 offset:30848
M v[144:147],a[224:227],v[96:99],v[144:147]
s_waitcnt lgkmcnt(4)
M v[156:159],a[228:231],v[96:99],v[156:159]
T a[224:225],v9 offset:24832
L v104,s[12:15],s31 offen offset:1024 lds
M v[152:155],a[228:231],v[92:95],v[152:155]
T a[226:227],v9 offset:30976
M v[148:151],a[228:231],v[88:91],v[148:151]
M v[160:163],a[232:235],v[88:91],v[160:163]
T a[228:229],v10 offset:24832
L v105,s[12:15],s31 offen offset:2048 lds
M v[164:167],a[232:235],v[92:95],v[164:167]
T a[230:231],v10 offset:30976
M v[168:171],a[232:235],v[96:99],v[168:171]
s_add_u32 m0,m0,0xc00
M v[180:183],a[236:239],v[96:99],v[180:183]
T a[232:233],v11 offset:24832
M v[176:179],a[236:239],v[92:95],v[176:179]
T a[234:235],v11 offset:30976
M v[172:175],a[236:239],v[88:91],v[172:175]
s_waitcnt lgkmcnt(4)
M v[184:187],a[216:219],v[88:91],v[184:187]
T a[236:237],v12 offset:24832
s_add_u32 s31,s31,0x60000
M v[188:191],a[216:219],v[92:95],v[188:191]
T a[238:239],v12 offset:30976
M v[192:195],a[216:219],v[96:99],v[192:195]
M v[204:207],a[220:223],v[96:99],v[204:207]
L v103,s[12:15],s35 offen lds
M v[200:203],a[220:223],v[92:95],v[200:203]
M v[196:199],a[220:223],v[88:91],v[196:199]
L v104,s[12:15],s35 offen offset:1024 lds
M v[208:211],a[224:227],v[88:91],v[208:211]
v_xor_b32 v17,0x38000,v17
M v[212:215],a[224:227],v[92:95],v[212:215]
v_xor_b32 v18,0x38000,v18
M v[216:219],a[224:227],v[96:99],v[216:219]
s_waitcnt vmcnt(14) lgkmcnt(0)
s_barrier
M v[228:231],a[228:231],v[96:99],v[228:231]
T a[216:217],v5
T a[218:219],v5 offset:6144
M v[224:227],a[228:231],v[92:95],v[224:227]
ds_read_b128 v[76:79],v17
T a[220:221],v6
M v[220:223],a[228:231],v[88:91],v[220:223]
T a[222:223],v6 offset:6144
ds_read_b128 v[80:83],v17 offset:2048
M v[232:235],a[232:235],v[88:91],v[232:235]
ds_read_b128 v[84:87],v17 offset:4096
T a[224:225],v7
M v[236:239],a[232:235],v[92:95],v[236:239]
T a[226:227],v7 offset:6144
T a[228:229],v8
M v[240:243],a[232:235],v[96:99],v[240:243]
T a[230:231],v8 offset:6144
T a[232:233],v5 offset:128
M v[252:255],a[236:239],v[96:99],v[252:255]
T a[234:235],v5 offset:6272
L v105,s[12:15],s35 offen offset:2048 lds
M v[248:251],a[236:239],v[92:95],v[248:251]
M v[244:247],a[236:239],v[88:91],v[244:247]
s_waitcnt lgkmcnt(4)
M v[112:115],a[216:219],v[76:79],v[112:115]
T a[236:237],v6 offset:128
s_add_u32 m0,s28,0x12000
M v[116:119],a[216:219],v[80:83],v[116:119]
T a[238:239],v6 offset:6272
M v[120:123],a[216:219],v[84:87],v[120:123]
s_add_u32 s35,s31,0x30000
M v[132:135],a[220:223],v[84:87],v[132:135]
T a[216:217],v7 offset:128
L v103,s[12:15],s31 offen lds
M v[128:131],a[220:223],v[80:83],v[128:131]
T a[218:219],v7 offset:6272
M v[124:127],a[220:223],v[76:79],v[124:127]
L v104,s[12:15],s31 offen offset:1024 lds
M v[136:139],a[224:227],v[76:79],v[136:139]
T a[220:221],v8 offset:128
L v105,s[12:15],s31 offen offset:2048 lds
M v[140:143],a[224:227],v[80:83],v[140:143]
T a[222:223],v8 offset:6272
M v[144:147],a[224:227],v[84:87],v[144:147]
s_add_u32 m0,m0,0xc00
s_waitcnt lgkmcnt(4)
M v[156:159],a[228:231],v[84:87],v[156:159]
T a[224:225],v5 offset:256
M v[152:155],a[228:231],v[80:83],v[152:155]
T a[226:227],v5 offset:6400
s_add_u32 s31,s31,0x60000
M v[148:151],a[228:231],v[76:79],v[148:151]
L v103,s[12:15],s35 offen lds
M v[160:163],a[232:235],v[76:79],v[160:163]
T a[228:229],v6 offset:256
M v[164:167],a[232:235],v[80:83],v[164:167]
T a[230:231],v6 offset:6400
L v104,s[12:15],s35 offen offset:1024 lds
M v[168:171],a[232:235],v[84:87],v[168:171]
L v105,s[12:15],s35 offen offset:2048 lds
M v[180:183],a[236:239],v[84:87],v[180:183]
T a[232:233],v7 offset:256
M v[176:179],a[236:239],v[80:83],v[176:179]
T a[234:235],v7 offset:6400
M v[172:175],a[236:239],v[76:79],v[172:175]
s_waitcnt lgkmcnt(4)
M v[184:187],a[216:219],v[76:79],v[184:187]
T a[236:237],v8 offset:256
M v[188:191],a[216:219],v[80:83],v[188:191]
T a[238:239],v8 offset:6400
M v[192:195],a[216:219],v[84:87],v[192:195]
s_cmp_eq_u32 s31,s39
s_cselect_b32 s31,s38,s31
M v[204:207],a[220:223],v[84:87],v[204:207]
s_add_u32 m0,s34,0
s_nop 0
L v106,s[20:23],s33 offen lds
M v[200:203],a[220:223],v[80:83],v[200:203]
L v107,s[20:23],s33 offen offset:1024 lds
M v[196:199],a[220:223],v[76:79],v[196:199]
L v108,s[20:23],s33 offen offset:2048 lds
M v[208:211],a[224:227],v[76:79],v[208:211]
s_add_u32 s33,s33,0x80
M v[212:215],a[224:227],v[80:83],v[212:215]
M v[216:219],a[224:227],v[84:87],v[216:219]
s_waitcnt vmcnt(15) lgkmcnt(0)
s_barrier
M v[228:231],a[228:231],v[84:87],v[228:231]
T a[216:217],v5 offset:24576
T a[218:219],v5 offset:30720
M v[224:227],a[228:231],v[80:83],v[224:227]
ds_read_b128 v[88:91],v18
T a[220:221],v6 offset:24576
M v[220:223],a[228:231],v[76:79],v[220:223]
T a[222:223],v6 offset:30720
ds_read_b128 v[92:95],v18 offset:2048
M v[232:235],a[232:235],v[76:79],v[232:235]
ds_read_b128 v[96:99],v18 offset:4096
T a[224:225],v7 offset:24576
M v[236:239],a[232:235],v[80:83],v[236:239]
T a[226:227],v7 offset:30720
T a[228:229],v8 offset:24576
M v[240:243],a[232:235],v[84:87],v[240:243]
T a[230:231],v8 offset:30720
T a[232:233],v5 offset:24704
M v[252:255],a[236:239],v[84:87],v[252:255]
T a[234:235],v5 offset:30848
M v[248:251],a[236:239],v[80:83],v[248:251]
s_cmp_eq_u32 s33,s41
s_cselect_b32 s33,s40,s33
M v[244:247],a[236:239],v[76:79],v[244:247]
s_sub_u32 s36,s36,1
s_cmp_lg_u32 s36,0
s_cbranch_scc1 C0_loop1
s_waitcnt lgkmcnt(4)
M v[112:115],a[216:219],v[88:91],v[112:115]
T a[236:237],v6 offset:24704
s_add_u32 m0,s28,0
M v[116:119],a[216:219],v[92:95],v[116:119]
T a[238:239],v6 offset:30848
M v[120:123],a[216:219],v[96:99],v[120:123]
s_add_u32 s35,s31,0x30000
M v[132:135],a[220:223],v[96:99],v[132:135]
T a[216:217],v7 offset:24704
L v103,s[12:15],s31 offen lds
M v[128:131],a[220:223],v[92:95],v[128:131]
T a[218:219],v7 offset:30848
M v[124:127],a[220:223],v[88:91],v[124:127]
L v104,s[12:15],s31 offen offset:1024 lds
M v[136:139],a[224:227],v[88:91],v[136:139]
T a[220:221],v8 offset:24704
L v105,s[12:15],s31 offen offset:2048 lds
M v[140:143],a[224:227],v[92:95],v[140:143]
T a[222:223],v8 offset:30848
M v[144:147],a[224:227],v[96:99],v[144:147]
s_waitcnt lgkmcnt(4)
M v[156:159],a[228:231],v[96:99],v[156:159]
T a[224:225],v5 offset:24832
s_add_u32 m0,m0,0xc00
M v[152:155],a[228:231],v[92:95],v[152:155]
T a[226:227],v5 offset:30976
M v[148:151],a[228:231],v[88:91],v[148:151]
s_add_u32 s31,s31,0x60000
M v[160:163],a[232:235],v[88:91],v[160:163]
T a[228:229],v6 offset:24832
L v103,s[12:15],s35 offen lds
M v[164:167],a[232:235],v[92:95],v[164:167]
T a[230:231],v6 offset:30976
M v[168:171],a[232:235],v[96:99],v[168:171]
L v104,s[12:15],s35 offen offset:1024 lds
M v[180:183],a[236:239],v[96:99],v[180:183]
T a[232:233],v7 offset:24832
L v105,s[12:15],s35 offen offset:2048 lds
M v[176:179],a[236:239],v[92:95],v[176:179]
T a[234:235],v7 offset:30976
M v[172:175],a[236:239],v[88:91],v[172:175]
s_waitcnt lgkmcnt(4)
M v[184:187],a[216:219],v[88:91],v[184:187]
T a[236:237],v8 offset:24832
s_add_u32 m0,s34,0x3000
M v[188:191],a[216:219],v[92:95],v[188:191]
T a[238:239],v8 offset:30976
M v[192:195],a[216:219],v[96:99],v[192:195]
s_xor_b32 s34,s34,0x38000
M v[204:207],a[220:223],v[96:99],v[204:207]
L v106,s[20:23],s33 offen lds
M v[200:203],a[220:223],v[92:95],v[200:203]
L v107,s[20:23],s33 offen offset:1024 lds
M v[196:199],a[220:223],v[88:91],v[196:199]
L v108,s[20:23],s33 offen offset:2048 lds
M v[208:211],a[224:227],v[88:91],v[208:211]
s_add_u32 s33,s33,0x80
M v[212:215],a[224:227],v[92:95],v[212:215]
M v[216:219],a[224:227],v[96:99],v[216:219]
s_waitcnt vmcnt(18) lgkmcnt(0)
s_barrier
M v[228:231],a[228:231],v[96:99],v[228:231]
T a[216:217],v9
T a[218:219],v9 offset:6144
M v[224:227],a[228:231],v[92:95],v[224:227]
ds_read_b128 v[76:79],v17 offset:12288
T a[220:221],v10
M v[220:223],a[228:231],v[88:91],v[220:223]
T a[222:223],v10 offset:6144
ds_read_b128 v[80:83],v17 offset:14336
M v[232:235],a[232:235],v[88:91],v[232:235]
ds_read_b128 v[84:87],v17 offset:16384
T a[224:225],v11
M v[236:239],a[232:235],v[92:95],v[236:239]
T a[226:227],v11 offset:6144
T a[228:229],v12
M v[240:243],a[232:235],v[96:99],v[240:243]
T a[230:231],v12 offset:6144
T a[232:233],v9 offset:128
M v[252:255],a[236:239],v[96:99],v[252:255]
T a[234:235],v9 offset:6272
M v[248:251],a[236:239],v[92:95],v[248:251]
s_cmp_eq_u32 s33,s41
s_cselect_b32 s33,s40,s33
M v[244:247],a[236:239],v[88:91],v[244:247]
s_waitcnt lgkmcnt(4)
M v[112:115],a[216:219],v[76:79],v[112:115]
T a[236:237],v10 offset:128
s_add_u32 m0,s28,0x6000
M v[116:119],a[216:219],v[80:83],v[116:119]
T a[238:239],v10 offset:6272
M v[120:123],a[216:219],v[84:87],v[120:123]
s_add_u32 s35,s31,0x30000
M v[132:135],a[220:223],v[84:87],v[132:135]
T a[216:217],v11 offset:128
M v[128:131],a[220:223],v[80:83],v[128:131]
T a[218:219],v11 offset:6272
M v[124:127],a[220:223],v[76:79],v[124:127]
L v103,s[12:15],s31 offen lds
M v[136:139],a[224:227],v[76:79],v[136:139]
T a[220:221],v12 offset:128
M v[140:143],a[224:227],v[80:83],v[140:143]
T a[222:223],v12 offset:6272
L v104,s[12:15],s31 offen offset:1024 lds
M v[144:147],a[224:227],v[84:87],v[144:147]
s_waitcnt lgkmcnt(4)
M v[156:159],a[228:231],v[84:87],v[156:159]
T a[224:225],v9 offset:256
M v[152:155],a[228:231],v[80:83],v[152:155]
T a[226:227],v9 offset:6400
M v[148:151],a[228:231],v[76:79],v[148:151]
L v105,s[12:15],s31 offen offset:2048 lds
M v[160:163],a[232:235],v[76:79],v[160:163]
T a[228:229],v10 offset:256
M v[164:167],a[232:235],v[80:83],v[164:167]
T a[230:231],v10 offset:6400
s_add_u32 m0,m0,0xc00
M v[168:171],a[232:235],v[84:87],v[168:171]
M v[180:183],a[236:239],v[84:87],v[180:183]
T a[232:233],v11 offset:256
s_add_u32 s31,s31,0x60000
M v[176:179],a[236:239],v[80:83],v[176:179]
T a[234:235],v11 offset:6400
M v[172:175],a[236:239],v[76:79],v[172:175]
s_waitcnt lgkmcnt(4)
M v[184:187],a[216:219],v[76:79],v[184:187]
T a[236:237],v12 offset:256
M v[188:191],a[216:219],v[80:83],v[188:191]
T a[238:239],v12 offset:6400
L v103,s[12:15],s35 offen lds
M v[192:195],a[216:219],v[84:87],v[192:195]
M v[204:207],a[220:223],v[84:87],v[204:207]
L v104,s[12:15],s35 offen offset:1024 lds
M v[200:203],a[220:223],v[80:83],v[200:203]
L v105,s[12:15],s35 offen offset:2048 lds
M v[196:199],a[220:223],v[76:79],v[196:199]
M v[208:211],a[224:227],v[76:79],v[208:211]
M v[212:215],a[224:227],v[80:83],v[212:215]
M v[216:219],a[224:227],v[84:87],v[216:219]
s_waitcnt vmcnt(18) lgkmcnt(0)
s_barrier
M v[228:231],a[228:231],v[84:87],v[228:231]
T a[216:217],v9 offset:24576
T a[218:219],v9 offset:30720
M v[224:227],a[228:231],v[80:83],v[224:227]
ds_read_b128 v[88:91],v18 offset:12288
T a[220:221],v10 offset:24576
M v[220:223],a[228:231],v[76:79],v[220:223]
T a[222:223],v10 offset:30720
ds_read_b128 v[92:95],v18 offset:14336
M v[232:235],a[232:235],v[76:79],v[232:235]
ds_read_b128 v[96:99],v18 offset:16384
T a[224:225],v11 offset:24576
M v[236:239],a[232:235],v[80:83],v[236:239]
T a[226:227],v11 offset:30720
T a[228:229],v12 offset:24576
M v[240:243],a[232:235],v[84:87],v[240:243]
T a[230:231],v12 offset:30720
T a[232:233],v9 offset:24704
M v[252:255],a[236:239],v[84:87],v[252:255]
T a[234:235],v9 offset:30848
M v[248:251],a[236:239],v[80:83],v[248:251]
s_cmp_eq_u32 s31,s39
s_cselect_b32 s31,s38,s31
M v[244:247],a[236:239],v[76:79],v[244:247]
s_waitcnt lgkmcnt(4)
M v[112:115],a[216:219],v[88:91],v[112:115]
T a[236:237],v10 offset:24704
s_add_u32 m0,s28,0xc000
M v[116:119],a[216:219],v[92:95],v[116:119]
T a[238:239],v10 offset:30848
M v[120:123],a[216:219],v[96:99],v[120:123]
s_add_u32 s35,s31,0x30000
M v[132:135],a[220:223],v[96:99],v[132:135]
T a[216:217],v11 offset:24704
M v[128:131],a[220:223],v[92:95],v[128:131]
T a[218:219],v11 offset:30848
M v[124:127],a[220:223],v[88:91],v[124:127]
L v103,s[12:15],s31 offen lds
M v[136:139],a[224:227],v[88:91],v[136:139]
T a[220:221],v12 offset:24704
M v[140:143],a[224:227],v[92:95],v[140:143]
T a[222:223],v12 offset:30848
M v[144:147],a[224:227],v[96:99],v[144:147]
s_waitcnt lgkmcnt(4)
M v[156:159],a[228:231],v[96:99],v[156:159]
T a[224:225],v9 offset:24832
L v104,s[12:15],s31 offen offset:1024 lds
M v[152:155],a[228:231],v[92:95],v[152:155]
T a[226:227],v9 offset:30976
M v[148:151],a[228:231],v[88:91],v[148:151]
M v[160:163],a[232:235],v[88:91],v[160:163]
T a[228:229],v10 offset:24832
L v105,s[12:15],s31 offen offset:2048 lds
M v[164:167],a[232:235],v[92:95],v[164:167]
T a[230:231],v10 offset:30976
M v[168:171],a[232:235],v[96:99],v[168:171]
s_add_u32 m0,m0,0xc00
M v[180:183],a[236:239],v[96:99],v[180:183]
T a[232:233],v11 offset:24832
M v[176:179],a[236:239],v[92:95],v[176:179]
T a[234:235],v11 offset:30976
M v[172:175],a[236:239],v[88:91],v[172:175]
s_waitcnt lgkmcnt(4)
M v[184:187],a[216:219],v[88:91],v[184:187]
T a[236:237],v12 offset:24832
s_add_u32 s31,s31,0x60000
M v[188:191],a[216:219],v[92:95],v[188:191]
T a[238:239],v12 offset:30976
M v[192:195],a[216:219],v[96:99],v[192:195]
M v[204:207],a[220:223],v[96:99],v[204:207]
L v103,s[12:15],s35 offen lds
M v[200:203],a[220:223],v[92:95],v[200:203]
M v[196:199],a[220:223],v[88:91],v[196:199]
L v104,s[12:15],s35 offen offset:1024 lds
M v[208:211],a[224:227],v[88:91],v[208:211]
v_xor_b32 v17,0x38000,v17
M v[212:215],a[224:227],v[92:95],v[212:215]
v_xor_b32 v18,0x38000,v18
M v[216:219],a[224:227],v[96:99],v[216:219]
s_waitcnt vmcnt(14) lgkmcnt(0)
s_barrier
M v[228:231],a[228:231],v[96:99],v[228:231]
T a[216:217],v5
T a[218:219],v5 offset:6144
M v[224:227],a[228:231],v[92:95],v[224:227]
ds_read_b128 v[76:79],v17
T a[220:221],v6
M v[220:223],a[228:231],v[88:91],v[220:223]
T a[222:223],v6 offset:6144
ds_read_b128 v[80:83],v17 offset:2048
M v[232:235],a[232:235],v[88:91],v[232:235]
ds_read_b128 v[84:87],v17 offset:4096
T a[224:225],v7
M v[236:239],a[232:235],v[92:95],v[236:239]
T a[226:227],v7 offset:6144
T a[228:229],v8
M v[240:243],a[232:235],v[96:99],v[240:243]
T a[230:231],v8 offset:6144
T a[232:233],v5 offset:128
M v[252:255],a[236:239],v[96:99],v[252:255]
T a[234:235],v5 offset:6272
L v105,s[12:15],s35 offen offset:2048 lds
M v[248:251],a[236:239],v[92:95],v[248:251]
M v[244:247],a[236:239],v[88:91],v[244:247]
s_waitcnt lgkmcnt(4)
M v[112:115],a[216:219],v[76:79],v[112:115]
T a[236:237],v6 offset:128
s_add_u32 m0,s28,0x12000
M v[116:119],a[216:219],v[80:83],v[116:119]
T a[238:239],v6 offset:6272
M v[120:123],a[216:219],v[84:87],v[120:123]
s_add_u32 s35,s31,0x30000
M v[132:135],a[220:223],v[84:87],v[132:135]
T a[216:217],v7 offset:128
M v[128:131],a[220:223],v[80:83],v[128:131]
T a[218:219],v7 offset:6272
L v103,s[12:15],s31 offen lds
M v[124:127],a[220:223],v[76:79],v[124:127]
L v104,s[12:15],s31 offen offset:1024 lds
M v[136:139],a[224:227],v[76:79],v[136:139]
T a[220:221],v8 offset:128
M v[140:143],a[224:227],v[80:83],v[140:143]
T a[222:223],v8 offset:6272
M v[144:147],a[224:227],v[84:87],v[144:147]
L v105,s[12:15],s31 offen offset:2048 lds
s_waitcnt lgkmcnt(4)
M v[156:159],a[228:231],v[84:87],v[156:159]
T a[224:225],v5 offset:256
M v[152:155],a[228:231],v[80:83],v[152:155]
T a[226:227],v5 offset:6400
M v[148:151],a[228:231],v[76:79],v[148:151]
s_add_u32 m0,m0,0xc00
M v[160:163],a[232:235],v[76:79],v[160:163]
T a[228:229],v6 offset:256
s_add_u32 s31,s31,0x60000
M v[164:167],a[232:235],v[80:83],v[164:167]
T a[230:231],v6 offset:6400
M v[168:171],a[232:235],v[84:87],v[168:171]
L v103,s[12:15],s35 offen lds
M v[180:183],a[236:239],v[84:87],v[180:183]
T a[232:233],v7 offset:256
M v[176:179],a[236:239],v[80:83],v[176:179]
T a[234:235],v7 offset:6400
M v[172:175],a[236:239],v[76:79],v[172:175]
L v104,s[12:15],s35 offen offset:1024 lds
s_waitcnt lgkmcnt(4)
M v[184:187],a[216:219],v[76:79],v[184:187]
T a[236:237],v8 offset:256
M v[188:191],a[216:219],v[80:83],v[188:191]
T a[238:239],v8 offset:6400
L v105,s[12:15],s35 offen offset:2048 lds
M v[192:195],a[216:219],v[84:87],v[192:195]
M v[204:207],a[220:223],v[84:87],v[204:207]
M v[200:203],a[220:223],v[80:83],v[200:203]
s_cmp_eq_u32 s31,s39
s_cselect_b32 s31,s38,s31
M v[196:199],a[220:223],v[76:79],v[196:199]
s_add_u32 s31,s31,0x180
M v[208:211],a[224:227],v[76:79],v[208:211]
M v[212:215],a[224:227],v[80:83],v[212:215]
s_add_u32 s38,s38,0x180
M v[216:219],a[224:227],v[84:87],v[216:219]
s_waitcnt vmcnt(12) lgkmcnt(0)
s_barrier
M v[228:231],a[228:231],v[84:87],v[228:231]
T a[216:217],v5 offset:24576
T a[218:219],v5 offset:30720
M v[224:227],a[228:231],v[80:83],v[224:227]
ds_read_b128 v[88:91],v18
T a[220:221],v6 offset:24576
M v[220:223],a[228:231],v[76:79],v[220:223]
T a[222:223],v6 offset:30720
ds_read_b128 v[92:95],v18 offset:2048
M v[232:235],a[232:235],v[76:79],v[232:235]
ds_read_b128 v[96:99],v18 offset:4096
T a[224:225],v7 offset:24576
M v[236:239],a[232:235],v[80:83],v[236:239]
T a[226:227],v7 offset:30720
T a[228:229],v8 offset:24576
M v[240:243],a[232:235],v[84:87],v[240:243]
T a[230:231],v8 offset:30720
T a[232:233],v5 offset:24704
M v[252:255],a[236:239],v[84:87],v[252:255]
T a[234:235],v5 offset:30848
M v[248:251],a[236:239],v[80:83],v[248:251]
s_add_u32 s39,s39,0x180
M v[244:247],a[236:239],v[76:79],v[244:247]
s_waitcnt lgkmcnt(4)
M v[112:115],a[216:219],v[88:91],v[112:115]
T a[236:237],v6 offset:24704
s_add_u32 m0,s28,0
M v[116:119],a[216:219],v[92:95],v[116:119]
T a[238:239],v6 offset:30848
M v[120:123],a[216:219],v[96:99],v[120:123]
s_add_u32 s35,s29,0xc00
M v[132:135],a[220:223],v[96:99],v[132:135]
T a[216:217],v7 offset:24704
M v[128:131],a[220:223],v[92:95],v[128:131]
T a[218:219],v7 offset:30848
M v[124:127],a[220:223],v[88:91],v[124:127]
L v100,s[4:7],s29 offen nt lds
M v[136:139],a[224:227],v[88:91],v[136:139]
T a[220:221],v8 offset:24704
M v[140:143],a[224:227],v[92:95],v[140:143]
T a[222:223],v8 offset:30848
M v[144:147],a[224:227],v[96:99],v[144:147]
s_waitcnt lgkmcnt(4)
M v[156:159],a[228:231],v[96:99],v[156:159]
T a[224:225],v5 offset:24832
L v101,s[4:7],s29 offen offset:1024 nt lds
M v[152:155],a[228:231],v[92:95],v[152:155]
T a[226:227],v5 offset:30976
M v[148:151],a[228:231],v[88:91],v[148:151]
M v[160:163],a[232:235],v[88:91],v[160:163]
T a[228:229],v6 offset:24832
L v102,s[4:7],s29 offen offset:2048 nt lds
M v[164:167],a[232:235],v[92:95],v[164:167]
T a[230:231],v6 offset:30976
M v[168:171],a[232:235],v[96:99],v[168:171]
M v[180:183],a[236:239],v[96:99],v[180:183]
T a[232:233],v7 offset:24832
s_add_u32 m0,m0,0xc00
M v[176:179],a[236:239],v[92:95],v[176:179]
T a[234:235],v7 offset:30976
M v[172:175],a[236:239],v[88:91],v[172:175]
s_waitcnt lgkmcnt(4)
M v[184:187],a[216:219],v[88:91],v[184:187]
T a[236:237],v8 offset:24832
M v[188:191],a[216:219],v[92:95],v[188:191]
T a[238:239],v8 offset:30976
s_add_u32 s29,s29,0x3000
M v[192:195],a[216:219],v[96:99],v[192:195]
M v[204:207],a[220:223],v[96:99],v[204:207]
L v100,s[4:7],s35 offen nt lds
M v[200:203],a[220:223],v[92:95],v[200:203]
M v[196:199],a[220:223],v[88:91],v[196:199]
L v101,s[4:7],s35 offen offset:1024 nt lds
M v[208:211],a[224:227],v[88:91],v[208:211]
M v[212:215],a[224:227],v[92:95],v[212:215]
L v102,s[4:7],s35 offen offset:2048 nt lds
M v[216:219],a[224:227],v[96:99],v[216:219]
s_waitcnt vmcnt(12) lgkmcnt(0)
s_barrier
M v[228:231],a[228:231],v[96:99],v[228:231]
T a[216:217],v9
T a[218:219],v9 offset:6144
M v[224:227],a[228:231],v[92:95],v[224:227]
ds_read_b128 v[76:79],v17 offset:12288
T a[220:221],v10
M v[220:223],a[228:231],v[88:91],v[220:223]
T a[222:223],v10 offset:6144
ds_read_b128 v[80:83],v17 offset:14336
M v[232:235],a[232:235],v[88:91],v[232:235]
ds_read_b128 v[84:87],v17 offset:16384
T a[224:225],v11
M v[236:239],a[232:235],v[92:95],v[236:239]
T a[226:227],v11 offset:6144
T a[228:229],v12
M v[240:243],a[232:235],v[96:99],v[240:243]
T a[230:231],v12 offset:6144
T a[232:233],v9 offset:128
M v[252:255],a[236:239],v[96:99],v[252:255]
T a[234:235],v9 offset:6272
M v[248:251],a[236:239],v[92:95],v[248:251]
M v[244:247],a[236:239],v[88:91],v[244:247]
s_waitcnt lgkmcnt(4)
M v[112:115],a[216:219],v[76:79],v[112:115]
T a[236:237],v10 offset:128
s_add_u32 m0,s28,0x6000
M v[116:119],a[216:219],v[80:83],v[116:119]
T a[238:239],v10 offset:6272
M v[120:123],a[216:219],v[84:87],v[120:123]
s_add_u32 s35,s30,0xc00
M v[132:135],a[220:223],v[84:87],v[132:135]
T a[216:217],v11 offset:128
M v[128:131],a[220:223],v[80:83],v[128:131]
T a[218:219],v11 offset:6272
M v[124:127],a[220:223],v[76:79],v[124:127]
L v100,s[8:11],s30 offen nt lds
M v[136:139],a[224:227],v[76:79],v[136:139]
T a[220:221],v12 offset:128
M v[140:143],a[224:227],v[80:83],v[140:143]
T a[222:223],v12 offset:6272
M v[144:147],a[224:227],v[84:87],v[144:147]
s_waitcnt lgkmcnt(4)
M v[156:159],a[228:231],v[84:87],v[156:159]
T a[224:225],v9 offset:256
L v101,s[8:11],s30 offen offset:1024 nt lds
M v[152:155],a[228:231],v[80:83],v[152:155]
T a[226:227],v9 offset:6400
M v[148:151],a[228:231],v[76:79],v[148:151]
M v[160:163],a[232:235],v[76:79],v[160:163]
T a[228:229],v10 offset:256
L v102,s[8:11],s30 offen offset:2048 nt lds
M v[164:167],a[232:235],v[80:83],v[164:167]
T a[230:231],v10 offset:6400
M v[168:171],a[232:235],v[84:87],v[168:171]
M v[180:183],a[236:239],v[84:87],v[180:183]
T a[232:233],v11 offset:256
s_add_u32 m0,m0,0xc00
M v[176:179],a[236:239],v[80:83],v[176:179]
T a[234:235],v11 offset:6400
M v[172:175],a[236:239],v[76:79],v[172:175]
s_waitcnt lgkmcnt(4)
M v[184:187],a[216:219],v[76:79],v[184:187]
T a[236:237],v12 offset:256
M v[188:191],a[216:219],v[80:83],v[188:191]
T a[238:239],v12 offset:6400
s_add_u32 s30,s30,0x3000
M v[192:195],a[216:219],v[84:87],v[192:195]
M v[204:207],a[220:223],v[84:87],v[204:207]
L v100,s[8:11],s35 offen nt lds
M v[200:203],a[220:223],v[80:83],v[200:203]
M v[196:199],a[220:223],v[76:79],v[196:199]
L v101,s[8:11],s35 offen offset:1024 nt lds
M v[208:211],a[224:227],v[76:79],v[208:211]
M v[212:215],a[224:227],v[80:83],v[212:215]
L v102,s[8:11],s35 offen offset:2048 nt lds
M v[216:219],a[224:227],v[84:87],v[216:219]
s_waitcnt vmcnt(12) lgkmcnt(0)
s_barrier
M v[228:231],a[228:231],v[84:87],v[228:231]
T a[216:217],v9 offset:24576
T a[218:219],v9 offset:30720
M v[224:227],a[228:231],v[80:83],v[224:227]
ds_read_b128 v[88:91],v18 offset:12288
T a[220:221],v10 offset:24576
M v[220:223],a[228:231],v[76:79],v[220:223]
T a[222:223],v10 offset:30720
ds_read_b128 v[92:95],v18 offset:14336
M v[232:235],a[232:235],v[76:79],v[232:235]
ds_read_b128 v[96:99],v18 offset:16384
T a[224:225],v11 offset:24576
M v[236:239],a[232:235],v[80:83],v[236:239]
T a[226:227],v11 offset:30720
T a[228:229],v12 offset:24576
M v[240:243],a[232:235],v[84:87],v[240:243]
T a[230:231],v12 offset:30720
T a[232:233],v9 offset:24704
M v[252:255],a[236:239],v[84:87],v[252:255]
T a[234:235],v9 offset:30848
M v[248:251],a[236:239],v[80:83],v[248:251]
M v[244:247],a[236:239],v[76:79],v[244:247]
s_waitcnt lgkmcnt(4)
M v[112:115],a[216:219],v[88:91],v[112:115]
T a[236:237],v10 offset:24704
s_add_u32 m0,s28,0xc000
M v[116:119],a[216:219],v[92:95],v[116:119]
T a[238:239],v10 offset:30848
M v[120:123],a[216:219],v[96:99],v[120:123]
M v[132:135],a[220:223],v[96:99],v[132:135]
T a[216:217],v11 offset:24704
s_add_u32 s35,s29,0xc00
M v[128:131],a[220:223],v[92:95],v[128:131]
T a[218:219],v11 offset:30848
M v[124:127],a[220:223],v[88:91],v[124:127]
M v[136:139],a[224:227],v[88:91],v[136:139]
T a[220:221],v12 offset:24704
M v[140:143],a[224:227],v[92:95],v[140:143]
T a[222:223],v12 offset:30848
L v100,s[4:7],s29 offen nt lds
M v[144:147],a[224:227],v[96:99],v[144:147]
s_waitcnt lgkmcnt(4)
M v[156:159],a[228:231],v[96:99],v[156:159]
T a[224:225],v9 offset:24832
C v52,v112,v113
C v53,v114,v115
C v54,v124,v125
C v55,v126,v127
M v[152:155],a[228:231],v[92:95],v[152:155]
T a[226:227],v9 offset:30976
C v56,v116,v117
C v57,v118,v119
C v58,v128,v129
C v59,v130,v131
M v[148:151],a[228:231],v[88:91],v[148:151]
L v101,s[4:7],s29 offen offset:1024 nt lds
C v60,v120,v121
C v61,v122,v123
C v62,v132,v133
C v63,v134,v135
M v[160:163],a[232:235],v[88:91],v[160:163]
T a[228:229],v10 offset:24832
v_permlane32_swap_b32 v52,v54
v_permlane32_swap_b32 v53,v55
v_permlane32_swap_b32 v56,v58
v_permlane32_swap_b32 v57,v59
M v[164:167],a[232:235],v[92:95],v[164:167]
T a[230:231],v10 offset:30976
v_permlane32_swap_b32 v60,v62
v_permlane32_swap_b32 v61,v63
v_permlane16_swap_b32 v52,v54
v_permlane16_swap_b32 v53,v55
M v[168:171],a[232:235],v[96:99],v[168:171]
v_permlane16_swap_b32 v56,v58
v_permlane16_swap_b32 v57,v59
v_permlane16_swap_b32 v60,v62
v_permlane16_swap_b32 v61,v63
AW a144,v52
M v[180:183],a[236:239],v[96:99],v[180:183]
T a[232:233],v11 offset:24832
L v102,s[4:7],s29 offen offset:2048 nt lds
AW a145,v53
AW a146,v54
AW a147,v55
M v[176:179],a[236:239],v[92:95],v[176:179]
T a[234:235],v11 offset:30976
AW a148,v56
AW a149,v57
AW a150,v58
AW a151,v59
M v[172:175],a[236:239],v[88:91],v[172:175]
AW a152,v60
AW a153,v61
AW a154,v62
AW a155,v63
s_waitcnt lgkmcnt(4)
M v[184:187],a[216:219],v[88:91],v[184:187]
T a[236:237],v12 offset:24832
M v[188:191],a[216:219],v[92:95],v[188:191]
T a[238:239],v12 offset:30976
s_add_u32 m0,m0,0xc00
M v[192:195],a[216:219],v[96:99],v[192:195]
C v64,v136,v137
C v65,v138,v139
C v66,v148,v149
M v[204:207],a[220:223],v[96:99],v[204:207]
C v67,v150,v151
C v68,v140,v141
C v69,v142,v143
M v[200:203],a[220:223],v[92:95],v[200:203]
s_add_u32 s29,s29,0x3000
C v70,v152,v153
C v71,v154,v155
M v[196:199],a[220:223],v[88:91],v[196:199]
C v72,v144,v145
C v73,v146,v147
C v74,v156,v157
M v[208:211],a[224:227],v[88:91],v[208:211]
L v100,s[4:7],s35 offen nt lds
C v75,v158,v159
v_permlane32_swap_b32 v64,v66
M v[212:215],a[224:227],v[92:95],v[212:215]
v_permlane32_swap_b32 v65,v67
v_permlane32_swap_b32 v68,v70
v_permlane32_swap_b32 v69,v71
M v[216:219],a[224:227],v[96:99],v[216:219]
s_waitcnt vmcnt(10) lgkmcnt(0)
s_barrier
v_permlane32_swap_b32 v72,v74
M v[228:231],a[228:231],v[96:99],v[228:231]
ds_read_b128 a[216:219],v1
ds_read_b128 a[220:223],v2
v_permlane32_swap_b32 v73,v75
M v[224:227],a[228:231],v[92:95],v[224:227]
ds_read_b128 a[224:227],v1 offset:128
v_permlane16_swap_b32 v64,v66
v_permlane16_swap_b32 v65,v67
M v[220:223],a[228:231],v[88:91],v[220:223]
L v101,s[4:7],s35 offen offset:1024 nt lds
v_permlane16_swap_b32 v68,v70
v_permlane16_swap_b32 v69,v71
M v[232:235],a[232:235],v[88:91],v[232:235]
ds_read_b128 a[228:231],v2 offset:128
v_permlane16_swap_b32 v72,v74
v_permlane16_swap_b32 v73,v75
M v[236:239],a[232:235],v[92:95],v[236:239]
AW a156,v64
AW a157,v65
AW a158,v66
M v[240:243],a[232:235],v[96:99],v[240:243]
ds_read_b128 a[232:235],v1 offset:256
AW a159,v67
AW a160,v68
M v[252:255],a[236:239],v[96:99],v[252:255]
L v102,s[4:7],s35 offen offset:2048 nt lds
AW a161,v69
AW a162,v70
M v[248:251],a[236:239],v[92:95],v[248:251]
AW a163,v71
AW a164,v72
AW a165,v73
M v[244:247],a[236:239],v[88:91],v[244:247]
AW a166,v74
AW a167,v75
C v52,v160,v161
C v53,v162,v163
C v54,v172,v173
C v55,v174,v175
C v56,v164,v165
C v57,v166,v167
C v58,v176,v177
C v59,v178,v179
C v60,v168,v169
C v61,v170,v171
C v62,v180,v181
C v63,v182,v183
v_permlane32_swap_b32 v52,v54
v_permlane32_swap_b32 v53,v55
v_permlane32_swap_b32 v56,v58
v_permlane32_swap_b32 v57,v59
v_permlane32_swap_b32 v60,v62
v_permlane32_swap_b32 v61,v63
v_permlane16_swap_b32 v52,v54
v_permlane16_swap_b32 v53,v55
v_permlane16_swap_b32 v56,v58
v_permlane16_swap_b32 v57,v59
v_permlane16_swap_b32 v60,v62
v_permlane16_swap_b32 v61,v63
AW a168,v52
AW a169,v53
AW a170,v54
AW a171,v55
AW a172,v56
AW a173,v57
AW a174,v58
AW a175,v59
AW a176,v60
AW a177,v61
AW a178,v62
AW a179,v63
C v64,v184,v185
C v65,v186,v187
C v66,v196,v197
C v67,v198,v199
C v68,v188,v189
C v69,v190,v191
C v70,v200,v201
C v71,v202,v203
C v72,v192,v193
C v73,v194,v195
C v74,v204,v205
C v75,v206,v207
v_permlane32_swap_b32 v64,v66
v_permlane32_swap_b32 v65,v67
v_permlane32_swap_b32 v68,v70
v_permlane32_swap_b32 v69,v71
v_permlane32_swap_b32 v72,v74
v_permlane32_swap_b32 v73,v75
v_permlane16_swap_b32 v64,v66
v_permlane16_swap_b32 v65,v67
v_permlane16_swap_b32 v68,v70
v_permlane16_swap_b32 v69,v71
v_permlane16_swap_b32 v72,v74
v_permlane16_swap_b32 v73,v75
AW a180,v64
AW a181,v65
AW a182,v66
AW a183,v67
AW a184,v68
AW a185,v69
AW a186,v70
AW a187,v71
AW a188,v72
AW a189,v73
AW a190,v74
AW a191,v75
C v52,v208,v209
C v53,v210,v211
C v54,v220,v221
C v55,v222,v223
C v56,v212,v213
C v57,v214,v215
C v58,v224,v225
C v59,v226,v227
C v60,v216,v217
C v61,v218,v219
C v62,v228,v229
C v63,v230,v231
v_permlane32_swap_b32 v52,v54
v_permlane32_swap_b32 v53,v55
v_permlane32_swap_b32 v56,v58
v_permlane32_swap_b32 v57,v59
v_permlane32_swap_b32 v60,v62
v_permlane32_swap_b32 v61,v63
v_permlane16_swap_b32 v52,v54
v_permlane16_swap_b32 v53,v55
v_permlane16_swap_b32 v56,v58
v_permlane16_swap_b32 v57,v59
v_permlane16_swap_b32 v60,v62
v_permlane16_swap_b32 v61,v63
AW a192,v52
AW a193,v53
AW a194,v54
AW a195,v55
AW a196,v56
AW a197,v57
AW a198,v58
AW a199,v59
AW a200,v60
AW a201,v61
AW a202,v62
AW a203,v63
C v64,v232,v233
C v65,v234,v235
C v66,v244,v245
C v67,v246,v247
C v68,v236,v237
C v69,v238,v239
C v70,v248,v249
C v71,v250,v251
C v72,v240,v241
C v73,v242,v243
C v74,v252,v253
C v75,v254,v255
v_permlane32_swap_b32 v64,v66
v_permlane32_swap_b32 v65,v67
v_permlane32_swap_b32 v68,v70
v_permlane32_swap_b32 v69,v71
v_permlane32_swap_b32 v72,v74
v_permlane32_swap_b32 v73,v75
v_permlane16_swap_b32 v64,v66
v_permlane16_swap_b32 v65,v67
v_permlane16_swap_b32 v68,v70
v_permlane16_swap_b32 v69,v71
v_permlane16_swap_b32 v72,v74
v_permlane16_swap_b32 v73,v75
AW a204,v64
AW a205,v65
AW a206,v66
AW a207,v67
AW a208,v68
AW a209,v69
AW a210,v70
AW a211,v71
AW a212,v72
AW a213,v73
AW a214,v74
AW a215,v75
s_waitcnt lgkmcnt(2)
M v[52:55],a[216:219],a[144:147],0
ds_read_b128 a[236:239],v2 offset:256
s_add_u32 m0,s28,0x12000
M v[56:59],a[216:219],a[148:151],0
M v[60:63],a[216:219],a[152:155],0
s_add_u32 s35,s30,0xc00
M v[60:63],a[220:223],a[164:167],v[60:63]
ds_read_b128 a[216:219],v1 offset:6144
M v[56:59],a[220:223],a[160:163],v[56:59]
M v[52:55],a[220:223],a[156:159],v[52:55]
L v100,s[8:11],s30 offen nt lds
M v[52:55],a[224:227],a[168:171],v[52:55]
ds_read_b128 a[220:223],v2 offset:6144
M v[56:59],a[224:227],a[172:175],v[56:59]
M v[60:63],a[224:227],a[176:179],v[60:63]
s_waitcnt lgkmcnt(2)
M v[60:63],a[228:231],a[188:191],v[60:63]
ds_read_b128 a[224:227],v1 offset:6272
L v101,s[8:11],s30 offen offset:1024 nt lds
M v[56:59],a[228:231],a[184:187],v[56:59]
M v[52:55],a[228:231],a[180:183],v[52:55]
M v[52:55],a[232:235],a[192:195],v[52:55]
ds_read_b128 a[228:231],v2 offset:6272
L v102,s[8:11],s30 offen offset:2048 nt lds
M v[56:59],a[232:235],a[196:199],v[56:59]
M v[60:63],a[232:235],a[200:203],v[60:63]
M v[60:63],a[236:239],a[212:215],v[60:63]
ds_read_b128 a[232:235],v1 offset:6400
s_add_u32 m0,m0,0xc00
M v[56:59],a[236:239],a[208:211],v[56:59]
M v[52:55],a[236:239],a[204:207],v[52:55]
s_waitcnt lgkmcnt(2)
M v[64:67],a[216:219],a[144:147],0
ds_read_b128 a[236:239],v2 offset:6400
M v[68:71],a[216:219],a[148:151],0
s_add_u32 s30,s30,0x3000
M v[72:75],a[216:219],a[152:155],0
M v[72:75],a[220:223],a[164:167],v[72:75]
L v100,s[8:11],s35 offen nt lds
M v[68:71],a[220:223],a[160:163],v[68:71]
M v[64:67],a[220:223],a[156:159],v[64:67]
M v[64:67],a[224:227],a[168:171],v[64:67]
L v101,s[8:11],s35 offen offset:1024 nt lds
M v[68:71],a[224:227],a[172:175],v[68:71]
M v[72:75],a[224:227],a[176:179],v[72:75]
s_waitcnt vmcnt(11) lgkmcnt(0)
s_barrier
M v[72:75],a[228:231],a[188:191],v[72:75]
T a[216:217],v5 offset:24576
T a[218:219],v5 offset:30720
M v[68:71],a[228:231],a[184:187],v[68:71]
T a[220:221],v6 offset:24576
T a[222:223],v6 offset:30720
M v[64:67],a[228:231],a[180:183],v[64:67]
T a[224:225],v7 offset:24576
T a[226:227],v7 offset:30720
M v[64:67],a[232:235],a[192:195],v[64:67]
T a[228:229],v8 offset:24576
T a[230:231],v8 offset:30720
M v[68:71],a[232:235],a[196:199],v[68:71]
L v102,s[8:11],s35 offen offset:2048 nt lds
M v[72:75],a[232:235],a[200:203],v[72:75]
T a[232:233],v5 offset:24704
T a[234:235],v5 offset:30848
M v[72:75],a[236:239],a[212:215],v[72:75]
M v[68:71],a[236:239],a[208:211],v[68:71]
M v[64:67],a[236:239],a[204:207],v[64:67]
s_add_u32 m0,s28,0
s_add_u32 s35,s29,0xc00
v_max3_f32 v19,v52,v53,v54
v_max3_f32 v20,v56,v57,v58
v_max3_f32 v21,v60,v61,v62
s_nop 2
v_max3_f32 v19,v19,v55,v64
v_max3_f32 v20,v20,v59,v68
v_max3_f32 v21,v21,v63,v72
v_max3_f32 v19,v19,v65,v66
v_max3_f32 v20,v20,v69,v70
v_max3_f32 v21,v21,v73,v74
v_max_f32 v19,v19,v67
v_max_f32 v20,v20,v71
v_max_f32 v21,v21,v75
v_mov_b32 v25,v19
L v100,s[4:7],s29 offen nt lds
v_mov_b32 v26,v20
v_mov_b32 v27,v21
v_permlane32_swap_b32 v19,v25
v_permlane32_swap_b32 v20,v26
v_permlane32_swap_b32 v21,v27
v_max_f32 v19,v19,v25
v_max_f32 v20,v20,v26
v_max_f32 v21,v21,v27
v_mov_b32 v25,v19
v_mov_b32 v26,v20
v_mov_b32 v27,v21
v_permlane16_swap_b32 v19,v25
v_permlane16_swap_b32 v20,v26
L v101,s[4:7],s29 offen offset:1024 nt lds
v_permlane16_swap_b32 v21,v27
v_max_f32 v19,v19,v25
v_max_f32 v20,v20,v26
v_max_f32 v21,v21,v27
v_mul_f32 v19,s37,v19
v_mul_f32 v20,s37,v20
v_mul_f32 v21,s37,v21
v_mov_b32 v22,0
v_mov_b32 v23,0
v_mov_b32 v24,0
v_fma_f32 v52,v52,s37,-v19
v_fma_f32 v53,v53,s37,-v19
v_fma_f32 v54,v54,s37,-v19
L v102,s[4:7],s29 offen offset:2048 nt lds
v_fma_f32 v55,v55,s37,-v19
v_fma_f32 v56,v56,s37,-v20
v_fma_f32 v57,v57,s37,-v20
v_fma_f32 v58,v58,s37,-v20
v_fma_f32 v59,v59,s37,-v20
v_fma_f32 v60,v60,s37,-v21
v_fma_f32 v61,v61,s37,-v21
v_fma_f32 v62,v62,s37,-v21
v_fma_f32 v63,v63,s37,-v21
v_fma_f32 v64,v64,s37,-v19
v_fma_f32 v65,v65,s37,-v19
v_fma_f32 v66,v66,s37,-v19
v_fma_f32 v67,v67,s37,-v19
s_add_u32 m0,m0,0xc00
v_fma_f32 v68,v68,s37,-v20
v_fma_f32 v69,v69,s37,-v20
v_fma_f32 v70,v70,s37,-v20
v_fma_f32 v71,v71,s37,-v20
v_fma_f32 v72,v72,s37,-v21
v_fma_f32 v73,v73,s37,-v21
v_fma_f32 v74,v74,s37,-v21
v_fma_f32 v75,v75,s37,-v21
v_exp_f32 v52,v52
v_exp_f32 v56,v56
v_exp_f32 v60,v60
v_exp_f32 v53,v53
v_exp_f32 v57,v57
s_add_u32 s29,s29,0x3000
v_exp_f32 v61,v61
v_add_f32 v22,v22,v52
v_add_f32 v23,v23,v56
v_add_f32 v24,v24,v60
v_exp_f32 v54,v54
v_exp_f32 v58,v58
v_exp_f32 v62,v62
v_add_f32 v22,v22,v53
v_add_f32 v23,v23,v57
v_add_f32 v24,v24,v61
C v40,v52,v53
C v44,v56,v57
C v48,v60,v61
L v100,s[4:7],s35 offen nt lds
v_exp_f32 v55,v55
v_exp_f32 v59,v59
v_exp_f32 v63,v63
v_add_f32 v22,v22,v54
v_add_f32 v23,v23,v58
v_add_f32 v24,v24,v62
v_exp_f32 v64,v64
v_exp_f32 v68,v68
v_exp_f32 v72,v72
v_add_f32 v22,v22,v55
v_add_f32 v23,v23,v59
v_add_f32 v24,v24,v63
C v41,v54,v55
L v101,s[4:7],s35 offen offset:1024 nt lds
C v45,v58,v59
C v49,v62,v63
v_exp_f32 v65,v65
v_exp_f32 v69,v69
v_exp_f32 v73,v73
v_add_f32 v22,v22,v64
v_add_f32 v23,v23,v68
v_add_f32 v24,v24,v72
v_exp_f32 v66,v66
v_exp_f32 v70,v70
v_exp_f32 v74,v74
v_add_f32 v22,v22,v65
v_add_f32 v23,v23,v69
L v102,s[4:7],s35 offen offset:2048 nt lds
v_add_f32 v24,v24,v73
C v42,v64,v65
C v46,v68,v69
C v50,v72,v73
v_exp_f32 v67,v67
v_exp_f32 v71,v71
v_exp_f32 v75,v75
v_add_f32 v22,v22,v66
v_add_f32 v23,v23,v70
v_add_f32 v24,v24,v74
C v43,v66,v67
C v47,v70,v71
C v51,v74,v75
s_waitcnt lgkmcnt(4)
M v[112:115],a[216:219],v[40:43],0
T a[236:237],v6 offset:24704
v_add_f32 v22,v22,v67
M v[116:119],a[216:219],v[44:47],0
T a[238:239],v6 offset:30848
v_add_f32 v23,v23,v71
M v[120:123],a[216:219],v[48:51],0
v_add_f32 v24,v24,v75
M v[132:135],a[220:223],v[48:51],0
T a[216:217],v7 offset:24704
M v[128:131],a[220:223],v[44:47],0
T a[218:219],v7 offset:30848
M v[124:127],a[220:223],v[40:43],0
M v[136:139],a[224:227],v[40:43],0
T a[220:221],v8 offset:24704
M v[140:143],a[224:227],v[44:47],0
T a[222:223],v8 offset:30848
M v[144:147],a[224:227],v[48:51],0
s_waitcnt lgkmcnt(4)
M v[156:159],a[228:231],v[48:51],0
T a[224:225],v5 offset:24832
M v[152:155],a[228:231],v[44:47],0
T a[226:227],v5 offset:30976
M v[148:151],a[228:231],v[40:43],0
M v[160:163],a[232:235],v[40:43],0
T a[228:229],v6 offset:24832
M v[164:167],a[232:235],v[44:47],0
T a[230:231],v6 offset:30976
M v[168:171],a[232:235],v[48:51],0
M v[180:183],a[236:239],v[48:51],0
T a[232:233],v7 offset:24832
M v[176:179],a[236:239],v[44:47],0
T a[234:235],v7 offset:30976
M v[172:175],a[236:239],v[40:43],0
s_waitcnt lgkmcnt(4)
M v[184:187],a[216:219],v[40:43],0
T a[236:237],v8 offset:24832
M v[188:191],a[216:219],v[44:47],0
T a[238:239],v8 offset:30976
M v[192:195],a[216:219],v[48:51],0
M v[204:207],a[220:223],v[48:51],0
M v[200:203],a[220:223],v[44:47],0
M v[196:199],a[220:223],v[40:43],0
M v[208:211],a[224:227],v[40:43],0
M v[212:215],a[224:227],v[44:47],0
M v[216:219],a[224:227],v[48:51],0
s_waitcnt vmcnt(12) lgkmcnt(0)
s_barrier
M v[228:231],a[228:231],v[48:51],0
ds_read_b128 a[216:219],v3
ds_read_b128 a[220:223],v4
M v[224:227],a[228:231],v[44:47],0
ds_read_b128 a[224:227],v3 offset:128
M v[220:223],a[228:231],v[40:43],0
M v[232:235],a[232:235],v[40:43],0
ds_read_b128 a[228:231],v4 offset:128
M v[236:239],a[232:235],v[44:47],0
M v[240:243],a[232:235],v[48:51],0
ds_read_b128 a[232:235],v3 offset:256
M v[252:255],a[236:239],v[48:51],0
M v[248:251],a[236:239],v[44:47],0
M v[244:247],a[236:239],v[40:43],0
s_waitcnt lgkmcnt(2)
M v[52:55],a[216:219],a[144:147],0
ds_read_b128 a[236:239],v4 offset:256
s_add_u32 m0,s28,0x6000
M v[56:59],a[216:219],a[148:151],0
M v[60:63],a[216:219],a[152:155],0
s_add_u32 s35,s30,0xc00
M v[60:63],a[220:223],a[164:167],v[60:63]
ds_read_b128 a[216:219],v3 offset:6144
M v[56:59],a[220:223],a[160:163],v[56:59]
M v[52:55],a[220:223],a[156:159],v[52:55]
L v100,s[8:11],s30 offen nt lds
M v[52:55],a[224:227],a[168:171],v[52:55]
ds_read_b128 a[220:223],v4 offset:6144
M v[56:59],a[224:227],a[172:175],v[56:59]
M v[60:63],a[224:227],a[176:179],v[60:63]
s_waitcnt lgkmcnt(2)
M v[60:63],a[228:231],a[188:191],v[60:63]
ds_read_b128 a[224:227],v3 offset:6272
L v101,s[8:11],s30 offen offset:1024 nt lds
M v[56:59],a[228:231],a[184:187],v[56:59]
M v[52:55],a[228:231],a[180:183],v[52:55]
M v[52:55],a[232:235],a[192:195],v[52:55]
ds_read_b128 a[228:231],v4 offset:6272
L v102,s[8:11],s30 offen offset:2048 nt lds
M v[56:59],a[232:235],a[196:199],v[56:59]
M v[60:63],a[232:235],a[200:203],v[60:63]
M v[60:63],a[236:239],a[212:215],v[60:63]
ds_read_b128 a[232:235],v3 offset:6400
s_add_u32 m0,m0,0xc00
M v[56:59],a[236:239],a[208:211],v[56:59]
M v[52:55],a[236:239],a[204:207],v[52:55]
s_waitcnt lgkmcnt(2)
M v[64:67],a[216:219],a[144:147],0
ds_read_b128 a[236:239],v4 offset:6400
M v[68:71],a[216:219],a[148:151],0
s_add_u32 s30,s30,0x3000
M v[72:75],a[216:219],a[152:155],0
s_nop 1
v_fma_f32 v52,v52,s37,-v19
v_fma_f32 v53,v53,s37,-v19
v_fma_f32 v54,v54,s37,-v19
M v[72:75],a[220:223],a[164:167],v[72:75]
L v100,s[8:11],s35 offen nt lds
v_fma_f32 v55,v55,s37,-v19
v_fma_f32 v56,v56,s37,-v20
M v[68:71],a[220:223],a[160:163],v[68:71]
v_fma_f32 v57,v57,s37,-v20
v_max3_f32 v28,v52,v53,v54
v_fma_f32 v58,v58,s37,-v20
M v[64:67],a[220:223],a[156:159],v[64:67]
v_fma_f32 v59,v59,s37,-v20
v_max3_f32 v28,v28,v55,v56
v_fma_f32 v60,v60,s37,-v21
M v[64:67],a[224:227],a[168:171],v[64:67]
L v101,s[8:11],s35 offen offset:1024 nt lds
v_fma_f32 v61,v61,s37,-v21
v_max3_f32 v28,v28,v57,v58
M v[68:71],a[224:227],a[172:175],v[68:71]
v_fma_f32 v62,v62,s37,-v21
v_fma_f32 v63,v63,s37,-v21
v_max3_f32 v28,v28,v59,v60
M v[72:75],a[224:227],a[176:179],v[72:75]
s_waitcnt vmcnt(11) lgkmcnt(0)
s_barrier
v_max3_f32 v28,v28,v61,v62
M v[72:75],a[228:231],a[188:191],v[72:75]
T a[216:217],v9 offset:24576
T a[218:219],v9 offset:30720
v_max_f32 v28,v28,v63
M v[68:71],a[228:231],a[184:187],v[68:71]
T a[220:221],v10 offset:24576
T a[222:223],v10 offset:30720
M v[64:67],a[228:231],a[180:183],v[64:67]
T a[224:225],v11 offset:24576
T a[226:227],v11 offset:30720
M v[64:67],a[232:235],a[192:195],v[64:67]
T a[228:229],v12 offset:24576
T a[230:231],v12 offset:30720
M v[68:71],a[232:235],a[196:199],v[68:71]
L v102,s[8:11],s35 offen offset:2048 nt lds
M v[72:75],a[232:235],a[200:203],v[72:75]
T a[232:233],v9 offset:24704
T a[234:235],v9 offset:30848
M v[72:75],a[236:239],a[212:215],v[72:75]
M v[68:71],a[236:239],a[208:211],v[68:71]
M v[64:67],a[236:239],a[204:207],v[64:67]
s_add_u32 m0,s28,0xc000
s_add_u32 s35,s29,0xc00
s_nop 5
v_fma_f32 v64,v64,s37,-v19
v_fma_f32 v65,v65,s37,-v19
v_fma_f32 v66,v66,s37,-v19
v_fma_f32 v67,v67,s37,-v19
v_fma_f32 v68,v68,s37,-v20
v_fma_f32 v69,v69,s37,-v20
v_max3_f32 v28,v28,v64,v65
v_fma_f32 v70,v70,s37,-v20
L v100,s[4:7],s29 offen nt lds
v_fma_f32 v71,v71,s37,-v20
v_max3_f32 v28,v28,v66,v67
v_fma_f32 v72,v72,s37,-v21
v_fma_f32 v73,v73,s37,-v21
v_max3_f32 v28,v28,v68,v69
v_fma_f32 v74,v74,s37,-v21
v_fma_f32 v75,v75,s37,-v21
v_max3_f32 v28,v28,v70,v71
L v101,s[4:7],s29 offen offset:1024 nt lds
v_max3_f32 v28,v28,v72,v73
v_max3_f32 v28,v28,v74,v75
v_cmp_lt_f32 vcc,0x41000000,v28
s_cbranch_vccnz C0_17_r
C0_17_b:
v_exp_f32 v52,v52
v_exp_f32 v56,v56
v_exp_f32 v60,v60
v_exp_f32 v53,v53
v_exp_f32 v57,v57
L v102,s[4:7],s29 offen offset:2048 nt lds
v_exp_f32 v61,v61
v_add_f32 v22,v22,v52
v_add_f32 v23,v23,v56
v_add_f32 v24,v24,v60
v_exp_f32 v54,v54
v_exp_f32 v58,v58
v_exp_f32 v62,v62
v_add_f32 v22,v22,v53
s_add_u32 m0,m0,0xc00
v_add_f32 v23,v23,v57
v_add_f32 v24,v24,v61
C v40,v52,v53
C v44,v56,v57
C v48,v60,v61
v_exp_f32 v55,v55
v_exp_f32 v59,v59
v_exp_f32 v63,v63
s_add_u32 s29,s29,0x3000
v_add_f32 v22,v22,v54
v_add_f32 v23,v23,v58
v_add_f32 v24,v24,v62
v_exp_f32 v64,v64
v_exp_f32 v68,v68
v_exp_f32 v72,v72
v_add_f32 v22,v22,v55
v_add_f32 v23,v23,v59
L v100,s[4:7],s35 offen nt lds
v_add_f32 v24,v24,v63
C v41,v54,v55
C v45,v58,v59
C v49,v62,v63
v_exp_f32 v65,v65
v_exp_f32 v69,v69
v_exp_f32 v73,v73
v_add_f32 v22,v22,v64
L v101,s[4:7],s35 offen offset:1024 nt lds
v_add_f32 v23,v23,v68
v_add_f32 v24,v24,v72
v_exp_f32 v66,v66
v_exp_f32 v70,v70
v_exp_f32 v74,v74
v_add_f32 v22,v22,v65
v_add_f32 v23,v23,v69
v_add_f32 v24,v24,v73
L v102,s[4:7],s35 offen offset:2048 nt lds
C v42,v64,v65
C v46,v68,v69
C v50,v72,v73
v_exp_f32 v67,v67
v_exp_f32 v71,v71
v_exp_f32 v75,v75
v_add_f32 v22,v22,v66
v_add_f32 v23,v23,v70
v_add_f32 v24,v24,v74
C v43,v66,v67
C v47,v70,v71
C v51,v74,v75
s_waitcnt lgkmcnt(4)
M v[112:115],a[216:219],v[40:43],v[112:115]
T a[236:237],v10 offset:24704
v_add_f32 v22,v22,v67
M v[116:119],a[216:219],v[44:47],v[116:119]
T a[238:239],v10 offset:30848
v_add_f32 v23,v23,v71
M v[120:123],a[216:219],v[48:51],v[120:123]
v_add_f32 v24,v24,v75
M v[132:135],a[220:223],v[48:51],v[132:135]
T a[216:217],v11 offset:24704
M v[128:131],a[220:223],v[44:47],v[128:131]
T a[218:219],v11 offset:30848
M v[124:127],a[220:223],v[40:43],v[124:127]
M v[136:139],a[224:227],v[40:43],v[136:139]
T a[220:221],v12 offset:24704
M v[140:143],a[224:227],v[44:47],v[140:143]
T a[222:223],v12 offset:30848
M v[144:147],a[224:227],v[48:51],v[144:147]
s_waitcnt lgkmcnt(4)
M v[156:159],a[228:231],v[48:51],v[156:159]
T a[224:225],v9 offset:24832
M v[152:155],a[228:231],v[44:47],v[152:155]
T a[226:227],v9 offset:30976
M v[148:151],a[228:231],v[40:43],v[148:151]
M v[160:163],a[232:235],v[40:43],v[160:163]
T a[228:229],v10 offset:24832
M v[164:167],a[232:235],v[44:47],v[164:167]
T a[230:231],v10 offset:30976
M v[168:171],a[232:235],v[48:51],v[168:171]
M v[180:183],a[236:239],v[48:51],v[180:183]
T a[232:233],v11 offset:24832
M v[176:179],a[236:239],v[44:47],v[176:179]
T a[234:235],v11 offset:30976
M v[172:175],a[236:239],v[40:43],v[172:175]
s_waitcnt lgkmcnt(4)
M v[184:187],a[216:219],v[40:43],v[184:187]
T a[236:237],v12 offset:24832
M v[188:191],a[216:219],v[44:47],v[188:191]
T a[238:239],v12 offset:30976
M v[192:195],a[216:219],v[48:51],v[192:195]
M v[204:207],a[220:223],v[48:51],v[204:207]
M v[200:203],a[220:223],v[44:47],v[200:203]
M v[196:199],a[220:223],v[40:43],v[196:199]
M v[208:211],a[224:227],v[40:43],v[208:211]
M v[212:215],a[224:227],v[44:47],v[212:215]
M v[216:219],a[224:227],v[48:51],v[216:219]
s_waitcnt vmcnt(12) lgkmcnt(0)
s_barrier
M v[228:231],a[228:231],v[48:51],v[228:231]
ds_read_b128 a[216:219],v1
ds_read_b128 a[220:223],v2
M v[224:227],a[228:231],v[44:47],v[224:227]
ds_read_b128 a[224:227],v1 offset:128
M v[220:223],a[228:231],v[40:43],v[220:223]
M v[232:235],a[232:235],v[40:43],v[232:235]
ds_read_b128 a[228:231],v2 offset:128
M v[236:239],a[232:235],v[44:47],v[236:239]
M v[240:243],a[232:235],v[48:51],v[240:243]
ds_read_b128 a[232:235],v1 offset:256
M v[252:255],a[236:239],v[48:51],v[252:255]
M v[248:251],a[236:239],v[44:47],v[248:251]
M v[244:247],a[236:239],v[40:43],v[244:247]
s_waitcnt lgkmcnt(2)
M v[52:55],a[216:219],a[144:147],0
ds_read_b128 a[236:239],v2 offset:256
s_add_u32 m0,s28,0x12000
M v[56:59],a[216:219],a[148:151],0
M v[60:63],a[216:219],a[152:155],0
s_add_u32 s35,s30,0xc00
M v[60:63],a[220:223],a[164:167],v[60:63]
ds_read_b128 a[216:219],v1 offset:6144
M v[56:59],a[220:223],a[160:163],v[56:59]
M v[52:55],a[220:223],a[156:159],v[52:55]
L v100,s[8:11],s30 offen nt lds
M v[52:55],a[224:227],a[168:171],v[52:55]
ds_read_b128 a[220:223],v2 offset:6144
M v[56:59],a[224:227],a[172:175],v[56:59]
M v[60:63],a[224:227],a[176:179],v[60:63]
s_waitcnt lgkmcnt(2)
M v[60:63],a[228:231],a[188:191],v[60:63]
ds_read_b128 a[224:227],v1 offset:6272
L v101,s[8:11],s30 offen offset:1024 nt lds
M v[56:59],a[228:231],a[184:187],v[56:59]
M v[52:55],a[228:231],a[180:183],v[52:55]
M v[52:55],a[232:235],a[192:195],v[52:55]
ds_read_b128 a[228:231],v2 offset:6272
L v102,s[8:11],s30 offen offset:2048 nt lds
M v[56:59],a[232:235],a[196:199],v[56:59]
M v[60:63],a[232:235],a[200:203],v[60:63]
M v[60:63],a[236:239],a[212:215],v[60:63]
ds_read_b128 a[232:235],v1 offset:6400
s_add_u32 m0,m0,0xc00
M v[56:59],a[236:239],a[208:211],v[56:59]
M v[52:55],a[236:239],a[204:207],v[52:55]
s_waitcnt lgkmcnt(2)
M v[64:67],a[216:219],a[144:147],0
ds_read_b128 a[236:239],v2 offset:6400
M v[68:71],a[216:219],a[148:151],0
s_add_u32 s30,s30,0x3000
M v[72:75],a[216:219],a[152:155],0
s_nop 1
v_fma_f32 v52,v52,s37,-v19
v_fma_f32 v53,v53,s37,-v19
v_fma_f32 v54,v54,s37,-v19
M v[72:75],a[220:223],a[164:167],v[72:75]
L v100,s[8:11],s35 offen nt lds
v_fma_f32 v55,v55,s37,-v19
v_fma_f32 v56,v56,s37,-v20
M v[68:71],a[220:223],a[160:163],v[68:71]
v_fma_f32 v57,v57,s37,-v20
v_max3_f32 v28,v52,v53,v54
v_fma_f32 v58,v58,s37,-v20
M v[64:67],a[220:223],a[156:159],v[64:67]
v_fma_f32 v59,v59,s37,-v20
v_max3_f32 v28,v28,v55,v56
v_fma_f32 v60,v60,s37,-v21
M v[64:67],a[224:227],a[168:171],v[64:67]
L v101,s[8:11],s35 offen offset:1024 nt lds
v_fma_f32 v61,v61,s37,-v21
v_max3_f32 v28,v28,v57,v58
M v[68:71],a[224:227],a[172:175],v[68:71]
v_fma_f32 v62,v62,s37,-v21
v_fma_f32 v63,v63,s37,-v21
v_max3_f32 v28,v28,v59,v60
M v[72:75],a[224:227],a[176:179],v[72:75]
s_waitcnt vmcnt(11) lgkmcnt(0)
s_barrier
v_max3_f32 v28,v28,v61,v62
M v[72:75],a[228:231],a[188:191],v[72:75]
T a[216:217],v5 offset:24576
T a[218:219],v5 offset:30720
v_max_f32 v28,v28,v63
M v[68:71],a[228:231],a[184:187],v[68:71]
T a[220:221],v6 offset:24576
T a[222:223],v6 offset:30720
M v[64:67],a[228:231],a[180:183],v[64:67]
T a[224:225],v7 offset:24576
T a[226:227],v7 offset:30720
M v[64:67],a[232:235],a[192:195],v[64:67]
T a[228:229],v8 offset:24576
T a[230:231],v8 offset:30720
M v[68:71],a[232:235],a[196:199],v[68:71]
L v102,s[8:11],s35 offen offset:2048 nt lds
M v[72:75],a[232:235],a[200:203],v[72:75]
T a[232:233],v5 offset:24704
T a[234:235],v5 offset:30848
M v[72:75],a[236:239],a[212:215],v[72:75]
M v[68:71],a[236:239],a[208:211],v[68:71]
M v[64:67],a[236:239],a[204:207],v[64:67]
s_add_u32 m0,s28,0
s_add_u32 s35,s29,0xc00
s_nop 5
v_fma_f32 v64,v64,s37,-v19
v_fma_f32 v65,v65,s37,-v19
v_fma_f32 v66,v66,s37,-v19
v_fma_f32 v67,v67,s37,-v19
v_fma_f32 v68,v68,s37,-v20
L v100,s[4:7],s29 offen nt lds
v_fma_f32 v69,v69,s37,-v20
v_max3_f32 v28,v28,v64,v65
v_fma_f32 v70,v70,s37,-v20
v_fma_f32 v71,v71,s37,-v20
v_max3_f32 v28,v28,v66,v67
L v101,s[4:7],s29 offen offset:1024 nt lds
v_fma_f32 v72,v72,s37,-v21
v_fma_f32 v73,v73,s37,-v21
v_max3_f32 v28,v28,v68,v69
v_fma_f32 v74,v74,s37,-v21
v_fma_f32 v75,v75,s37,-v21
L v102,s[4:7],s29 offen offset:2048 nt lds
v_max3_f32 v28,v28,v70,v71
v_max3_f32 v28,v28,v72,v73
v_max3_f32 v28,v28,v74,v75
v_cmp_lt_f32 vcc,0x41000000,v28
s_cbranch_vccnz C0_19_r
C0_19_b:
v_exp_f32 v52,v52
s_add_u32 m0,m0,0xc00
v_exp_f32 v56,v56
v_exp_f32 v60,v60
v_exp_f32 v53,v53
v_exp_f32 v57,v57
v_exp_f32 v61,v61
s_add_u32 s29,s29,0x3000
v_add_f32 v22,v22,v52
v_add_f32 v23,v23,v56
v_add_f32 v24,v24,v60
v_exp_f32 v54,v54
v_exp_f32 v58,v58
L v100,s[4:7],s35 offen nt lds
v_exp_f32 v62,v62
v_add_f32 v22,v22,v53
v_add_f32 v23,v23,v57
v_add_f32 v24,v24,v61
C v40,v52,v53
L v101,s[4:7],s35 offen offset:1024 nt lds
C v44,v56,v57
C v48,v60,v61
v_exp_f32 v55,v55
v_exp_f32 v59,v59
v_exp_f32 v63,v63
L v102,s[4:7],s35 offen offset:2048 nt lds
v_add_f32 v22,v22,v54
v_add_f32 v23,v23,v58
v_add_f32 v24,v24,v62
v_exp_f32 v64,v64
v_exp_f32 v68,v68
s_add_u32 m0,s34,0
v_exp_f32 v72,v72
v_add_f32 v22,v22,v55
v_add_f32 v23,v23,v59
v_add_f32 v24,v24,v63
C v41,v54,v55
L v106,s[20:23],s33 offen lds
C v45,v58,v59
C v49,v62,v63
v_exp_f32 v65,v65
v_exp_f32 v69,v69
v_exp_f32 v73,v73
L v107,s[20:23],s33 offen offset:1024 lds
v_add_f32 v22,v22,v64
v_add_f32 v23,v23,v68
v_add_f32 v24,v24,v72
v_exp_f32 v66,v66
v_exp_f32 v70,v70
L v108,s[20:23],s33 offen offset:2048 lds
v_exp_f32 v74,v74
v_add_f32 v22,v22,v65
v_add_f32 v23,v23,v69
v_add_f32 v24,v24,v73
C v42,v64,v65
s_add_u32 s33,s33,0x80
C v46,v68,v69
C v50,v72,v73
v_exp_f32 v67,v67
v_exp_f32 v71,v71
v_exp_f32 v75,v75
s_cmp_eq_u32 s33,s41
s_cselect_b32 s33,s40,s33
v_add_f32 v22,v22,v66
v_add_f32 v23,v23,v70
v_add_f32 v24,v24,v74
C v43,v66,v67
C v47,v70,v71
C v51,v74,v75
s_waitcnt lgkmcnt(4)
M v[112:115],a[216:219],v[40:43],v[112:115]
T a[236:237],v6 offset:24704
v_add_f32 v22,v22,v67
M v[116:119],a[216:219],v[44:47],v[116:119]
T a[238:239],v6 offset:30848
v_add_f32 v23,v23,v71
M v[120:123],a[216:219],v[48:51],v[120:123]
v_add_f32 v24,v24,v75
M v[132:135],a[220:223],v[48:51],v[132:135]
T a[216:217],v7 offset:24704
M v[128:131],a[220:223],v[44:47],v[128:131]
T a[218:219],v7 offset:30848
M v[124:127],a[220:223],v[40:43],v[124:127]
M v[136:139],a[224:227],v[40:43],v[136:139]
T a[220:221],v8 offset:24704
M v[140:143],a[224:227],v[44:47],v[140:143]
T a[222:223],v8 offset:30848
M v[144:147],a[224:227],v[48:51],v[144:147]
s_waitcnt lgkmcnt(4)
M v[156:159],a[228:231],v[48:51],v[156:159]
T a[224:225],v5 offset:24832
M v[152:155],a[228:231],v[44:47],v[152:155]
T a[226:227],v5 offset:30976
M v[148:151],a[228:231],v[40:43],v[148:151]
M v[160:163],a[232:235],v[40:43],v[160:163]
T a[228:229],v6 offset:24832
M v[164:167],a[232:235],v[44:47],v[164:167]
T a[230:231],v6 offset:30976
M v[168:171],a[232:235],v[48:51],v[168:171]
M v[180:183],a[236:239],v[48:51],v[180:183]
T a[232:233],v7 offset:24832
M v[176:179],a[236:239],v[44:47],v[176:179]
T a[234:235],v7 offset:30976
M v[172:175],a[236:239],v[40:43],v[172:175]
s_waitcnt lgkmcnt(4)
M v[184:187],a[216:219],v[40:43],v[184:187]
T a[236:237],v8 offset:24832
M v[188:191],a[216:219],v[44:47],v[188:191]
T a[238:239],v8 offset:30976
M v[192:195],a[216:219],v[48:51],v[192:195]
M v[204:207],a[220:223],v[48:51],v[204:207]
M v[200:203],a[220:223],v[44:47],v[200:203]
M v[196:199],a[220:223],v[40:43],v[196:199]
M v[208:211],a[224:227],v[40:43],v[208:211]
M v[212:215],a[224:227],v[44:47],v[212:215]
M v[216:219],a[224:227],v[48:51],v[216:219]
s_waitcnt vmcnt(15) lgkmcnt(0)
s_barrier
M v[228:231],a[228:231],v[48:51],v[228:231]
ds_read_b128 a[216:219],v3
ds_read_b128 a[220:223],v4
M v[224:227],a[228:231],v[44:47],v[224:227]
ds_read_b128 a[224:227],v3 offset:128
M v[220:223],a[228:231],v[40:43],v[220:223]
M v[232:235],a[232:235],v[40:43],v[232:235]
ds_read_b128 a[228:231],v4 offset:128
M v[236:239],a[232:235],v[44:47],v[236:239]
M v[240:243],a[232:235],v[48:51],v[240:243]
ds_read_b128 a[232:235],v3 offset:256
M v[252:255],a[236:239],v[48:51],v[252:255]
M v[248:251],a[236:239],v[44:47],v[248:251]
M v[244:247],a[236:239],v[40:43],v[244:247]
s_waitcnt lgkmcnt(2)
M v[52:55],a[216:219],a[144:147],0
ds_read_b128 a[236:239],v4 offset:256
s_add_u32 m0,s28,0x6000
M v[56:59],a[216:219],a[148:151],0
s_add_u32 s35,s31,0x30000
M v[60:63],a[216:219],a[152:155],0
M v[60:63],a[220:223],a[164:167],v[60:63]
ds_read_b128 a[216:219],v3 offset:6144
L v103,s[12:15],s31 offen lds
M v[56:59],a[220:223],a[160:163],v[56:59]
M v[52:55],a[220:223],a[156:159],v[52:55]
L v104,s[12:15],s31 offen offset:1024 lds
M v[52:55],a[224:227],a[168:171],v[52:55]
ds_read_b128 a[220:223],v4 offset:6144
M v[56:59],a[224:227],a[172:175],v[56:59]
L v105,s[12:15],s31 offen offset:2048 lds
M v[60:63],a[224:227],a[176:179],v[60:63]
s_add_u32 m0,m0,0xc00
s_waitcnt lgkmcnt(2)
M v[60:63],a[228:231],a[188:191],v[60:63]
ds_read_b128 a[224:227],v3 offset:6272
M v[56:59],a[228:231],a[184:187],v[56:59]
s_add_u32 s31,s31,0x60000
M v[52:55],a[228:231],a[180:183],v[52:55]
M v[52:55],a[232:235],a[192:195],v[52:55]
ds_read_b128 a[228:231],v4 offset:6272
L v103,s[12:15],s35 offen lds
M v[56:59],a[232:235],a[196:199],v[56:59]
M v[60:63],a[232:235],a[200:203],v[60:63]
L v104,s[12:15],s35 offen offset:1024 lds
M v[60:63],a[236:239],a[212:215],v[60:63]
ds_read_b128 a[232:235],v3 offset:6400
L v105,s[12:15],s35 offen offset:2048 lds
M v[56:59],a[236:239],a[208:211],v[56:59]
M v[52:55],a[236:239],a[204:207],v[52:55]
s_add_u32 m0,s34,0x3000
s_waitcnt lgkmcnt(2)
M v[64:67],a[216:219],a[144:147],0
ds_read_b128 a[236:239],v4 offset:6400
M v[68:71],a[216:219],a[148:151],0
s_xor_b32 s34,s34,0x38000
M v[72:75],a[216:219],a[152:155],0
s_nop 0
v_fma_f32 v52,v52,s37,-v19
v_fma_f32 v53,v53,s37,-v19
v_fma_f32 v54,v54,s37,-v19
M v[72:75],a[220:223],a[164:167],v[72:75]
L v106,s[20:23],s33 offen lds
v_fma_f32 v55,v55,s37,-v19
v_fma_f32 v56,v56,s37,-v20
M v[68:71],a[220:223],a[160:163],v[68:71]
L v107,s[20:23],s33 offen offset:1024 lds
v_fma_f32 v57,v57,s37,-v20
v_max3_f32 v28,v52,v53,v54
M v[64:67],a[220:223],a[156:159],v[64:67]
L v108,s[20:23],s33 offen offset:2048 lds
v_fma_f32 v58,v58,s37,-v20
v_fma_f32 v59,v59,s37,-v20
M v[64:67],a[224:227],a[168:171],v[64:67]
v_max3_f32 v28,v28,v55,v56
v_fma_f32 v60,v60,s37,-v21
v_fma_f32 v61,v61,s37,-v21
M v[68:71],a[224:227],a[172:175],v[68:71]
s_add_u32 s33,s33,0x80
v_max3_f32 v28,v28,v57,v58
v_fma_f32 v62,v62,s37,-v21
M v[72:75],a[224:227],a[176:179],v[72:75]
s_waitcnt vmcnt(18) lgkmcnt(0)
s_barrier
v_fma_f32 v63,v63,s37,-v21
M v[72:75],a[228:231],a[188:191],v[72:75]
T a[216:217],v9 offset:24576
T a[218:219],v9 offset:30720
v_max3_f32 v28,v28,v59,v60
M v[68:71],a[228:231],a[184:187],v[68:71]
T a[220:221],v10 offset:24576
T a[222:223],v10 offset:30720
v_max3_f32 v28,v28,v61,v62
M v[64:67],a[228:231],a[180:183],v[64:67]
T a[224:225],v11 offset:24576
T a[226:227],v11 offset:30720
v_max_f32 v28,v28,v63
M v[64:67],a[232:235],a[192:195],v[64:67]
T a[228:229],v12 offset:24576
T a[230:231],v12 offset:30720
M v[68:71],a[232:235],a[196:199],v[68:71]
M v[72:75],a[232:235],a[200:203],v[72:75]
T a[232:233],v9 offset:24704
T a[234:235],v9 offset:30848
M v[72:75],a[236:239],a[212:215],v[72:75]
M v[68:71],a[236:239],a[208:211],v[68:71]
s_cmp_eq_u32 s33,s41
s_cselect_b32 s33,s40,s33
M v[64:67],a[236:239],a[204:207],v[64:67]
s_add_u32 m0,s28,0xc000
s_add_u32 s35,s30,0xc00
s_nop 5
v_fma_f32 v64,v64,s37,-v19
v_fma_f32 v65,v65,s37,-v19
v_fma_f32 v66,v66,s37,-v19
v_fma_f32 v67,v67,s37,-v19
v_fma_f32 v68,v68,s37,-v20
v_fma_f32 v69,v69,s37,-v20
v_max3_f32 v28,v28,v64,v65
v_fma_f32 v70,v70,s37,-v20
L v100,s[8:11],s30 offen nt lds
v_fma_f32 v71,v71,s37,-v20
v_max3_f32 v28,v28,v66,v67
v_fma_f32 v72,v72,s37,-v21
v_fma_f32 v73,v73,s37,-v21
v_max3_f32 v28,v28,v68,v69
v_fma_f32 v74,v74,s37,-v21
v_fma_f32 v75,v75,s37,-v21
v_max3_f32 v28,v28,v70,v71
L v101,s[8:11],s30 offen offset:1024 nt lds
v_max3_f32 v28,v28,v72,v73
v_max3_f32 v28,v28,v74,v75
v_cmp_lt_f32 vcc,0x41000000,v28
s_cbranch_vccnz C0_21_r
C0_21_b:
v_exp_f32 v52,v52
v_exp_f32 v56,v56
v_exp_f32 v60,v60
v_exp_f32 v53,v53
v_exp_f32 v57,v57
L v102,s[8:11],s30 offen offset:2048 nt lds
v_exp_f32 v61,v61
v_add_f32 v22,v22,v52
v_add_f32 v23,v23,v56
v_add_f32 v24,v24,v60
v_exp_f32 v54,v54
v_exp_f32 v58,v58
v_exp_f32 v62,v62
v_add_f32 v22,v22,v53
s_add_u32 m0,m0,0xc00
v_add_f32 v23,v23,v57
v_add_f32 v24,v24,v61
C v40,v52,v53
C v44,v56,v57
C v48,v60,v61
v_exp_f32 v55,v55
v_exp_f32 v59,v59
v_exp_f32 v63,v63
s_add_u32 s30,s30,0x3000
v_add_f32 v22,v22,v54
v_add_f32 v23,v23,v58
v_add_f32 v24,v24,v62
v_exp_f32 v64,v64
v_exp_f32 v68,v68
v_exp_f32 v72,v72
v_add_f32 v22,v22,v55
v_add_f32 v23,v23,v59
L v100,s[8:11],s35 offen nt lds
v_add_f32 v24,v24,v63
C v41,v54,v55
C v45,v58,v59
C v49,v62,v63
v_exp_f32 v65,v65
v_exp_f32 v69,v69
v_exp_f32 v73,v73
v_add_f32 v22,v22,v64
L v101,s[8:11],s35 offen offset:1024 nt lds
v_add_f32 v23,v23,v68
v_add_f32 v24,v24,v72
v_exp_f32 v66,v66
v_exp_f32 v70,v70
v_exp_f32 v74,v74
v_add_f32 v22,v22,v65
v_add_f32 v23,v23,v69
v_add_f32 v24,v24,v73
L v102,s[8:11],s35 offen offset:2048 nt lds
C v42,v64,v65
C v46,v68,v69
C v50,v72,v73
v_exp_f32 v67,v67
v_exp_f32 v71,v71
v_exp_f32 v75,v75
v_add_f32 v22,v22,v66
v_add_f32 v23,v23,v70
v_add_f32 v24,v24,v74
C v43,v66,v67
C v47,v70,v71
C v51,v74,v75
s_waitcnt lgkmcnt(4)
M v[112:115],a[216:219],v[40:43],v[112:115]
T a[236:237],v10 offset:24704
v_add_f32 v22,v22,v67
M v[116:119],a[216:219],v[44:47],v[116:119]
T a[238:239],v10 offset:30848
v_add_f32 v23,v23,v71
M v[120:123],a[216:219],v[48:51],v[120:123]
v_add_f32 v24,v24,v75
M v[132:135],a[220:223],v[48:51],v[132:135]
T a[216:217],v11 offset:24704
M v[128:131],a[220:223],v[44:47],v[128:131]
T a[218:219],v11 offset:30848
M v[124:127],a[220:223],v[40:43],v[124:127]
M v[136:139],a[224:227],v[40:43],v[136:139]
T a[220:221],v12 offset:24704
M v[140:143],a[224:227],v[44:47],v[140:143]
T a[222:223],v12 offset:30848
M v[144:147],a[224:227],v[48:51],v[144:147]
s_waitcnt lgkmcnt(4)
M v[156:159],a[228:231],v[48:51],v[156:159]
T a[224:225],v9 offset:24832
M v[152:155],a[228:231],v[44:47],v[152:155]
T a[226:227],v9 offset:30976
M v[148:151],a[228:231],v[40:43],v[148:151]
M v[160:163],a[232:235],v[40:43],v[160:163]
T a[228:229],v10 offset:24832
M v[164:167],a[232:235],v[44:47],v[164:167]
T a[230:231],v10 offset:30976
M v[168:171],a[232:235],v[48:51],v[168:171]
M v[180:183],a[236:239],v[48:51],v[180:183]
T a[232:233],v11 offset:24832
M v[176:179],a[236:239],v[44:47],v[176:179]
T a[234:235],v11 offset:30976
M v[172:175],a[236:239],v[40:43],v[172:175]
s_waitcnt lgkmcnt(4)
M v[184:187],a[216:219],v[40:43],v[184:187]
T a[236:237],v12 offset:24832
M v[188:191],a[216:219],v[44:47],v[188:191]
T a[238:239],v12 offset:30976
M v[192:195],a[216:219],v[48:51],v[192:195]
M v[204:207],a[220:223],v[48:51],v[204:207]
M v[200:203],a[220:223],v[44:47],v[200:203]
M v[196:199],a[220:223],v[40:43],v[196:199]
M v[208:211],a[224:227],v[40:43],v[208:211]
M v[212:215],a[224:227],v[44:47],v[212:215]
M v[216:219],a[224:227],v[48:51],v[216:219]
s_waitcnt vmcnt(18) lgkmcnt(0)
s_barrier
M v[228:231],a[228:231],v[48:51],v[228:231]
ds_read_b128 a[216:219],v1
ds_read_b128 a[220:223],v2
M v[224:227],a[228:231],v[44:47],v[224:227]
ds_read_b128 a[224:227],v1 offset:128
M v[220:223],a[228:231],v[40:43],v[220:223]
M v[232:235],a[232:235],v[40:43],v[232:235]
ds_read_b128 a[228:231],v2 offset:128
M v[236:239],a[232:235],v[44:47],v[236:239]
M v[240:243],a[232:235],v[48:51],v[240:243]
ds_read_b128 a[232:235],v1 offset:256
M v[252:255],a[236:239],v[48:51],v[252:255]
M v[248:251],a[236:239],v[44:47],v[248:251]
M v[244:247],a[236:239],v[40:43],v[244:247]
s_waitcnt lgkmcnt(2)
M v[52:55],a[216:219],a[144:147],0
ds_read_b128 a[236:239],v2 offset:256
s_add_u32 m0,s28,0x12000
M v[56:59],a[216:219],a[148:151],0
M v[60:63],a[216:219],a[152:155],0
s_add_u32 s35,s29,0xc00
M v[60:63],a[220:223],a[164:167],v[60:63]
ds_read_b128 a[216:219],v1 offset:6144
M v[56:59],a[220:223],a[160:163],v[56:59]
M v[52:55],a[220:223],a[156:159],v[52:55]
L v100,s[4:7],s29 offen nt lds
M v[52:55],a[224:227],a[168:171],v[52:55]
ds_read_b128 a[220:223],v2 offset:6144
M v[56:59],a[224:227],a[172:175],v[56:59]
M v[60:63],a[224:227],a[176:179],v[60:63]
L v101,s[4:7],s29 offen offset:1024 nt lds
s_waitcnt lgkmcnt(2)
M v[60:63],a[228:231],a[188:191],v[60:63]
ds_read_b128 a[224:227],v1 offset:6272
M v[56:59],a[228:231],a[184:187],v[56:59]
M v[52:55],a[228:231],a[180:183],v[52:55]
L v102,s[4:7],s29 offen offset:2048 nt lds
M v[52:55],a[232:235],a[192:195],v[52:55]
ds_read_b128 a[228:231],v2 offset:6272
M v[56:59],a[232:235],a[196:199],v[56:59]
M v[60:63],a[232:235],a[200:203],v[60:63]
s_add_u32 m0,m0,0xc00
M v[60:63],a[236:239],a[212:215],v[60:63]
ds_read_b128 a[232:235],v1 offset:6400
M v[56:59],a[236:239],a[208:211],v[56:59]
s_add_u32 s29,s29,0x3000
M v[52:55],a[236:239],a[204:207],v[52:55]
s_waitcnt lgkmcnt(2)
M v[64:67],a[216:219],a[144:147],0
ds_read_b128 a[236:239],v2 offset:6400
M v[68:71],a[216:219],a[148:151],0
M v[72:75],a[216:219],a[152:155],0
L v100,s[4:7],s35 offen nt lds
s_nop 1
v_fma_f32 v52,v52,s37,-v19
v_fma_f32 v53,v53,s37,-v19
M v[72:75],a[220:223],a[164:167],v[72:75]
v_fma_f32 v54,v54,s37,-v19
v_fma_f32 v55,v55,s37,-v19
v_fma_f32 v56,v56,s37,-v20
M v[68:71],a[220:223],a[160:163],v[68:71]
L v101,s[4:7],s35 offen offset:1024 nt lds
v_fma_f32 v57,v57,s37,-v20
v_max3_f32 v28,v52,v53,v54
M v[64:67],a[220:223],a[156:159],v[64:67]
v_fma_f32 v58,v58,s37,-v20
v_fma_f32 v59,v59,s37,-v20
v_max3_f32 v28,v28,v55,v56
M v[64:67],a[224:227],a[168:171],v[64:67]
v_xor_b32 v17,0x38000,v17
v_fma_f32 v60,v60,s37,-v21
v_fma_f32 v61,v61,s37,-v21
M v[68:71],a[224:227],a[172:175],v[68:71]
v_xor_b32 v18,0x38000,v18
L v102,s[4:7],s35 offen offset:2048 nt lds
v_max3_f32 v28,v28,v57,v58
M v[72:75],a[224:227],a[176:179],v[72:75]
s_waitcnt vmcnt(15) lgkmcnt(0)
s_barrier
v_fma_f32 v62,v62,s37,-v21
M v[72:75],a[228:231],a[188:191],v[72:75]
T a[216:217],v5 offset:24576
T a[218:219],v5 offset:30720
v_fma_f32 v63,v63,s37,-v21
M v[68:71],a[228:231],a[184:187],v[68:71]
ds_read_b128 v[76:79],v17
T a[220:221],v6 offset:24576
v_max3_f32 v28,v28,v59,v60
M v[64:67],a[228:231],a[180:183],v[64:67]
T a[222:223],v6 offset:30720
ds_read_b128 v[80:83],v17 offset:2048
v_max3_f32 v28,v28,v61,v62
M v[64:67],a[232:235],a[192:195],v[64:67]
ds_read_b128 v[84:87],v17 offset:4096
T a[224:225],v7 offset:24576
v_max_f32 v28,v28,v63
M v[68:71],a[232:235],a[196:199],v[68:71]
T a[226:227],v7 offset:30720
T a[228:229],v8 offset:24576
M v[72:75],a[232:235],a[200:203],v[72:75]
T a[230:231],v8 offset:30720
T a[232:233],v5 offset:24704
M v[72:75],a[236:239],a[212:215],v[72:75]
T a[234:235],v5 offset:30848
M v[68:71],a[236:239],a[208:211],v[68:71]
M v[64:67],a[236:239],a[204:207],v[64:67]
s_waitcnt lgkmcnt(4)
M a[0:3],a[216:219],v[76:79],0
T a[236:237],v6 offset:24704
s_add_u32 m0,s28,0
M a[4:7],a[216:219],v[80:83],0
T a[238:239],v6 offset:30848
M a[8:11],a[216:219],v[84:87],0
s_add_u32 s35,s31,0x30000
M a[20:23],a[220:223],v[84:87],0
T a[216:217],v7 offset:24704
v_fma_f32 v64,v64,s37,-v19
v_fma_f32 v65,v65,s37,-v19
v_fma_f32 v66,v66,s37,-v19
v_fma_f32 v67,v67,s37,-v19
M a[16:19],a[220:223],v[80:83],0
T a[218:219],v7 offset:30848
v_fma_f32 v68,v68,s37,-v20
v_fma_f32 v69,v69,s37,-v20
v_max3_f32 v28,v28,v64,v65
v_fma_f32 v70,v70,s37,-v20
M a[12:15],a[220:223],v[76:79],0
L v103,s[12:15],s31 offen lds
v_fma_f32 v71,v71,s37,-v20
v_max3_f32 v28,v28,v66,v67
v_fma_f32 v72,v72,s37,-v21
v_fma_f32 v73,v73,s37,-v21
M a[24:27],a[224:227],v[76:79],0
T a[220:221],v8 offset:24704
v_max3_f32 v28,v28,v68,v69
v_fma_f32 v74,v74,s37,-v21
v_fma_f32 v75,v75,s37,-v21
v_max3_f32 v28,v28,v70,v71
M a[28:31],a[224:227],v[80:83],0
T a[222:223],v8 offset:30848
v_max3_f32 v28,v28,v72,v73
v_max3_f32 v28,v28,v74,v75
M a[32:35],a[224:227],v[84:87],0
L v104,s[12:15],s31 offen offset:1024 lds
s_waitcnt lgkmcnt(4)
M a[44:47],a[228:231],v[84:87],0
T a[224:225],v5 offset:24832
v_cmp_lt_f32 vcc,0x41000000,v28
s_cbranch_vccnz C0_23_r
C0_23_b:
M a[40:43],a[228:231],v[80:83],0
T a[226:227],v5 offset:30976
v_exp_f32 v52,v52
v_exp_f32 v56,v56
M a[36:39],a[228:231],v[76:79],0
L v105,s[12:15],s31 offen offset:2048 lds
v_exp_f32 v60,v60
v_exp_f32 v53,v53
M a[48:51],a[232:235],v[76:79],0
T a[228:229],v6 offset:24832
v_exp_f32 v57,v57
v_exp_f32 v61,v61
M a[52:55],a[232:235],v[80:83],0
T a[230:231],v6 offset:30976
v_add_f32 v22,v22,v52
v_add_f32 v23,v23,v56
v_add_f32 v24,v24,v60
M a[56:59],a[232:235],v[84:87],0
s_add_u32 m0,m0,0xc00
v_exp_f32 v54,v54
v_exp_f32 v58,v58
M a[68:71],a[236:239],v[84:87],0
T a[232:233],v7 offset:24832
v_exp_f32 v62,v62
v_add_f32 v22,v22,v53
v_add_f32 v23,v23,v57
M a[64:67],a[236:239],v[80:83],0
T a[234:235],v7 offset:30976
v_add_f32 v24,v24,v61
C v40,v52,v53
C v44,v56,v57
C v48,v60,v61
M a[60:63],a[236:239],v[76:79],0
s_add_u32 s31,s31,0x60000
v_exp_f32 v55,v55
s_waitcnt lgkmcnt(4)
M a[72:75],a[216:219],v[76:79],0
T a[236:237],v8 offset:24832
v_exp_f32 v59,v59
v_exp_f32 v63,v63
M a[76:79],a[216:219],v[80:83],0
T a[238:239],v8 offset:30976
v_add_f32 v22,v22,v54
v_add_f32 v23,v23,v58
v_add_f32 v24,v24,v62
M a[80:83],a[216:219],v[84:87],0
L v103,s[12:15],s35 offen lds
v_exp_f32 v64,v64
v_exp_f32 v68,v68
M a[92:95],a[220:223],v[84:87],0
v_exp_f32 v72,v72
v_add_f32 v22,v22,v55
v_add_f32 v23,v23,v59
v_add_f32 v24,v24,v63
M a[88:91],a[220:223],v[80:83],0
L v104,s[12:15],s35 offen offset:1024 lds
C v41,v54,v55
C v45,v58,v59
C v49,v62,v63
M a[84:87],a[220:223],v[76:79],0
v_exp_f32 v65,v65
v_exp_f32 v69,v69
M a[96:99],a[224:227],v[76:79],0
L v105,s[12:15],s35 offen offset:2048 lds
v_exp_f32 v73,v73
v_add_f32 v22,v22,v64
v_add_f32 v23,v23,v68
M a[100:103],a[224:227],v[80:83],0
v_add_f32 v24,v24,v72
v_exp_f32 v66,v66
v_exp_f32 v70,v70
M a[104:107],a[224:227],v[84:87],0
s_waitcnt vmcnt(12) lgkmcnt(0)
s_barrier
v_exp_f32 v74,v74
v_add_f32 v22,v22,v65
M a[116:119],a[228:231],v[84:87],0
T a[216:217],v9
T a[218:219],v9 offset:6144
v_add_f32 v23,v23,v69
v_add_f32 v24,v24,v73
C v42,v64,v65
M a[112:115],a[228:231],v[80:83],0
T a[220:221],v10
T a[222:223],v10 offset:6144
C v46,v68,v69
C v50,v72,v73
M a[108:111],a[228:231],v[76:79],0
T a[224:225],v11
T a[226:227],v11 offset:6144
v_exp_f32 v67,v67
M a[120:123],a[232:235],v[76:79],0
T a[228:229],v12
T a[230:231],v12 offset:6144
v_exp_f32 v71,v71
M a[124:127],a[232:235],v[80:83],0
v_exp_f32 v75,v75
v_add_f32 v22,v22,v66
v_add_f32 v23,v23,v70
v_add_f32 v24,v24,v74
M a[128:131],a[232:235],v[84:87],0
T a[232:233],v9 offset:128
T a[234:235],v9 offset:6272
C v43,v66,v67
C v47,v70,v71
C v51,v74,v75
M a[140:143],a[236:239],v[84:87],0
s_cmp_eq_u32 s31,s39
s_cselect_b32 s31,s38,s31
v_add_f32 v22,v22,v67
v_add_f32 v23,v23,v71
v_add_f32 v24,v24,v75
M a[136:139],a[236:239],v[80:83],0
M a[132:135],a[236:239],v[76:79],0
s_waitcnt lgkmcnt(4)
M v[112:115],a[216:219],v[40:43],v[112:115]
T a[236:237],v10 offset:128
s_add_u32 m0,s28,0x6000
M v[116:119],a[216:219],v[44:47],v[116:119]
T a[238:239],v10 offset:6272
M v[120:123],a[216:219],v[48:51],v[120:123]
M v[132:135],a[220:223],v[48:51],v[132:135]
T a[216:217],v11 offset:128
s_add_u32 s35,s30,0xc00
M v[128:131],a[220:223],v[44:47],v[128:131]
T a[218:219],v11 offset:6272
M v[124:127],a[220:223],v[40:43],v[124:127]
M v[136:139],a[224:227],v[40:43],v[136:139]
T a[220:221],v12 offset:128
M v[140:143],a[224:227],v[44:47],v[140:143]
T a[222:223],v12 offset:6272
L v100,s[8:11],s30 offen nt lds
M v[144:147],a[224:227],v[48:51],v[144:147]
s_waitcnt lgkmcnt(4)
M v[156:159],a[228:231],v[48:51],v[156:159]
T a[224:225],v9 offset:256
M v[152:155],a[228:231],v[44:47],v[152:155]
T a[226:227],v9 offset:6400
M v[148:151],a[228:231],v[40:43],v[148:151]
L v101,s[8:11],s30 offen offset:1024 nt lds
M v[160:163],a[232:235],v[40:43],v[160:163]
T a[228:229],v10 offset:256
M v[164:167],a[232:235],v[44:47],v[164:167]
T a[230:231],v10 offset:6400
M v[168:171],a[232:235],v[48:51],v[168:171]
M v[180:183],a[236:239],v[48:51],v[180:183]
T a[232:233],v11 offset:256
L v102,s[8:11],s30 offen offset:2048 nt lds
M v[176:179],a[236:239],v[44:47],v[176:179]
T a[234:235],v11 offset:6400
M v[172:175],a[236:239],v[40:43],v[172:175]
s_waitcnt lgkmcnt(4)
M v[184:187],a[216:219],v[40:43],v[184:187]
T a[236:237],v12 offset:256
M v[188:191],a[216:219],v[44:47],v[188:191]
T a[238:239],v12 offset:6400
s_add_u32 m0,m0,0xc00
M v[192:195],a[216:219],v[48:51],v[192:195]
M v[204:207],a[220:223],v[48:51],v[204:207]
M v[200:203],a[220:223],v[44:47],v[200:203]
s_add_u32 s30,s30,0x3000
M v[196:199],a[220:223],v[40:43],v[196:199]
M v[208:211],a[224:227],v[40:43],v[208:211]
L v100,s[8:11],s35 offen nt lds
M v[212:215],a[224:227],v[44:47],v[212:215]
M v[216:219],a[224:227],v[48:51],v[216:219]
s_waitcnt vmcnt(10) lgkmcnt(0)
s_barrier
M v[228:231],a[228:231],v[48:51],v[228:231]
ds_read_b128 a[216:219],v3 offset:24576
ds_read_b128 a[220:223],v4 offset:24576
M v[224:227],a[228:231],v[44:47],v[224:227]
ds_read_b128 a[224:227],v3 offset:24704
M v[220:223],a[228:231],v[40:43],v[220:223]
L v101,s[8:11],s35 offen offset:1024 nt lds
M v[232:235],a[232:235],v[40:43],v[232:235]
ds_read_b128 a[228:231],v4 offset:24704
M v[236:239],a[232:235],v[44:47],v[236:239]
M v[240:243],a[232:235],v[48:51],v[240:243]
ds_read_b128 a[232:235],v3 offset:24832
M v[252:255],a[236:239],v[48:51],v[252:255]
L v102,s[8:11],s35 offen offset:2048 nt lds
M v[248:251],a[236:239],v[44:47],v[248:251]
M v[244:247],a[236:239],v[40:43],v[244:247]
s_waitcnt lgkmcnt(2)
M v[52:55],a[216:219],a[144:147],0
ds_read_b128 a[236:239],v4 offset:24832
s_add_u32 m0,s28,0xc000
M v[56:59],a[216:219],a[148:151],0
M v[60:63],a[216:219],a[152:155],0
s_add_u32 s35,s29,0xc00
M v[60:63],a[220:223],a[164:167],v[60:63]
ds_read_b128 a[216:219],v3 offset:30720
M v[56:59],a[220:223],a[160:163],v[56:59]
M v[52:55],a[220:223],a[156:159],v[52:55]
L v100,s[4:7],s29 offen nt lds
M v[52:55],a[224:227],a[168:171],v[52:55]
ds_read_b128 a[220:223],v4 offset:30720
M v[56:59],a[224:227],a[172:175],v[56:59]
M v[60:63],a[224:227],a[176:179],v[60:63]
s_waitcnt lgkmcnt(2)
M v[60:63],a[228:231],a[188:191],v[60:63]
ds_read_b128 a[224:227],v3 offset:30848
L v101,s[4:7],s29 offen offset:1024 nt lds
M v[56:59],a[228:231],a[184:187],v[56:59]
M v[52:55],a[228:231],a[180:183],v[52:55]
L v102,s[4:7],s29 offen offset:2048 nt lds
M v[52:55],a[232:235],a[192:195],v[52:55]
ds_read_b128 a[228:231],v4 offset:30848
M v[56:59],a[232:235],a[196:199],v[56:59]
M v[60:63],a[232:235],a[200:203],v[60:63]
s_add_u32 m0,m0,0xc00
M v[60:63],a[236:239],a[212:215],v[60:63]
ds_read_b128 a[232:235],v3 offset:30976
M v[56:59],a[236:239],a[208:211],v[56:59]
M v[52:55],a[236:239],a[204:207],v[52:55]
s_waitcnt lgkmcnt(2)
M v[64:67],a[216:219],a[144:147],0
ds_read_b128 a[236:239],v4 offset:30976
s_add_u32 s29,s29,0x3000
M v[68:71],a[216:219],a[148:151],0
M v[72:75],a[216:219],a[152:155],0
L v100,s[4:7],s35 offen nt lds
s_nop 0
v_fma_f32 v52,v52,s37,-v19
v_fma_f32 v53,v53,s37,-v19
M v[72:75],a[220:223],a[164:167],v[72:75]
v_fma_f32 v54,v54,s37,-v19
v_fma_f32 v55,v55,s37,-v19
v_fma_f32 v56,v56,s37,-v20
M v[68:71],a[220:223],a[160:163],v[68:71]
v_fma_f32 v57,v57,s37,-v20
v_max3_f32 v28,v52,v53,v54
v_fma_f32 v58,v58,s37,-v20
M v[64:67],a[220:223],a[156:159],v[64:67]
L v101,s[4:7],s35 offen offset:1024 nt lds
v_fma_f32 v59,v59,s37,-v20
v_max3_f32 v28,v28,v55,v56
M v[64:67],a[224:227],a[168:171],v[64:67]
v_fma_f32 v60,v60,s37,-v21
v_fma_f32 v61,v61,s37,-v21
v_max3_f32 v28,v28,v57,v58
M v[68:71],a[224:227],a[172:175],v[68:71]
L v102,s[4:7],s35 offen offset:2048 nt lds
v_fma_f32 v62,v62,s37,-v21
v_fma_f32 v63,v63,s37,-v21
M v[72:75],a[224:227],a[176:179],v[72:75]
s_waitcnt vmcnt(12) lgkmcnt(0)
s_barrier
v_max3_f32 v28,v28,v59,v60
M v[72:75],a[228:231],a[188:191],v[72:75]
T a[216:217],v5
T a[218:219],v5 offset:6144
v_max3_f32 v28,v28,v61,v62
M v[68:71],a[228:231],a[184:187],v[68:71]
ds_read_b128 v[88:91],v18
T a[220:221],v6
v_max_f32 v28,v28,v63
M v[64:67],a[228:231],a[180:183],v[64:67]
T a[222:223],v6 offset:6144
ds_read_b128 v[92:95],v18 offset:2048
M v[64:67],a[232:235],a[192:195],v[64:67]
ds_read_b128 v[96:99],v18 offset:4096
T a[224:225],v7
M v[68:71],a[232:235],a[196:199],v[68:71]
T a[226:227],v7 offset:6144
T a[228:229],v8
M v[72:75],a[232:235],a[200:203],v[72:75]
T a[230:231],v8 offset:6144
T a[232:233],v5 offset:128
M v[72:75],a[236:239],a[212:215],v[72:75]
T a[234:235],v5 offset:6272
M v[68:71],a[236:239],a[208:211],v[68:71]
M v[64:67],a[236:239],a[204:207],v[64:67]
s_waitcnt lgkmcnt(4)
M a[0:3],a[216:219],v[88:91],a[0:3]
T a[236:237],v6 offset:128
s_add_u32 m0,s28,0x12000
M a[4:7],a[216:219],v[92:95],a[4:7]
T a[238:239],v6 offset:6272
M a[8:11],a[216:219],v[96:99],a[8:11]
M a[20:23],a[220:223],v[96:99],a[20:23]
T a[216:217],v7 offset:128
s_add_u32 s35,s31,0x30000
v_fma_f32 v64,v64,s37,-v19
v_fma_f32 v65,v65,s37,-v19
v_fma_f32 v66,v66,s37,-v19
M a[16:19],a[220:223],v[92:95],a[16:19]
T a[218:219],v7 offset:6272
v_fma_f32 v67,v67,s37,-v19
v_fma_f32 v68,v68,s37,-v20
v_fma_f32 v69,v69,s37,-v20
v_max3_f32 v28,v28,v64,v65
M a[12:15],a[220:223],v[88:91],a[12:15]
v_fma_f32 v70,v70,s37,-v20
v_fma_f32 v71,v71,s37,-v20
v_max3_f32 v28,v28,v66,v67
v_fma_f32 v72,v72,s37,-v21
v_fma_f32 v73,v73,s37,-v21
M a[24:27],a[224:227],v[88:91],a[24:27]
T a[220:221],v8 offset:128
L v103,s[12:15],s31 offen lds
v_max3_f32 v28,v28,v68,v69
v_fma_f32 v74,v74,s37,-v21
v_fma_f32 v75,v75,s37,-v21
M a[28:31],a[224:227],v[92:95],a[28:31]
T a[222:223],v8 offset:6272
v_max3_f32 v28,v28,v70,v71
v_max3_f32 v28,v28,v72,v73
v_max3_f32 v28,v28,v74,v75
M a[32:35],a[224:227],v[96:99],a[32:35]
v_cmp_lt_f32 vcc,0x41000000,v28
s_cbranch_vccnz C0_26_r
C0_26_b:
s_waitcnt lgkmcnt(4)
M a[44:47],a[228:231],v[96:99],a[44:47]
T a[224:225],v5 offset:256
v_exp_f32 v52,v52
v_exp_f32 v56,v56
M a[40:43],a[228:231],v[92:95],a[40:43]
T a[226:227],v5 offset:6400
L v104,s[12:15],s31 offen offset:1024 lds
v_exp_f32 v60,v60
M a[36:39],a[228:231],v[88:91],a[36:39]
v_exp_f32 v53,v53
v_exp_f32 v57,v57
M a[48:51],a[232:235],v[88:91],a[48:51]
T a[228:229],v6 offset:256
v_exp_f32 v61,v61
v_add_f32 v22,v22,v52
v_add_f32 v23,v23,v56
M a[52:55],a[232:235],v[92:95],a[52:55]
T a[230:231],v6 offset:6400
v_add_f32 v24,v24,v60
v_exp_f32 v54,v54
M a[56:59],a[232:235],v[96:99],a[56:59]
L v105,s[12:15],s31 offen offset:2048 lds
v_exp_f32 v58,v58
v_exp_f32 v62,v62
M a[68:71],a[236:239],v[96:99],a[68:71]
T a[232:233],v7 offset:256
v_add_f32 v22,v22,v53
v_add_f32 v23,v23,v57
v_add_f32 v24,v24,v61
C v40,v52,v53
M a[64:67],a[236:239],v[92:95],a[64:67]
T a[234:235],v7 offset:6400
C v44,v56,v57
C v48,v60,v61
v_exp_f32 v55,v55
M a[60:63],a[236:239],v[88:91],a[60:63]
s_add_u32 m0,m0,0xc00
v_exp_f32 v59,v59
s_waitcnt lgkmcnt(4)
M a[72:75],a[216:219],v[88:91],a[72:75]
T a[236:237],v8 offset:256
v_exp_f32 v63,v63
v_add_f32 v22,v22,v54
v_add_f32 v23,v23,v58
M a[76:79],a[216:219],v[92:95],a[76:79]
T a[238:239],v8 offset:6400
v_add_f32 v24,v24,v62
v_exp_f32 v64,v64
M a[80:83],a[216:219],v[96:99],a[80:83]
s_add_u32 s31,s31,0x60000
v_exp_f32 v68,v68
v_exp_f32 v72,v72
M a[92:95],a[220:223],v[96:99],a[92:95]
v_add_f32 v22,v22,v55
v_add_f32 v23,v23,v59
v_add_f32 v24,v24,v63
C v41,v54,v55
C v45,v58,v59
M a[88:91],a[220:223],v[92:95],a[88:91]
C v49,v62,v63
v_exp_f32 v65,v65
v_exp_f32 v69,v69
M a[84:87],a[220:223],v[88:91],a[84:87]
L v103,s[12:15],s35 offen lds
v_exp_f32 v73,v73
v_add_f32 v22,v22,v64
v_add_f32 v23,v23,v68
M a[96:99],a[224:227],v[88:91],a[96:99]
v_add_f32 v24,v24,v72
v_exp_f32 v66,v66
v_exp_f32 v70,v70
M a[100:103],a[224:227],v[92:95],a[100:103]
L v104,s[12:15],s35 offen offset:1024 lds
v_exp_f32 v74,v74
v_add_f32 v22,v22,v65
v_add_f32 v23,v23,v69
M a[104:107],a[224:227],v[96:99],a[104:107]
s_waitcnt vmcnt(11) lgkmcnt(0)
s_barrier
v_add_f32 v24,v24,v73
C v42,v64,v65
C v46,v68,v69
M a[116:119],a[228:231],v[96:99],a[116:119]
T a[216:217],v5 offset:24576
T a[218:219],v5 offset:30720
C v50,v72,v73
v_exp_f32 v67,v67
M a[112:115],a[228:231],v[92:95],a[112:115]
T a[220:221],v6 offset:24576
T a[222:223],v6 offset:30720
v_exp_f32 v71,v71
M a[108:111],a[228:231],v[88:91],a[108:111]
T a[224:225],v7 offset:24576
T a[226:227],v7 offset:30720
v_exp_f32 v75,v75
v_add_f32 v22,v22,v66
M a[120:123],a[232:235],v[88:91],a[120:123]
T a[228:229],v8 offset:24576
T a[230:231],v8 offset:30720
v_add_f32 v23,v23,v70
v_add_f32 v24,v24,v74
C v43,v66,v67
M a[124:127],a[232:235],v[92:95],a[124:127]
C v47,v70,v71
C v51,v74,v75
v_add_f32 v22,v22,v67
v_add_f32 v23,v23,v71
v_add_f32 v24,v24,v75
M a[128:131],a[232:235],v[96:99],a[128:131]
T a[232:233],v5 offset:24704
T a[234:235],v5 offset:30848
M a[140:143],a[236:239],v[96:99],a[140:143]
L v105,s[12:15],s35 offen offset:2048 lds
M a[136:139],a[236:239],v[92:95],a[136:139]
M a[132:135],a[236:239],v[88:91],a[132:135]
s_waitcnt lgkmcnt(4)
M v[112:115],a[216:219],v[40:43],v[112:115]
T a[236:237],v6 offset:24704
s_add_u32 m0,s28,0
M v[116:119],a[216:219],v[44:47],v[116:119]
T a[238:239],v6 offset:30848
M v[120:123],a[216:219],v[48:51],v[120:123]
M v[132:135],a[220:223],v[48:51],v[132:135]
T a[216:217],v7 offset:24704
s_add_u32 s35,s30,0xc00
M v[128:131],a[220:223],v[44:47],v[128:131]
T a[218:219],v7 offset:30848
M v[124:127],a[220:223],v[40:43],v[124:127]
M v[136:139],a[224:227],v[40:43],v[136:139]
T a[220:221],v8 offset:24704
M v[140:143],a[224:227],v[44:47],v[140:143]
T a[222:223],v8 offset:30848
L v100,s[8:11],s30 offen nt lds
M v[144:147],a[224:227],v[48:51],v[144:147]
s_waitcnt lgkmcnt(4)
M v[156:159],a[228:231],v[48:51],v[156:159]
T a[224:225],v5 offset:24832
M v[152:155],a[228:231],v[44:47],v[152:155]
T a[226:227],v5 offset:30976
M v[148:151],a[228:231],v[40:43],v[148:151]
L v101,s[8:11],s30 offen offset:1024 nt lds
M v[160:163],a[232:235],v[40:43],v[160:163]
T a[228:229],v6 offset:24832
M v[164:167],a[232:235],v[44:47],v[164:167]
T a[230:231],v6 offset:30976
M v[168:171],a[232:235],v[48:51],v[168:171]
M v[180:183],a[236:239],v[48:51],v[180:183]
T a[232:233],v7 offset:24832
L v102,s[8:11],s30 offen offset:2048 nt lds
M v[176:179],a[236:239],v[44:47],v[176:179]
T a[234:235],v7 offset:30976
M v[172:175],a[236:239],v[40:43],v[172:175]
s_waitcnt lgkmcnt(4)
M v[184:187],a[216:219],v[40:43],v[184:187]
T a[236:237],v8 offset:24832
M v[188:191],a[216:219],v[44:47],v[188:191]
T a[238:239],v8 offset:30976
s_add_u32 m0,m0,0xc00
M v[192:195],a[216:219],v[48:51],v[192:195]
M v[204:207],a[220:223],v[48:51],v[204:207]
M v[200:203],a[220:223],v[44:47],v[200:203]
s_add_u32 s30,s30,0x3000
M v[196:199],a[220:223],v[40:43],v[196:199]
M v[208:211],a[224:227],v[40:43],v[208:211]
L v100,s[8:11],s35 offen nt lds
M v[212:215],a[224:227],v[44:47],v[212:215]
M v[216:219],a[224:227],v[48:51],v[216:219]
s_waitcnt vmcnt(10) lgkmcnt(0)
s_barrier
M v[228:231],a[228:231],v[48:51],v[228:231]
ds_read_b128 a[216:219],v3
ds_read_b128 a[220:223],v4
M v[224:227],a[228:231],v[44:47],v[224:227]
ds_read_b128 a[224:227],v3 offset:128
M v[220:223],a[228:231],v[40:43],v[220:223]
L v101,s[8:11],s35 offen offset:1024 nt lds
M v[232:235],a[232:235],v[40:43],v[232:235]
ds_read_b128 a[228:231],v4 offset:128
M v[236:239],a[232:235],v[44:47],v[236:239]
M v[240:243],a[232:235],v[48:51],v[240:243]
ds_read_b128 a[232:235],v3 offset:256
M v[252:255],a[236:239],v[48:51],v[252:255]
L v102,s[8:11],s35 offen offset:2048 nt lds
M v[248:251],a[236:239],v[44:47],v[248:251]
M v[244:247],a[236:239],v[40:43],v[244:247]
s_waitcnt lgkmcnt(2)
M v[52:55],a[216:219],a[144:147],0
ds_read_b128 a[236:239],v4 offset:256
s_add_u32 m0,s28,0x6000
M v[56:59],a[216:219],a[148:151],0
M v[60:63],a[216:219],a[152:155],0
s_add_u32 s35,s29,0xc00
M v[60:63],a[220:223],a[164:167],v[60:63]
ds_read_b128 a[216:219],v3 offset:6144
M v[56:59],a[220:223],a[160:163],v[56:59]
M v[52:55],a[220:223],a[156:159],v[52:55]
L v100,s[4:7],s29 offen nt lds
M v[52:55],a[224:227],a[168:171],v[52:55]
ds_read_b128 a[220:223],v4 offset:6144
M v[56:59],a[224:227],a[172:175],v[56:59]
M v[60:63],a[224:227],a[176:179],v[60:63]
s_waitcnt lgkmcnt(2)
M v[60:63],a[228:231],a[188:191],v[60:63]
ds_read_b128 a[224:227],v3 offset:6272
L v101,s[4:7],s29 offen offset:1024 nt lds
M v[56:59],a[228:231],a[184:187],v[56:59]
M v[52:55],a[228:231],a[180:183],v[52:55]
L v102,s[4:7],s29 offen offset:2048 nt lds
M v[52:55],a[232:235],a[192:195],v[52:55]
ds_read_b128 a[228:231],v4 offset:6272
M v[56:59],a[232:235],a[196:199],v[56:59]
M v[60:63],a[232:235],a[200:203],v[60:63]
s_add_u32 m0,m0,0xc00
M v[60:63],a[236:239],a[212:215],v[60:63]
ds_read_b128 a[232:235],v3 offset:6400
M v[56:59],a[236:239],a[208:211],v[56:59]
M v[52:55],a[236:239],a[204:207],v[52:55]
s_waitcnt lgkmcnt(2)
M v[64:67],a[216:219],a[144:147],0
ds_read_b128 a[236:239],v4 offset:6400
s_add_u32 s29,s29,0x3000
M v[68:71],a[216:219],a[148:151],0
M v[72:75],a[216:219],a[152:155],0
L v100,s[4:7],s35 offen nt lds
s_nop 0
v_fma_f32 v52,v52,s37,-v19
v_fma_f32 v53,v53,s37,-v19
M v[72:75],a[220:223],a[164:167],v[72:75]
v_fma_f32 v54,v54,s37,-v19
v_fma_f32 v55,v55,s37,-v19
v_fma_f32 v56,v56,s37,-v20
M v[68:71],a[220:223],a[160:163],v[68:71]
v_fma_f32 v57,v57,s37,-v20
v_max3_f32 v28,v52,v53,v54
v_fma_f32 v58,v58,s37,-v20
M v[64:67],a[220:223],a[156:159],v[64:67]
L v101,s[4:7],s35 offen offset:1024 nt lds
v_fma_f32 v59,v59,s37,-v20
v_max3_f32 v28,v28,v55,v56
M v[64:67],a[224:227],a[168:171],v[64:67]
v_fma_f32 v60,v60,s37,-v21
v_fma_f32 v61,v61,s37,-v21
v_max3_f32 v28,v28,v57,v58
M v[68:71],a[224:227],a[172:175],v[68:71]
L v102,s[4:7],s35 offen offset:2048 nt lds
v_fma_f32 v62,v62,s37,-v21
v_fma_f32 v63,v63,s37,-v21
M v[72:75],a[224:227],a[176:179],v[72:75]
s_waitcnt vmcnt(12) lgkmcnt(0)
s_barrier
v_max3_f32 v28,v28,v59,v60
M v[72:75],a[228:231],a[188:191],v[72:75]
T a[216:217],v9 offset:24576
T a[218:219],v9 offset:30720
v_max3_f32 v28,v28,v61,v62
M v[68:71],a[228:231],a[184:187],v[68:71]
ds_read_b128 v[76:79],v17 offset:12288
T a[220:221],v10 offset:24576
v_max_f32 v28,v28,v63
M v[64:67],a[228:231],a[180:183],v[64:67]
T a[222:223],v10 offset:30720
ds_read_b128 v[80:83],v17 offset:14336
M v[64:67],a[232:235],a[192:195],v[64:67]
ds_read_b128 v[84:87],v17 offset:16384
T a[224:225],v11 offset:24576
M v[68:71],a[232:235],a[196:199],v[68:71]
T a[226:227],v11 offset:30720
T a[228:229],v12 offset:24576
M v[72:75],a[232:235],a[200:203],v[72:75]
T a[230:231],v12 offset:30720
T a[232:233],v9 offset:24704
M v[72:75],a[236:239],a[212:215],v[72:75]
T a[234:235],v9 offset:30848
M v[68:71],a[236:239],a[208:211],v[68:71]
M v[64:67],a[236:239],a[204:207],v[64:67]
s_waitcnt lgkmcnt(4)
M a[0:3],a[216:219],v[76:79],a[0:3]
T a[236:237],v10 offset:24704
s_add_u32 m0,s28,0xc000
M a[4:7],a[216:219],v[80:83],a[4:7]
T a[238:239],v10 offset:30848
M a[8:11],a[216:219],v[84:87],a[8:11]
s_add_u32 s35,s31,0x30000
M a[20:23],a[220:223],v[84:87],a[20:23]
T a[216:217],v11 offset:24704
v_fma_f32 v64,v64,s37,-v19
v_fma_f32 v65,v65,s37,-v19
v_fma_f32 v66,v66,s37,-v19
v_fma_f32 v67,v67,s37,-v19
M a[16:19],a[220:223],v[80:83],a[16:19]
T a[218:219],v11 offset:30848
v_fma_f32 v68,v68,s37,-v20
v_fma_f32 v69,v69,s37,-v20
v_max3_f32 v28,v28,v64,v65
v_fma_f32 v70,v70,s37,-v20
M a[12:15],a[220:223],v[76:79],a[12:15]
L v103,s[12:15],s31 offen lds
v_fma_f32 v71,v71,s37,-v20
v_max3_f32 v28,v28,v66,v67
v_fma_f32 v72,v72,s37,-v21
v_fma_f32 v73,v73,s37,-v21
M a[24:27],a[224:227],v[76:79],a[24:27]
T a[220:221],v12 offset:24704
v_max3_f32 v28,v28,v68,v69
v_fma_f32 v74,v74,s37,-v21
v_fma_f32 v75,v75,s37,-v21
v_max3_f32 v28,v28,v70,v71
M a[28:31],a[224:227],v[80:83],a[28:31]
T a[222:223],v12 offset:30848
v_max3_f32 v28,v28,v72,v73
v_max3_f32 v28,v28,v74,v75
M a[32:35],a[224:227],v[84:87],a[32:35]
L v104,s[12:15],s31 offen offset:1024 lds
s_waitcnt lgkmcnt(4)
M a[44:47],a[228:231],v[84:87],a[44:47]
T a[224:225],v9 offset:24832
v_cmp_lt_f32 vcc,0x41000000,v28
s_cbranch_vccnz C0_29_r
C0_29_b:
M a[40:43],a[228:231],v[80:83],a[40:43]
T a[226:227],v9 offset:30976
v_exp_f32 v52,v52
v_exp_f32 v56,v56
M a[36:39],a[228:231],v[76:79],a[36:39]
L v105,s[12:15],s31 offen offset:2048 lds
v_exp_f32 v60,v60
v_exp_f32 v53,v53
M a[48:51],a[232:235],v[76:79],a[48:51]
T a[228:229],v10 offset:24832
v_exp_f32 v57,v57
v_exp_f32 v61,v61
M a[52:55],a[232:235],v[80:83],a[52:55]
T a[230:231],v10 offset:30976
v_add_f32 v22,v22,v52
v_add_f32 v23,v23,v56
v_add_f32 v24,v24,v60
M a[56:59],a[232:235],v[84:87],a[56:59]
s_add_u32 m0,m0,0xc00
v_exp_f32 v54,v54
v_exp_f32 v58,v58
M a[68:71],a[236:239],v[84:87],a[68:71]
T a[232:233],v11 offset:24832
v_exp_f32 v62,v62
v_add_f32 v22,v22,v53
v_add_f32 v23,v23,v57
M a[64:67],a[236:239],v[80:83],a[64:67]
T a[234:235],v11 offset:30976
v_add_f32 v24,v24,v61
C v40,v52,v53
C v44,v56,v57
C v48,v60,v61
M a[60:63],a[236:239],v[76:79],a[60:63]
s_add_u32 s31,s31,0x60000
v_exp_f32 v55,v55
s_waitcnt lgkmcnt(4)
M a[72:75],a[216:219],v[76:79],a[72:75]
T a[236:237],v12 offset:24832
v_exp_f32 v59,v59
v_exp_f32 v63,v63
M a[76:79],a[216:219],v[80:83],a[76:79]
T a[238:239],v12 offset:30976
v_add_f32 v22,v22,v54
v_add_f32 v23,v23,v58
v_add_f32 v24,v24,v62
M a[80:83],a[216:219],v[84:87],a[80:83]
L v103,s[12:15],s35 offen lds
v_exp_f32 v64,v64
v_exp_f32 v68,v68
M a[92:95],a[220:223],v[84:87],a[92:95]
v_exp_f32 v72,v72
v_add_f32 v22,v22,v55
v_add_f32 v23,v23,v59
v_add_f32 v24,v24,v63
M a[88:91],a[220:223],v[80:83],a[88:91]
L v104,s[12:15],s35 offen offset:1024 lds
C v41,v54,v55
C v45,v58,v59
C v49,v62,v63
M a[84:87],a[220:223],v[76:79],a[84:87]
v_exp_f32 v65,v65
v_exp_f32 v69,v69
M a[96:99],a[224:227],v[76:79],a[96:99]
L v105,s[12:15],s35 offen offset:2048 lds
v_exp_f32 v73,v73
v_add_f32 v22,v22,v64
v_add_f32 v23,v23,v68
M a[100:103],a[224:227],v[80:83],a[100:103]
v_add_f32 v24,v24,v72
v_exp_f32 v66,v66
v_exp_f32 v70,v70
M a[104:107],a[224:227],v[84:87],a[104:107]
s_waitcnt vmcnt(12) lgkmcnt(0)
s_barrier
v_exp_f32 v74,v74
v_add_f32 v22,v22,v65
M a[116:119],a[228:231],v[84:87],a[116:119]
T a[216:217],v5
T a[218:219],v5 offset:6144
v_add_f32 v23,v23,v69
v_add_f32 v24,v24,v73
C v42,v64,v65
M a[112:115],a[228:231],v[80:83],a[112:115]
T a[220:221],v6
T a[222:223],v6 offset:6144
C v46,v68,v69
C v50,v72,v73
M a[108:111],a[228:231],v[76:79],a[108:111]
T a[224:225],v7
T a[226:227],v7 offset:6144
v_exp_f32 v67,v67
M a[120:123],a[232:235],v[76:79],a[120:123]
T a[228:229],v8
T a[230:231],v8 offset:6144
v_exp_f32 v71,v71
M a[124:127],a[232:235],v[80:83],a[124:127]
v_exp_f32 v75,v75
v_add_f32 v22,v22,v66
v_add_f32 v23,v23,v70
v_add_f32 v24,v24,v74
M a[128:131],a[232:235],v[84:87],a[128:131]
T a[232:233],v5 offset:128
T a[234:235],v5 offset:6272
C v43,v66,v67
C v47,v70,v71
C v51,v74,v75
M a[140:143],a[236:239],v[84:87],a[140:143]
s_cmp_eq_u32 s31,s39
s_cselect_b32 s31,s38,s31
v_add_f32 v22,v22,v67
v_add_f32 v23,v23,v71
v_add_f32 v24,v24,v75
M a[136:139],a[236:239],v[80:83],a[136:139]
M a[132:135],a[236:239],v[76:79],a[132:135]
s_waitcnt lgkmcnt(4)
M v[112:115],a[216:219],v[40:43],v[112:115]
T a[236:237],v6 offset:128
s_add_u32 m0,s28,0x12000
M v[116:119],a[216:219],v[44:47],v[116:119]
T a[238:239],v6 offset:6272
M v[120:123],a[216:219],v[48:51],v[120:123]
M v[132:135],a[220:223],v[48:51],v[132:135]
T a[216:217],v7 offset:128
s_add_u32 s35,s30,0xc00
M v[128:131],a[220:223],v[44:47],v[128:131]
T a[218:219],v7 offset:6272
M v[124:127],a[220:223],v[40:43],v[124:127]
M v[136:139],a[224:227],v[40:43],v[136:139]
T a[220:221],v8 offset:128
M v[140:143],a[224:227],v[44:47],v[140:143]
T a[222:223],v8 offset:6272
L v100,s[8:11],s30 offen nt lds
M v[144:147],a[224:227],v[48:51],v[144:147]
s_waitcnt lgkmcnt(4)
M v[156:159],a[228:231],v[48:51],v[156:159]
T a[224:225],v5 offset:256
M v[152:155],a[228:231],v[44:47],v[152:155]
T a[226:227],v5 offset:6400
M v[148:151],a[228:231],v[40:43],v[148:151]
L v101,s[8:11],s30 offen offset:1024 nt lds
M v[160:163],a[232:235],v[40:43],v[160:163]
T a[228:229],v6 offset:256
M v[164:167],a[232:235],v[44:47],v[164:167]
T a[230:231],v6 offset:6400
M v[168:171],a[232:235],v[48:51],v[168:171]
M v[180:183],a[236:239],v[48:51],v[180:183]
T a[232:233],v7 offset:256
L v102,s[8:11],s30 offen offset:2048 nt lds
M v[176:179],a[236:239],v[44:47],v[176:179]
T a[234:235],v7 offset:6400
M v[172:175],a[236:239],v[40:43],v[172:175]
s_waitcnt lgkmcnt(4)
M v[184:187],a[216:219],v[40:43],v[184:187]
T a[236:237],v8 offset:256
M v[188:191],a[216:219],v[44:47],v[188:191]
T a[238:239],v8 offset:6400
s_add_u32 m0,m0,0xc00
M v[192:195],a[216:219],v[48:51],v[192:195]
M v[204:207],a[220:223],v[48:51],v[204:207]
M v[200:203],a[220:223],v[44:47],v[200:203]
s_add_u32 s30,s30,0x3000
M v[196:199],a[220:223],v[40:43],v[196:199]
M v[208:211],a[224:227],v[40:43],v[208:211]
L v100,s[8:11],s35 offen nt lds
M v[212:215],a[224:227],v[44:47],v[212:215]
M v[216:219],a[224:227],v[48:51],v[216:219]
s_waitcnt vmcnt(10) lgkmcnt(0)
s_barrier
M v[228:231],a[228:231],v[48:51],v[228:231]
ds_read_b128 a[216:219],v1 offset:24576
ds_read_b128 a[220:223],v2 offset:24576
M v[224:227],a[228:231],v[44:47],v[224:227]
ds_read_b128 a[224:227],v1 offset:24704
M v[220:223],a[228:231],v[40:43],v[220:223]
L v101,s[8:11],s35 offen offset:1024 nt lds
M v[232:235],a[232:235],v[40:43],v[232:235]
ds_read_b128 a[228:231],v2 offset:24704
M v[236:239],a[232:235],v[44:47],v[236:239]
M v[240:243],a[232:235],v[48:51],v[240:243]
ds_read_b128 a[232:235],v1 offset:24832
M v[252:255],a[236:239],v[48:51],v[252:255]
L v102,s[8:11],s35 offen offset:2048 nt lds
M v[248:251],a[236:239],v[44:47],v[248:251]
M v[244:247],a[236:239],v[40:43],v[244:247]
s_waitcnt lgkmcnt(2)
M v[52:55],a[216:219],a[144:147],0
ds_read_b128 a[236:239],v2 offset:24832
s_add_u32 m0,s28,0
M v[56:59],a[216:219],a[148:151],0
s_add_u32 s35,s29,0xc00
M v[60:63],a[216:219],a[152:155],0
M v[60:63],a[220:223],a[164:167],v[60:63]
ds_read_b128 a[216:219],v1 offset:30720
L v100,s[4:7],s29 offen nt lds
M v[56:59],a[220:223],a[160:163],v[56:59]
M v[52:55],a[220:223],a[156:159],v[52:55]
L v101,s[4:7],s29 offen offset:1024 nt lds
M v[52:55],a[224:227],a[168:171],v[52:55]
ds_read_b128 a[220:223],v2 offset:30720
M v[56:59],a[224:227],a[172:175],v[56:59]
L v102,s[4:7],s29 offen offset:2048 nt lds
M v[60:63],a[224:227],a[176:179],v[60:63]
s_add_u32 m0,m0,0xc00
s_waitcnt lgkmcnt(2)
M v[60:63],a[228:231],a[188:191],v[60:63]
ds_read_b128 a[224:227],v1 offset:30848
M v[56:59],a[228:231],a[184:187],v[56:59]
s_add_u32 s29,s29,0x3000
M v[52:55],a[228:231],a[180:183],v[52:55]
M v[52:55],a[232:235],a[192:195],v[52:55]
ds_read_b128 a[228:231],v2 offset:30848
L v100,s[4:7],s35 offen nt lds
M v[56:59],a[232:235],a[196:199],v[56:59]
M v[60:63],a[232:235],a[200:203],v[60:63]
L v101,s[4:7],s35 offen offset:1024 nt lds
M v[60:63],a[236:239],a[212:215],v[60:63]
ds_read_b128 a[232:235],v1 offset:30976
L v102,s[4:7],s35 offen offset:2048 nt lds
M v[56:59],a[236:239],a[208:211],v[56:59]
M v[52:55],a[236:239],a[204:207],v[52:55]
s_add_u32 m0,s34,0
s_waitcnt lgkmcnt(2)
M v[64:67],a[216:219],a[144:147],0
ds_read_b128 a[236:239],v2 offset:30976
M v[68:71],a[216:219],a[148:151],0
L v106,s[20:23],s33 offen lds
M v[72:75],a[216:219],a[152:155],0
s_nop 0
v_fma_f32 v52,v52,s37,-v19
v_fma_f32 v53,v53,s37,-v19
v_fma_f32 v54,v54,s37,-v19
M v[72:75],a[220:223],a[164:167],v[72:75]
L v107,s[20:23],s33 offen offset:1024 lds
v_fma_f32 v55,v55,s37,-v19
v_fma_f32 v56,v56,s37,-v20
M v[68:71],a[220:223],a[160:163],v[68:71]
L v108,s[20:23],s33 offen offset:2048 lds
v_fma_f32 v57,v57,s37,-v20
v_max3_f32 v28,v52,v53,v54
M v[64:67],a[220:223],a[156:159],v[64:67]
s_add_u32 s33,s33,0x80
v_fma_f32 v58,v58,s37,-v20
v_fma_f32 v59,v59,s37,-v20
M v[64:67],a[224:227],a[168:171],v[64:67]
v_max3_f32 v28,v28,v55,v56
v_fma_f32 v60,v60,s37,-v21
v_fma_f32 v61,v61,s37,-v21
M v[68:71],a[224:227],a[172:175],v[68:71]
v_max3_f32 v28,v28,v57,v58
v_fma_f32 v62,v62,s37,-v21
v_fma_f32 v63,v63,s37,-v21
M v[72:75],a[224:227],a[176:179],v[72:75]
s_waitcnt vmcnt(15) lgkmcnt(0)
s_barrier
v_max3_f32 v28,v28,v59,v60
M v[72:75],a[228:231],a[188:191],v[72:75]
T a[216:217],v9
T a[218:219],v9 offset:6144
v_max3_f32 v28,v28,v61,v62
M v[68:71],a[228:231],a[184:187],v[68:71]
ds_read_b128 v[88:91],v18 offset:12288
T a[220:221],v10
v_max_f32 v28,v28,v63
M v[64:67],a[228:231],a[180:183],v[64:67]
T a[222:223],v10 offset:6144
ds_read_b128 v[92:95],v18 offset:14336
M v[64:67],a[232:235],a[192:195],v[64:67]
ds_read_b128 v[96:99],v18 offset:16384
T a[224:225],v11
M v[68:71],a[232:235],a[196:199],v[68:71]
T a[226:227],v11 offset:6144
T a[228:229],v12
M v[72:75],a[232:235],a[200:203],v[72:75]
T a[230:231],v12 offset:6144
T a[232:233],v9 offset:128
M v[72:75],a[236:239],a[212:215],v[72:75]
T a[234:235],v9 offset:6272
M v[68:71],a[236:239],a[208:211],v[68:71]
s_cmp_eq_u32 s33,s41
s_cselect_b32 s33,s40,s33
M v[64:67],a[236:239],a[204:207],v[64:67]
s_waitcnt lgkmcnt(4)
M a[0:3],a[216:219],v[88:91],a[0:3]
T a[236:237],v10 offset:128
s_add_u32 m0,s28,0x6000
M a[4:7],a[216:219],v[92:95],a[4:7]
T a[238:239],v10 offset:6272
M a[8:11],a[216:219],v[96:99],a[8:11]
s_add_u32 s35,s31,0x30000
M a[20:23],a[220:223],v[96:99],a[20:23]
T a[216:217],v11 offset:128
L v103,s[12:15],s31 offen lds
v_fma_f32 v64,v64,s37,-v19
v_fma_f32 v65,v65,s37,-v19
v_fma_f32 v66,v66,s37,-v19
M a[16:19],a[220:223],v[92:95],a[16:19]
T a[218:219],v11 offset:6272
v_fma_f32 v67,v67,s37,-v19
v_fma_f32 v68,v68,s37,-v20
v_fma_f32 v69,v69,s37,-v20
v_max3_f32 v28,v28,v64,v65
M a[12:15],a[220:223],v[88:91],a[12:15]
L v104,s[12:15],s31 offen offset:1024 lds
v_fma_f32 v70,v70,s37,-v20
v_fma_f32 v71,v71,s37,-v20
v_max3_f32 v28,v28,v66,v67
v_fma_f32 v72,v72,s37,-v21
M a[24:27],a[224:227],v[88:91],a[24:27]
T a[220:221],v12 offset:128
v_fma_f32 v73,v73,s37,-v21
v_max3_f32 v28,v28,v68,v69
v_fma_f32 v74,v74,s37,-v21
v_fma_f32 v75,v75,s37,-v21
M a[28:31],a[224:227],v[92:95],a[28:31]
T a[222:223],v12 offset:6272
L v105,s[12:15],s31 offen offset:2048 lds
v_max3_f32 v28,v28,v70,v71
v_max3_f32 v28,v28,v72,v73
v_max3_f32 v28,v28,v74,v75
M a[32:35],a[224:227],v[96:99],a[32:35]
v_cmp_lt_f32 vcc,0x41000000,v28
s_cbranch_vccnz C0_32_r
C0_32_b:
s_waitcnt lgkmcnt(4)
M a[44:47],a[228:231],v[96:99],a[44:47]
T a[224:225],v9 offset:256
s_add_u32 m0,m0,0xc00
v_exp_f32 v52,v52
M a[40:43],a[228:231],v[92:95],a[40:43]
T a[226:227],v9 offset:6400
v_exp_f32 v56,v56
v_exp_f32 v60,v60
M a[36:39],a[228:231],v[88:91],a[36:39]
s_add_u32 s31,s31,0x60000
v_exp_f32 v53,v53
v_exp_f32 v57,v57
M a[48:51],a[232:235],v[88:91],a[48:51]
T a[228:229],v10 offset:256
v_exp_f32 v61,v61
v_add_f32 v22,v22,v52
v_add_f32 v23,v23,v56
M a[52:55],a[232:235],v[92:95],a[52:55]
T a[230:231],v10 offset:6400
L v103,s[12:15],s35 offen lds
v_add_f32 v24,v24,v60
v_exp_f32 v54,v54
M a[56:59],a[232:235],v[96:99],a[56:59]
v_exp_f32 v58,v58
v_exp_f32 v62,v62
v_add_f32 v22,v22,v53
M a[68:71],a[236:239],v[96:99],a[68:71]
T a[232:233],v11 offset:256
L v104,s[12:15],s35 offen offset:1024 lds
v_add_f32 v23,v23,v57
v_add_f32 v24,v24,v61
C v40,v52,v53
M a[64:67],a[236:239],v[92:95],a[64:67]
T a[234:235],v11 offset:6400
C v44,v56,v57
C v48,v60,v61
v_exp_f32 v55,v55
M a[60:63],a[236:239],v[88:91],a[60:63]
L v105,s[12:15],s35 offen offset:2048 lds
v_exp_f32 v59,v59
s_waitcnt lgkmcnt(4)
M a[72:75],a[216:219],v[88:91],a[72:75]
T a[236:237],v12 offset:256
v_exp_f32 v63,v63
v_add_f32 v22,v22,v54
v_add_f32 v23,v23,v58
M a[76:79],a[216:219],v[92:95],a[76:79]
T a[238:239],v12 offset:6400
s_add_u32 m0,s34,0x3000
v_add_f32 v24,v24,v62
v_exp_f32 v64,v64
M a[80:83],a[216:219],v[96:99],a[80:83]
v_exp_f32 v68,v68
v_exp_f32 v72,v72
v_add_f32 v22,v22,v55
M a[92:95],a[220:223],v[96:99],a[92:95]
s_xor_b32 s34,s34,0x38000
v_add_f32 v23,v23,v59
v_add_f32 v24,v24,v63
C v41,v54,v55
C v45,v58,v59
M a[88:91],a[220:223],v[92:95],a[88:91]
L v106,s[20:23],s33 offen lds
C v49,v62,v63
v_exp_f32 v65,v65
M a[84:87],a[220:223],v[88:91],a[84:87]
L v107,s[20:23],s33 offen offset:1024 lds
v_exp_f32 v69,v69
v_exp_f32 v73,v73
M a[96:99],a[224:227],v[88:91],a[96:99]
L v108,s[20:23],s33 offen offset:2048 lds
v_add_f32 v22,v22,v64
v_add_f32 v23,v23,v68
v_add_f32 v24,v24,v72
M a[100:103],a[224:227],v[92:95],a[100:103]
s_add_u32 s33,s33,0x80
v_exp_f32 v66,v66
v_exp_f32 v70,v70
M a[104:107],a[224:227],v[96:99],a[104:107]
s_waitcnt vmcnt(18) lgkmcnt(0)
s_barrier
v_exp_f32 v74,v74
v_add_f32 v22,v22,v65
M a[116:119],a[228:231],v[96:99],a[116:119]
T a[216:217],v9 offset:24576
T a[218:219],v9 offset:30720
v_add_f32 v23,v23,v69
v_add_f32 v24,v24,v73
C v42,v64,v65
M a[112:115],a[228:231],v[92:95],a[112:115]
T a[220:221],v10 offset:24576
T a[222:223],v10 offset:30720
C v46,v68,v69
C v50,v72,v73
M a[108:111],a[228:231],v[88:91],a[108:111]
T a[224:225],v11 offset:24576
T a[226:227],v11 offset:30720
v_exp_f32 v67,v67
M a[120:123],a[232:235],v[88:91],a[120:123]
T a[228:229],v12 offset:24576
T a[230:231],v12 offset:30720
v_exp_f32 v71,v71
M a[124:127],a[232:235],v[92:95],a[124:127]
v_exp_f32 v75,v75
v_add_f32 v22,v22,v66
v_add_f32 v23,v23,v70
v_add_f32 v24,v24,v74
M a[128:131],a[232:235],v[96:99],a[128:131]
T a[232:233],v9 offset:24704
T a[234:235],v9 offset:30848
C v43,v66,v67
C v47,v70,v71
C v51,v74,v75
M a[140:143],a[236:239],v[96:99],a[140:143]
v_add_f32 v22,v22,v67
v_add_f32 v23,v23,v71
v_add_f32 v24,v24,v75
M a[136:139],a[236:239],v[92:95],a[136:139]
s_cmp_eq_u32 s33,s41
s_cselect_b32 s33,s40,s33
M a[132:135],a[236:239],v[88:91],a[132:135]
s_mov_b32 s36,3
.p2align 3
C0_loop2:
s_waitcnt lgkmcnt(4)
M v[112:115],a[216:219],v[40:43],v[112:115]
T a[236:237],v10 offset:24704
s_add_u32 m0,s28,0xc000
M v[116:119],a[216:219],v[44:47],v[116:119]
T a[238:239],v10 offset:30848
M v[120:123],a[216:219],v[48:51],v[120:123]
s_add_u32 s35,s31,0x30000
M v[132:135],a[220:223],v[48:51],v[132:135]
T a[216:217],v11 offset:24704
M v[128:131],a[220:223],v[44:47],v[128:131]
T a[218:219],v11 offset:30848
M v[124:127],a[220:223],v[40:43],v[124:127]
L v103,s[12:15],s31 offen lds
M v[136:139],a[224:227],v[40:43],v[136:139]
T a[220:221],v12 offset:24704
M v[140:143],a[224:227],v[44:47],v[140:143]
T a[222:223],v12 offset:30848
M v[144:147],a[224:227],v[48:51],v[144:147]
s_waitcnt lgkmcnt(4)
M v[156:159],a[228:231],v[48:51],v[156:159]
T a[224:225],v9 offset:24832
L v104,s[12:15],s31 offen offset:1024 lds
M v[152:155],a[228:231],v[44:47],v[152:155]
T a[226:227],v9 offset:30976
M v[148:151],a[228:231],v[40:43],v[148:151]
M v[160:163],a[232:235],v[40:43],v[160:163]
T a[228:229],v10 offset:24832
L v105,s[12:15],s31 offen offset:2048 lds
M v[164:167],a[232:235],v[44:47],v[164:167]
T a[230:231],v10 offset:30976
M v[168:171],a[232:235],v[48:51],v[168:171]
M v[180:183],a[236:239],v[48:51],v[180:183]
T a[232:233],v11 offset:24832
s_add_u32 m0,m0,0xc00
M v[176:179],a[236:239],v[44:47],v[176:179]
T a[234:235],v11 offset:30976
M v[172:175],a[236:239],v[40:43],v[172:175]
s_waitcnt lgkmcnt(4)
M v[184:187],a[216:219],v[40:43],v[184:187]
T a[236:237],v12 offset:24832
M v[188:191],a[216:219],v[44:47],v[188:191]
T a[238:239],v12 offset:30976
s_add_u32 s31,s31,0x60000
M v[192:195],a[216:219],v[48:51],v[192:195]
M v[204:207],a[220:223],v[48:51],v[204:207]
L v103,s[12:15],s35 offen lds
M v[200:203],a[220:223],v[44:47],v[200:203]
M v[196:199],a[220:223],v[40:43],v[196:199]
L v104,s[12:15],s35 offen offset:1024 lds
M v[208:211],a[224:227],v[40:43],v[208:211]
M v[212:215],a[224:227],v[44:47],v[212:215]
L v105,s[12:15],s35 offen offset:2048 lds
M v[216:219],a[224:227],v[48:51],v[216:219]
s_waitcnt vmcnt(18) lgkmcnt(0)
s_barrier
M v[228:231],a[228:231],v[48:51],v[228:231]
ds_read_b128 a[216:219],v1
ds_read_b128 a[220:223],v2
M v[224:227],a[228:231],v[44:47],v[224:227]
ds_read_b128 a[224:227],v1 offset:128
M v[220:223],a[228:231],v[40:43],v[220:223]
M v[232:235],a[232:235],v[40:43],v[232:235]
ds_read_b128 a[228:231],v2 offset:128
M v[236:239],a[232:235],v[44:47],v[236:239]
M v[240:243],a[232:235],v[48:51],v[240:243]
ds_read_b128 a[232:235],v1 offset:256
M v[252:255],a[236:239],v[48:51],v[252:255]
s_cmp_eq_u32 s31,s39
s_cselect_b32 s31,s38,s31
M v[248:251],a[236:239],v[44:47],v[248:251]
M v[244:247],a[236:239],v[40:43],v[244:247]
s_waitcnt lgkmcnt(2)
M v[52:55],a[216:219],a[144:147],0
ds_read_b128 a[236:239],v2 offset:256
s_add_u32 m0,s28,0x12000
M v[56:59],a[216:219],a[148:151],0
M v[60:63],a[216:219],a[152:155],0
s_add_u32 s35,s30,0xc00
M v[60:63],a[220:223],a[164:167],v[60:63]
ds_read_b128 a[216:219],v1 offset:6144
M v[56:59],a[220:223],a[160:163],v[56:59]
M v[52:55],a[220:223],a[156:159],v[52:55]
L v100,s[8:11],s30 offen nt lds
M v[52:55],a[224:227],a[168:171],v[52:55]
ds_read_b128 a[220:223],v2 offset:6144
M v[56:59],a[224:227],a[172:175],v[56:59]
M v[60:63],a[224:227],a[176:179],v[60:63]
L v101,s[8:11],s30 offen offset:1024 nt lds
s_waitcnt lgkmcnt(2)
M v[60:63],a[228:231],a[188:191],v[60:63]
ds_read_b128 a[224:227],v1 offset:6272
M v[56:59],a[228:231],a[184:187],v[56:59]
M v[52:55],a[228:231],a[180:183],v[52:55]
L v102,s[8:11],s30 offen offset:2048 nt lds
M v[52:55],a[232:235],a[192:195],v[52:55]
ds_read_b128 a[228:231],v2 offset:6272
M v[56:59],a[232:235],a[196:199],v[56:59]
M v[60:63],a[232:235],a[200:203],v[60:63]
s_add_u32 m0,m0,0xc00
M v[60:63],a[236:239],a[212:215],v[60:63]
ds_read_b128 a[232:235],v1 offset:6400
M v[56:59],a[236:239],a[208:211],v[56:59]
s_add_u32 s30,s30,0x3000
M v[52:55],a[236:239],a[204:207],v[52:55]
s_waitcnt lgkmcnt(2)
M v[64:67],a[216:219],a[144:147],0
ds_read_b128 a[236:239],v2 offset:6400
M v[68:71],a[216:219],a[148:151],0
M v[72:75],a[216:219],a[152:155],0
L v100,s[8:11],s35 offen nt lds
s_nop 1
v_fma_f32 v52,v52,s37,-v19
v_fma_f32 v53,v53,s37,-v19
M v[72:75],a[220:223],a[164:167],v[72:75]
v_fma_f32 v54,v54,s37,-v19
v_fma_f32 v55,v55,s37,-v19
v_fma_f32 v56,v56,s37,-v20
M v[68:71],a[220:223],a[160:163],v[68:71]
L v101,s[8:11],s35 offen offset:1024 nt lds
v_fma_f32 v57,v57,s37,-v20
v_max3_f32 v28,v52,v53,v54
M v[64:67],a[220:223],a[156:159],v[64:67]
v_fma_f32 v58,v58,s37,-v20
v_fma_f32 v59,v59,s37,-v20
v_max3_f32 v28,v28,v55,v56
M v[64:67],a[224:227],a[168:171],v[64:67]
v_xor_b32 v17,0x38000,v17
v_fma_f32 v60,v60,s37,-v21
v_fma_f32 v61,v61,s37,-v21
M v[68:71],a[224:227],a[172:175],v[68:71]
v_xor_b32 v18,0x38000,v18
L v102,s[8:11],s35 offen offset:2048 nt lds
v_max3_f32 v28,v28,v57,v58
M v[72:75],a[224:227],a[176:179],v[72:75]
s_waitcnt vmcnt(15) lgkmcnt(0)
s_barrier
v_fma_f32 v62,v62,s37,-v21
M v[72:75],a[228:231],a[188:191],v[72:75]
T a[216:217],v5 offset:24576
T a[218:219],v5 offset:30720
v_fma_f32 v63,v63,s37,-v21
M v[68:71],a[228:231],a[184:187],v[68:71]
ds_read_b128 v[76:79],v17
T a[220:221],v6 offset:24576
v_max3_f32 v28,v28,v59,v60
M v[64:67],a[228:231],a[180:183],v[64:67]
T a[222:223],v6 offset:30720
ds_read_b128 v[80:83],v17 offset:2048
v_max3_f32 v28,v28,v61,v62
M v[64:67],a[232:235],a[192:195],v[64:67]
ds_read_b128 v[84:87],v17 offset:4096
T a[224:225],v7 offset:24576
v_max_f32 v28,v28,v63
M v[68:71],a[232:235],a[196:199],v[68:71]
T a[226:227],v7 offset:30720
T a[228:229],v8 offset:24576
M v[72:75],a[232:235],a[200:203],v[72:75]
T a[230:231],v8 offset:30720
T a[232:233],v5 offset:24704
M v[72:75],a[236:239],a[212:215],v[72:75]
T a[234:235],v5 offset:30848
M v[68:71],a[236:239],a[208:211],v[68:71]
M v[64:67],a[236:239],a[204:207],v[64:67]
s_waitcnt lgkmcnt(4)
M a[0:3],a[216:219],v[76:79],a[0:3]
T a[236:237],v6 offset:24704
s_add_u32 m0,s28,0
M a[4:7],a[216:219],v[80:83],a[4:7]
T a[238:239],v6 offset:30848
M a[8:11],a[216:219],v[84:87],a[8:11]
s_add_u32 s35,s29,0xc00
M a[20:23],a[220:223],v[84:87],a[20:23]
T a[216:217],v7 offset:24704
v_fma_f32 v64,v64,s37,-v19
v_fma_f32 v65,v65,s37,-v19
M a[16:19],a[220:223],v[80:83],a[16:19]
T a[218:219],v7 offset:30848
v_fma_f32 v66,v66,s37,-v19
v_fma_f32 v67,v67,s37,-v19
M a[12:15],a[220:223],v[76:79],a[12:15]
L v100,s[4:7],s29 offen nt lds
v_fma_f32 v68,v68,s37,-v20
v_fma_f32 v69,v69,s37,-v20
M a[24:27],a[224:227],v[76:79],a[24:27]
T a[220:221],v8 offset:24704
v_max3_f32 v28,v28,v64,v65
v_fma_f32 v70,v70,s37,-v20
M a[28:31],a[224:227],v[80:83],a[28:31]
T a[222:223],v8 offset:30848
v_fma_f32 v71,v71,s37,-v20
v_max3_f32 v28,v28,v66,v67
M a[32:35],a[224:227],v[84:87],a[32:35]
v_fma_f32 v72,v72,s37,-v21
v_fma_f32 v73,v73,s37,-v21
s_waitcnt lgkmcnt(4)
M a[44:47],a[228:231],v[84:87],a[44:47]
T a[224:225],v5 offset:24832
L v101,s[4:7],s29 offen offset:1024 nt lds
v_max3_f32 v28,v28,v68,v69
M a[40:43],a[228:231],v[80:83],a[40:43]
T a[226:227],v5 offset:30976
v_fma_f32 v74,v74,s37,-v21
v_fma_f32 v75,v75,s37,-v21
M a[36:39],a[228:231],v[76:79],a[36:39]
v_max3_f32 v28,v28,v70,v71
v_max3_f32 v28,v28,v72,v73
v_max3_f32 v28,v28,v74,v75
M a[48:51],a[232:235],v[76:79],a[48:51]
T a[228:229],v6 offset:24832
L v102,s[4:7],s29 offen offset:2048 nt lds
M a[52:55],a[232:235],v[80:83],a[52:55]
T a[230:231],v6 offset:30976
M a[56:59],a[232:235],v[84:87],a[56:59]
v_cmp_lt_f32 vcc,0x41000000,v28
s_cbranch_vccnz C0_35_r
C0_35_b:
M a[68:71],a[236:239],v[84:87],a[68:71]
T a[232:233],v7 offset:24832
s_add_u32 m0,m0,0xc00
M a[64:67],a[236:239],v[80:83],a[64:67]
T a[234:235],v7 offset:30976
v_exp_f32 v52,v52
M a[60:63],a[236:239],v[76:79],a[60:63]
v_exp_f32 v56,v56
s_waitcnt lgkmcnt(4)
M a[72:75],a[216:219],v[76:79],a[72:75]
T a[236:237],v8 offset:24832
v_exp_f32 v60,v60
M a[76:79],a[216:219],v[80:83],a[76:79]
T a[238:239],v8 offset:30976
s_add_u32 s29,s29,0x3000
M a[80:83],a[216:219],v[84:87],a[80:83]
v_exp_f32 v53,v53
M a[92:95],a[220:223],v[84:87],a[92:95]
L v100,s[4:7],s35 offen nt lds
v_exp_f32 v57,v57
M a[88:91],a[220:223],v[80:83],a[88:91]
v_exp_f32 v61,v61
v_add_f32 v22,v22,v52
M a[84:87],a[220:223],v[76:79],a[84:87]
L v101,s[4:7],s35 offen offset:1024 nt lds
v_add_f32 v23,v23,v56
v_add_f32 v24,v24,v60
M a[96:99],a[224:227],v[76:79],a[96:99]
v_exp_f32 v54,v54
M a[100:103],a[224:227],v[80:83],a[100:103]
L v102,s[4:7],s35 offen offset:2048 nt lds
v_exp_f32 v58,v58
M a[104:107],a[224:227],v[84:87],a[104:107]
s_waitcnt vmcnt(12) lgkmcnt(0)
s_barrier
M a[116:119],a[228:231],v[84:87],a[116:119]
T a[216:217],v9
T a[218:219],v9 offset:6144
M a[112:115],a[228:231],v[80:83],a[112:115]
ds_read_b128 v[88:91],v18
T a[220:221],v10
M a[108:111],a[228:231],v[76:79],a[108:111]
T a[222:223],v10 offset:6144
ds_read_b128 v[92:95],v18 offset:2048
M a[120:123],a[232:235],v[76:79],a[120:123]
ds_read_b128 v[96:99],v18 offset:4096
T a[224:225],v11
M a[124:127],a[232:235],v[80:83],a[124:127]
T a[226:227],v11 offset:6144
T a[228:229],v12
M a[128:131],a[232:235],v[84:87],a[128:131]
T a[230:231],v12 offset:6144
T a[232:233],v9 offset:128
M a[140:143],a[236:239],v[84:87],a[140:143]
T a[234:235],v9 offset:6272
v_exp_f32 v62,v62
M a[136:139],a[236:239],v[80:83],a[136:139]
v_add_f32 v22,v22,v53
v_add_f32 v23,v23,v57
v_add_f32 v24,v24,v61
M a[132:135],a[236:239],v[76:79],a[132:135]
C v40,v52,v53
C v44,v56,v57
s_waitcnt lgkmcnt(4)
M a[0:3],a[216:219],v[88:91],a[0:3]
T a[236:237],v10 offset:128
s_add_u32 m0,s28,0x6000
C v48,v60,v61
M a[4:7],a[216:219],v[92:95],a[4:7]
T a[238:239],v10 offset:6272
v_exp_f32 v55,v55
M a[8:11],a[216:219],v[96:99],a[8:11]
v_exp_f32 v59,v59
M a[20:23],a[220:223],v[96:99],a[20:23]
T a[216:217],v11 offset:128
s_add_u32 s35,s31,0x30000
M a[16:19],a[220:223],v[92:95],a[16:19]
T a[218:219],v11 offset:6272
v_exp_f32 v63,v63
M a[12:15],a[220:223],v[88:91],a[12:15]
v_add_f32 v22,v22,v54
v_add_f32 v23,v23,v58
v_add_f32 v24,v24,v62
M a[24:27],a[224:227],v[88:91],a[24:27]
T a[220:221],v12 offset:128
L v103,s[12:15],s31 offen lds
M a[28:31],a[224:227],v[92:95],a[28:31]
T a[222:223],v12 offset:6272
v_exp_f32 v64,v64
M a[32:35],a[224:227],v[96:99],a[32:35]
v_exp_f32 v68,v68
s_waitcnt lgkmcnt(4)
M a[44:47],a[228:231],v[96:99],a[44:47]
T a[224:225],v9 offset:256
v_exp_f32 v72,v72
M a[40:43],a[228:231],v[92:95],a[40:43]
T a[226:227],v9 offset:6400
L v104,s[12:15],s31 offen offset:1024 lds
v_add_f32 v22,v22,v55
M a[36:39],a[228:231],v[88:91],a[36:39]
v_add_f32 v23,v23,v59
v_add_f32 v24,v24,v63
C v41,v54,v55
M a[48:51],a[232:235],v[88:91],a[48:51]
T a[228:229],v10 offset:256
C v45,v58,v59
C v49,v62,v63
M a[52:55],a[232:235],v[92:95],a[52:55]
T a[230:231],v10 offset:6400
v_exp_f32 v65,v65
M a[56:59],a[232:235],v[96:99],a[56:59]
L v105,s[12:15],s31 offen offset:2048 lds
v_exp_f32 v69,v69
M a[68:71],a[236:239],v[96:99],a[68:71]
T a[232:233],v11 offset:256
v_exp_f32 v73,v73
M a[64:67],a[236:239],v[92:95],a[64:67]
T a[234:235],v11 offset:6400
v_add_f32 v22,v22,v64
v_add_f32 v23,v23,v68
M a[60:63],a[236:239],v[88:91],a[60:63]
s_add_u32 m0,m0,0xc00
v_add_f32 v24,v24,v72
s_waitcnt lgkmcnt(4)
M a[72:75],a[216:219],v[88:91],a[72:75]
T a[236:237],v12 offset:256
v_exp_f32 v66,v66
M a[76:79],a[216:219],v[92:95],a[76:79]
T a[238:239],v12 offset:6400
v_exp_f32 v70,v70
M a[80:83],a[216:219],v[96:99],a[80:83]
s_add_u32 s31,s31,0x60000
v_exp_f32 v74,v74
M a[92:95],a[220:223],v[96:99],a[92:95]
v_add_f32 v22,v22,v65
v_add_f32 v23,v23,v69
v_add_f32 v24,v24,v73
M a[88:91],a[220:223],v[92:95],a[88:91]
C v42,v64,v65
C v46,v68,v69
C v50,v72,v73
M a[84:87],a[220:223],v[88:91],a[84:87]
L v103,s[12:15],s35 offen lds
v_exp_f32 v67,v67
M a[96:99],a[224:227],v[88:91],a[96:99]
v_exp_f32 v71,v71
M a[100:103],a[224:227],v[92:95],a[100:103]
L v104,s[12:15],s35 offen offset:1024 lds
v_exp_f32 v75,v75
M a[104:107],a[224:227],v[96:99],a[104:107]
s_waitcnt vmcnt(11) lgkmcnt(0)
s_barrier
v_add_f32 v22,v22,v66
M a[116:119],a[228:231],v[96:99],a[116:119]
T a[216:217],v9 offset:24576
T a[218:219],v9 offset:30720
v_add_f32 v23,v23,v70
M a[112:115],a[228:231],v[92:95],a[112:115]
T a[220:221],v10 offset:24576
T a[222:223],v10 offset:30720
v_add_f32 v24,v24,v74
M a[108:111],a[228:231],v[88:91],a[108:111]
T a[224:225],v11 offset:24576
T a[226:227],v11 offset:30720
C v43,v66,v67
M a[120:123],a[232:235],v[88:91],a[120:123]
T a[228:229],v12 offset:24576
T a[230:231],v12 offset:30720
C v47,v70,v71
M a[124:127],a[232:235],v[92:95],a[124:127]
C v51,v74,v75
v_add_f32 v22,v22,v67
v_add_f32 v23,v23,v71
M a[128:131],a[232:235],v[96:99],a[128:131]
T a[232:233],v9 offset:24704
T a[234:235],v9 offset:30848
v_add_f32 v24,v24,v75
M a[140:143],a[236:239],v[96:99],a[140:143]
L v105,s[12:15],s35 offen offset:2048 lds
M a[136:139],a[236:239],v[92:95],a[136:139]
M a[132:135],a[236:239],v[88:91],a[132:135]
s_waitcnt lgkmcnt(4)
M v[112:115],a[216:219],v[40:43],v[112:115]
T a[236:237],v10 offset:24704
s_add_u32 m0,s28,0xc000
M v[116:119],a[216:219],v[44:47],v[116:119]
T a[238:239],v10 offset:30848
M v[120:123],a[216:219],v[48:51],v[120:123]
s_add_u32 s35,s31,0x30000
M v[132:135],a[220:223],v[48:51],v[132:135]
T a[216:217],v11 offset:24704
M v[128:131],a[220:223],v[44:47],v[128:131]
T a[218:219],v11 offset:30848
M v[124:127],a[220:223],v[40:43],v[124:127]
L v103,s[12:15],s31 offen lds
M v[136:139],a[224:227],v[40:43],v[136:139]
T a[220:221],v12 offset:24704
M v[140:143],a[224:227],v[44:47],v[140:143]
T a[222:223],v12 offset:30848
M v[144:147],a[224:227],v[48:51],v[144:147]
s_waitcnt lgkmcnt(4)
M v[156:159],a[228:231],v[48:51],v[156:159]
T a[224:225],v9 offset:24832
L v104,s[12:15],s31 offen offset:1024 lds
M v[152:155],a[228:231],v[44:47],v[152:155]
T a[226:227],v9 offset:30976
M v[148:151],a[228:231],v[40:43],v[148:151]
M v[160:163],a[232:235],v[40:43],v[160:163]
T a[228:229],v10 offset:24832
L v105,s[12:15],s31 offen offset:2048 lds
M v[164:167],a[232:235],v[44:47],v[164:167]
T a[230:231],v10 offset:30976
M v[168:171],a[232:235],v[48:51],v[168:171]
M v[180:183],a[236:239],v[48:51],v[180:183]
T a[232:233],v11 offset:24832
s_add_u32 m0,m0,0xc00
M v[176:179],a[236:239],v[44:47],v[176:179]
T a[234:235],v11 offset:30976
M v[172:175],a[236:239],v[40:43],v[172:175]
s_waitcnt lgkmcnt(4)
M v[184:187],a[216:219],v[40:43],v[184:187]
T a[236:237],v12 offset:24832
M v[188:191],a[216:219],v[44:47],v[188:191]
T a[238:239],v12 offset:30976
s_add_u32 s31,s31,0x60000
M v[192:195],a[216:219],v[48:51],v[192:195]
M v[204:207],a[220:223],v[48:51],v[204:207]
L v103,s[12:15],s35 offen lds
M v[200:203],a[220:223],v[44:47],v[200:203]
M v[196:199],a[220:223],v[40:43],v[196:199]
L v104,s[12:15],s35 offen offset:1024 lds
M v[208:211],a[224:227],v[40:43],v[208:211]
M v[212:215],a[224:227],v[44:47],v[212:215]
L v105,s[12:15],s35 offen offset:2048 lds
M v[216:219],a[224:227],v[48:51],v[216:219]
s_waitcnt vmcnt(12) lgkmcnt(0)
s_barrier
M v[228:231],a[228:231],v[48:51],v[228:231]
ds_read_b128 a[216:219],v1
ds_read_b128 a[220:223],v2
M v[224:227],a[228:231],v[44:47],v[224:227]
ds_read_b128 a[224:227],v1 offset:128
M v[220:223],a[228:231],v[40:43],v[220:223]
M v[232:235],a[232:235],v[40:43],v[232:235]
ds_read_b128 a[228:231],v2 offset:128
M v[236:239],a[232:235],v[44:47],v[236:239]
M v[240:243],a[232:235],v[48:51],v[240:243]
ds_read_b128 a[232:235],v1 offset:256
M v[252:255],a[236:239],v[48:51],v[252:255]
s_cmp_eq_u32 s31,s39
s_cselect_b32 s31,s38,s31
M v[248:251],a[236:239],v[44:47],v[248:251]
M v[244:247],a[236:239],v[40:43],v[244:247]
s_waitcnt lgkmcnt(2)
M v[52:55],a[216:219],a[144:147],0
ds_read_b128 a[236:239],v2 offset:256
s_add_u32 m0,s28,0x12000
M v[56:59],a[216:219],a[148:151],0
M v[60:63],a[216:219],a[152:155],0
s_add_u32 s35,s30,0xc00
M v[60:63],a[220:223],a[164:167],v[60:63]
ds_read_b128 a[216:219],v1 offset:6144
M v[56:59],a[220:223],a[160:163],v[56:59]
M v[52:55],a[220:223],a[156:159],v[52:55]
L v100,s[8:11],s30 offen nt lds
M v[52:55],a[224:227],a[168:171],v[52:55]
ds_read_b128 a[220:223],v2 offset:6144
M v[56:59],a[224:227],a[172:175],v[56:59]
M v[60:63],a[224:227],a[176:179],v[60:63]
s_waitcnt lgkmcnt(2)
M v[60:63],a[228:231],a[188:191],v[60:63]
ds_read_b128 a[224:227],v1 offset:6272
L v101,s[8:11],s30 offen offset:1024 nt lds
M v[56:59],a[228:231],a[184:187],v[56:59]
M v[52:55],a[228:231],a[180:183],v[52:55]
L v102,s[8:11],s30 offen offset:2048 nt lds
M v[52:55],a[232:235],a[192:195],v[52:55]
ds_read_b128 a[228:231],v2 offset:6272
M v[56:59],a[232:235],a[196:199],v[56:59]
M v[60:63],a[232:235],a[200:203],v[60:63]
s_add_u32 m0,m0,0xc00
M v[60:63],a[236:239],a[212:215],v[60:63]
ds_read_b128 a[232:235],v1 offset:6400
M v[56:59],a[236:239],a[208:211],v[56:59]
M v[52:55],a[236:239],a[204:207],v[52:55]
s_waitcnt lgkmcnt(2)
M v[64:67],a[216:219],a[144:147],0
ds_read_b128 a[236:239],v2 offset:6400
s_add_u32 s30,s30,0x3000
M v[68:71],a[216:219],a[148:151],0
M v[72:75],a[216:219],a[152:155],0
L v100,s[8:11],s35 offen nt lds
s_nop 0
v_fma_f32 v52,v52,s37,-v19
v_fma_f32 v53,v53,s37,-v19
M v[72:75],a[220:223],a[164:167],v[72:75]
v_fma_f32 v54,v54,s37,-v19
v_fma_f32 v55,v55,s37,-v19
v_fma_f32 v56,v56,s37,-v20
M v[68:71],a[220:223],a[160:163],v[68:71]
v_fma_f32 v57,v57,s37,-v20
v_max3_f32 v28,v52,v53,v54
v_fma_f32 v58,v58,s37,-v20
M v[64:67],a[220:223],a[156:159],v[64:67]
L v101,s[8:11],s35 offen offset:1024 nt lds
v_fma_f32 v59,v59,s37,-v20
v_max3_f32 v28,v28,v55,v56
M v[64:67],a[224:227],a[168:171],v[64:67]
v_fma_f32 v60,v60,s37,-v21
v_fma_f32 v61,v61,s37,-v21
v_max3_f32 v28,v28,v57,v58
M v[68:71],a[224:227],a[172:175],v[68:71]
L v102,s[8:11],s35 offen offset:2048 nt lds
v_fma_f32 v62,v62,s37,-v21
v_fma_f32 v63,v63,s37,-v21
M v[72:75],a[224:227],a[176:179],v[72:75]
s_waitcnt vmcnt(12) lgkmcnt(0)
s_barrier
v_max3_f32 v28,v28,v59,v60
M v[72:75],a[228:231],a[188:191],v[72:75]
T a[216:217],v5 offset:24576
T a[218:219],v5 offset:30720
v_max3_f32 v28,v28,v61,v62
M v[68:71],a[228:231],a[184:187],v[68:71]
ds_read_b128 v[76:79],v17 offset:12288
T a[220:221],v6 offset:24576
v_max_f32 v28,v28,v63
M v[64:67],a[228:231],a[180:183],v[64:67]
T a[222:223],v6 offset:30720
ds_read_b128 v[80:83],v17 offset:14336
M v[64:67],a[232:235],a[192:195],v[64:67]
ds_read_b128 v[84:87],v17 offset:16384
T a[224:225],v7 offset:24576
M v[68:71],a[232:235],a[196:199],v[68:71]
T a[226:227],v7 offset:30720
T a[228:229],v8 offset:24576
M v[72:75],a[232:235],a[200:203],v[72:75]
T a[230:231],v8 offset:30720
T a[232:233],v5 offset:24704
M v[72:75],a[236:239],a[212:215],v[72:75]
T a[234:235],v5 offset:30848
M v[68:71],a[236:239],a[208:211],v[68:71]
M v[64:67],a[236:239],a[204:207],v[64:67]
s_waitcnt lgkmcnt(4)
M a[0:3],a[216:219],v[76:79],a[0:3]
T a[236:237],v6 offset:24704
s_add_u32 m0,s28,0
M a[4:7],a[216:219],v[80:83],a[4:7]
T a[238:239],v6 offset:30848
M a[8:11],a[216:219],v[84:87],a[8:11]
s_add_u32 s35,s29,0xc00
M a[20:23],a[220:223],v[84:87],a[20:23]
T a[216:217],v7 offset:24704
L v100,s[4:7],s29 offen nt lds
v_fma_f32 v64,v64,s37,-v19
v_fma_f32 v65,v65,s37,-v19
M a[16:19],a[220:223],v[80:83],a[16:19]
T a[218:219],v7 offset:30848
v_fma_f32 v66,v66,s37,-v19
v_fma_f32 v67,v67,s37,-v19
v_fma_f32 v68,v68,s37,-v20
M a[12:15],a[220:223],v[76:79],a[12:15]
L v101,s[4:7],s29 offen offset:1024 nt lds
v_fma_f32 v69,v69,s37,-v20
v_max3_f32 v28,v28,v64,v65
v_fma_f32 v70,v70,s37,-v20
M a[24:27],a[224:227],v[76:79],a[24:27]
T a[220:221],v8 offset:24704
v_fma_f32 v71,v71,s37,-v20
v_max3_f32 v28,v28,v66,v67
v_fma_f32 v72,v72,s37,-v21
M a[28:31],a[224:227],v[80:83],a[28:31]
T a[222:223],v8 offset:30848
L v102,s[4:7],s29 offen offset:2048 nt lds
v_fma_f32 v73,v73,s37,-v21
v_max3_f32 v28,v28,v68,v69
M a[32:35],a[224:227],v[84:87],a[32:35]
v_fma_f32 v74,v74,s37,-v21
v_fma_f32 v75,v75,s37,-v21
v_max3_f32 v28,v28,v70,v71
s_waitcnt lgkmcnt(4)
M a[44:47],a[228:231],v[84:87],a[44:47]
T a[224:225],v5 offset:24832
s_add_u32 m0,m0,0xc00
v_max3_f32 v28,v28,v72,v73
v_max3_f32 v28,v28,v74,v75
M a[40:43],a[228:231],v[80:83],a[40:43]
T a[226:227],v5 offset:30976
M a[36:39],a[228:231],v[76:79],a[36:39]
s_add_u32 s29,s29,0x3000
M a[48:51],a[232:235],v[76:79],a[48:51]
T a[228:229],v6 offset:24832
M a[52:55],a[232:235],v[80:83],a[52:55]
T a[230:231],v6 offset:30976
L v100,s[4:7],s35 offen nt lds
M a[56:59],a[232:235],v[84:87],a[56:59]
L v101,s[4:7],s35 offen offset:1024 nt lds
M a[68:71],a[236:239],v[84:87],a[68:71]
T a[232:233],v7 offset:24832
M a[64:67],a[236:239],v[80:83],a[64:67]
T a[234:235],v7 offset:30976
M a[60:63],a[236:239],v[76:79],a[60:63]
L v102,s[4:7],s35 offen offset:2048 nt lds
s_waitcnt lgkmcnt(4)
M a[72:75],a[216:219],v[76:79],a[72:75]
T a[236:237],v8 offset:24832
M a[76:79],a[216:219],v[80:83],a[76:79]
T a[238:239],v8 offset:30976
s_add_u32 m0,s34,0
M a[80:83],a[216:219],v[84:87],a[80:83]
L v106,s[20:23],s33 offen lds
M a[92:95],a[220:223],v[84:87],a[92:95]
v_cmp_lt_f32 vcc,0x41000000,v28
s_cbranch_vccnz C0_39_r
C0_39_b:
M a[88:91],a[220:223],v[80:83],a[88:91]
L v107,s[20:23],s33 offen offset:1024 lds
v_exp_f32 v52,v52
M a[84:87],a[220:223],v[76:79],a[84:87]
L v108,s[20:23],s33 offen offset:2048 lds
v_exp_f32 v56,v56
M a[96:99],a[224:227],v[76:79],a[96:99]
s_add_u32 s33,s33,0x80
v_exp_f32 v60,v60
M a[100:103],a[224:227],v[80:83],a[100:103]
v_exp_f32 v53,v53
v_exp_f32 v57,v57
M a[104:107],a[224:227],v[84:87],a[104:107]
s_waitcnt vmcnt(15) lgkmcnt(0)
s_barrier
v_exp_f32 v61,v61
M a[116:119],a[228:231],v[84:87],a[116:119]
T a[216:217],v9
T a[218:219],v9 offset:6144
v_add_f32 v22,v22,v52
v_add_f32 v23,v23,v56
M a[112:115],a[228:231],v[80:83],a[112:115]
ds_read_b128 v[88:91],v18 offset:12288
T a[220:221],v10
v_add_f32 v24,v24,v60
M a[108:111],a[228:231],v[76:79],a[108:111]
T a[222:223],v10 offset:6144
ds_read_b128 v[92:95],v18 offset:14336
v_exp_f32 v54,v54
M a[120:123],a[232:235],v[76:79],a[120:123]
ds_read_b128 v[96:99],v18 offset:16384
T a[224:225],v11
v_exp_f32 v58,v58
M a[124:127],a[232:235],v[80:83],a[124:127]
T a[226:227],v11 offset:6144
T a[228:229],v12
v_exp_f32 v62,v62
M a[128:131],a[232:235],v[84:87],a[128:131]
T a[230:231],v12 offset:6144
T a[232:233],v9 offset:128
v_add_f32 v22,v22,v53
v_add_f32 v23,v23,v57
M a[140:143],a[236:239],v[84:87],a[140:143]
T a[234:235],v9 offset:6272
v_add_f32 v24,v24,v61
C v40,v52,v53
C v44,v56,v57
M a[136:139],a[236:239],v[80:83],a[136:139]
s_cmp_eq_u32 s33,s41
s_cselect_b32 s33,s40,s33
C v48,v60,v61
M a[132:135],a[236:239],v[76:79],a[132:135]
v_exp_f32 v55,v55
s_waitcnt lgkmcnt(4)
M a[0:3],a[216:219],v[88:91],a[0:3]
T a[236:237],v10 offset:128
s_add_u32 m0,s28,0x6000
v_exp_f32 v59,v59
M a[4:7],a[216:219],v[92:95],a[4:7]
T a[238:239],v10 offset:6272
v_exp_f32 v63,v63
v_add_f32 v22,v22,v54
M a[8:11],a[216:219],v[96:99],a[8:11]
s_add_u32 s35,s31,0x30000
v_add_f32 v23,v23,v58
v_add_f32 v24,v24,v62
M a[20:23],a[220:223],v[96:99],a[20:23]
T a[216:217],v11 offset:128
L v103,s[12:15],s31 offen lds
v_exp_f32 v64,v64
M a[16:19],a[220:223],v[92:95],a[16:19]
T a[218:219],v11 offset:6272
v_exp_f32 v68,v68
M a[12:15],a[220:223],v[88:91],a[12:15]
L v104,s[12:15],s31 offen offset:1024 lds
v_exp_f32 v72,v72
v_add_f32 v22,v22,v55
M a[24:27],a[224:227],v[88:91],a[24:27]
T a[220:221],v12 offset:128
v_add_f32 v23,v23,v59
v_add_f32 v24,v24,v63
C v41,v54,v55
M a[28:31],a[224:227],v[92:95],a[28:31]
T a[222:223],v12 offset:6272
L v105,s[12:15],s31 offen offset:2048 lds
C v45,v58,v59
C v49,v62,v63
M a[32:35],a[224:227],v[96:99],a[32:35]
v_exp_f32 v65,v65
s_waitcnt lgkmcnt(4)
M a[44:47],a[228:231],v[96:99],a[44:47]
T a[224:225],v9 offset:256
s_add_u32 m0,m0,0xc00
v_exp_f32 v69,v69
M a[40:43],a[228:231],v[92:95],a[40:43]
T a[226:227],v9 offset:6400
v_exp_f32 v73,v73
v_add_f32 v22,v22,v64
M a[36:39],a[228:231],v[88:91],a[36:39]
s_add_u32 s31,s31,0x60000
v_add_f32 v23,v23,v68
v_add_f32 v24,v24,v72
M a[48:51],a[232:235],v[88:91],a[48:51]
T a[228:229],v10 offset:256
v_exp_f32 v66,v66
M a[52:55],a[232:235],v[92:95],a[52:55]
T a[230:231],v10 offset:6400
L v103,s[12:15],s35 offen lds
v_exp_f32 v70,v70
M a[56:59],a[232:235],v[96:99],a[56:59]
v_exp_f32 v74,v74
v_add_f32 v22,v22,v65
v_add_f32 v23,v23,v69
M a[68:71],a[236:239],v[96:99],a[68:71]
T a[232:233],v11 offset:256
L v104,s[12:15],s35 offen offset:1024 lds
v_add_f32 v24,v24,v73
C v42,v64,v65
M a[64:67],a[236:239],v[92:95],a[64:67]
T a[234:235],v11 offset:6400
C v46,v68,v69
C v50,v72,v73
M a[60:63],a[236:239],v[88:91],a[60:63]
L v105,s[12:15],s35 offen offset:2048 lds
v_exp_f32 v67,v67
s_waitcnt lgkmcnt(4)
M a[72:75],a[216:219],v[88:91],a[72:75]
T a[236:237],v12 offset:256
v_exp_f32 v71,v71
M a[76:79],a[216:219],v[92:95],a[76:79]
T a[238:239],v12 offset:6400
s_add_u32 m0,s34,0x3000
v_exp_f32 v75,v75
M a[80:83],a[216:219],v[96:99],a[80:83]
v_add_f32 v22,v22,v66
v_add_f32 v23,v23,v70
v_add_f32 v24,v24,v74
C v43,v66,v67
M a[92:95],a[220:223],v[96:99],a[92:95]
s_xor_b32 s34,s34,0x38000
C v47,v70,v71
C v51,v74,v75
v_add_f32 v22,v22,v67
M a[88:91],a[220:223],v[92:95],a[88:91]
L v106,s[20:23],s33 offen lds
v_add_f32 v23,v23,v71
v_add_f32 v24,v24,v75
M a[84:87],a[220:223],v[88:91],a[84:87]
L v107,s[20:23],s33 offen offset:1024 lds
M a[96:99],a[224:227],v[88:91],a[96:99]
L v108,s[20:23],s33 offen offset:2048 lds
M a[100:103],a[224:227],v[92:95],a[100:103]
s_add_u32 s33,s33,0x80
M a[104:107],a[224:227],v[96:99],a[104:107]
s_waitcnt vmcnt(18) lgkmcnt(0)
s_barrier
M a[116:119],a[228:231],v[96:99],a[116:119]
T a[216:217],v9 offset:24576
T a[218:219],v9 offset:30720
M a[112:115],a[228:231],v[92:95],a[112:115]
T a[220:221],v10 offset:24576
T a[222:223],v10 offset:30720
M a[108:111],a[228:231],v[88:91],a[108:111]
T a[224:225],v11 offset:24576
T a[226:227],v11 offset:30720
M a[120:123],a[232:235],v[88:91],a[120:123]
T a[228:229],v12 offset:24576
T a[230:231],v12 offset:30720
M a[124:127],a[232:235],v[92:95],a[124:127]
M a[128:131],a[232:235],v[96:99],a[128:131]
T a[232:233],v9 offset:24704
T a[234:235],v9 offset:30848
M a[140:143],a[236:239],v[96:99],a[140:143]
M a[136:139],a[236:239],v[92:95],a[136:139]
s_cmp_eq_u32 s33,s41
s_cselect_b32 s33,s40,s33
M a[132:135],a[236:239],v[88:91],a[132:135]
s_sub_u32 s36,s36,1
s_cmp_lg_u32 s36,0
s_cbranch_scc1 C0_loop2
s_waitcnt lgkmcnt(4)
M v[112:115],a[216:219],v[40:43],v[112:115]
T a[236:237],v10 offset:24704
s_add_u32 m0,s28,0xc000
M v[116:119],a[216:219],v[44:47],v[116:119]
T a[238:239],v10 offset:30848
M v[120:123],a[216:219],v[48:51],v[120:123]
s_add_u32 s35,s31,0x30000
M v[132:135],a[220:223],v[48:51],v[132:135]
T a[216:217],v11 offset:24704
M v[128:131],a[220:223],v[44:47],v[128:131]
T a[218:219],v11 offset:30848
M v[124:127],a[220:223],v[40:43],v[124:127]
L v103,s[12:15],s31 offen lds
M v[136:139],a[224:227],v[40:43],v[136:139]
T a[220:221],v12 offset:24704
M v[140:143],a[224:227],v[44:47],v[140:143]
T a[222:223],v12 offset:30848
M v[144:147],a[224:227],v[48:51],v[144:147]
s_waitcnt lgkmcnt(4)
M v[156:159],a[228:231],v[48:51],v[156:159]
T a[224:225],v9 offset:24832
L v104,s[12:15],s31 offen offset:1024 lds
M v[152:155],a[228:231],v[44:47],v[152:155]
T a[226:227],v9 offset:30976
M v[148:151],a[228:231],v[40:43],v[148:151]
M v[160:163],a[232:235],v[40:43],v[160:163]
T a[228:229],v10 offset:24832
L v105,s[12:15],s31 offen offset:2048 lds
M v[164:167],a[232:235],v[44:47],v[164:167]
T a[230:231],v10 offset:30976
M v[168:171],a[232:235],v[48:51],v[168:171]
M v[180:183],a[236:239],v[48:51],v[180:183]
T a[232:233],v11 offset:24832
s_add_u32 m0,m0,0xc00
M v[176:179],a[236:239],v[44:47],v[176:179]
T a[234:235],v11 offset:30976
M v[172:175],a[236:239],v[40:43],v[172:175]
s_waitcnt lgkmcnt(4)
M v[184:187],a[216:219],v[40:43],v[184:187]
T a[236:237],v12 offset:24832
M v[188:191],a[216:219],v[44:47],v[188:191]
T a[238:239],v12 offset:30976
s_add_u32 s31,s31,0x60000
M v[192:195],a[216:219],v[48:51],v[192:195]
M v[204:207],a[220:223],v[48:51],v[204:207]
L v103,s[12:15],s35 offen lds
M v[200:203],a[220:223],v[44:47],v[200:203]
M v[196:199],a[220:223],v[40:43],v[196:199]
L v104,s[12:15],s35 offen offset:1024 lds
M v[208:211],a[224:227],v[40:43],v[208:211]
M v[212:215],a[224:227],v[44:47],v[212:215]
L v105,s[12:15],s35 offen offset:2048 lds
M v[216:219],a[224:227],v[48:51],v[216:219]
s_waitcnt vmcnt(18) lgkmcnt(0)
s_barrier
M v[228:231],a[228:231],v[48:51],v[228:231]
ds_read_b128 a[216:219],v1
ds_read_b128 a[220:223],v2
M v[224:227],a[228:231],v[44:47],v[224:227]
ds_read_b128 a[224:227],v1 offset:128
M v[220:223],a[228:231],v[40:43],v[220:223]
M v[232:235],a[232:235],v[40:43],v[232:235]
ds_read_b128 a[228:231],v2 offset:128
M v[236:239],a[232:235],v[44:47],v[236:239]
M v[240:243],a[232:235],v[48:51],v[240:243]
ds_read_b128 a[232:235],v1 offset:256
M v[252:255],a[236:239],v[48:51],v[252:255]
s_cmp_eq_u32 s31,s39
s_cselect_b32 s31,s38,s31
M v[248:251],a[236:239],v[44:47],v[248:251]
M v[244:247],a[236:239],v[40:43],v[244:247]
s_waitcnt lgkmcnt(2)
M v[52:55],a[216:219],a[144:147],0
ds_read_b128 a[236:239],v2 offset:256
s_add_u32 m0,s28,0x12000
M v[56:59],a[216:219],a[148:151],0
M v[60:63],a[216:219],a[152:155],0
s_add_u32 s35,s30,0xc00
M v[60:63],a[220:223],a[164:167],v[60:63]
ds_read_b128 a[216:219],v1 offset:6144
M v[56:59],a[220:223],a[160:163],v[56:59]
M v[52:55],a[220:223],a[156:159],v[52:55]
L v100,s[8:11],s30 offen nt lds
M v[52:55],a[224:227],a[168:171],v[52:55]
ds_read_b128 a[220:223],v2 offset:6144
M v[56:59],a[224:227],a[172:175],v[56:59]
M v[60:63],a[224:227],a[176:179],v[60:63]
L v101,s[8:11],s30 offen offset:1024 nt lds
s_waitcnt lgkmcnt(2)
M v[60:63],a[228:231],a[188:191],v[60:63]
ds_read_b128 a[224:227],v1 offset:6272
M v[56:59],a[228:231],a[184:187],v[56:59]
M v[52:55],a[228:231],a[180:183],v[52:55]
L v102,s[8:11],s30 offen offset:2048 nt lds
M v[52:55],a[232:235],a[192:195],v[52:55]
ds_read_b128 a[228:231],v2 offset:6272
M v[56:59],a[232:235],a[196:199],v[56:59]
M v[60:63],a[232:235],a[200:203],v[60:63]
s_add_u32 m0,m0,0xc00
M v[60:63],a[236:239],a[212:215],v[60:63]
ds_read_b128 a[232:235],v1 offset:6400
M v[56:59],a[236:239],a[208:211],v[56:59]
s_add_u32 s30,s30,0x3000
M v[52:55],a[236:239],a[204:207],v[52:55]
s_waitcnt lgkmcnt(2)
M v[64:67],a[216:219],a[144:147],0
ds_read_b128 a[236:239],v2 offset:6400
M v[68:71],a[216:219],a[148:151],0
M v[72:75],a[216:219],a[152:155],0
L v100,s[8:11],s35 offen nt lds
s_nop 1
v_fma_f32 v52,v52,s37,-v19
v_fma_f32 v53,v53,s37,-v19
M v[72:75],a[220:223],a[164:167],v[72:75]
v_fma_f32 v54,v54,s37,-v19
v_fma_f32 v55,v55,s37,-v19
v_fma_f32 v56,v56,s37,-v20
M v[68:71],a[220:223],a[160:163],v[68:71]
L v101,s[8:11],s35 offen offset:1024 nt lds
v_fma_f32 v57,v57,s37,-v20
v_max3_f32 v28,v52,v53,v54
M v[64:67],a[220:223],a[156:159],v[64:67]
v_fma_f32 v58,v58,s37,-v20
v_fma_f32 v59,v59,s37,-v20
v_max3_f32 v28,v28,v55,v56
M v[64:67],a[224:227],a[168:171],v[64:67]
v_xor_b32 v17,0x38000,v17
v_fma_f32 v60,v60,s37,-v21
v_fma_f32 v61,v61,s37,-v21
M v[68:71],a[224:227],a[172:175],v[68:71]
v_xor_b32 v18,0x38000,v18
L v102,s[8:11],s35 offen offset:2048 nt lds
v_max3_f32 v28,v28,v57,v58
M v[72:75],a[224:227],a[176:179],v[72:75]
s_waitcnt vmcnt(15) lgkmcnt(0)
s_barrier
v_fma_f32 v62,v62,s37,-v21
M v[72:75],a[228:231],a[188:191],v[72:75]
T a[216:217],v5 offset:24576
T a[218:219],v5 offset:30720
v_fma_f32 v63,v63,s37,-v21
M v[68:71],a[228:231],a[184:187],v[68:71]
ds_read_b128 v[76:79],v17
T a[220:221],v6 offset:24576
v_max3_f32 v28,v28,v59,v60
M v[64:67],a[228:231],a[180:183],v[64:67]
T a[222:223],v6 offset:30720
ds_read_b128 v[80:83],v17 offset:2048
v_max3_f32 v28,v28,v61,v62
M v[64:67],a[232:235],a[192:195],v[64:67]
ds_read_b128 v[84:87],v17 offset:4096
T a[224:225],v7 offset:24576
v_max_f32 v28,v28,v63
M v[68:71],a[232:235],a[196:199],v[68:71]
T a[226:227],v7 offset:30720
T a[228:229],v8 offset:24576
M v[72:75],a[232:235],a[200:203],v[72:75]
T a[230:231],v8 offset:30720
T a[232:233],v5 offset:24704
M v[72:75],a[236:239],a[212:215],v[72:75]
T a[234:235],v5 offset:30848
M v[68:71],a[236:239],a[208:211],v[68:71]
M v[64:67],a[236:239],a[204:207],v[64:67]
s_waitcnt lgkmcnt(4)
M a[0:3],a[216:219],v[76:79],a[0:3]
T a[236:237],v6 offset:24704
s_add_u32 m0,s28,0
M a[4:7],a[216:219],v[80:83],a[4:7]
T a[238:239],v6 offset:30848
M a[8:11],a[216:219],v[84:87],a[8:11]
s_add_u32 s35,s29,0xc00
M a[20:23],a[220:223],v[84:87],a[20:23]
T a[216:217],v7 offset:24704
v_fma_f32 v64,v64,s37,-v19
v_fma_f32 v65,v65,s37,-v19
M a[16:19],a[220:223],v[80:83],a[16:19]
T a[218:219],v7 offset:30848
v_fma_f32 v66,v66,s37,-v19
v_fma_f32 v67,v67,s37,-v19
M a[12:15],a[220:223],v[76:79],a[12:15]
L v100,s[4:7],s29 offen nt lds
v_fma_f32 v68,v68,s37,-v20
v_fma_f32 v69,v69,s37,-v20
M a[24:27],a[224:227],v[76:79],a[24:27]
T a[220:221],v8 offset:24704
v_max3_f32 v28,v28,v64,v65
v_fma_f32 v70,v70,s37,-v20
M a[28:31],a[224:227],v[80:83],a[28:31]
T a[222:223],v8 offset:30848
v_fma_f32 v71,v71,s37,-v20
v_max3_f32 v28,v28,v66,v67
M a[32:35],a[224:227],v[84:87],a[32:35]
v_fma_f32 v72,v72,s37,-v21
v_fma_f32 v73,v73,s37,-v21
s_waitcnt lgkmcnt(4)
M a[44:47],a[228:231],v[84:87],a[44:47]
T a[224:225],v5 offset:24832
L v101,s[4:7],s29 offen offset:1024 nt lds
v_max3_f32 v28,v28,v68,v69
M a[40:43],a[228:231],v[80:83],a[40:43]
T a[226:227],v5 offset:30976
v_fma_f32 v74,v74,s37,-v21
v_fma_f32 v75,v75,s37,-v21
M a[36:39],a[228:231],v[76:79],a[36:39]
v_max3_f32 v28,v28,v70,v71
v_max3_f32 v28,v28,v72,v73
v_max3_f32 v28,v28,v74,v75
M a[48:51],a[232:235],v[76:79],a[48:51]
T a[228:229],v6 offset:24832
L v102,s[4:7],s29 offen offset:2048 nt lds
M a[52:55],a[232:235],v[80:83],a[52:55]
T a[230:231],v6 offset:30976
M a[56:59],a[232:235],v[84:87],a[56:59]
v_cmp_lt_f32 vcc,0x41000000,v28
s_cbranch_vccnz C0_43_r
C0_43_b:
M a[68:71],a[236:239],v[84:87],a[68:71]
T a[232:233],v7 offset:24832
s_add_u32 m0,m0,0xc00
M a[64:67],a[236:239],v[80:83],a[64:67]
T a[234:235],v7 offset:30976
v_exp_f32 v52,v52
M a[60:63],a[236:239],v[76:79],a[60:63]
v_exp_f32 v56,v56
s_waitcnt lgkmcnt(4)
M a[72:75],a[216:219],v[76:79],a[72:75]
T a[236:237],v8 offset:24832
v_exp_f32 v60,v60
M a[76:79],a[216:219],v[80:83],a[76:79]
T a[238:239],v8 offset:30976
s_add_u32 s29,s29,0x3000
M a[80:83],a[216:219],v[84:87],a[80:83]
v_exp_f32 v53,v53
M a[92:95],a[220:223],v[84:87],a[92:95]
L v100,s[4:7],s35 offen nt lds
v_exp_f32 v57,v57
M a[88:91],a[220:223],v[80:83],a[88:91]
v_exp_f32 v61,v61
v_add_f32 v22,v22,v52
M a[84:87],a[220:223],v[76:79],a[84:87]
L v101,s[4:7],s35 offen offset:1024 nt lds
v_add_f32 v23,v23,v56
v_add_f32 v24,v24,v60
M a[96:99],a[224:227],v[76:79],a[96:99]
v_exp_f32 v54,v54
M a[100:103],a[224:227],v[80:83],a[100:103]
L v102,s[4:7],s35 offen offset:2048 nt lds
v_exp_f32 v58,v58
M a[104:107],a[224:227],v[84:87],a[104:107]
s_waitcnt vmcnt(12) lgkmcnt(0)
s_barrier
M a[116:119],a[228:231],v[84:87],a[116:119]
T a[216:217],v9
T a[218:219],v9 offset:6144
M a[112:115],a[228:231],v[80:83],a[112:115]
ds_read_b128 v[88:91],v18
T a[220:221],v10
M a[108:111],a[228:231],v[76:79],a[108:111]
T a[222:223],v10 offset:6144
ds_read_b128 v[92:95],v18 offset:2048
M a[120:123],a[232:235],v[76:79],a[120:123]
ds_read_b128 v[96:99],v18 offset:4096
T a[224:225],v11
M a[124:127],a[232:235],v[80:83],a[124:127]
T a[226:227],v11 offset:6144
T a[228:229],v12
M a[128:131],a[232:235],v[84:87],a[128:131]
T a[230:231],v12 offset:6144
T a[232:233],v9 offset:128
M a[140:143],a[236:239],v[84:87],a[140:143]
T a[234:235],v9 offset:6272
v_exp_f32 v62,v62
M a[136:139],a[236:239],v[80:83],a[136:139]
v_add_f32 v22,v22,v53
v_add_f32 v23,v23,v57
v_add_f32 v24,v24,v61
M a[132:135],a[236:239],v[76:79],a[132:135]
C v40,v52,v53
C v44,v56,v57
s_waitcnt lgkmcnt(4)
M a[0:3],a[216:219],v[88:91],a[0:3]
T a[236:237],v10 offset:128
s_add_u32 m0,s28,0x6000
C v48,v60,v61
M a[4:7],a[216:219],v[92:95],a[4:7]
T a[238:239],v10 offset:6272
v_exp_f32 v55,v55
M a[8:11],a[216:219],v[96:99],a[8:11]
v_exp_f32 v59,v59
M a[20:23],a[220:223],v[96:99],a[20:23]
T a[216:217],v11 offset:128
s_add_u32 s35,s31,0x30000
M a[16:19],a[220:223],v[92:95],a[16:19]
T a[218:219],v11 offset:6272
v_exp_f32 v63,v63
M a[12:15],a[220:223],v[88:91],a[12:15]
v_add_f32 v22,v22,v54
v_add_f32 v23,v23,v58
v_add_f32 v24,v24,v62
M a[24:27],a[224:227],v[88:91],a[24:27]
T a[220:221],v12 offset:128
L v103,s[12:15],s31 offen lds
M a[28:31],a[224:227],v[92:95],a[28:31]
T a[222:223],v12 offset:6272
v_exp_f32 v64,v64
M a[32:35],a[224:227],v[96:99],a[32:35]
v_exp_f32 v68,v68
s_waitcnt lgkmcnt(4)
M a[44:47],a[228:231],v[96:99],a[44:47]
T a[224:225],v9 offset:256
v_exp_f32 v72,v72
M a[40:43],a[228:231],v[92:95],a[40:43]
T a[226:227],v9 offset:6400
L v104,s[12:15],s31 offen offset:1024 lds
v_add_f32 v22,v22,v55
M a[36:39],a[228:231],v[88:91],a[36:39]
v_add_f32 v23,v23,v59
v_add_f32 v24,v24,v63
C v41,v54,v55
M a[48:51],a[232:235],v[88:91],a[48:51]
T a[228:229],v10 offset:256
C v45,v58,v59
C v49,v62,v63
M a[52:55],a[232:235],v[92:95],a[52:55]
T a[230:231],v10 offset:6400
v_exp_f32 v65,v65
M a[56:59],a[232:235],v[96:99],a[56:59]
L v105,s[12:15],s31 offen offset:2048 lds
v_exp_f32 v69,v69
M a[68:71],a[236:239],v[96:99],a[68:71]
T a[232:233],v11 offset:256
v_exp_f32 v73,v73
M a[64:67],a[236:239],v[92:95],a[64:67]
T a[234:235],v11 offset:6400
v_add_f32 v22,v22,v64
v_add_f32 v23,v23,v68
M a[60:63],a[236:239],v[88:91],a[60:63]
s_add_u32 m0,m0,0xc00
v_add_f32 v24,v24,v72
s_waitcnt lgkmcnt(4)
M a[72:75],a[216:219],v[88:91],a[72:75]
T a[236:237],v12 offset:256
v_exp_f32 v66,v66
M a[76:79],a[216:219],v[92:95],a[76:79]
T a[238:239],v12 offset:6400
v_exp_f32 v70,v70
M a[80:83],a[216:219],v[96:99],a[80:83]
s_add_u32 s31,s31,0x60000
v_exp_f32 v74,v74
M a[92:95],a[220:223],v[96:99],a[92:95]
v_add_f32 v22,v22,v65
v_add_f32 v23,v23,v69
v_add_f32 v24,v24,v73
M a[88:91],a[220:223],v[92:95],a[88:91]
C v42,v64,v65
C v46,v68,v69
C v50,v72,v73
M a[84:87],a[220:223],v[88:91],a[84:87]
L v103,s[12:15],s35 offen lds
v_exp_f32 v67,v67
M a[96:99],a[224:227],v[88:91],a[96:99]
v_exp_f32 v71,v71
M a[100:103],a[224:227],v[92:95],a[100:103]
L v104,s[12:15],s35 offen offset:1024 lds
v_exp_f32 v75,v75
M a[104:107],a[224:227],v[96:99],a[104:107]
s_waitcnt vmcnt(11) lgkmcnt(0)
s_barrier
v_add_f32 v22,v22,v66
M a[116:119],a[228:231],v[96:99],a[116:119]
T a[216:217],v9 offset:24576
T a[218:219],v9 offset:30720
v_add_f32 v23,v23,v70
M a[112:115],a[228:231],v[92:95],a[112:115]
T a[220:221],v10 offset:24576
T a[222:223],v10 offset:30720
v_add_f32 v24,v24,v74
M a[108:111],a[228:231],v[88:91],a[108:111]
T a[224:225],v11 offset:24576
T a[226:227],v11 offset:30720
C v43,v66,v67
M a[120:123],a[232:235],v[88:91],a[120:123]
T a[228:229],v12 offset:24576
T a[230:231],v12 offset:30720
C v47,v70,v71
M a[124:127],a[232:235],v[92:95],a[124:127]
C v51,v74,v75
v_add_f32 v22,v22,v67
v_add_f32 v23,v23,v71
M a[128:131],a[232:235],v[96:99],a[128:131]
T a[232:233],v9 offset:24704
T a[234:235],v9 offset:30848
v_add_f32 v24,v24,v75
M a[140:143],a[236:239],v[96:99],a[140:143]
L v105,s[12:15],s35 offen offset:2048 lds
M a[136:139],a[236:239],v[92:95],a[136:139]
M a[132:135],a[236:239],v[88:91],a[132:135]
s_waitcnt lgkmcnt(4)
M v[112:115],a[216:219],v[40:43],v[112:115]
T a[236:237],v10 offset:24704
s_add_u32 m0,s28,0xc000
M v[116:119],a[216:219],v[44:47],v[116:119]
T a[238:239],v10 offset:30848
M v[120:123],a[216:219],v[48:51],v[120:123]
s_add_u32 s35,s31,0x30000
M v[132:135],a[220:223],v[48:51],v[132:135]
T a[216:217],v11 offset:24704
M v[128:131],a[220:223],v[44:47],v[128:131]
T a[218:219],v11 offset:30848
M v[124:127],a[220:223],v[40:43],v[124:127]
L v103,s[12:15],s31 offen lds
M v[136:139],a[224:227],v[40:43],v[136:139]
T a[220:221],v12 offset:24704
M v[140:143],a[224:227],v[44:47],v[140:143]
T a[222:223],v12 offset:30848
L v104,s[12:15],s31 offen offset:1024 lds
M v[144:147],a[224:227],v[48:51],v[144:147]
s_waitcnt lgkmcnt(4)
M v[156:159],a[228:231],v[48:51],v[156:159]
T a[224:225],v9 offset:24832
M v[152:155],a[228:231],v[44:47],v[152:155]
T a[226:227],v9 offset:30976
L v105,s[12:15],s31 offen offset:2048 lds
M v[148:151],a[228:231],v[40:43],v[148:151]
M v[160:163],a[232:235],v[40:43],v[160:163]
T a[228:229],v10 offset:24832
s_add_u32 m0,m0,0xc00
M v[164:167],a[232:235],v[44:47],v[164:167]
T a[230:231],v10 offset:30976
M v[168:171],a[232:235],v[48:51],v[168:171]
M v[180:183],a[236:239],v[48:51],v[180:183]
T a[232:233],v11 offset:24832
s_add_u32 s31,s31,0x60000
M v[176:179],a[236:239],v[44:47],v[176:179]
T a[234:235],v11 offset:30976
M v[172:175],a[236:239],v[40:43],v[172:175]
s_waitcnt lgkmcnt(4)
M v[184:187],a[216:219],v[40:43],v[184:187]
T a[236:237],v12 offset:24832
L v103,s[12:15],s35 offen lds
M v[188:191],a[216:219],v[44:47],v[188:191]
T a[238:239],v12 offset:30976
M v[192:195],a[216:219],v[48:51],v[192:195]
L v104,s[12:15],s35 offen offset:1024 lds
M v[204:207],a[220:223],v[48:51],v[204:207]
M v[200:203],a[220:223],v[44:47],v[200:203]
L v105,s[12:15],s35 offen offset:2048 lds
M v[196:199],a[220:223],v[40:43],v[196:199]
M v[208:211],a[224:227],v[40:43],v[208:211]
M v[212:215],a[224:227],v[44:47],v[212:215]
s_cmp_eq_u32 s31,s39
s_cselect_b32 s31,s38,s31
M v[216:219],a[224:227],v[48:51],v[216:219]
s_waitcnt vmcnt(12) lgkmcnt(0)
s_barrier
M v[228:231],a[228:231],v[48:51],v[228:231]
ds_read_b128 a[216:219],v1
ds_read_b128 a[220:223],v2
M v[224:227],a[228:231],v[44:47],v[224:227]
ds_read_b128 a[224:227],v1 offset:128
M v[220:223],a[228:231],v[40:43],v[220:223]
s_add_u32 s31,s31,0x180
M v[232:235],a[232:235],v[40:43],v[232:235]
ds_read_b128 a[228:231],v2 offset:128
M v[236:239],a[232:235],v[44:47],v[236:239]
s_add_u32 s38,s38,0x180
M v[240:243],a[232:235],v[48:51],v[240:243]
ds_read_b128 a[232:235],v1 offset:256
M v[252:255],a[236:239],v[48:51],v[252:255]
s_add_u32 s39,s39,0x180
M v[248:251],a[236:239],v[44:47],v[248:251]
M v[244:247],a[236:239],v[40:43],v[244:247]
s_waitcnt lgkmcnt(2)
M v[52:55],a[216:219],a[144:147],0
ds_read_b128 a[236:239],v2 offset:256
s_add_u32 m0,s28,0x12000
M v[56:59],a[216:219],a[148:151],0
M v[60:63],a[216:219],a[152:155],0
s_add_u32 s35,s30,0xc00
M v[60:63],a[220:223],a[164:167],v[60:63]
ds_read_b128 a[216:219],v1 offset:6144
M v[56:59],a[220:223],a[160:163],v[56:59]
M v[52:55],a[220:223],a[156:159],v[52:55]
L v100,s[8:11],s30 offen nt lds
M v[52:55],a[224:227],a[168:171],v[52:55]
ds_read_b128 a[220:223],v2 offset:6144
M v[56:59],a[224:227],a[172:175],v[56:59]
M v[60:63],a[224:227],a[176:179],v[60:63]
s_waitcnt lgkmcnt(2)
M v[60:63],a[228:231],a[188:191],v[60:63]
ds_read_b128 a[224:227],v1 offset:6272
L v101,s[8:11],s30 offen offset:1024 nt lds
M v[56:59],a[228:231],a[184:187],v[56:59]
M v[52:55],a[228:231],a[180:183],v[52:55]
L v102,s[8:11],s30 offen offset:2048 nt lds
M v[52:55],a[232:235],a[192:195],v[52:55]
ds_read_b128 a[228:231],v2 offset:6272
M v[56:59],a[232:235],a[196:199],v[56:59]
M v[60:63],a[232:235],a[200:203],v[60:63]
s_add_u32 m0,m0,0xc00
M v[60:63],a[236:239],a[212:215],v[60:63]
ds_read_b128 a[232:235],v1 offset:6400
M v[56:59],a[236:239],a[208:211],v[56:59]
M v[52:55],a[236:239],a[204:207],v[52:55]
s_waitcnt lgkmcnt(2)
M v[64:67],a[216:219],a[144:147],0
ds_read_b128 a[236:239],v2 offset:6400
s_add_u32 s30,s30,0x3000
M v[68:71],a[216:219],a[148:151],0
M v[72:75],a[216:219],a[152:155],0
L v100,s[8:11],s35 offen nt lds
s_nop 0
v_fma_f32 v52,v52,s37,-v19
v_fma_f32 v53,v53,s37,-v19
M v[72:75],a[220:223],a[164:167],v[72:75]
v_fma_f32 v54,v54,s37,-v19
v_fma_f32 v55,v55,s37,-v19
v_fma_f32 v56,v56,s37,-v20
M v[68:71],a[220:223],a[160:163],v[68:71]
v_fma_f32 v57,v57,s37,-v20
v_max3_f32 v28,v52,v53,v54
v_fma_f32 v58,v58,s37,-v20
M v[64:67],a[220:223],a[156:159],v[64:67]
L v101,s[8:11],s35 offen offset:1024 nt lds
v_fma_f32 v59,v59,s37,-v20
v_max3_f32 v28,v28,v55,v56
M v[64:67],a[224:227],a[168:171],v[64:67]
v_fma_f32 v60,v60,s37,-v21
v_fma_f32 v61,v61,s37,-v21
v_max3_f32 v28,v28,v57,v58
M v[68:71],a[224:227],a[172:175],v[68:71]
L v102,s[8:11],s35 offen offset:2048 nt lds
v_fma_f32 v62,v62,s37,-v21
v_fma_f32 v63,v63,s37,-v21
M v[72:75],a[224:227],a[176:179],v[72:75]
s_waitcnt vmcnt(12) lgkmcnt(0)
s_barrier
v_max3_f32 v28,v28,v59,v60
M v[72:75],a[228:231],a[188:191],v[72:75]
T a[216:217],v5 offset:24576
T a[218:219],v5 offset:30720
v_max3_f32 v28,v28,v61,v62
M v[68:71],a[228:231],a[184:187],v[68:71]
ds_read_b128 v[76:79],v17 offset:12288
T a[220:221],v6 offset:24576
v_max_f32 v28,v28,v63
M v[64:67],a[228:231],a[180:183],v[64:67]
T a[222:223],v6 offset:30720
ds_read_b128 v[80:83],v17 offset:14336
M v[64:67],a[232:235],a[192:195],v[64:67]
ds_read_b128 v[84:87],v17 offset:16384
T a[224:225],v7 offset:24576
M v[68:71],a[232:235],a[196:199],v[68:71]
T a[226:227],v7 offset:30720
T a[228:229],v8 offset:24576
M v[72:75],a[232:235],a[200:203],v[72:75]
T a[230:231],v8 offset:30720
T a[232:233],v5 offset:24704
M v[72:75],a[236:239],a[212:215],v[72:75]
T a[234:235],v5 offset:30848
M v[68:71],a[236:239],a[208:211],v[68:71]
M v[64:67],a[236:239],a[204:207],v[64:67]
s_waitcnt lgkmcnt(4)
M a[0:3],a[216:219],v[76:79],a[0:3]
T a[236:237],v6 offset:24704
s_add_u32 m0,s28,0
M a[4:7],a[216:219],v[80:83],a[4:7]
T a[238:239],v6 offset:30848
M a[8:11],a[216:219],v[84:87],a[8:11]
s_add_u32 s35,s32,0x7800
M a[20:23],a[220:223],v[84:87],a[20:23]
T a[216:217],v7 offset:24704
v_fma_f32 v64,v64,s37,-v19
v_fma_f32 v65,v65,s37,-v19
M a[16:19],a[220:223],v[80:83],a[16:19]
T a[218:219],v7 offset:30848
v_fma_f32 v66,v66,s37,-v19
v_fma_f32 v67,v67,s37,-v19
M a[12:15],a[220:223],v[76:79],a[12:15]
L v106,s[16:19],s32 offen lds
v_fma_f32 v68,v68,s37,-v20
v_fma_f32 v69,v69,s37,-v20
M a[24:27],a[224:227],v[76:79],a[24:27]
T a[220:221],v8 offset:24704
v_max3_f32 v28,v28,v64,v65
v_fma_f32 v70,v70,s37,-v20
M a[28:31],a[224:227],v[80:83],a[28:31]
T a[222:223],v8 offset:30848
v_fma_f32 v71,v71,s37,-v20
v_max3_f32 v28,v28,v66,v67
M a[32:35],a[224:227],v[84:87],a[32:35]
v_fma_f32 v72,v72,s37,-v21
v_fma_f32 v73,v73,s37,-v21
s_waitcnt lgkmcnt(4)
M a[44:47],a[228:231],v[84:87],a[44:47]
T a[224:225],v5 offset:24832
L v107,s[16:19],s32 offen offset:1024 lds
v_max3_f32 v28,v28,v68,v69
M a[40:43],a[228:231],v[80:83],a[40:43]
T a[226:227],v5 offset:30976
v_fma_f32 v74,v74,s37,-v21
v_fma_f32 v75,v75,s37,-v21
M a[36:39],a[228:231],v[76:79],a[36:39]
v_max3_f32 v28,v28,v70,v71
v_max3_f32 v28,v28,v72,v73
v_max3_f32 v28,v28,v74,v75
M a[48:51],a[232:235],v[76:79],a[48:51]
T a[228:229],v6 offset:24832
L v108,s[16:19],s32 offen offset:2048 lds
M a[52:55],a[232:235],v[80:83],a[52:55]
T a[230:231],v6 offset:30976
M a[56:59],a[232:235],v[84:87],a[56:59]
v_cmp_lt_f32 vcc,0x41000000,v28
s_cbranch_vccnz C0_47_r
C0_47_b:
M a[68:71],a[236:239],v[84:87],a[68:71]
T a[232:233],v7 offset:24832
s_add_u32 m0,m0,0xc00
M a[64:67],a[236:239],v[80:83],a[64:67]
T a[234:235],v7 offset:30976
v_exp_f32 v52,v52
M a[60:63],a[236:239],v[76:79],a[60:63]
v_exp_f32 v56,v56
s_waitcnt lgkmcnt(4)
M a[72:75],a[216:219],v[76:79],a[72:75]
T a[236:237],v8 offset:24832
v_exp_f32 v60,v60
M a[76:79],a[216:219],v[80:83],a[76:79]
T a[238:239],v8 offset:30976
s_add_u32 s32,s32,0x78000
M a[80:83],a[216:219],v[84:87],a[80:83]
v_exp_f32 v53,v53
M a[92:95],a[220:223],v[84:87],a[92:95]
L v106,s[16:19],s35 offen lds
v_exp_f32 v57,v57
M a[88:91],a[220:223],v[80:83],a[88:91]
v_exp_f32 v61,v61
v_add_f32 v22,v22,v52
M a[84:87],a[220:223],v[76:79],a[84:87]
L v107,s[16:19],s35 offen offset:1024 lds
v_add_f32 v23,v23,v56
v_add_f32 v24,v24,v60
M a[96:99],a[224:227],v[76:79],a[96:99]
v_exp_f32 v54,v54
M a[100:103],a[224:227],v[80:83],a[100:103]
L v108,s[16:19],s35 offen offset:2048 lds
v_exp_f32 v58,v58
M a[104:107],a[224:227],v[84:87],a[104:107]
s_waitcnt vmcnt(12) lgkmcnt(0)
s_barrier
M a[116:119],a[228:231],v[84:87],a[116:119]
T a[216:217],v9
T a[218:219],v9 offset:6144
M a[112:115],a[228:231],v[80:83],a[112:115]
ds_read_b128 v[88:91],v18 offset:12288
T a[220:221],v10
M a[108:111],a[228:231],v[76:79],a[108:111]
T a[222:223],v10 offset:6144
ds_read_b128 v[92:95],v18 offset:14336
M a[120:123],a[232:235],v[76:79],a[120:123]
ds_read_b128 v[96:99],v18 offset:16384
T a[224:225],v11
M a[124:127],a[232:235],v[80:83],a[124:127]
T a[226:227],v11 offset:6144
T a[228:229],v12
M a[128:131],a[232:235],v[84:87],a[128:131]
T a[230:231],v12 offset:6144
T a[232:233],v9 offset:128
M a[140:143],a[236:239],v[84:87],a[140:143]
T a[234:235],v9 offset:6272
v_exp_f32 v62,v62
M a[136:139],a[236:239],v[80:83],a[136:139]
v_add_f32 v22,v22,v53
v_add_f32 v23,v23,v57
v_add_f32 v24,v24,v61
M a[132:135],a[236:239],v[76:79],a[132:135]
C v40,v52,v53
C v44,v56,v57
s_waitcnt lgkmcnt(4)
M a[0:3],a[216:219],v[88:91],a[0:3]
T a[236:237],v10 offset:128
s_add_u32 m0,s28,0x6000
C v48,v60,v61
M a[4:7],a[216:219],v[92:95],a[4:7]
T a[238:239],v10 offset:6272
v_exp_f32 v55,v55
M a[8:11],a[216:219],v[96:99],a[8:11]
s_add_u32 s35,s32,0x7800
v_exp_f32 v59,v59
M a[20:23],a[220:223],v[96:99],a[20:23]
T a[216:217],v11 offset:128
v_exp_f32 v63,v63
M a[16:19],a[220:223],v[92:95],a[16:19]
T a[218:219],v11 offset:6272
v_add_f32 v22,v22,v54
v_add_f32 v23,v23,v58
M a[12:15],a[220:223],v[88:91],a[12:15]
L v106,s[16:19],s32 offen lds
v_add_f32 v24,v24,v62
M a[24:27],a[224:227],v[88:91],a[24:27]
T a[220:221],v12 offset:128
v_exp_f32 v64,v64
M a[28:31],a[224:227],v[92:95],a[28:31]
T a[222:223],v12 offset:6272
v_exp_f32 v68,v68
M a[32:35],a[224:227],v[96:99],a[32:35]
L v107,s[16:19],s32 offen offset:1024 lds
s_waitcnt lgkmcnt(4)
M a[44:47],a[228:231],v[96:99],a[44:47]
T a[224:225],v9 offset:256
v_exp_f32 v72,v72
M a[40:43],a[228:231],v[92:95],a[40:43]
T a[226:227],v9 offset:6400
v_add_f32 v22,v22,v55
v_add_f32 v23,v23,v59
M a[36:39],a[228:231],v[88:91],a[36:39]
L v108,s[16:19],s32 offen offset:2048 lds
v_add_f32 v24,v24,v63
C v41,v54,v55
M a[48:51],a[232:235],v[88:91],a[48:51]
T a[228:229],v10 offset:256
C v45,v58,v59
C v49,v62,v63
M a[52:55],a[232:235],v[92:95],a[52:55]
T a[230:231],v10 offset:6400
v_exp_f32 v65,v65
M a[56:59],a[232:235],v[96:99],a[56:59]
s_add_u32 m0,m0,0xc00
v_exp_f32 v69,v69
M a[68:71],a[236:239],v[96:99],a[68:71]
T a[232:233],v11 offset:256
v_exp_f32 v73,v73
M a[64:67],a[236:239],v[92:95],a[64:67]
T a[234:235],v11 offset:6400
v_add_f32 v22,v22,v64
v_add_f32 v23,v23,v68
M a[60:63],a[236:239],v[88:91],a[60:63]
s_add_u32 s32,s32,0xfff88080
v_add_f32 v24,v24,v72
s_waitcnt lgkmcnt(4)
M a[72:75],a[216:219],v[88:91],a[72:75]
T a[236:237],v12 offset:256
v_exp_f32 v66,v66
M a[76:79],a[216:219],v[92:95],a[76:79]
T a[238:239],v12 offset:6400
v_exp_f32 v70,v70
M a[80:83],a[216:219],v[96:99],a[80:83]
L v106,s[16:19],s35 offen lds
v_exp_f32 v74,v74
M a[92:95],a[220:223],v[96:99],a[92:95]
v_add_f32 v22,v22,v65
v_add_f32 v23,v23,v69
v_add_f32 v24,v24,v73
M a[88:91],a[220:223],v[92:95],a[88:91]
L v107,s[16:19],s35 offen offset:1024 lds
C v42,v64,v65
C v46,v68,v69
M a[84:87],a[220:223],v[88:91],a[84:87]
C v50,v72,v73
v_exp_f32 v67,v67
M a[96:99],a[224:227],v[88:91],a[96:99]
L v108,s[16:19],s35 offen offset:2048 lds
v_exp_f32 v71,v71
M a[100:103],a[224:227],v[92:95],a[100:103]
v_exp_f32 v75,v75
v_add_f32 v22,v22,v66
M a[104:107],a[224:227],v[96:99],a[104:107]
s_waitcnt vmcnt(12) lgkmcnt(0)
s_barrier
v_add_f32 v23,v23,v70
M a[116:119],a[228:231],v[96:99],a[116:119]
T a[216:217],v9 offset:24576
T a[218:219],v9 offset:30720
v_add_f32 v24,v24,v74
M a[112:115],a[228:231],v[92:95],a[112:115]
T a[220:221],v10 offset:24576
T a[222:223],v10 offset:30720
C v43,v66,v67
M a[108:111],a[228:231],v[88:91],a[108:111]
T a[224:225],v11 offset:24576
T a[226:227],v11 offset:30720
C v47,v70,v71
M a[120:123],a[232:235],v[88:91],a[120:123]
T a[228:229],v12 offset:24576
T a[230:231],v12 offset:30720
C v51,v74,v75
M a[124:127],a[232:235],v[92:95],a[124:127]
v_add_f32 v22,v22,v67
v_add_f32 v23,v23,v71
v_add_f32 v24,v24,v75
M a[128:131],a[232:235],v[96:99],a[128:131]
T a[232:233],v9 offset:24704
T a[234:235],v9 offset:30848
M a[140:143],a[236:239],v[96:99],a[140:143]
s_cmp_eq_u32 s32,s43
s_cselect_b32 s32,s42,s32
M a[136:139],a[236:239],v[92:95],a[136:139]
M a[132:135],a[236:239],v[88:91],a[132:135]
s_waitcnt lgkmcnt(4)
M v[112:115],a[216:219],v[40:43],v[112:115]
T a[236:237],v10 offset:24704
s_add_u32 m0,s28,0xc000
M v[116:119],a[216:219],v[44:47],v[116:119]
T a[238:239],v10 offset:30848
M v[120:123],a[216:219],v[48:51],v[120:123]
M v[132:135],a[220:223],v[48:51],v[132:135]
T a[216:217],v11 offset:24704
s_add_u32 s35,s32,0x7800
M v[128:131],a[220:223],v[44:47],v[128:131]
T a[218:219],v11 offset:30848
M v[124:127],a[220:223],v[40:43],v[124:127]
M v[136:139],a[224:227],v[40:43],v[136:139]
T a[220:221],v12 offset:24704
L v106,s[16:19],s32 offen lds
v_mov_b32 v25,v22
v_mov_b32 v26,v23
v_mov_b32 v27,v24
M v[140:143],a[224:227],v[44:47],v[140:143]
T a[222:223],v12 offset:30848
v_permlane32_swap_b32 v22,v25
v_permlane32_swap_b32 v23,v26
v_permlane32_swap_b32 v24,v27
v_add_f32 v22,v22,v25
M v[144:147],a[224:227],v[48:51],v[144:147]
v_add_f32 v23,v23,v26
v_add_f32 v24,v24,v27
v_mov_b32 v25,v22
v_mov_b32 v26,v23
s_waitcnt lgkmcnt(4)
M v[156:159],a[228:231],v[48:51],v[156:159]
T a[224:225],v9 offset:24832
v_mov_b32 v27,v24
v_permlane16_swap_b32 v22,v25
v_permlane16_swap_b32 v23,v26
v_permlane16_swap_b32 v24,v27
M v[152:155],a[228:231],v[44:47],v[152:155]
T a[226:227],v9 offset:30976
L v107,s[16:19],s32 offen offset:1024 lds
v_add_f32 v22,v22,v25
v_add_f32 v23,v23,v26
v_add_f32 v24,v24,v27
M v[148:151],a[228:231],v[40:43],v[148:151]
v_rcp_f32 v30,v22
v_rcp_f32 v32,v23
M v[160:163],a[232:235],v[40:43],v[160:163]
T a[228:229],v10 offset:24832
v_rcp_f32 v34,v24
v_mov_b32 v31,v30
v_mov_b32 v33,v32
M v[164:167],a[232:235],v[44:47],v[164:167]
T a[230:231],v10 offset:30976
v_mov_b32 v35,v34
v_add_u32 v36,s47,v0
v_add_u32 v37,s48,v0
v_add_u32 v38,s49,v0
M v[168:171],a[232:235],v[48:51],v[168:171]
L v108,s[16:19],s32 offen offset:2048 lds
v_mul_f32 v112,v112,v30
v_mul_f32 v113,v113,v30
M v[180:183],a[236:239],v[48:51],v[180:183]
T a[232:233],v11 offset:24832
v_mul_f32 v114,v114,v30
v_mul_f32 v115,v115,v30
M v[176:179],a[236:239],v[44:47],v[176:179]
T a[234:235],v11 offset:30976
v_mul_f32 v124,v124,v30
v_mul_f32 v125,v125,v30
M v[172:175],a[236:239],v[40:43],v[172:175]
s_add_u32 m0,m0,0xc00
v_mul_f32 v126,v126,v30
s_waitcnt lgkmcnt(4)
M v[184:187],a[216:219],v[40:43],v[184:187]
T a[236:237],v12 offset:24832
v_mul_f32 v127,v127,v30
v_mul_f32 v116,v116,v32
M v[188:191],a[216:219],v[44:47],v[188:191]
T a[238:239],v12 offset:30976
v_mul_f32 v117,v117,v32
v_mul_f32 v118,v118,v32
M v[192:195],a[216:219],v[48:51],v[192:195]
s_add_u32 s32,s32,0x78000
v_mul_f32 v119,v119,v32
v_mul_f32 v128,v128,v32
M v[204:207],a[220:223],v[48:51],v[204:207]
v_mul_f32 v129,v129,v32
v_mul_f32 v130,v130,v32
v_mul_f32 v131,v131,v32
M v[200:203],a[220:223],v[44:47],v[200:203]
v_mul_f32 v120,v120,v34
v_mul_f32 v121,v121,v34
v_mul_f32 v122,v122,v34
M v[196:199],a[220:223],v[40:43],v[196:199]
L v106,s[16:19],s35 offen lds
v_mul_f32 v123,v123,v34
v_mul_f32 v132,v132,v34
M v[208:211],a[224:227],v[40:43],v[208:211]
v_mul_f32 v133,v133,v34
v_mul_f32 v134,v134,v34
v_mul_f32 v135,v135,v34
M v[212:215],a[224:227],v[44:47],v[212:215]
L v107,s[16:19],s35 offen offset:1024 lds
C v52,v112,v113
C v53,v114,v115
M v[216:219],a[224:227],v[48:51],v[216:219]
s_waitcnt vmcnt(11) lgkmcnt(0)
s_barrier
C v54,v124,v125
M v[228:231],a[228:231],v[48:51],v[228:231]
T a[216:217],v13
T a[218:219],v13 offset:2048
C v55,v126,v127
M v[224:227],a[228:231],v[44:47],v[224:227]
T a[220:221],v14
T a[222:223],v14 offset:2048
C v56,v116,v117
M v[220:223],a[228:231],v[40:43],v[220:223]
T a[224:225],v13 offset:4096
T a[226:227],v13 offset:6144
C v57,v118,v119
M v[232:235],a[232:235],v[40:43],v[232:235]
T a[228:229],v14 offset:4096
T a[230:231],v14 offset:6144
C v58,v128,v129
M v[236:239],a[232:235],v[44:47],v[236:239]
C v59,v130,v131
C v60,v120,v121
C v61,v122,v123
M v[240:243],a[232:235],v[48:51],v[240:243]
T a[232:233],v13 offset:8192
T a[234:235],v13 offset:10240
C v62,v132,v133
M v[252:255],a[236:239],v[48:51],v[252:255]
L v108,s[16:19],s35 offen offset:2048 lds
C v63,v134,v135
M v[248:251],a[236:239],v[44:47],v[248:251]
M v[244:247],a[236:239],v[40:43],v[244:247]
ds_write_b128 v36,v[52:55]
ds_write_b128 v36,v[56:59] offset:1024
ds_write_b128 v36,v[60:63] offset:2048
v_accvgpr_read_b32 v76,a0
v_accvgpr_read_b32 v77,a1
v_accvgpr_read_b32 v78,a2
v_accvgpr_read_b32 v79,a3
v_accvgpr_read_b32 v80,a12
v_accvgpr_read_b32 v81,a13
v_accvgpr_read_b32 v82,a14
v_accvgpr_read_b32 v83,a15
v_accvgpr_read_b32 v84,a4
v_accvgpr_read_b32 v85,a5
v_accvgpr_read_b32 v86,a6
v_accvgpr_read_b32 v87,a7
v_accvgpr_read_b32 v88,a16
v_accvgpr_read_b32 v89,a17
v_accvgpr_read_b32 v90,a18
v_accvgpr_read_b32 v91,a19
v_accvgpr_read_b32 v92,a8
v_accvgpr_read_b32 v93,a9
v_accvgpr_read_b32 v94,a10
v_accvgpr_read_b32 v95,a11
v_accvgpr_read_b32 v96,a20
v_accvgpr_read_b32 v97,a21
v_accvgpr_read_b32 v98,a22
v_accvgpr_read_b32 v99,a23
C v64,v76,v77
C v65,v78,v79
C v66,v80,v81
C v67,v82,v83
C v68,v84,v85
C v69,v86,v87
C v70,v88,v89
C v71,v90,v91
C v72,v92,v93
C v73,v94,v95
C v74,v96,v97
C v75,v98,v99
v_permlane32_swap_b32 v64,v66
v_permlane32_swap_b32 v65,v67
v_permlane32_swap_b32 v68,v70
v_permlane32_swap_b32 v69,v71
v_permlane32_swap_b32 v72,v74
v_permlane32_swap_b32 v73,v75
v_permlane16_swap_b32 v64,v66
v_permlane16_swap_b32 v65,v67
v_permlane16_swap_b32 v68,v70
v_permlane16_swap_b32 v69,v71
v_permlane16_swap_b32 v72,v74
v_permlane16_swap_b32 v73,v75
AW a144,v64
AW a145,v65
AW a146,v66
AW a147,v67
AW a148,v68
AW a149,v69
AW a150,v70
AW a151,v71
AW a152,v72
AW a153,v73
AW a154,v74
AW a155,v75
v_accvgpr_read_b32 v76,a24
v_accvgpr_read_b32 v77,a25
v_accvgpr_read_b32 v78,a26
v_accvgpr_read_b32 v79,a27
v_accvgpr_read_b32 v80,a36
v_accvgpr_read_b32 v81,a37
v_accvgpr_read_b32 v82,a38
v_accvgpr_read_b32 v83,a39
v_accvgpr_read_b32 v84,a28
v_accvgpr_read_b32 v85,a29
v_accvgpr_read_b32 v86,a30
v_accvgpr_read_b32 v87,a31
v_accvgpr_read_b32 v88,a40
v_accvgpr_read_b32 v89,a41
v_accvgpr_read_b32 v90,a42
v_accvgpr_read_b32 v91,a43
v_accvgpr_read_b32 v92,a32
v_accvgpr_read_b32 v93,a33
v_accvgpr_read_b32 v94,a34
v_accvgpr_read_b32 v95,a35
v_accvgpr_read_b32 v96,a44
v_accvgpr_read_b32 v97,a45
v_accvgpr_read_b32 v98,a46
v_accvgpr_read_b32 v99,a47
C v64,v76,v77
C v65,v78,v79
C v66,v80,v81
C v67,v82,v83
C v68,v84,v85
C v69,v86,v87
C v70,v88,v89
C v71,v90,v91
C v72,v92,v93
C v73,v94,v95
C v74,v96,v97
C v75,v98,v99
v_permlane32_swap_b32 v64,v66
v_permlane32_swap_b32 v65,v67
v_permlane32_swap_b32 v68,v70
v_permlane32_swap_b32 v69,v71
v_permlane32_swap_b32 v72,v74
v_permlane32_swap_b32 v73,v75
v_permlane16_swap_b32 v64,v66
v_permlane16_swap_b32 v65,v67
v_permlane16_swap_b32 v68,v70
v_permlane16_swap_b32 v69,v71
v_permlane16_swap_b32 v72,v74
v_permlane16_swap_b32 v73,v75
AW a156,v64
AW a157,v65
AW a158,v66
AW a159,v67
AW a160,v68
AW a161,v69
AW a162,v70
AW a163,v71
AW a164,v72
AW a165,v73
AW a166,v74
AW a167,v75
v_accvgpr_read_b32 v76,a48
v_accvgpr_read_b32 v77,a49
v_accvgpr_read_b32 v78,a50
v_accvgpr_read_b32 v79,a51
v_accvgpr_read_b32 v80,a60
v_accvgpr_read_b32 v81,a61
v_accvgpr_read_b32 v82,a62
v_accvgpr_read_b32 v83,a63
v_accvgpr_read_b32 v84,a52
v_accvgpr_read_b32 v85,a53
v_accvgpr_read_b32 v86,a54
v_accvgpr_read_b32 v87,a55
v_accvgpr_read_b32 v88,a64
v_accvgpr_read_b32 v89,a65
v_accvgpr_read_b32 v90,a66
v_accvgpr_read_b32 v91,a67
v_accvgpr_read_b32 v92,a56
v_accvgpr_read_b32 v93,a57
v_accvgpr_read_b32 v94,a58
v_accvgpr_read_b32 v95,a59
v_accvgpr_read_b32 v96,a68
v_accvgpr_read_b32 v97,a69
v_accvgpr_read_b32 v98,a70
v_accvgpr_read_b32 v99,a71
C v64,v76,v77
C v65,v78,v79
C v66,v80,v81
C v67,v82,v83
C v68,v84,v85
C v69,v86,v87
C v70,v88,v89
C v71,v90,v91
C v72,v92,v93
C v73,v94,v95
C v74,v96,v97
C v75,v98,v99
v_permlane32_swap_b32 v64,v66
v_permlane32_swap_b32 v65,v67
v_permlane32_swap_b32 v68,v70
v_permlane32_swap_b32 v69,v71
v_permlane32_swap_b32 v72,v74
v_permlane32_swap_b32 v73,v75
v_permlane16_swap_b32 v64,v66
v_permlane16_swap_b32 v65,v67
v_permlane16_swap_b32 v68,v70
v_permlane16_swap_b32 v69,v71
v_permlane16_swap_b32 v72,v74
v_permlane16_swap_b32 v73,v75
AW a168,v64
AW a169,v65
AW a170,v66
AW a171,v67
AW a172,v68
AW a173,v69
AW a174,v70
AW a175,v71
AW a176,v72
AW a177,v73
AW a178,v74
AW a179,v75
v_accvgpr_read_b32 v76,a72
v_accvgpr_read_b32 v77,a73
v_accvgpr_read_b32 v78,a74
v_accvgpr_read_b32 v79,a75
v_accvgpr_read_b32 v80,a84
v_accvgpr_read_b32 v81,a85
v_accvgpr_read_b32 v82,a86
v_accvgpr_read_b32 v83,a87
v_accvgpr_read_b32 v84,a76
v_accvgpr_read_b32 v85,a77
v_accvgpr_read_b32 v86,a78
v_accvgpr_read_b32 v87,a79
v_accvgpr_read_b32 v88,a88
v_accvgpr_read_b32 v89,a89
v_accvgpr_read_b32 v90,a90
v_accvgpr_read_b32 v91,a91
v_accvgpr_read_b32 v92,a80
v_accvgpr_read_b32 v93,a81
v_accvgpr_read_b32 v94,a82
v_accvgpr_read_b32 v95,a83
v_accvgpr_read_b32 v96,a92
v_accvgpr_read_b32 v97,a93
v_accvgpr_read_b32 v98,a94
v_accvgpr_read_b32 v99,a95
C v64,v76,v77
C v65,v78,v79
C v66,v80,v81
C v67,v82,v83
C v68,v84,v85
C v69,v86,v87
C v70,v88,v89
C v71,v90,v91
C v72,v92,v93
C v73,v94,v95
C v74,v96,v97
C v75,v98,v99
v_permlane32_swap_b32 v64,v66
v_permlane32_swap_b32 v65,v67
v_permlane32_swap_b32 v68,v70
v_permlane32_swap_b32 v69,v71
v_permlane32_swap_b32 v72,v74
v_permlane32_swap_b32 v73,v75
v_permlane16_swap_b32 v64,v66
v_permlane16_swap_b32 v65,v67
v_permlane16_swap_b32 v68,v70
v_permlane16_swap_b32 v69,v71
v_permlane16_swap_b32 v72,v74
v_permlane16_swap_b32 v73,v75
AW a180,v64
AW a181,v65
AW a182,v66
AW a183,v67
AW a184,v68
AW a185,v69
AW a186,v70
AW a187,v71
AW a188,v72
AW a189,v73
AW a190,v74
AW a191,v75
v_accvgpr_read_b32 v76,a96
v_accvgpr_read_b32 v77,a97
v_accvgpr_read_b32 v78,a98
v_accvgpr_read_b32 v79,a99
v_accvgpr_read_b32 v80,a108
v_accvgpr_read_b32 v81,a109
v_accvgpr_read_b32 v82,a110
v_accvgpr_read_b32 v83,a111
v_accvgpr_read_b32 v84,a100
v_accvgpr_read_b32 v85,a101
v_accvgpr_read_b32 v86,a102
v_accvgpr_read_b32 v87,a103
v_accvgpr_read_b32 v88,a112
v_accvgpr_read_b32 v89,a113
v_accvgpr_read_b32 v90,a114
v_accvgpr_read_b32 v91,a115
v_accvgpr_read_b32 v92,a104
v_accvgpr_read_b32 v93,a105
v_accvgpr_read_b32 v94,a106
v_accvgpr_read_b32 v95,a107
v_accvgpr_read_b32 v96,a116
v_accvgpr_read_b32 v97,a117
v_accvgpr_read_b32 v98,a118
v_accvgpr_read_b32 v99,a119
C v64,v76,v77
C v65,v78,v79
C v66,v80,v81
C v67,v82,v83
C v68,v84,v85
C v69,v86,v87
C v70,v88,v89
C v71,v90,v91
C v72,v92,v93
C v73,v94,v95
C v74,v96,v97
C v75,v98,v99
v_permlane32_swap_b32 v64,v66
v_permlane32_swap_b32 v65,v67
v_permlane32_swap_b32 v68,v70
v_permlane32_swap_b32 v69,v71
v_permlane32_swap_b32 v72,v74
v_permlane32_swap_b32 v73,v75
v_permlane16_swap_b32 v64,v66
v_permlane16_swap_b32 v65,v67
v_permlane16_swap_b32 v68,v70
v_permlane16_swap_b32 v69,v71
v_permlane16_swap_b32 v72,v74
v_permlane16_swap_b32 v73,v75
AW a192,v64
AW a193,v65
AW a194,v66
AW a195,v67
AW a196,v68
AW a197,v69
AW a198,v70
AW a199,v71
AW a200,v72
AW a201,v73
AW a202,v74
AW a203,v75
v_accvgpr_read_b32 v76,a120
v_accvgpr_read_b32 v77,a121
v_accvgpr_read_b32 v78,a122
v_accvgpr_read_b32 v79,a123
v_accvgpr_read_b32 v80,a132
v_accvgpr_read_b32 v81,a133
v_accvgpr_read_b32 v82,a134
v_accvgpr_read_b32 v83,a135
v_accvgpr_read_b32 v84,a124
v_accvgpr_read_b32 v85,a125
v_accvgpr_read_b32 v86,a126
v_accvgpr_read_b32 v87,a127
v_accvgpr_read_b32 v88,a136
v_accvgpr_read_b32 v89,a137
v_accvgpr_read_b32 v90,a138
v_accvgpr_read_b32 v91,a139
v_accvgpr_read_b32 v92,a128
v_accvgpr_read_b32 v93,a129
v_accvgpr_read_b32 v94,a130
v_accvgpr_read_b32 v95,a131
v_accvgpr_read_b32 v96,a140
v_accvgpr_read_b32 v97,a141
v_accvgpr_read_b32 v98,a142
v_accvgpr_read_b32 v99,a143
C v64,v76,v77
C v65,v78,v79
C v66,v80,v81
C v67,v82,v83
C v68,v84,v85
C v69,v86,v87
C v70,v88,v89
C v71,v90,v91
C v72,v92,v93
C v73,v94,v95
C v74,v96,v97
C v75,v98,v99
v_permlane32_swap_b32 v64,v66
v_permlane32_swap_b32 v65,v67
v_permlane32_swap_b32 v68,v70
v_permlane32_swap_b32 v69,v71
v_permlane32_swap_b32 v72,v74
v_permlane32_swap_b32 v73,v75
v_permlane16_swap_b32 v64,v66
v_permlane16_swap_b32 v65,v67
v_permlane16_swap_b32 v68,v70
v_permlane16_swap_b32 v69,v71
v_permlane16_swap_b32 v72,v74
v_permlane16_swap_b32 v73,v75
AW a204,v64
AW a205,v65
AW a206,v66
AW a207,v67
AW a208,v68
AW a209,v69
AW a210,v70
AW a211,v71
AW a212,v72
AW a213,v73
AW a214,v74
AW a215,v75
v_pk_mul_f32 v[136:137],v[136:137],v[30:31]
v_pk_mul_f32 v[138:139],v[138:139],v[30:31]
v_pk_mul_f32 v[148:149],v[148:149],v[30:31]
v_pk_mul_f32 v[150:151],v[150:151],v[30:31]
v_pk_mul_f32 v[140:141],v[140:141],v[32:33]
v_pk_mul_f32 v[142:143],v[142:143],v[32:33]
v_pk_mul_f32 v[152:153],v[152:153],v[32:33]
v_pk_mul_f32 v[154:155],v[154:155],v[32:33]
v_pk_mul_f32 v[144:145],v[144:145],v[34:35]
v_pk_mul_f32 v[146:147],v[146:147],v[34:35]
v_pk_mul_f32 v[156:157],v[156:157],v[34:35]
v_pk_mul_f32 v[158:159],v[158:159],v[34:35]
C v64,v136,v137
C v65,v138,v139
C v66,v148,v149
C v67,v150,v151
ds_write_b128 v36,v[64:67] offset:3072
C v68,v140,v141
C v69,v142,v143
C v70,v152,v153
C v71,v154,v155
ds_write_b128 v36,v[68:71] offset:4096
C v72,v144,v145
C v73,v146,v147
C v74,v156,v157
C v75,v158,v159
ds_write_b128 v36,v[72:75] offset:5120
v_pk_mul_f32 v[160:161],v[160:161],v[30:31]
v_pk_mul_f32 v[162:163],v[162:163],v[30:31]
v_pk_mul_f32 v[172:173],v[172:173],v[30:31]
v_pk_mul_f32 v[174:175],v[174:175],v[30:31]
v_pk_mul_f32 v[164:165],v[164:165],v[32:33]
v_pk_mul_f32 v[166:167],v[166:167],v[32:33]
v_pk_mul_f32 v[176:177],v[176:177],v[32:33]
v_pk_mul_f32 v[178:179],v[178:179],v[32:33]
v_pk_mul_f32 v[168:169],v[168:169],v[34:35]
v_pk_mul_f32 v[170:171],v[170:171],v[34:35]
v_pk_mul_f32 v[180:181],v[180:181],v[34:35]
v_pk_mul_f32 v[182:183],v[182:183],v[34:35]
C v52,v160,v161
C v53,v162,v163
C v54,v172,v173
C v55,v174,v175
ds_write_b128 v36,v[52:55] offset:6144
C v56,v164,v165
C v57,v166,v167
C v58,v176,v177
C v59,v178,v179
ds_write_b128 v36,v[56:59] offset:7168
C v60,v168,v169
C v61,v170,v171
C v62,v180,v181
C v63,v182,v183
ds_write_b128 v36,v[60:63] offset:8192
v_pk_mul_f32 v[184:185],v[184:185],v[30:31]
v_pk_mul_f32 v[186:187],v[186:187],v[30:31]
v_pk_mul_f32 v[196:197],v[196:197],v[30:31]
v_pk_mul_f32 v[198:199],v[198:199],v[30:31]
v_pk_mul_f32 v[188:189],v[188:189],v[32:33]
v_pk_mul_f32 v[190:191],v[190:191],v[32:33]
v_pk_mul_f32 v[200:201],v[200:201],v[32:33]
v_pk_mul_f32 v[202:203],v[202:203],v[32:33]
v_pk_mul_f32 v[192:193],v[192:193],v[34:35]
v_pk_mul_f32 v[194:195],v[194:195],v[34:35]
v_pk_mul_f32 v[204:205],v[204:205],v[34:35]
v_pk_mul_f32 v[206:207],v[206:207],v[34:35]
C v64,v184,v185
C v65,v186,v187
C v66,v196,v197
C v67,v198,v199
ds_write_b128 v36,v[64:67] offset:9216
C v68,v188,v189
C v69,v190,v191
C v70,v200,v201
C v71,v202,v203
ds_write_b128 v36,v[68:71] offset:10240
C v72,v192,v193
C v73,v194,v195
C v74,v204,v205
C v75,v206,v207
ds_write_b128 v36,v[72:75] offset:11264
v_pk_mul_f32 v[208:209],v[208:209],v[30:31]
v_pk_mul_f32 v[210:211],v[210:211],v[30:31]
v_pk_mul_f32 v[220:221],v[220:221],v[30:31]
v_pk_mul_f32 v[222:223],v[222:223],v[30:31]
v_pk_mul_f32 v[212:213],v[212:213],v[32:33]
v_pk_mul_f32 v[214:215],v[214:215],v[32:33]
v_pk_mul_f32 v[224:225],v[224:225],v[32:33]
v_pk_mul_f32 v[226:227],v[226:227],v[32:33]
v_pk_mul_f32 v[216:217],v[216:217],v[34:35]
v_pk_mul_f32 v[218:219],v[218:219],v[34:35]
v_pk_mul_f32 v[228:229],v[228:229],v[34:35]
v_pk_mul_f32 v[230:231],v[230:231],v[34:35]
C v52,v208,v209
C v53,v210,v211
C v54,v220,v221
C v55,v222,v223
ds_write_b128 v36,v[52:55] offset:12288
C v56,v212,v213
C v57,v214,v215
C v58,v224,v225
C v59,v226,v227
ds_write_b128 v36,v[56:59] offset:13312
C v60,v216,v217
C v61,v218,v219
C v62,v228,v229
C v63,v230,v231
ds_write_b128 v36,v[60:63] offset:14336
v_pk_mul_f32 v[232:233],v[232:233],v[30:31]
v_pk_mul_f32 v[234:235],v[234:235],v[30:31]
v_pk_mul_f32 v[244:245],v[244:245],v[30:31]
v_pk_mul_f32 v[246:247],v[246:247],v[30:31]
v_pk_mul_f32 v[236:237],v[236:237],v[32:33]
v_pk_mul_f32 v[238:239],v[238:239],v[32:33]
v_pk_mul_f32 v[248:249],v[248:249],v[32:33]
v_pk_mul_f32 v[250:251],v[250:251],v[32:33]
v_pk_mul_f32 v[240:241],v[240:241],v[34:35]
v_pk_mul_f32 v[242:243],v[242:243],v[34:35]
v_pk_mul_f32 v[252:253],v[252:253],v[34:35]
v_pk_mul_f32 v[254:255],v[254:255],v[34:35]
C v64,v232,v233
C v65,v234,v235
C v66,v244,v245
C v67,v246,v247
ds_write_b128 v36,v[64:67] offset:15360
C v68,v236,v237
C v69,v238,v239
C v70,v248,v249
C v71,v250,v251
ds_write_b128 v36,v[68:71] offset:16384
C v72,v240,v241
C v73,v242,v243
C v74,v252,v253
C v75,v254,v255
ds_write_b128 v36,v[72:75] offset:17408
s_waitcnt lgkmcnt(0)
s_barrier
ds_read_b128 v[112:115],v37
ds_read_b128 v[116:119],v37 offset:1024
ds_read_b128 v[120:123],v37 offset:2048
ds_read_b128 v[124:127],v37 offset:3072
ds_read_b128 v[128:131],v37 offset:4096
ds_read_b128 v[132:135],v37 offset:5120
s_waitcnt lgkmcnt(3)
M v[76:79],a[216:219],v[112:115],0
T a[236:237],v14 offset:8192
ds_read_b128 v[136:139],v37 offset:6144
M v[80:83],a[216:219],v[116:119],0
T a[238:239],v14 offset:10240
ds_read_b128 v[140:143],v37 offset:7168
M v[84:87],a[216:219],v[120:123],0
ds_read_b128 v[144:147],v37 offset:8192
ds_read_b128 v[148:151],v37 offset:9216
M v[96:99],a[220:223],v[120:123],0
T a[216:217],v13 offset:12288
ds_read_b128 v[152:155],v37 offset:10240
M v[92:95],a[220:223],v[116:119],0
T a[218:219],v13 offset:14336
ds_read_b128 v[156:159],v37 offset:11264
M v[88:91],a[220:223],v[112:115],0
ds_read_b128 v[160:163],v37 offset:12288
ds_read_b128 v[164:167],v37 offset:13312
s_waitcnt lgkmcnt(12)
M v[76:79],a[224:227],v[124:127],v[76:79]
T a[220:221],v14 offset:12288
ds_read_b128 v[168:171],v37 offset:14336
M v[80:83],a[224:227],v[128:131],v[80:83]
T a[222:223],v14 offset:14336
ds_read_b128 v[172:175],v37 offset:15360
M v[84:87],a[224:227],v[132:135],v[84:87]
ds_read_b128 v[176:179],v37 offset:16384
s_waitcnt lgkmcnt(14)
M v[96:99],a[228:231],v[132:135],v[96:99]
T a[224:225],v13 offset:16384
ds_read_b128 v[180:183],v37 offset:17408
M v[92:95],a[228:231],v[128:131],v[92:95]
T a[226:227],v13 offset:18432
ds_read_b128 v[184:187],v38
M v[88:91],a[228:231],v[124:127],v[88:91]
ds_read_b128 v[188:191],v38 offset:1024
ds_read_b128 v[192:195],v38 offset:2048
s_waitcnt lgkmcnt(15)
M v[76:79],a[232:235],v[136:139],v[76:79]
T a[228:229],v14 offset:16384
ds_read_b128 v[196:199],v38 offset:3072
M v[80:83],a[232:235],v[140:143],v[80:83]
T a[230:231],v14 offset:18432
ds_read_b128 v[200:203],v38 offset:4096
M v[84:87],a[232:235],v[144:147],v[84:87]
ds_read_b128 v[204:207],v38 offset:5120
ds_read_b128 v[208:211],v38 offset:6144
M v[96:99],a[236:239],v[144:147],v[96:99]
T a[232:233],v13 offset:20480
ds_read_b128 v[212:215],v38 offset:7168
M v[92:95],a[236:239],v[140:143],v[92:95]
T a[234:235],v13 offset:22528
ds_read_b128 v[216:219],v38 offset:8192
M v[88:91],a[236:239],v[136:139],v[88:91]
ds_read_b128 v[220:223],v38 offset:9216
s_waitcnt lgkmcnt(14)
M v[76:79],a[216:219],v[148:151],v[76:79]
T a[236:237],v14 offset:20480
ds_read_b128 v[224:227],v38 offset:10240
M v[80:83],a[216:219],v[152:155],v[80:83]
T a[238:239],v14 offset:22528
ds_read_b128 v[228:231],v38 offset:11264
M v[84:87],a[216:219],v[156:159],v[84:87]
ds_read_b128 v[232:235],v38 offset:12288
ds_read_b128 v[236:239],v38 offset:13312
M v[96:99],a[220:223],v[156:159],v[96:99]
ds_read_b128 v[240:243],v38 offset:14336
ds_read_b128 v[244:247],v38 offset:15360
M v[92:95],a[220:223],v[152:155],v[92:95]
ds_read_b128 v[248:251],v38 offset:16384
ds_read_b128 v[252:255],v38 offset:17408
M v[88:91],a[220:223],v[148:151],v[88:91]
M v[76:79],a[224:227],v[160:163],v[76:79]
M v[80:83],a[224:227],v[164:167],v[80:83]
M v[84:87],a[224:227],v[168:171],v[84:87]
s_waitcnt vmcnt(6) lgkmcnt(0)
s_barrier
M v[96:99],a[228:231],v[168:171],v[96:99]
T a[216:217],v13 offset:24576
T a[218:219],v13 offset:26624
M v[92:95],a[228:231],v[164:167],v[92:95]
T a[220:221],v14 offset:24576
T a[222:223],v14 offset:26624
M v[88:91],a[228:231],v[160:163],v[88:91]
T a[224:225],v13 offset:28672
T a[226:227],v13 offset:30720
M v[76:79],a[232:235],v[172:175],v[76:79]
T a[228:229],v14 offset:28672
T a[230:231],v14 offset:30720
M v[80:83],a[232:235],v[176:179],v[80:83]
s_add_u32 m0,s28,0x12000
s_add_u32 s35,s32,0x7800
M v[84:87],a[232:235],v[180:183],v[84:87]
T a[232:233],v13 offset:32768
T a[234:235],v13 offset:34816
M v[96:99],a[236:239],v[180:183],v[96:99]
L v106,s[16:19],s32 offen lds
L v107,s[16:19],s32 offen offset:1024 lds
M v[92:95],a[236:239],v[176:179],v[92:95]
M v[88:91],a[236:239],v[172:175],v[88:91]
s_waitcnt lgkmcnt(4)
M v[76:79],a[216:219],v[184:187],v[76:79]
T a[236:237],v14 offset:32768
L v108,s[16:19],s32 offen offset:2048 lds
M v[80:83],a[216:219],v[188:191],v[80:83]
T a[238:239],v14 offset:34816
M v[84:87],a[216:219],v[192:195],v[84:87]
s_add_u32 m0,m0,0xc00
M v[96:99],a[220:223],v[192:195],v[96:99]
T a[216:217],v13 offset:36864
s_add_u32 s32,s32,0xfff88080
M v[92:95],a[220:223],v[188:191],v[92:95]
T a[218:219],v13 offset:38912
M v[88:91],a[220:223],v[184:187],v[88:91]
L v106,s[16:19],s35 offen lds
M v[76:79],a[224:227],v[196:199],v[76:79]
T a[220:221],v14 offset:36864
M v[80:83],a[224:227],v[200:203],v[80:83]
T a[222:223],v14 offset:38912
L v107,s[16:19],s35 offen offset:1024 lds
M v[84:87],a[224:227],v[204:207],v[84:87]
s_waitcnt lgkmcnt(4)
M v[96:99],a[228:231],v[204:207],v[96:99]
T a[224:225],v13 offset:40960
L v108,s[16:19],s35 offen offset:2048 lds
M v[92:95],a[228:231],v[200:203],v[92:95]
T a[226:227],v13 offset:43008
M v[88:91],a[228:231],v[196:199],v[88:91]
M v[76:79],a[232:235],v[208:211],v[76:79]
T a[228:229],v14 offset:40960
M v[80:83],a[232:235],v[212:215],v[80:83]
T a[230:231],v14 offset:43008
M v[84:87],a[232:235],v[216:219],v[84:87]
s_cmp_eq_u32 s32,s43
s_cselect_b32 s32,s42,s32
M v[96:99],a[236:239],v[216:219],v[96:99]
T a[232:233],v13 offset:45056
s_add_u32 m0,s28,0
M v[92:95],a[236:239],v[212:215],v[92:95]
T a[234:235],v13 offset:47104
M v[88:91],a[236:239],v[208:211],v[88:91]
s_add_u32 s35,s32,0x7800
s_waitcnt lgkmcnt(4)
M v[76:79],a[216:219],v[220:223],v[76:79]
T a[236:237],v14 offset:45056
M v[80:83],a[216:219],v[224:227],v[80:83]
T a[238:239],v14 offset:47104
L v106,s[16:19],s32 offen lds
M v[84:87],a[216:219],v[228:231],v[84:87]
M v[96:99],a[220:223],v[228:231],v[96:99]
L v107,s[16:19],s32 offen offset:1024 lds
M v[92:95],a[220:223],v[224:227],v[92:95]
L v108,s[16:19],s32 offen offset:2048 lds
M v[88:91],a[220:223],v[220:223],v[88:91]
s_add_u32 m0,m0,0xc00
M v[76:79],a[224:227],v[232:235],v[76:79]
s_add_u32 s32,s32,0x78000
M v[80:83],a[224:227],v[236:239],v[80:83]
L v106,s[16:19],s35 offen lds
M v[84:87],a[224:227],v[240:243],v[84:87]
s_waitcnt vmcnt(10) lgkmcnt(0)
s_barrier
M v[96:99],a[228:231],v[240:243],v[96:99]
T a[216:217],v15
T a[218:219],v15 offset:2048
M v[92:95],a[228:231],v[236:239],v[92:95]
T a[220:221],v16
T a[222:223],v16 offset:2048
M v[88:91],a[228:231],v[232:235],v[88:91]
T a[224:225],v15 offset:4096
T a[226:227],v15 offset:6144
M v[76:79],a[232:235],v[244:247],v[76:79]
T a[228:229],v16 offset:4096
T a[230:231],v16 offset:6144
M v[80:83],a[232:235],v[248:251],v[80:83]
M v[84:87],a[232:235],v[252:255],v[84:87]
T a[232:233],v15 offset:8192
T a[234:235],v15 offset:10240
M v[96:99],a[236:239],v[252:255],v[96:99]
L v107,s[16:19],s35 offen offset:1024 lds
M v[92:95],a[236:239],v[248:251],v[92:95]
L v108,s[16:19],s35 offen offset:2048 lds
M v[88:91],a[236:239],v[244:247],v[88:91]
s_waitcnt lgkmcnt(4)
M v[52:55],a[216:219],v[112:115],0
T a[236:237],v16 offset:8192
s_add_u32 m0,s28,0x6000
M v[56:59],a[216:219],v[116:119],0
T a[238:239],v16 offset:10240
M v[60:63],a[216:219],v[120:123],0
s_add_u32 s35,s32,0x7800
M v[72:75],a[220:223],v[120:123],0
T a[216:217],v15 offset:12288
C v40,v76,v77
M v[68:71],a[220:223],v[116:119],0
T a[218:219],v15 offset:14336
L v106,s[16:19],s32 offen lds
M v[64:67],a[220:223],v[112:115],0
C v41,v78,v79
M v[52:55],a[224:227],v[124:127],v[52:55]
T a[220:221],v16 offset:12288
M v[56:59],a[224:227],v[128:131],v[56:59]
T a[222:223],v16 offset:14336
L v107,s[16:19],s32 offen offset:1024 lds
M v[60:63],a[224:227],v[132:135],v[60:63]
C v42,v88,v89
s_waitcnt lgkmcnt(4)
M v[72:75],a[228:231],v[132:135],v[72:75]
T a[224:225],v15 offset:16384
M v[68:71],a[228:231],v[128:131],v[68:71]
T a[226:227],v15 offset:18432
L v108,s[16:19],s32 offen offset:2048 lds
M v[64:67],a[228:231],v[124:127],v[64:67]
C v43,v90,v91
M v[52:55],a[232:235],v[136:139],v[52:55]
T a[228:229],v16 offset:16384
M v[56:59],a[232:235],v[140:143],v[56:59]
T a[230:231],v16 offset:18432
C v44,v80,v81
M v[60:63],a[232:235],v[144:147],v[60:63]
s_add_u32 m0,m0,0xc00
M v[72:75],a[236:239],v[144:147],v[72:75]
T a[232:233],v15 offset:20480
s_add_u32 s32,s32,0xfff88080
M v[68:71],a[236:239],v[140:143],v[68:71]
T a[234:235],v15 offset:22528
C v45,v82,v83
M v[64:67],a[236:239],v[136:139],v[64:67]
s_waitcnt lgkmcnt(4)
M v[52:55],a[216:219],v[148:151],v[52:55]
T a[236:237],v16 offset:20480
M v[56:59],a[216:219],v[152:155],v[56:59]
T a[238:239],v16 offset:22528
C v46,v92,v93
M v[60:63],a[216:219],v[156:159],v[60:63]
L v106,s[16:19],s35 offen lds
M v[72:75],a[220:223],v[156:159],v[72:75]
C v47,v94,v95
L v107,s[16:19],s35 offen offset:1024 lds
M v[68:71],a[220:223],v[152:155],v[68:71]
C v48,v84,v85
M v[64:67],a[220:223],v[148:151],v[64:67]
L v108,s[16:19],s35 offen offset:2048 lds
M v[52:55],a[224:227],v[160:163],v[52:55]
C v49,v86,v87
M v[56:59],a[224:227],v[164:167],v[56:59]
M v[60:63],a[224:227],v[168:171],v[60:63]
s_waitcnt vmcnt(12) lgkmcnt(0)
s_barrier
M v[72:75],a[228:231],v[168:171],v[72:75]
T a[216:217],v15 offset:24576
T a[218:219],v15 offset:26624
M v[68:71],a[228:231],v[164:167],v[68:71]
T a[220:221],v16 offset:24576
T a[222:223],v16 offset:26624
M v[64:67],a[228:231],v[160:163],v[64:67]
T a[224:225],v15 offset:28672
T a[226:227],v15 offset:30720
M v[52:55],a[232:235],v[172:175],v[52:55]
T a[228:229],v16 offset:28672
T a[230:231],v16 offset:30720
M v[56:59],a[232:235],v[176:179],v[56:59]
C v50,v96,v97
M v[60:63],a[232:235],v[180:183],v[60:63]
T a[232:233],v15 offset:32768
T a[234:235],v15 offset:34816
M v[72:75],a[236:239],v[180:183],v[72:75]
C v51,v98,v99
M v[68:71],a[236:239],v[176:179],v[68:71]
s_cmp_eq_u32 s32,s43
s_cselect_b32 s32,s42,s32
M v[64:67],a[236:239],v[172:175],v[64:67]
AW a0,v40
s_waitcnt lgkmcnt(4)
M v[52:55],a[216:219],v[184:187],v[52:55]
T a[236:237],v16 offset:32768
s_add_u32 m0,s28,0xc000
M v[56:59],a[216:219],v[188:191],v[56:59]
T a[238:239],v16 offset:34816
M v[60:63],a[216:219],v[192:195],v[60:63]
AW a1,v41
M v[72:75],a[220:223],v[192:195],v[72:75]
T a[216:217],v15 offset:36864
s_add_u32 s35,s32,0x7800
M v[68:71],a[220:223],v[188:191],v[68:71]
T a[218:219],v15 offset:38912
AW a2,v42
M v[64:67],a[220:223],v[184:187],v[64:67]
M v[52:55],a[224:227],v[196:199],v[52:55]
T a[220:221],v16 offset:36864
L v106,s[16:19],s32 offen lds
M v[56:59],a[224:227],v[200:203],v[56:59]
T a[222:223],v16 offset:38912
AW a3,v43
M v[60:63],a[224:227],v[204:207],v[60:63]
s_waitcnt lgkmcnt(4)
M v[72:75],a[228:231],v[204:207],v[72:75]
T a[224:225],v15 offset:40960
M v[68:71],a[228:231],v[200:203],v[68:71]
T a[226:227],v15 offset:43008
AW a4,v44
M v[64:67],a[228:231],v[196:199],v[64:67]
L v107,s[16:19],s32 offen offset:1024 lds
M v[52:55],a[232:235],v[208:211],v[52:55]
T a[228:229],v16 offset:40960
AW a5,v45
M v[56:59],a[232:235],v[212:215],v[56:59]
T a[230:231],v16 offset:43008
M v[60:63],a[232:235],v[216:219],v[60:63]
AW a6,v46
L v108,s[16:19],s32 offen offset:2048 lds
M v[72:75],a[236:239],v[216:219],v[72:75]
T a[232:233],v15 offset:45056
M v[68:71],a[236:239],v[212:215],v[68:71]
T a[234:235],v15 offset:47104
M v[64:67],a[236:239],v[208:211],v[64:67]
AW a7,v47
s_waitcnt lgkmcnt(4)
M v[52:55],a[216:219],v[220:223],v[52:55]
T a[236:237],v16 offset:45056
s_add_u32 m0,m0,0xc00
M v[56:59],a[216:219],v[224:227],v[56:59]
T a[238:239],v16 offset:47104
M v[60:63],a[216:219],v[228:231],v[60:63]
AW a8,v48
M v[72:75],a[220:223],v[228:231],v[72:75]
s_add_u32 s32,s32,0x78000
M v[68:71],a[220:223],v[224:227],v[68:71]
AW a9,v49
M v[64:67],a[220:223],v[220:223],v[64:67]
AW a10,v50
M v[52:55],a[224:227],v[232:235],v[52:55]
L v106,s[16:19],s35 offen lds
M v[56:59],a[224:227],v[236:239],v[56:59]
AW a11,v51
M v[60:63],a[224:227],v[240:243],v[60:63]
s_waitcnt vmcnt(10) lgkmcnt(0)
s_barrier
M v[72:75],a[228:231],v[240:243],v[72:75]
T a[216:217],v13
T a[218:219],v13 offset:2048
M v[68:71],a[228:231],v[236:239],v[68:71]
T a[220:221],v14
T a[222:223],v14 offset:2048
M v[64:67],a[228:231],v[232:235],v[64:67]
T a[224:225],v13 offset:4096
T a[226:227],v13 offset:6144
M v[52:55],a[232:235],v[244:247],v[52:55]
T a[228:229],v14 offset:4096
T a[230:231],v14 offset:6144
M v[56:59],a[232:235],v[248:251],v[56:59]
L v107,s[16:19],s35 offen offset:1024 lds
M v[60:63],a[232:235],v[252:255],v[60:63]
T a[232:233],v13 offset:8192
T a[234:235],v13 offset:10240
M v[72:75],a[236:239],v[252:255],v[72:75]
L v108,s[16:19],s35 offen offset:2048 lds
M v[68:71],a[236:239],v[248:251],v[68:71]
M v[64:67],a[236:239],v[244:247],v[64:67]
s_waitcnt lgkmcnt(4)
M v[76:79],a[216:219],v[112:115],0
T a[236:237],v14 offset:8192
s_add_u32 m0,s28,0x12000
M v[80:83],a[216:219],v[116:119],0
T a[238:239],v14 offset:10240
M v[84:87],a[216:219],v[120:123],0
s_add_u32 s35,s32,0x7800
M v[96:99],a[220:223],v[120:123],0
T a[216:217],v13 offset:12288
C v40,v52,v53
M v[92:95],a[220:223],v[116:119],0
T a[218:219],v13 offset:14336
L v106,s[16:19],s32 offen lds
M v[88:91],a[220:223],v[112:115],0
C v41,v54,v55
M v[76:79],a[224:227],v[124:127],v[76:79]
T a[220:221],v14 offset:12288
M v[80:83],a[224:227],v[128:131],v[80:83]
T a[222:223],v14 offset:14336
L v107,s[16:19],s32 offen offset:1024 lds
M v[84:87],a[224:227],v[132:135],v[84:87]
C v42,v64,v65
s_waitcnt lgkmcnt(4)
M v[96:99],a[228:231],v[132:135],v[96:99]
T a[224:225],v13 offset:16384
M v[92:95],a[228:231],v[128:131],v[92:95]
T a[226:227],v13 offset:18432
L v108,s[16:19],s32 offen offset:2048 lds
M v[88:91],a[228:231],v[124:127],v[88:91]
C v43,v66,v67
M v[76:79],a[232:235],v[136:139],v[76:79]
T a[228:229],v14 offset:16384
M v[80:83],a[232:235],v[140:143],v[80:83]
T a[230:231],v14 offset:18432
C v44,v56,v57
M v[84:87],a[232:235],v[144:147],v[84:87]
s_add_u32 m0,m0,0xc00
M v[96:99],a[236:239],v[144:147],v[96:99]
T a[232:233],v13 offset:20480
s_add_u32 s32,s32,0xfff88080
M v[92:95],a[236:239],v[140:143],v[92:95]
T a[234:235],v13 offset:22528
C v45,v58,v59
M v[88:91],a[236:239],v[136:139],v[88:91]
s_waitcnt lgkmcnt(4)
M v[76:79],a[216:219],v[148:151],v[76:79]
T a[236:237],v14 offset:20480
M v[80:83],a[216:219],v[152:155],v[80:83]
T a[238:239],v14 offset:22528
C v46,v68,v69
M v[84:87],a[216:219],v[156:159],v[84:87]
L v106,s[16:19],s35 offen lds
M v[96:99],a[220:223],v[156:159],v[96:99]
C v47,v70,v71
L v107,s[16:19],s35 offen offset:1024 lds
M v[92:95],a[220:223],v[152:155],v[92:95]
C v48,v60,v61
M v[88:91],a[220:223],v[148:151],v[88:91]
L v108,s[16:19],s35 offen offset:2048 lds
M v[76:79],a[224:227],v[160:163],v[76:79]
C v49,v62,v63
M v[80:83],a[224:227],v[164:167],v[80:83]
M v[84:87],a[224:227],v[168:171],v[84:87]
s_waitcnt vmcnt(12) lgkmcnt(0)
s_barrier
M v[96:99],a[228:231],v[168:171],v[96:99]
T a[216:217],v13 offset:24576
T a[218:219],v13 offset:26624
M v[92:95],a[228:231],v[164:167],v[92:95]
T a[220:221],v14 offset:24576
T a[222:223],v14 offset:26624
M v[88:91],a[228:231],v[160:163],v[88:91]
T a[224:225],v13 offset:28672
T a[226:227],v13 offset:30720
M v[76:79],a[232:235],v[172:175],v[76:79]
T a[228:229],v14 offset:28672
T a[230:231],v14 offset:30720
M v[80:83],a[232:235],v[176:179],v[80:83]
C v50,v72,v73
M v[84:87],a[232:235],v[180:183],v[84:87]
T a[232:233],v13 offset:32768
T a[234:235],v13 offset:34816
M v[96:99],a[236:239],v[180:183],v[96:99]
C v51,v74,v75
M v[92:95],a[236:239],v[176:179],v[92:95]
s_cmp_eq_u32 s32,s43
s_cselect_b32 s32,s42,s32
M v[88:91],a[236:239],v[172:175],v[88:91]
AW a12,v40
s_waitcnt lgkmcnt(4)
M v[76:79],a[216:219],v[184:187],v[76:79]
T a[236:237],v14 offset:32768
s_add_u32 m0,s28,0
M v[80:83],a[216:219],v[188:191],v[80:83]
T a[238:239],v14 offset:34816
M v[84:87],a[216:219],v[192:195],v[84:87]
AW a13,v41
M v[96:99],a[220:223],v[192:195],v[96:99]
T a[216:217],v13 offset:36864
s_add_u32 s35,s32,0x7800
M v[92:95],a[220:223],v[188:191],v[92:95]
T a[218:219],v13 offset:38912
AW a14,v42
M v[88:91],a[220:223],v[184:187],v[88:91]
M v[76:79],a[224:227],v[196:199],v[76:79]
T a[220:221],v14 offset:36864
L v106,s[16:19],s32 offen lds
M v[80:83],a[224:227],v[200:203],v[80:83]
T a[222:223],v14 offset:38912
AW a15,v43
M v[84:87],a[224:227],v[204:207],v[84:87]
s_waitcnt lgkmcnt(4)
M v[96:99],a[228:231],v[204:207],v[96:99]
T a[224:225],v13 offset:40960
M v[92:95],a[228:231],v[200:203],v[92:95]
T a[226:227],v13 offset:43008
AW a16,v44
M v[88:91],a[228:231],v[196:199],v[88:91]
L v107,s[16:19],s32 offen offset:1024 lds
M v[76:79],a[232:235],v[208:211],v[76:79]
T a[228:229],v14 offset:40960
AW a17,v45
M v[80:83],a[232:235],v[212:215],v[80:83]
T a[230:231],v14 offset:43008
M v[84:87],a[232:235],v[216:219],v[84:87]
AW a18,v46
L v108,s[16:19],s32 offen offset:2048 lds
M v[96:99],a[236:239],v[216:219],v[96:99]
T a[232:233],v13 offset:45056
M v[92:95],a[236:239],v[212:215],v[92:95]
T a[234:235],v13 offset:47104
M v[88:91],a[236:239],v[208:211],v[88:91]
AW a19,v47
s_waitcnt lgkmcnt(4)
M v[76:79],a[216:219],v[220:223],v[76:79]
T a[236:237],v14 offset:45056
s_add_u32 m0,m0,0xc00
M v[80:83],a[216:219],v[224:227],v[80:83]
T a[238:239],v14 offset:47104
M v[84:87],a[216:219],v[228:231],v[84:87]
AW a20,v48
M v[96:99],a[220:223],v[228:231],v[96:99]
s_add_u32 s32,s32,0x78000
M v[92:95],a[220:223],v[224:227],v[92:95]
AW a21,v49
M v[88:91],a[220:223],v[220:223],v[88:91]
AW a22,v50
M v[76:79],a[224:227],v[232:235],v[76:79]
L v106,s[16:19],s35 offen lds
M v[80:83],a[224:227],v[236:239],v[80:83]
AW a23,v51
M v[84:87],a[224:227],v[240:243],v[84:87]
s_waitcnt vmcnt(10) lgkmcnt(0)
s_barrier
M v[96:99],a[228:231],v[240:243],v[96:99]
T a[216:217],v15
T a[218:219],v15 offset:2048
M v[92:95],a[228:231],v[236:239],v[92:95]
T a[220:221],v16
T a[222:223],v16 offset:2048
M v[88:91],a[228:231],v[232:235],v[88:91]
T a[224:225],v15 offset:4096
T a[226:227],v15 offset:6144
M v[76:79],a[232:235],v[244:247],v[76:79]
T a[228:229],v16 offset:4096
T a[230:231],v16 offset:6144
M v[80:83],a[232:235],v[248:251],v[80:83]
L v107,s[16:19],s35 offen offset:1024 lds
M v[84:87],a[232:235],v[252:255],v[84:87]
T a[232:233],v15 offset:8192
T a[234:235],v15 offset:10240
M v[96:99],a[236:239],v[252:255],v[96:99]
L v108,s[16:19],s35 offen offset:2048 lds
M v[92:95],a[236:239],v[248:251],v[92:95]
M v[88:91],a[236:239],v[244:247],v[88:91]
s_waitcnt lgkmcnt(4)
M v[52:55],a[216:219],v[112:115],0
T a[236:237],v16 offset:8192
s_add_u32 m0,s28,0x6000
M v[56:59],a[216:219],v[116:119],0
T a[238:239],v16 offset:10240
M v[60:63],a[216:219],v[120:123],0
s_add_u32 s35,s32,0x7800
M v[72:75],a[220:223],v[120:123],0
T a[216:217],v15 offset:12288
C v40,v76,v77
M v[68:71],a[220:223],v[116:119],0
T a[218:219],v15 offset:14336
L v106,s[16:19],s32 offen lds
M v[64:67],a[220:223],v[112:115],0
C v41,v78,v79
M v[52:55],a[224:227],v[124:127],v[52:55]
T a[220:221],v16 offset:12288
M v[56:59],a[224:227],v[128:131],v[56:59]
T a[222:223],v16 offset:14336
L v107,s[16:19],s32 offen offset:1024 lds
M v[60:63],a[224:227],v[132:135],v[60:63]
C v42,v88,v89
s_waitcnt lgkmcnt(4)
M v[72:75],a[228:231],v[132:135],v[72:75]
T a[224:225],v15 offset:16384
M v[68:71],a[228:231],v[128:131],v[68:71]
T a[226:227],v15 offset:18432
L v108,s[16:19],s32 offen offset:2048 lds
M v[64:67],a[228:231],v[124:127],v[64:67]
C v43,v90,v91
M v[52:55],a[232:235],v[136:139],v[52:55]
T a[228:229],v16 offset:16384
M v[56:59],a[232:235],v[140:143],v[56:59]
T a[230:231],v16 offset:18432
C v44,v80,v81
M v[60:63],a[232:235],v[144:147],v[60:63]
s_add_u32 m0,m0,0xc00
M v[72:75],a[236:239],v[144:147],v[72:75]
T a[232:233],v15 offset:20480
s_add_u32 s32,s32,0xfff88080
M v[68:71],a[236:239],v[140:143],v[68:71]
T a[234:235],v15 offset:22528
C v45,v82,v83
M v[64:67],a[236:239],v[136:139],v[64:67]
s_waitcnt lgkmcnt(4)
M v[52:55],a[216:219],v[148:151],v[52:55]
T a[236:237],v16 offset:20480
M v[56:59],a[216:219],v[152:155],v[56:59]
T a[238:239],v16 offset:22528
C v46,v92,v93
M v[60:63],a[216:219],v[156:159],v[60:63]
L v106,s[16:19],s35 offen lds
M v[72:75],a[220:223],v[156:159],v[72:75]
C v47,v94,v95
L v107,s[16:19],s35 offen offset:1024 lds
M v[68:71],a[220:223],v[152:155],v[68:71]
C v48,v84,v85
M v[64:67],a[220:223],v[148:151],v[64:67]
L v108,s[16:19],s35 offen offset:2048 lds
M v[52:55],a[224:227],v[160:163],v[52:55]
C v49,v86,v87
M v[56:59],a[224:227],v[164:167],v[56:59]
M v[60:63],a[224:227],v[168:171],v[60:63]
s_waitcnt vmcnt(12) lgkmcnt(0)
s_barrier
M v[72:75],a[228:231],v[168:171],v[72:75]
T a[216:217],v15 offset:24576
T a[218:219],v15 offset:26624
M v[68:71],a[228:231],v[164:167],v[68:71]
T a[220:221],v16 offset:24576
T a[222:223],v16 offset:26624
M v[64:67],a[228:231],v[160:163],v[64:67]
T a[224:225],v15 offset:28672
T a[226:227],v15 offset:30720
M v[52:55],a[232:235],v[172:175],v[52:55]
T a[228:229],v16 offset:28672
T a[230:231],v16 offset:30720
M v[56:59],a[232:235],v[176:179],v[56:59]
C v50,v96,v97
M v[60:63],a[232:235],v[180:183],v[60:63]
T a[232:233],v15 offset:32768
T a[234:235],v15 offset:34816
M v[72:75],a[236:239],v[180:183],v[72:75]
C v51,v98,v99
M v[68:71],a[236:239],v[176:179],v[68:71]
s_cmp_eq_u32 s32,s43
s_cselect_b32 s32,s42,s32
M v[64:67],a[236:239],v[172:175],v[64:67]
AW a24,v40
s_waitcnt lgkmcnt(4)
M v[52:55],a[216:219],v[184:187],v[52:55]
T a[236:237],v16 offset:32768
s_add_u32 m0,s28,0xc000
M v[56:59],a[216:219],v[188:191],v[56:59]
T a[238:239],v16 offset:34816
M v[60:63],a[216:219],v[192:195],v[60:63]
AW a25,v41
M v[72:75],a[220:223],v[192:195],v[72:75]
T a[216:217],v15 offset:36864
s_add_u32 s35,s32,0x7800
M v[68:71],a[220:223],v[188:191],v[68:71]
T a[218:219],v15 offset:38912
AW a26,v42
M v[64:67],a[220:223],v[184:187],v[64:67]
M v[52:55],a[224:227],v[196:199],v[52:55]
T a[220:221],v16 offset:36864
L v106,s[16:19],s32 offen lds
M v[56:59],a[224:227],v[200:203],v[56:59]
T a[222:223],v16 offset:38912
AW a27,v43
M v[60:63],a[224:227],v[204:207],v[60:63]
s_waitcnt lgkmcnt(4)
M v[72:75],a[228:231],v[204:207],v[72:75]
T a[224:225],v15 offset:40960
M v[68:71],a[228:231],v[200:203],v[68:71]
T a[226:227],v15 offset:43008
AW a28,v44
M v[64:67],a[228:231],v[196:199],v[64:67]
L v107,s[16:19],s32 offen offset:1024 lds
M v[52:55],a[232:235],v[208:211],v[52:55]
T a[228:229],v16 offset:40960
AW a29,v45
M v[56:59],a[232:235],v[212:215],v[56:59]
T a[230:231],v16 offset:43008
M v[60:63],a[232:235],v[216:219],v[60:63]
AW a30,v46
L v108,s[16:19],s32 offen offset:2048 lds
M v[72:75],a[236:239],v[216:219],v[72:75]
T a[232:233],v15 offset:45056
M v[68:71],a[236:239],v[212:215],v[68:71]
T a[234:235],v15 offset:47104
M v[64:67],a[236:239],v[208:211],v[64:67]
AW a31,v47
s_waitcnt lgkmcnt(4)
M v[52:55],a[216:219],v[220:223],v[52:55]
T a[236:237],v16 offset:45056
s_add_u32 m0,m0,0xc00
M v[56:59],a[216:219],v[224:227],v[56:59]
T a[238:239],v16 offset:47104
M v[60:63],a[216:219],v[228:231],v[60:63]
AW a32,v48
M v[72:75],a[220:223],v[228:231],v[72:75]
s_add_u32 s32,s32,0x78000
M v[68:71],a[220:223],v[224:227],v[68:71]
AW a33,v49
M v[64:67],a[220:223],v[220:223],v[64:67]
AW a34,v50
M v[52:55],a[224:227],v[232:235],v[52:55]
L v106,s[16:19],s35 offen lds
M v[56:59],a[224:227],v[236:239],v[56:59]
AW a35,v51
M v[60:63],a[224:227],v[240:243],v[60:63]
s_waitcnt vmcnt(10) lgkmcnt(0)
s_barrier
M v[72:75],a[228:231],v[240:243],v[72:75]
T a[216:217],v13
T a[218:219],v13 offset:2048
M v[68:71],a[228:231],v[236:239],v[68:71]
T a[220:221],v14
T a[222:223],v14 offset:2048
M v[64:67],a[228:231],v[232:235],v[64:67]
T a[224:225],v13 offset:4096
T a[226:227],v13 offset:6144
M v[52:55],a[232:235],v[244:247],v[52:55]
T a[228:229],v14 offset:4096
T a[230:231],v14 offset:6144
M v[56:59],a[232:235],v[248:251],v[56:59]
L v107,s[16:19],s35 offen offset:1024 lds
M v[60:63],a[232:235],v[252:255],v[60:63]
T a[232:233],v13 offset:8192
T a[234:235],v13 offset:10240
M v[72:75],a[236:239],v[252:255],v[72:75]
L v108,s[16:19],s35 offen offset:2048 lds
M v[68:71],a[236:239],v[248:251],v[68:71]
M v[64:67],a[236:239],v[244:247],v[64:67]
s_waitcnt lgkmcnt(4)
M v[76:79],a[216:219],v[112:115],0
T a[236:237],v14 offset:8192
s_add_u32 m0,s28,0x12000
M v[80:83],a[216:219],v[116:119],0
T a[238:239],v14 offset:10240
M v[84:87],a[216:219],v[120:123],0
s_add_u32 s35,s32,0x7800
M v[96:99],a[220:223],v[120:123],0
T a[216:217],v13 offset:12288
C v40,v52,v53
M v[92:95],a[220:223],v[116:119],0
T a[218:219],v13 offset:14336
L v106,s[16:19],s32 offen lds
M v[88:91],a[220:223],v[112:115],0
C v41,v54,v55
M v[76:79],a[224:227],v[124:127],v[76:79]
T a[220:221],v14 offset:12288
M v[80:83],a[224:227],v[128:131],v[80:83]
T a[222:223],v14 offset:14336
L v107,s[16:19],s32 offen offset:1024 lds
M v[84:87],a[224:227],v[132:135],v[84:87]
C v42,v64,v65
s_waitcnt lgkmcnt(4)
M v[96:99],a[228:231],v[132:135],v[96:99]
T a[224:225],v13 offset:16384
M v[92:95],a[228:231],v[128:131],v[92:95]
T a[226:227],v13 offset:18432
L v108,s[16:19],s32 offen offset:2048 lds
M v[88:91],a[228:231],v[124:127],v[88:91]
C v43,v66,v67
M v[76:79],a[232:235],v[136:139],v[76:79]
T a[228:229],v14 offset:16384
M v[80:83],a[232:235],v[140:143],v[80:83]
T a[230:231],v14 offset:18432
C v44,v56,v57
M v[84:87],a[232:235],v[144:147],v[84:87]
s_add_u32 m0,m0,0xc00
M v[96:99],a[236:239],v[144:147],v[96:99]
T a[232:233],v13 offset:20480
s_add_u32 s32,s32,0xfff88080
M v[92:95],a[236:239],v[140:143],v[92:95]
T a[234:235],v13 offset:22528
C v45,v58,v59
M v[88:91],a[236:239],v[136:139],v[88:91]
s_waitcnt lgkmcnt(4)
M v[76:79],a[216:219],v[148:151],v[76:79]
T a[236:237],v14 offset:20480
M v[80:83],a[216:219],v[152:155],v[80:83]
T a[238:239],v14 offset:22528
C v46,v68,v69
M v[84:87],a[216:219],v[156:159],v[84:87]
L v106,s[16:19],s35 offen lds
M v[96:99],a[220:223],v[156:159],v[96:99]
C v47,v70,v71
L v107,s[16:19],s35 offen offset:1024 lds
M v[92:95],a[220:223],v[152:155],v[92:95]
C v48,v60,v61
M v[88:91],a[220:223],v[148:151],v[88:91]
L v108,s[16:19],s35 offen offset:2048 lds
M v[76:79],a[224:227],v[160:163],v[76:79]
C v49,v62,v63
M v[80:83],a[224:227],v[164:167],v[80:83]
M v[84:87],a[224:227],v[168:171],v[84:87]
s_waitcnt vmcnt(12) lgkmcnt(0)
s_barrier
M v[96:99],a[228:231],v[168:171],v[96:99]
T a[216:217],v13 offset:24576
T a[218:219],v13 offset:26624
M v[92:95],a[228:231],v[164:167],v[92:95]
T a[220:221],v14 offset:24576
T a[222:223],v14 offset:26624
M v[88:91],a[228:231],v[160:163],v[88:91]
T a[224:225],v13 offset:28672
T a[226:227],v13 offset:30720
M v[76:79],a[232:235],v[172:175],v[76:79]
T a[228:229],v14 offset:28672
T a[230:231],v14 offset:30720
M v[80:83],a[232:235],v[176:179],v[80:83]
C v50,v72,v73
M v[84:87],a[232:235],v[180:183],v[84:87]
T a[232:233],v13 offset:32768
T a[234:235],v13 offset:34816
M v[96:99],a[236:239],v[180:183],v[96:99]
C v51,v74,v75
M v[92:95],a[236:239],v[176:179],v[92:95]
s_cmp_eq_u32 s32,s43
s_cselect_b32 s32,s42,s32
M v[88:91],a[236:239],v[172:175],v[88:91]
AW a36,v40
s_waitcnt lgkmcnt(4)
M v[76:79],a[216:219],v[184:187],v[76:79]
T a[236:237],v14 offset:32768
s_add_u32 m0,s28,0
M v[80:83],a[216:219],v[188:191],v[80:83]
T a[238:239],v14 offset:34816
M v[84:87],a[216:219],v[192:195],v[84:87]
AW a37,v41
M v[96:99],a[220:223],v[192:195],v[96:99]
T a[216:217],v13 offset:36864
s_add_u32 s35,s32,0x7800
M v[92:95],a[220:223],v[188:191],v[92:95]
T a[218:219],v13 offset:38912
AW a38,v42
M v[88:91],a[220:223],v[184:187],v[88:91]
M v[76:79],a[224:227],v[196:199],v[76:79]
T a[220:221],v14 offset:36864
L v106,s[16:19],s32 offen lds
M v[80:83],a[224:227],v[200:203],v[80:83]
T a[222:223],v14 offset:38912
AW a39,v43
M v[84:87],a[224:227],v[204:207],v[84:87]
s_waitcnt lgkmcnt(4)
M v[96:99],a[228:231],v[204:207],v[96:99]
T a[224:225],v13 offset:40960
M v[92:95],a[228:231],v[200:203],v[92:95]
T a[226:227],v13 offset:43008
AW a40,v44
M v[88:91],a[228:231],v[196:199],v[88:91]
L v107,s[16:19],s32 offen offset:1024 lds
M v[76:79],a[232:235],v[208:211],v[76:79]
T a[228:229],v14 offset:40960
AW a41,v45
M v[80:83],a[232:235],v[212:215],v[80:83]
T a[230:231],v14 offset:43008
M v[84:87],a[232:235],v[216:219],v[84:87]
AW a42,v46
L v108,s[16:19],s32 offen offset:2048 lds
M v[96:99],a[236:239],v[216:219],v[96:99]
T a[232:233],v13 offset:45056
M v[92:95],a[236:239],v[212:215],v[92:95]
T a[234:235],v13 offset:47104
M v[88:91],a[236:239],v[208:211],v[88:91]
AW a43,v47
s_waitcnt lgkmcnt(4)
M v[76:79],a[216:219],v[220:223],v[76:79]
T a[236:237],v14 offset:45056
s_add_u32 m0,m0,0xc00
M v[80:83],a[216:219],v[224:227],v[80:83]
T a[238:239],v14 offset:47104
M v[84:87],a[216:219],v[228:231],v[84:87]
AW a44,v48
M v[96:99],a[220:223],v[228:231],v[96:99]
s_add_u32 s32,s32,0x78000
M v[92:95],a[220:223],v[224:227],v[92:95]
AW a45,v49
M v[88:91],a[220:223],v[220:223],v[88:91]
AW a46,v50
M v[76:79],a[224:227],v[232:235],v[76:79]
L v106,s[16:19],s35 offen lds
M v[80:83],a[224:227],v[236:239],v[80:83]
AW a47,v51
M v[84:87],a[224:227],v[240:243],v[84:87]
s_waitcnt vmcnt(10) lgkmcnt(0)
s_barrier
M v[96:99],a[228:231],v[240:243],v[96:99]
T a[216:217],v15
T a[218:219],v15 offset:2048
M v[92:95],a[228:231],v[236:239],v[92:95]
T a[220:221],v16
T a[222:223],v16 offset:2048
M v[88:91],a[228:231],v[232:235],v[88:91]
T a[224:225],v15 offset:4096
T a[226:227],v15 offset:6144
M v[76:79],a[232:235],v[244:247],v[76:79]
T a[228:229],v16 offset:4096
T a[230:231],v16 offset:6144
M v[80:83],a[232:235],v[248:251],v[80:83]
L v107,s[16:19],s35 offen offset:1024 lds
M v[84:87],a[232:235],v[252:255],v[84:87]
T a[232:233],v15 offset:8192
T a[234:235],v15 offset:10240
M v[96:99],a[236:239],v[252:255],v[96:99]
L v108,s[16:19],s35 offen offset:2048 lds
M v[92:95],a[236:239],v[248:251],v[92:95]
M v[88:91],a[236:239],v[244:247],v[88:91]
s_waitcnt lgkmcnt(4)
M v[52:55],a[216:219],v[112:115],0
T a[236:237],v16 offset:8192
s_add_u32 m0,s28,0x6000
M v[56:59],a[216:219],v[116:119],0
T a[238:239],v16 offset:10240
M v[60:63],a[216:219],v[120:123],0
s_add_u32 s35,s32,0x7800
M v[72:75],a[220:223],v[120:123],0
T a[216:217],v15 offset:12288
C v40,v76,v77
M v[68:71],a[220:223],v[116:119],0
T a[218:219],v15 offset:14336
L v106,s[16:19],s32 offen lds
M v[64:67],a[220:223],v[112:115],0
C v41,v78,v79
M v[52:55],a[224:227],v[124:127],v[52:55]
T a[220:221],v16 offset:12288
M v[56:59],a[224:227],v[128:131],v[56:59]
T a[222:223],v16 offset:14336
L v107,s[16:19],s32 offen offset:1024 lds
M v[60:63],a[224:227],v[132:135],v[60:63]
C v42,v88,v89
s_waitcnt lgkmcnt(4)
M v[72:75],a[228:231],v[132:135],v[72:75]
T a[224:225],v15 offset:16384
M v[68:71],a[228:231],v[128:131],v[68:71]
T a[226:227],v15 offset:18432
L v108,s[16:19],s32 offen offset:2048 lds
M v[64:67],a[228:231],v[124:127],v[64:67]
C v43,v90,v91
M v[52:55],a[232:235],v[136:139],v[52:55]
T a[228:229],v16 offset:16384
M v[56:59],a[232:235],v[140:143],v[56:59]
T a[230:231],v16 offset:18432
C v44,v80,v81
M v[60:63],a[232:235],v[144:147],v[60:63]
s_add_u32 m0,m0,0xc00
M v[72:75],a[236:239],v[144:147],v[72:75]
T a[232:233],v15 offset:20480
s_add_u32 s32,s32,0xfff88080
M v[68:71],a[236:239],v[140:143],v[68:71]
T a[234:235],v15 offset:22528
C v45,v82,v83
M v[64:67],a[236:239],v[136:139],v[64:67]
s_waitcnt lgkmcnt(4)
M v[52:55],a[216:219],v[148:151],v[52:55]
T a[236:237],v16 offset:20480
M v[56:59],a[216:219],v[152:155],v[56:59]
T a[238:239],v16 offset:22528
C v46,v92,v93
M v[60:63],a[216:219],v[156:159],v[60:63]
L v106,s[16:19],s35 offen lds
M v[72:75],a[220:223],v[156:159],v[72:75]
C v47,v94,v95
L v107,s[16:19],s35 offen offset:1024 lds
M v[68:71],a[220:223],v[152:155],v[68:71]
C v48,v84,v85
M v[64:67],a[220:223],v[148:151],v[64:67]
L v108,s[16:19],s35 offen offset:2048 lds
M v[52:55],a[224:227],v[160:163],v[52:55]
C v49,v86,v87
M v[56:59],a[224:227],v[164:167],v[56:59]
M v[60:63],a[224:227],v[168:171],v[60:63]
s_waitcnt vmcnt(12) lgkmcnt(0)
s_barrier
M v[72:75],a[228:231],v[168:171],v[72:75]
T a[216:217],v15 offset:24576
T a[218:219],v15 offset:26624
M v[68:71],a[228:231],v[164:167],v[68:71]
T a[220:221],v16 offset:24576
T a[222:223],v16 offset:26624
M v[64:67],a[228:231],v[160:163],v[64:67]
T a[224:225],v15 offset:28672
T a[226:227],v15 offset:30720
M v[52:55],a[232:235],v[172:175],v[52:55]
T a[228:229],v16 offset:28672
T a[230:231],v16 offset:30720
M v[56:59],a[232:235],v[176:179],v[56:59]
C v50,v96,v97
M v[60:63],a[232:235],v[180:183],v[60:63]
T a[232:233],v15 offset:32768
T a[234:235],v15 offset:34816
M v[72:75],a[236:239],v[180:183],v[72:75]
C v51,v98,v99
M v[68:71],a[236:239],v[176:179],v[68:71]
s_cmp_eq_u32 s32,s43
s_cselect_b32 s32,s42,s32
M v[64:67],a[236:239],v[172:175],v[64:67]
AW a48,v40
s_waitcnt lgkmcnt(4)
M v[52:55],a[216:219],v[184:187],v[52:55]
T a[236:237],v16 offset:32768
s_add_u32 m0,s28,0xc000
M v[56:59],a[216:219],v[188:191],v[56:59]
T a[238:239],v16 offset:34816
M v[60:63],a[216:219],v[192:195],v[60:63]
AW a49,v41
M v[72:75],a[220:223],v[192:195],v[72:75]
T a[216:217],v15 offset:36864
s_add_u32 s35,s32,0x7800
M v[68:71],a[220:223],v[188:191],v[68:71]
T a[218:219],v15 offset:38912
AW a50,v42
M v[64:67],a[220:223],v[184:187],v[64:67]
M v[52:55],a[224:227],v[196:199],v[52:55]
T a[220:221],v16 offset:36864
L v106,s[16:19],s32 offen lds
M v[56:59],a[224:227],v[200:203],v[56:59]
T a[222:223],v16 offset:38912
AW a51,v43
M v[60:63],a[224:227],v[204:207],v[60:63]
s_waitcnt lgkmcnt(4)
M v[72:75],a[228:231],v[204:207],v[72:75]
T a[224:225],v15 offset:40960
M v[68:71],a[228:231],v[200:203],v[68:71]
T a[226:227],v15 offset:43008
AW a52,v44
M v[64:67],a[228:231],v[196:199],v[64:67]
L v107,s[16:19],s32 offen offset:1024 lds
M v[52:55],a[232:235],v[208:211],v[52:55]
T a[228:229],v16 offset:40960
AW a53,v45
M v[56:59],a[232:235],v[212:215],v[56:59]
T a[230:231],v16 offset:43008
M v[60:63],a[232:235],v[216:219],v[60:63]
AW a54,v46
L v108,s[16:19],s32 offen offset:2048 lds
M v[72:75],a[236:239],v[216:219],v[72:75]
T a[232:233],v15 offset:45056
M v[68:71],a[236:239],v[212:215],v[68:71]
T a[234:235],v15 offset:47104
M v[64:67],a[236:239],v[208:211],v[64:67]
AW a55,v47
s_waitcnt lgkmcnt(4)
M v[52:55],a[216:219],v[220:223],v[52:55]
T a[236:237],v16 offset:45056
s_add_u32 m0,m0,0xc00
M v[56:59],a[216:219],v[224:227],v[56:59]
T a[238:239],v16 offset:47104
M v[60:63],a[216:219],v[228:231],v[60:63]
AW a56,v48
M v[72:75],a[220:223],v[228:231],v[72:75]
s_add_u32 s32,s32,0x78000
M v[68:71],a[220:223],v[224:227],v[68:71]
AW a57,v49
M v[64:67],a[220:223],v[220:223],v[64:67]
AW a58,v50
M v[52:55],a[224:227],v[232:235],v[52:55]
L v106,s[16:19],s35 offen lds
M v[56:59],a[224:227],v[236:239],v[56:59]
AW a59,v51
M v[60:63],a[224:227],v[240:243],v[60:63]
s_waitcnt vmcnt(10) lgkmcnt(0)
s_barrier
M v[72:75],a[228:231],v[240:243],v[72:75]
T a[216:217],v13
T a[218:219],v13 offset:2048
M v[68:71],a[228:231],v[236:239],v[68:71]
T a[220:221],v14
T a[222:223],v14 offset:2048
M v[64:67],a[228:231],v[232:235],v[64:67]
T a[224:225],v13 offset:4096
T a[226:227],v13 offset:6144
M v[52:55],a[232:235],v[244:247],v[52:55]
T a[228:229],v14 offset:4096
T a[230:231],v14 offset:6144
M v[56:59],a[232:235],v[248:251],v[56:59]
L v107,s[16:19],s35 offen offset:1024 lds
M v[60:63],a[232:235],v[252:255],v[60:63]
T a[232:233],v13 offset:8192
T a[234:235],v13 offset:10240
M v[72:75],a[236:239],v[252:255],v[72:75]
L v108,s[16:19],s35 offen offset:2048 lds
M v[68:71],a[236:239],v[248:251],v[68:71]
M v[64:67],a[236:239],v[244:247],v[64:67]
s_waitcnt lgkmcnt(4)
M v[76:79],a[216:219],v[112:115],0
T a[236:237],v14 offset:8192
s_add_u32 m0,s28,0x12000
M v[80:83],a[216:219],v[116:119],0
T a[238:239],v14 offset:10240
M v[84:87],a[216:219],v[120:123],0
s_add_u32 s35,s32,0x7800
M v[96:99],a[220:223],v[120:123],0
T a[216:217],v13 offset:12288
C v40,v52,v53
M v[92:95],a[220:223],v[116:119],0
T a[218:219],v13 offset:14336
L v106,s[16:19],s32 offen lds
M v[88:91],a[220:223],v[112:115],0
C v41,v54,v55
M v[76:79],a[224:227],v[124:127],v[76:79]
T a[220:221],v14 offset:12288
M v[80:83],a[224:227],v[128:131],v[80:83]
T a[222:223],v14 offset:14336
L v107,s[16:19],s32 offen offset:1024 lds
M v[84:87],a[224:227],v[132:135],v[84:87]
C v42,v64,v65
s_waitcnt lgkmcnt(4)
M v[96:99],a[228:231],v[132:135],v[96:99]
T a[224:225],v13 offset:16384
M v[92:95],a[228:231],v[128:131],v[92:95]
T a[226:227],v13 offset:18432
L v108,s[16:19],s32 offen offset:2048 lds
M v[88:91],a[228:231],v[124:127],v[88:91]
C v43,v66,v67
M v[76:79],a[232:235],v[136:139],v[76:79]
T a[228:229],v14 offset:16384
M v[80:83],a[232:235],v[140:143],v[80:83]
T a[230:231],v14 offset:18432
C v44,v56,v57
M v[84:87],a[232:235],v[144:147],v[84:87]
s_add_u32 m0,m0,0xc00
M v[96:99],a[236:239],v[144:147],v[96:99]
T a[232:233],v13 offset:20480
s_add_u32 s32,s32,0xfff88080
M v[92:95],a[236:239],v[140:143],v[92:95]
T a[234:235],v13 offset:22528
C v45,v58,v59
M v[88:91],a[236:239],v[136:139],v[88:91]
s_waitcnt lgkmcnt(4)
M v[76:79],a[216:219],v[148:151],v[76:79]
T a[236:237],v14 offset:20480
M v[80:83],a[216:219],v[152:155],v[80:83]
T a[238:239],v14 offset:22528
C v46,v68,v69
M v[84:87],a[216:219],v[156:159],v[84:87]
L v106,s[16:19],s35 offen lds
M v[96:99],a[220:223],v[156:159],v[96:99]
C v47,v70,v71
L v107,s[16:19],s35 offen offset:1024 lds
M v[92:95],a[220:223],v[152:155],v[92:95]
C v48,v60,v61
M v[88:91],a[220:223],v[148:151],v[88:91]
L v108,s[16:19],s35 offen offset:2048 lds
M v[76:79],a[224:227],v[160:163],v[76:79]
C v49,v62,v63
M v[80:83],a[224:227],v[164:167],v[80:83]
M v[84:87],a[224:227],v[168:171],v[84:87]
s_waitcnt vmcnt(12) lgkmcnt(0)
s_barrier
M v[96:99],a[228:231],v[168:171],v[96:99]
T a[216:217],v13 offset:24576
T a[218:219],v13 offset:26624
M v[92:95],a[228:231],v[164:167],v[92:95]
T a[220:221],v14 offset:24576
T a[222:223],v14 offset:26624
M v[88:91],a[228:231],v[160:163],v[88:91]
T a[224:225],v13 offset:28672
T a[226:227],v13 offset:30720
M v[76:79],a[232:235],v[172:175],v[76:79]
T a[228:229],v14 offset:28672
T a[230:231],v14 offset:30720
M v[80:83],a[232:235],v[176:179],v[80:83]
C v50,v72,v73
M v[84:87],a[232:235],v[180:183],v[84:87]
T a[232:233],v13 offset:32768
T a[234:235],v13 offset:34816
M v[96:99],a[236:239],v[180:183],v[96:99]
C v51,v74,v75
M v[92:95],a[236:239],v[176:179],v[92:95]
s_cmp_eq_u32 s32,s43
s_cselect_b32 s32,s42,s32
M v[88:91],a[236:239],v[172:175],v[88:91]
AW a60,v40
s_waitcnt lgkmcnt(4)
M v[76:79],a[216:219],v[184:187],v[76:79]
T a[236:237],v14 offset:32768
s_add_u32 m0,s28,0
M v[80:83],a[216:219],v[188:191],v[80:83]
T a[238:239],v14 offset:34816
M v[84:87],a[216:219],v[192:195],v[84:87]
AW a61,v41
M v[96:99],a[220:223],v[192:195],v[96:99]
T a[216:217],v13 offset:36864
s_add_u32 s35,s32,0x7800
M v[92:95],a[220:223],v[188:191],v[92:95]
T a[218:219],v13 offset:38912
AW a62,v42
M v[88:91],a[220:223],v[184:187],v[88:91]
M v[76:79],a[224:227],v[196:199],v[76:79]
T a[220:221],v14 offset:36864
L v106,s[16:19],s32 offen lds
M v[80:83],a[224:227],v[200:203],v[80:83]
T a[222:223],v14 offset:38912
AW a63,v43
M v[84:87],a[224:227],v[204:207],v[84:87]
s_waitcnt lgkmcnt(4)
M v[96:99],a[228:231],v[204:207],v[96:99]
T a[224:225],v13 offset:40960
M v[92:95],a[228:231],v[200:203],v[92:95]
T a[226:227],v13 offset:43008
AW a64,v44
M v[88:91],a[228:231],v[196:199],v[88:91]
L v107,s[16:19],s32 offen offset:1024 lds
M v[76:79],a[232:235],v[208:211],v[76:79]
T a[228:229],v14 offset:40960
AW a65,v45
M v[80:83],a[232:235],v[212:215],v[80:83]
T a[230:231],v14 offset:43008
M v[84:87],a[232:235],v[216:219],v[84:87]
AW a66,v46
L v108,s[16:19],s32 offen offset:2048 lds
M v[96:99],a[236:239],v[216:219],v[96:99]
T a[232:233],v13 offset:45056
M v[92:95],a[236:239],v[212:215],v[92:95]
T a[234:235],v13 offset:47104
M v[88:91],a[236:239],v[208:211],v[88:91]
AW a67,v47
s_waitcnt lgkmcnt(4)
M v[76:79],a[216:219],v[220:223],v[76:79]
T a[236:237],v14 offset:45056
s_add_u32 m0,m0,0xc00
M v[80:83],a[216:219],v[224:227],v[80:83]
T a[238:239],v14 offset:47104
M v[84:87],a[216:219],v[228:231],v[84:87]
AW a68,v48
M v[96:99],a[220:223],v[228:231],v[96:99]
s_add_u32 s32,s32,0x78000
M v[92:95],a[220:223],v[224:227],v[92:95]
AW a69,v49
M v[88:91],a[220:223],v[220:223],v[88:91]
AW a70,v50
M v[76:79],a[224:227],v[232:235],v[76:79]
L v106,s[16:19],s35 offen lds
M v[80:83],a[224:227],v[236:239],v[80:83]
AW a71,v51
M v[84:87],a[224:227],v[240:243],v[84:87]
s_waitcnt vmcnt(10) lgkmcnt(0)
s_barrier
M v[96:99],a[228:231],v[240:243],v[96:99]
T a[216:217],v15
T a[218:219],v15 offset:2048
M v[92:95],a[228:231],v[236:239],v[92:95]
T a[220:221],v16
T a[222:223],v16 offset:2048
M v[88:91],a[228:231],v[232:235],v[88:91]
T a[224:225],v15 offset:4096
T a[226:227],v15 offset:6144
M v[76:79],a[232:235],v[244:247],v[76:79]
T a[228:229],v16 offset:4096
T a[230:231],v16 offset:6144
M v[80:83],a[232:235],v[248:251],v[80:83]
L v107,s[16:19],s35 offen offset:1024 lds
M v[84:87],a[232:235],v[252:255],v[84:87]
T a[232:233],v15 offset:8192
T a[234:235],v15 offset:10240
M v[96:99],a[236:239],v[252:255],v[96:99]
L v108,s[16:19],s35 offen offset:2048 lds
M v[92:95],a[236:239],v[248:251],v[92:95]
M v[88:91],a[236:239],v[244:247],v[88:91]
s_waitcnt lgkmcnt(4)
M v[52:55],a[216:219],v[112:115],0
T a[236:237],v16 offset:8192
s_add_u32 m0,s28,0x6000
M v[56:59],a[216:219],v[116:119],0
T a[238:239],v16 offset:10240
M v[60:63],a[216:219],v[120:123],0
s_add_u32 s35,s32,0x7800
M v[72:75],a[220:223],v[120:123],0
T a[216:217],v15 offset:12288
C v40,v76,v77
M v[68:71],a[220:223],v[116:119],0
T a[218:219],v15 offset:14336
L v106,s[16:19],s32 offen lds
M v[64:67],a[220:223],v[112:115],0
C v41,v78,v79
M v[52:55],a[224:227],v[124:127],v[52:55]
T a[220:221],v16 offset:12288
M v[56:59],a[224:227],v[128:131],v[56:59]
T a[222:223],v16 offset:14336
L v107,s[16:19],s32 offen offset:1024 lds
M v[60:63],a[224:227],v[132:135],v[60:63]
C v42,v88,v89
s_waitcnt lgkmcnt(4)
M v[72:75],a[228:231],v[132:135],v[72:75]
T a[224:225],v15 offset:16384
M v[68:71],a[228:231],v[128:131],v[68:71]
T a[226:227],v15 offset:18432
L v108,s[16:19],s32 offen offset:2048 lds
M v[64:67],a[228:231],v[124:127],v[64:67]
C v43,v90,v91
M v[52:55],a[232:235],v[136:139],v[52:55]
T a[228:229],v16 offset:16384
M v[56:59],a[232:235],v[140:143],v[56:59]
T a[230:231],v16 offset:18432
C v44,v80,v81
M v[60:63],a[232:235],v[144:147],v[60:63]
s_add_u32 m0,m0,0xc00
M v[72:75],a[236:239],v[144:147],v[72:75]
T a[232:233],v15 offset:20480
s_add_u32 s32,s32,0xfff88080
M v[68:71],a[236:239],v[140:143],v[68:71]
T a[234:235],v15 offset:22528
C v45,v82,v83
M v[64:67],a[236:239],v[136:139],v[64:67]
s_waitcnt lgkmcnt(4)
M v[52:55],a[216:219],v[148:151],v[52:55]
T a[236:237],v16 offset:20480
M v[56:59],a[216:219],v[152:155],v[56:59]
T a[238:239],v16 offset:22528
C v46,v92,v93
M v[60:63],a[216:219],v[156:159],v[60:63]
L v106,s[16:19],s35 offen lds
M v[72:75],a[220:223],v[156:159],v[72:75]
C v47,v94,v95
L v107,s[16:19],s35 offen offset:1024 lds
M v[68:71],a[220:223],v[152:155],v[68:71]
C v48,v84,v85
M v[64:67],a[220:223],v[148:151],v[64:67]
L v108,s[16:19],s35 offen offset:2048 lds
M v[52:55],a[224:227],v[160:163],v[52:55]
C v49,v86,v87
M v[56:59],a[224:227],v[164:167],v[56:59]
M v[60:63],a[224:227],v[168:171],v[60:63]
s_waitcnt vmcnt(12) lgkmcnt(0)
s_barrier
M v[72:75],a[228:231],v[168:171],v[72:75]
T a[216:217],v15 offset:24576
T a[218:219],v15 offset:26624
M v[68:71],a[228:231],v[164:167],v[68:71]
T a[220:221],v16 offset:24576
T a[222:223],v16 offset:26624
M v[64:67],a[228:231],v[160:163],v[64:67]
T a[224:225],v15 offset:28672
T a[226:227],v15 offset:30720
M v[52:55],a[232:235],v[172:175],v[52:55]
T a[228:229],v16 offset:28672
T a[230:231],v16 offset:30720
M v[56:59],a[232:235],v[176:179],v[56:59]
C v50,v96,v97
M v[60:63],a[232:235],v[180:183],v[60:63]
T a[232:233],v15 offset:32768
T a[234:235],v15 offset:34816
M v[72:75],a[236:239],v[180:183],v[72:75]
C v51,v98,v99
M v[68:71],a[236:239],v[176:179],v[68:71]
s_cmp_eq_u32 s32,s43
s_cselect_b32 s32,s42,s32
M v[64:67],a[236:239],v[172:175],v[64:67]
AW a72,v40
s_waitcnt lgkmcnt(4)
M v[52:55],a[216:219],v[184:187],v[52:55]
T a[236:237],v16 offset:32768
s_add_u32 m0,s28,0xc000
M v[56:59],a[216:219],v[188:191],v[56:59]
T a[238:239],v16 offset:34816
M v[60:63],a[216:219],v[192:195],v[60:63]
AW a73,v41
M v[72:75],a[220:223],v[192:195],v[72:75]
T a[216:217],v15 offset:36864
s_add_u32 s35,s32,0x7800
M v[68:71],a[220:223],v[188:191],v[68:71]
T a[218:219],v15 offset:38912
AW a74,v42
M v[64:67],a[220:223],v[184:187],v[64:67]
M v[52:55],a[224:227],v[196:199],v[52:55]
T a[220:221],v16 offset:36864
L v106,s[16:19],s32 offen lds
M v[56:59],a[224:227],v[200:203],v[56:59]
T a[222:223],v16 offset:38912
AW a75,v43
M v[60:63],a[224:227],v[204:207],v[60:63]
s_waitcnt lgkmcnt(4)
M v[72:75],a[228:231],v[204:207],v[72:75]
T a[224:225],v15 offset:40960
M v[68:71],a[228:231],v[200:203],v[68:71]
T a[226:227],v15 offset:43008
AW a76,v44
M v[64:67],a[228:231],v[196:199],v[64:67]
L v107,s[16:19],s32 offen offset:1024 lds
M v[52:55],a[232:235],v[208:211],v[52:55]
T a[228:229],v16 offset:40960
AW a77,v45
M v[56:59],a[232:235],v[212:215],v[56:59]
T a[230:231],v16 offset:43008
M v[60:63],a[232:235],v[216:219],v[60:63]
AW a78,v46
L v108,s[16:19],s32 offen offset:2048 lds
M v[72:75],a[236:239],v[216:219],v[72:75]
T a[232:233],v15 offset:45056
M v[68:71],a[236:239],v[212:215],v[68:71]
T a[234:235],v15 offset:47104
M v[64:67],a[236:239],v[208:211],v[64:67]
AW a79,v47
s_waitcnt lgkmcnt(4)
M v[52:55],a[216:219],v[220:223],v[52:55]
T a[236:237],v16 offset:45056
s_add_u32 m0,m0,0xc00
M v[56:59],a[216:219],v[224:227],v[56:59]
T a[238:239],v16 offset:47104
M v[60:63],a[216:219],v[228:231],v[60:63]
AW a80,v48
M v[72:75],a[220:223],v[228:231],v[72:75]
s_add_u32 s32,s32,0x78000
M v[68:71],a[220:223],v[224:227],v[68:71]
AW a81,v49
M v[64:67],a[220:223],v[220:223],v[64:67]
AW a82,v50
M v[52:55],a[224:227],v[232:235],v[52:55]
L v106,s[16:19],s35 offen lds
M v[56:59],a[224:227],v[236:239],v[56:59]
AW a83,v51
M v[60:63],a[224:227],v[240:243],v[60:63]
s_waitcnt vmcnt(10) lgkmcnt(0)
s_barrier
M v[72:75],a[228:231],v[240:243],v[72:75]
T a[216:217],v13
T a[218:219],v13 offset:2048
M v[68:71],a[228:231],v[236:239],v[68:71]
T a[220:221],v14
T a[222:223],v14 offset:2048
M v[64:67],a[228:231],v[232:235],v[64:67]
T a[224:225],v13 offset:4096
T a[226:227],v13 offset:6144
M v[52:55],a[232:235],v[244:247],v[52:55]
T a[228:229],v14 offset:4096
T a[230:231],v14 offset:6144
M v[56:59],a[232:235],v[248:251],v[56:59]
L v107,s[16:19],s35 offen offset:1024 lds
M v[60:63],a[232:235],v[252:255],v[60:63]
T a[232:233],v13 offset:8192
T a[234:235],v13 offset:10240
M v[72:75],a[236:239],v[252:255],v[72:75]
L v108,s[16:19],s35 offen offset:2048 lds
M v[68:71],a[236:239],v[248:251],v[68:71]
M v[64:67],a[236:239],v[244:247],v[64:67]
s_waitcnt lgkmcnt(4)
M v[76:79],a[216:219],v[112:115],0
T a[236:237],v14 offset:8192
s_add_u32 m0,s28,0x12000
M v[80:83],a[216:219],v[116:119],0
T a[238:239],v14 offset:10240
s_add_u32 s35,s32,0x7800
M v[84:87],a[216:219],v[120:123],0
L v106,s[16:19],s32 offen lds
M v[96:99],a[220:223],v[120:123],0
T a[216:217],v13 offset:12288
C v40,v52,v53
M v[92:95],a[220:223],v[116:119],0
T a[218:219],v13 offset:14336
M v[88:91],a[220:223],v[112:115],0
C v41,v54,v55
L v107,s[16:19],s32 offen offset:1024 lds
M v[76:79],a[224:227],v[124:127],v[76:79]
T a[220:221],v14 offset:12288
M v[80:83],a[224:227],v[128:131],v[80:83]
T a[222:223],v14 offset:14336
L v108,s[16:19],s32 offen offset:2048 lds
M v[84:87],a[224:227],v[132:135],v[84:87]
C v42,v64,v65
s_waitcnt lgkmcnt(4)
M v[96:99],a[228:231],v[132:135],v[96:99]
T a[224:225],v13 offset:16384
M v[92:95],a[228:231],v[128:131],v[92:95]
T a[226:227],v13 offset:18432
s_add_u32 m0,m0,0xc00
M v[88:91],a[228:231],v[124:127],v[88:91]
C v43,v66,v67
M v[76:79],a[232:235],v[136:139],v[76:79]
T a[228:229],v14 offset:16384
s_add_u32 s32,s32,0xfff88080
M v[80:83],a[232:235],v[140:143],v[80:83]
T a[230:231],v14 offset:18432
C v44,v56,v57
M v[84:87],a[232:235],v[144:147],v[84:87]
L v106,s[16:19],s35 offen lds
M v[96:99],a[236:239],v[144:147],v[96:99]
T a[232:233],v13 offset:20480
M v[92:95],a[236:239],v[140:143],v[92:95]
T a[234:235],v13 offset:22528
C v45,v58,v59
M v[88:91],a[236:239],v[136:139],v[88:91]
L v107,s[16:19],s35 offen offset:1024 lds
s_waitcnt lgkmcnt(4)
M v[76:79],a[216:219],v[148:151],v[76:79]
T a[236:237],v14 offset:20480
M v[80:83],a[216:219],v[152:155],v[80:83]
T a[238:239],v14 offset:22528
C v46,v68,v69
M v[84:87],a[216:219],v[156:159],v[84:87]
L v108,s[16:19],s35 offen offset:2048 lds
M v[96:99],a[220:223],v[156:159],v[96:99]
C v47,v70,v71
M v[92:95],a[220:223],v[152:155],v[92:95]
C v48,v60,v61
M v[88:91],a[220:223],v[148:151],v[88:91]
s_cmp_eq_u32 s32,s43
s_cselect_b32 s32,s42,s32
M v[76:79],a[224:227],v[160:163],v[76:79]
C v49,v62,v63
s_add_u32 s32,s32,0x3c000
M v[80:83],a[224:227],v[164:167],v[80:83]
s_add_u32 s42,s42,0x3c000
M v[84:87],a[224:227],v[168:171],v[84:87]
s_waitcnt vmcnt(12) lgkmcnt(0)
s_barrier
M v[96:99],a[228:231],v[168:171],v[96:99]
T a[216:217],v13 offset:24576
T a[218:219],v13 offset:26624
M v[92:95],a[228:231],v[164:167],v[92:95]
T a[220:221],v14 offset:24576
T a[222:223],v14 offset:26624
M v[88:91],a[228:231],v[160:163],v[88:91]
T a[224:225],v13 offset:28672
T a[226:227],v13 offset:30720
M v[76:79],a[232:235],v[172:175],v[76:79]
T a[228:229],v14 offset:28672
T a[230:231],v14 offset:30720
M v[80:83],a[232:235],v[176:179],v[80:83]
C v50,v72,v73
M v[84:87],a[232:235],v[180:183],v[84:87]
T a[232:233],v13 offset:32768
T a[234:235],v13 offset:34816
M v[96:99],a[236:239],v[180:183],v[96:99]
C v51,v74,v75
s_add_u32 s43,s43,0x3c000
M v[92:95],a[236:239],v[176:179],v[92:95]
M v[88:91],a[236:239],v[172:175],v[88:91]
AW a84,v40
s_waitcnt lgkmcnt(4)
M v[76:79],a[216:219],v[184:187],v[76:79]
T a[236:237],v14 offset:32768
s_add_u32 m0,s28,0
M v[80:83],a[216:219],v[188:191],v[80:83]
T a[238:239],v14 offset:34816
M v[84:87],a[216:219],v[192:195],v[84:87]
AW a85,v41
M v[96:99],a[220:223],v[192:195],v[96:99]
T a[216:217],v13 offset:36864
s_add_u32 s35,s29,0xc00
M v[92:95],a[220:223],v[188:191],v[92:95]
T a[218:219],v13 offset:38912
AW a86,v42
M v[88:91],a[220:223],v[184:187],v[88:91]
M v[76:79],a[224:227],v[196:199],v[76:79]
T a[220:221],v14 offset:36864
L v100,s[4:7],s29 offen nt lds
M v[80:83],a[224:227],v[200:203],v[80:83]
T a[222:223],v14 offset:38912
AW a87,v43
M v[84:87],a[224:227],v[204:207],v[84:87]
s_waitcnt lgkmcnt(4)
M v[96:99],a[228:231],v[204:207],v[96:99]
T a[224:225],v13 offset:40960
M v[92:95],a[228:231],v[200:203],v[92:95]
T a[226:227],v13 offset:43008
AW a88,v44
M v[88:91],a[228:231],v[196:199],v[88:91]
L v101,s[4:7],s29 offen offset:1024 nt lds
M v[76:79],a[232:235],v[208:211],v[76:79]
T a[228:229],v14 offset:40960
AW a89,v45
M v[80:83],a[232:235],v[212:215],v[80:83]
T a[230:231],v14 offset:43008
M v[84:87],a[232:235],v[216:219],v[84:87]
AW a90,v46
L v102,s[4:7],s29 offen offset:2048 nt lds
M v[96:99],a[236:239],v[216:219],v[96:99]
T a[232:233],v13 offset:45056
M v[92:95],a[236:239],v[212:215],v[92:95]
T a[234:235],v13 offset:47104
M v[88:91],a[236:239],v[208:211],v[88:91]
AW a91,v47
s_waitcnt lgkmcnt(4)
M v[76:79],a[216:219],v[220:223],v[76:79]
T a[236:237],v14 offset:45056
s_add_u32 m0,m0,0xc00
M v[80:83],a[216:219],v[224:227],v[80:83]
T a[238:239],v14 offset:47104
M v[84:87],a[216:219],v[228:231],v[84:87]
AW a92,v48
M v[96:99],a[220:223],v[228:231],v[96:99]
s_add_u32 s29,s29,0x3000
M v[92:95],a[220:223],v[224:227],v[92:95]
AW a93,v49
M v[88:91],a[220:223],v[220:223],v[88:91]
AW a94,v50
M v[76:79],a[224:227],v[232:235],v[76:79]
L v100,s[4:7],s35 offen nt lds
M v[80:83],a[224:227],v[236:239],v[80:83]
AW a95,v51
M v[84:87],a[224:227],v[240:243],v[84:87]
s_waitcnt vmcnt(10) lgkmcnt(0)
s_barrier
M v[96:99],a[228:231],v[240:243],v[96:99]
T a[216:217],v15
T a[218:219],v15 offset:2048
M v[92:95],a[228:231],v[236:239],v[92:95]
T a[220:221],v16
T a[222:223],v16 offset:2048
M v[88:91],a[228:231],v[232:235],v[88:91]
T a[224:225],v15 offset:4096
T a[226:227],v15 offset:6144
M v[76:79],a[232:235],v[244:247],v[76:79]
T a[228:229],v16 offset:4096
T a[230:231],v16 offset:6144
M v[80:83],a[232:235],v[248:251],v[80:83]
L v101,s[4:7],s35 offen offset:1024 nt lds
M v[84:87],a[232:235],v[252:255],v[84:87]
T a[232:233],v15 offset:8192
T a[234:235],v15 offset:10240
M v[96:99],a[236:239],v[252:255],v[96:99]
L v102,s[4:7],s35 offen offset:2048 nt lds
M v[92:95],a[236:239],v[248:251],v[92:95]
M v[88:91],a[236:239],v[244:247],v[88:91]
s_waitcnt lgkmcnt(4)
M v[52:55],a[216:219],v[112:115],0
T a[236:237],v16 offset:8192
s_add_u32 m0,s28,0x6000
M v[56:59],a[216:219],v[116:119],0
T a[238:239],v16 offset:10240
M v[60:63],a[216:219],v[120:123],0
s_add_u32 s35,s29,0xc00
M v[72:75],a[220:223],v[120:123],0
T a[216:217],v15 offset:12288
C v40,v76,v77
M v[68:71],a[220:223],v[116:119],0
T a[218:219],v15 offset:14336
M v[64:67],a[220:223],v[112:115],0
C v41,v78,v79
M v[52:55],a[224:227],v[124:127],v[52:55]
T a[220:221],v16 offset:12288
L v100,s[4:7],s29 offen nt lds
M v[56:59],a[224:227],v[128:131],v[56:59]
T a[222:223],v16 offset:14336
M v[60:63],a[224:227],v[132:135],v[60:63]
C v42,v88,v89
s_waitcnt lgkmcnt(4)
M v[72:75],a[228:231],v[132:135],v[72:75]
T a[224:225],v15 offset:16384
M v[68:71],a[228:231],v[128:131],v[68:71]
T a[226:227],v15 offset:18432
L v101,s[4:7],s29 offen offset:1024 nt lds
M v[64:67],a[228:231],v[124:127],v[64:67]
C v43,v90,v91
M v[52:55],a[232:235],v[136:139],v[52:55]
T a[228:229],v16 offset:16384
M v[56:59],a[232:235],v[140:143],v[56:59]
T a[230:231],v16 offset:18432
L v102,s[4:7],s29 offen offset:2048 nt lds
M v[60:63],a[232:235],v[144:147],v[60:63]
C v44,v80,v81
M v[72:75],a[236:239],v[144:147],v[72:75]
T a[232:233],v15 offset:20480
M v[68:71],a[236:239],v[140:143],v[68:71]
T a[234:235],v15 offset:22528
s_add_u32 m0,m0,0xc00
M v[64:67],a[236:239],v[136:139],v[64:67]
C v45,v82,v83
s_waitcnt lgkmcnt(4)
M v[52:55],a[216:219],v[148:151],v[52:55]
T a[236:237],v16 offset:20480
M v[56:59],a[216:219],v[152:155],v[56:59]
T a[238:239],v16 offset:22528
M v[60:63],a[216:219],v[156:159],v[60:63]
C v46,v92,v93
s_add_u32 s29,s29,0x3000
M v[72:75],a[220:223],v[156:159],v[72:75]
C v47,v94,v95
M v[68:71],a[220:223],v[152:155],v[68:71]
L v100,s[4:7],s35 offen nt lds
M v[64:67],a[220:223],v[148:151],v[64:67]
C v48,v84,v85
M v[52:55],a[224:227],v[160:163],v[52:55]
L v101,s[4:7],s35 offen offset:1024 nt lds
M v[56:59],a[224:227],v[164:167],v[56:59]
C v49,v86,v87
M v[60:63],a[224:227],v[168:171],v[60:63]
s_waitcnt vmcnt(11) lgkmcnt(0)
s_barrier
M v[72:75],a[228:231],v[168:171],v[72:75]
T a[216:217],v15 offset:24576
T a[218:219],v15 offset:26624
M v[68:71],a[228:231],v[164:167],v[68:71]
T a[220:221],v16 offset:24576
T a[222:223],v16 offset:26624
M v[64:67],a[228:231],v[160:163],v[64:67]
T a[224:225],v15 offset:28672
T a[226:227],v15 offset:30720
M v[52:55],a[232:235],v[172:175],v[52:55]
T a[228:229],v16 offset:28672
T a[230:231],v16 offset:30720
M v[56:59],a[232:235],v[176:179],v[56:59]
L v102,s[4:7],s35 offen offset:2048 nt lds
M v[60:63],a[232:235],v[180:183],v[60:63]
T a[232:233],v15 offset:32768
T a[234:235],v15 offset:34816
M v[72:75],a[236:239],v[180:183],v[72:75]
C v50,v96,v97
M v[68:71],a[236:239],v[176:179],v[68:71]
C v51,v98,v99
M v[64:67],a[236:239],v[172:175],v[64:67]
s_waitcnt lgkmcnt(4)
M v[52:55],a[216:219],v[184:187],v[52:55]
T a[236:237],v16 offset:32768
s_add_u32 m0,s28,0xc000
M v[56:59],a[216:219],v[188:191],v[56:59]
T a[238:239],v16 offset:34816
AW a96,v40
M v[60:63],a[216:219],v[192:195],v[60:63]
M v[72:75],a[220:223],v[192:195],v[72:75]
T a[216:217],v15 offset:36864
s_add_u32 s35,s30,0xc00
M v[68:71],a[220:223],v[188:191],v[68:71]
T a[218:219],v15 offset:38912
AW a97,v41
M v[64:67],a[220:223],v[184:187],v[64:67]
M v[52:55],a[224:227],v[196:199],v[52:55]
T a[220:221],v16 offset:36864
AW a98,v42
M v[56:59],a[224:227],v[200:203],v[56:59]
T a[222:223],v16 offset:38912
M v[60:63],a[224:227],v[204:207],v[60:63]
L v100,s[8:11],s30 offen nt lds
s_waitcnt lgkmcnt(4)
M v[72:75],a[228:231],v[204:207],v[72:75]
T a[224:225],v15 offset:40960
M v[68:71],a[228:231],v[200:203],v[68:71]
T a[226:227],v15 offset:43008
AW a99,v43
M v[64:67],a[228:231],v[196:199],v[64:67]
L v101,s[8:11],s30 offen offset:1024 nt lds
M v[52:55],a[232:235],v[208:211],v[52:55]
T a[228:229],v16 offset:40960
AW a100,v44
M v[56:59],a[232:235],v[212:215],v[56:59]
T a[230:231],v16 offset:43008
M v[60:63],a[232:235],v[216:219],v[60:63]
M v[72:75],a[236:239],v[216:219],v[72:75]
T a[232:233],v15 offset:45056
AW a101,v45
M v[68:71],a[236:239],v[212:215],v[68:71]
T a[234:235],v15 offset:47104
L v102,s[8:11],s30 offen offset:2048 nt lds
M v[64:67],a[236:239],v[208:211],v[64:67]
s_waitcnt lgkmcnt(4)
M v[52:55],a[216:219],v[220:223],v[52:55]
T a[236:237],v16 offset:45056
AW a102,v46
M v[56:59],a[216:219],v[224:227],v[56:59]
T a[238:239],v16 offset:47104
M v[60:63],a[216:219],v[228:231],v[60:63]
AW a103,v47
s_add_u32 m0,m0,0xc00
M v[72:75],a[220:223],v[228:231],v[72:75]
M v[68:71],a[220:223],v[224:227],v[68:71]
AW a104,v48
M v[64:67],a[220:223],v[220:223],v[64:67]
s_add_u32 s30,s30,0x3000
M v[52:55],a[224:227],v[232:235],v[52:55]
AW a105,v49
M v[56:59],a[224:227],v[236:239],v[56:59]
L v100,s[8:11],s35 offen nt lds
M v[60:63],a[224:227],v[240:243],v[60:63]
s_waitcnt vmcnt(10) lgkmcnt(0)
s_barrier
M v[72:75],a[228:231],v[240:243],v[72:75]
ds_read_b128 a[216:219],v1
ds_read_b128 a[220:223],v2
M v[68:71],a[228:231],v[236:239],v[68:71]
ds_read_b128 a[224:227],v1 offset:128
AW a106,v50
M v[64:67],a[228:231],v[232:235],v[64:67]
M v[52:55],a[232:235],v[244:247],v[52:55]
ds_read_b128 a[228:231],v2 offset:128
AW a107,v51
M v[56:59],a[232:235],v[248:251],v[56:59]
L v101,s[8:11],s35 offen offset:1024 nt lds
M v[60:63],a[232:235],v[252:255],v[60:63]
ds_read_b128 a[232:235],v1 offset:256
M v[72:75],a[236:239],v[252:255],v[72:75]
L v102,s[8:11],s35 offen offset:2048 nt lds
M v[68:71],a[236:239],v[248:251],v[68:71]
M v[64:67],a[236:239],v[244:247],v[64:67]
C v40,v52,v53
C v41,v54,v55
s_nop 5
C v42,v64,v65
C v43,v66,v67
C v44,v56,v57
C v45,v58,v59
C v46,v68,v69
C v47,v70,v71
C v48,v60,v61
C v49,v62,v63
C v50,v72,v73
C v51,v74,v75
AW a108,v40
AW a109,v41
AW a110,v42
AW a111,v43
AW a112,v44
AW a113,v45
AW a114,v46
AW a115,v47
AW a116,v48
AW a117,v49
AW a118,v50
AW a119,v51
s_waitcnt lgkmcnt(2)
M v[52:55],a[216:219],a[144:147],0
ds_read_b128 a[236:239],v2 offset:256
s_add_u32 m0,s28,0x12000
M v[56:59],a[216:219],a[148:151],0
M v[60:63],a[216:219],a[152:155],0
M v[60:63],a[220:223],a[164:167],v[60:63]
ds_read_b128 a[216:219],v1 offset:6144
s_add_u32 s35,s29,0xc00
M v[56:59],a[220:223],a[160:163],v[56:59]
M v[52:55],a[220:223],a[156:159],v[52:55]
M v[52:55],a[224:227],a[168:171],v[52:55]
ds_read_b128 a[220:223],v2 offset:6144
L v100,s[4:7],s29 offen nt lds
M v[56:59],a[224:227],a[172:175],v[56:59]
M v[60:63],a[224:227],a[176:179],v[60:63]
s_waitcnt lgkmcnt(2)
M v[60:63],a[228:231],a[188:191],v[60:63]
ds_read_b128 a[224:227],v1 offset:6272
M v[56:59],a[228:231],a[184:187],v[56:59]
L v101,s[4:7],s29 offen offset:1024 nt lds
M v[52:55],a[228:231],a[180:183],v[52:55]
M v[52:55],a[232:235],a[192:195],v[52:55]
ds_read_b128 a[228:231],v2 offset:6272
M v[56:59],a[232:235],a[196:199],v[56:59]
L v102,s[4:7],s29 offen offset:2048 nt lds
M v[60:63],a[232:235],a[200:203],v[60:63]
M v[60:63],a[236:239],a[212:215],v[60:63]
ds_read_b128 a[232:235],v1 offset:6400
M v[56:59],a[236:239],a[208:211],v[56:59]
M v[52:55],a[236:239],a[204:207],v[52:55]
s_add_u32 m0,m0,0xc00
s_waitcnt lgkmcnt(2)
M v[64:67],a[216:219],a[144:147],0
ds_read_b128 a[236:239],v2 offset:6400
M v[68:71],a[216:219],a[148:151],0
M v[72:75],a[216:219],a[152:155],0
s_add_u32 s29,s29,0x3000
M v[72:75],a[220:223],a[164:167],v[72:75]
M v[68:71],a[220:223],a[160:163],v[68:71]
M v[64:67],a[220:223],a[156:159],v[64:67]
L v100,s[4:7],s35 offen nt lds
M v[64:67],a[224:227],a[168:171],v[64:67]
M v[68:71],a[224:227],a[172:175],v[68:71]
M v[72:75],a[224:227],a[176:179],v[72:75]
s_waitcnt vmcnt(10) lgkmcnt(0)
s_barrier
M v[72:75],a[228:231],a[188:191],v[72:75]
ds_read_b128 a[216:219],v1 offset:24576
ds_read_b128 a[220:223],v2 offset:24576
M v[68:71],a[228:231],a[184:187],v[68:71]
ds_read_b128 a[224:227],v1 offset:24704
L v101,s[4:7],s35 offen offset:1024 nt lds
M v[64:67],a[228:231],a[180:183],v[64:67]
M v[64:67],a[232:235],a[192:195],v[64:67]
ds_read_b128 a[228:231],v2 offset:24704
M v[68:71],a[232:235],a[196:199],v[68:71]
M v[72:75],a[232:235],a[200:203],v[72:75]
ds_read_b128 a[232:235],v1 offset:24832
L v102,s[4:7],s35 offen offset:2048 nt lds
M v[72:75],a[236:239],a[212:215],v[72:75]
M v[68:71],a[236:239],a[208:211],v[68:71]
M v[64:67],a[236:239],a[204:207],v[64:67]
v_max3_f32 v19,v52,v53,v54
v_max3_f32 v20,v56,v57,v58
v_max3_f32 v21,v60,v61,v62
s_nop 4
v_max3_f32 v19,v19,v55,v64
v_max3_f32 v20,v20,v59,v68
v_max3_f32 v21,v21,v63,v72
v_max3_f32 v19,v19,v65,v66
v_max3_f32 v20,v20,v69,v70
v_max3_f32 v21,v21,v73,v74
v_max_f32 v19,v19,v67
v_max_f32 v20,v20,v71
v_max_f32 v21,v21,v75
v_mov_b32 v25,v19
v_mov_b32 v26,v20
v_mov_b32 v27,v21
v_permlane32_swap_b32 v19,v25
v_permlane32_swap_b32 v20,v26
v_permlane32_swap_b32 v21,v27
v_max_f32 v19,v19,v25
v_max_f32 v20,v20,v26
v_max_f32 v21,v21,v27
v_mov_b32 v25,v19
v_mov_b32 v26,v20
v_mov_b32 v27,v21
v_permlane16_swap_b32 v19,v25
v_permlane16_swap_b32 v20,v26
v_permlane16_swap_b32 v21,v27
v_max_f32 v19,v19,v25
v_max_f32 v20,v20,v26
v_max_f32 v21,v21,v27
v_mul_f32 v19,s37,v19
v_mul_f32 v20,s37,v20
v_mul_f32 v21,s37,v21
v_mov_b32 v22,0
v_mov_b32 v23,0
v_mov_b32 v24,0
v_fma_f32 v52,v52,s37,-v19
v_fma_f32 v53,v53,s37,-v19
v_fma_f32 v54,v54,s37,-v19
v_fma_f32 v55,v55,s37,-v19
v_fma_f32 v56,v56,s37,-v20
v_fma_f32 v57,v57,s37,-v20
v_fma_f32 v58,v58,s37,-v20
v_fma_f32 v59,v59,s37,-v20
v_fma_f32 v60,v60,s37,-v21
v_fma_f32 v61,v61,s37,-v21
v_fma_f32 v62,v62,s37,-v21
v_fma_f32 v63,v63,s37,-v21
v_fma_f32 v64,v64,s37,-v19
v_fma_f32 v65,v65,s37,-v19
v_fma_f32 v66,v66,s37,-v19
v_fma_f32 v67,v67,s37,-v19
v_fma_f32 v68,v68,s37,-v20
v_fma_f32 v69,v69,s37,-v20
v_fma_f32 v70,v70,s37,-v20
v_fma_f32 v71,v71,s37,-v20
v_fma_f32 v72,v72,s37,-v21
v_fma_f32 v73,v73,s37,-v21
v_fma_f32 v74,v74,s37,-v21
v_fma_f32 v75,v75,s37,-v21
s_waitcnt lgkmcnt(2)
M v[76:79],a[216:219],a[144:147],0
ds_read_b128 a[236:239],v2 offset:24832
s_add_u32 m0,s28,0
v_exp_f32 v52,v52
M v[80:83],a[216:219],a[148:151],0
v_exp_f32 v56,v56
v_exp_f32 v60,v60
M v[84:87],a[216:219],a[152:155],0
s_add_u32 s35,s30,0xc00
v_exp_f32 v53,v53
M v[84:87],a[220:223],a[164:167],v[84:87]
ds_read_b128 a[216:219],v1 offset:30720
v_exp_f32 v57,v57
M v[80:83],a[220:223],a[160:163],v[80:83]
v_exp_f32 v61,v61
v_add_f32 v22,v22,v52
v_add_f32 v23,v23,v56
M v[76:79],a[220:223],a[156:159],v[76:79]
L v100,s[8:11],s30 offen nt lds
v_add_f32 v24,v24,v60
v_exp_f32 v54,v54
M v[76:79],a[224:227],a[168:171],v[76:79]
ds_read_b128 a[220:223],v2 offset:30720
v_exp_f32 v58,v58
M v[80:83],a[224:227],a[172:175],v[80:83]
v_exp_f32 v62,v62
v_add_f32 v22,v22,v53
v_add_f32 v23,v23,v57
M v[84:87],a[224:227],a[176:179],v[84:87]
v_add_f32 v24,v24,v61
C v40,v52,v53
C v44,v56,v57
s_waitcnt lgkmcnt(2)
M v[84:87],a[228:231],a[188:191],v[84:87]
ds_read_b128 a[224:227],v1 offset:30848
L v101,s[8:11],s30 offen offset:1024 nt lds
C v48,v60,v61
M v[80:83],a[228:231],a[184:187],v[80:83]
v_exp_f32 v55,v55
v_exp_f32 v59,v59
M v[76:79],a[228:231],a[180:183],v[76:79]
v_exp_f32 v63,v63
v_add_f32 v22,v22,v54
v_add_f32 v23,v23,v58
M v[76:79],a[232:235],a[192:195],v[76:79]
ds_read_b128 a[228:231],v2 offset:30848
L v102,s[8:11],s30 offen offset:2048 nt lds
v_add_f32 v24,v24,v62
M v[80:83],a[232:235],a[196:199],v[80:83]
v_exp_f32 v64,v64
v_exp_f32 v68,v68
M v[84:87],a[232:235],a[200:203],v[84:87]
v_exp_f32 v72,v72
v_add_f32 v22,v22,v55
v_add_f32 v23,v23,v59
M v[84:87],a[236:239],a[212:215],v[84:87]
ds_read_b128 a[232:235],v1 offset:30976
s_add_u32 m0,m0,0xc00
v_add_f32 v24,v24,v63
C v41,v54,v55
M v[80:83],a[236:239],a[208:211],v[80:83]
C v45,v58,v59
C v49,v62,v63
v_exp_f32 v65,v65
M v[76:79],a[236:239],a[204:207],v[76:79]
v_exp_f32 v69,v69
s_waitcnt lgkmcnt(2)
M v[88:91],a[216:219],a[144:147],0
ds_read_b128 a[236:239],v2 offset:30976
v_exp_f32 v73,v73
v_add_f32 v22,v22,v64
M v[92:95],a[216:219],a[148:151],0
s_add_u32 s30,s30,0x3000
v_add_f32 v23,v23,v68
v_add_f32 v24,v24,v72
M v[96:99],a[216:219],a[152:155],0
v_exp_f32 v66,v66
v_exp_f32 v70,v70
M v[96:99],a[220:223],a[164:167],v[96:99]
L v100,s[8:11],s35 offen nt lds
v_exp_f32 v74,v74
v_add_f32 v22,v22,v65
M v[92:95],a[220:223],a[160:163],v[92:95]
v_add_f32 v23,v23,v69
v_add_f32 v24,v24,v73
C v42,v64,v65
C v46,v68,v69
M v[88:91],a[220:223],a[156:159],v[88:91]
C v50,v72,v73
v_exp_f32 v67,v67
M v[88:91],a[224:227],a[168:171],v[88:91]
L v101,s[8:11],s35 offen offset:1024 nt lds
v_exp_f32 v71,v71
M v[92:95],a[224:227],a[172:175],v[92:95]
v_exp_f32 v75,v75
v_add_f32 v22,v22,v66
v_add_f32 v23,v23,v70
M v[96:99],a[224:227],a[176:179],v[96:99]
s_waitcnt vmcnt(11) lgkmcnt(0)
s_barrier
v_add_f32 v24,v24,v74
C v43,v66,v67
M v[96:99],a[228:231],a[188:191],v[96:99]
T a[216:217],v9
T a[218:219],v9 offset:6144
C v47,v70,v71
C v51,v74,v75
M v[92:95],a[228:231],a[184:187],v[92:95]
T a[220:221],v10
T a[222:223],v10 offset:6144
v_add_f32 v22,v22,v67
v_add_f32 v23,v23,v71
M v[88:91],a[228:231],a[180:183],v[88:91]
T a[224:225],v11
T a[226:227],v11 offset:6144
v_add_f32 v24,v24,v75
M v[88:91],a[232:235],a[192:195],v[88:91]
T a[228:229],v12
T a[230:231],v12 offset:6144
M v[92:95],a[232:235],a[196:199],v[92:95]
L v102,s[8:11],s35 offen offset:2048 nt lds
M v[96:99],a[232:235],a[200:203],v[96:99]
T a[232:233],v9 offset:128
T a[234:235],v9 offset:6272
M v[96:99],a[236:239],a[212:215],v[96:99]
M v[92:95],a[236:239],a[208:211],v[92:95]
M v[88:91],a[236:239],a[204:207],v[88:91]
s_waitcnt lgkmcnt(4)
M v[112:115],a[216:219],v[40:43],0
T a[236:237],v10 offset:128
s_add_u32 m0,s28,0x6000
M v[116:119],a[216:219],v[44:47],0
T a[238:239],v10 offset:6272
M v[120:123],a[216:219],v[48:51],0
M v[132:135],a[220:223],v[48:51],0
T a[216:217],v11 offset:128
s_add_u32 s35,s29,0xc00
v_fma_f32 v76,v76,s37,-v19
M v[128:131],a[220:223],v[44:47],0
T a[218:219],v11 offset:6272
v_fma_f32 v77,v77,s37,-v19
v_fma_f32 v78,v78,s37,-v19
M v[124:127],a[220:223],v[40:43],0
v_fma_f32 v79,v79,s37,-v19
v_fma_f32 v80,v80,s37,-v20
v_fma_f32 v81,v81,s37,-v20
M v[136:139],a[224:227],v[40:43],0
T a[220:221],v12 offset:128
v_max3_f32 v28,v76,v77,v78
v_fma_f32 v82,v82,s37,-v20
M v[140:143],a[224:227],v[44:47],0
T a[222:223],v12 offset:6272
L v100,s[4:7],s29 offen nt lds
v_fma_f32 v83,v83,s37,-v20
M v[144:147],a[224:227],v[48:51],0
v_max3_f32 v28,v28,v79,v80
v_fma_f32 v84,v84,s37,-v21
s_waitcnt lgkmcnt(4)
M v[156:159],a[228:231],v[48:51],0
T a[224:225],v9 offset:256
v_fma_f32 v85,v85,s37,-v21
v_max3_f32 v28,v28,v81,v82
M v[152:155],a[228:231],v[44:47],0
T a[226:227],v9 offset:6400
v_fma_f32 v86,v86,s37,-v21
v_fma_f32 v87,v87,s37,-v21
M v[148:151],a[228:231],v[40:43],0
L v101,s[4:7],s29 offen offset:1024 nt lds
v_max3_f32 v28,v28,v83,v84
v_max3_f32 v28,v28,v85,v86
M v[160:163],a[232:235],v[40:43],0
T a[228:229],v10 offset:256
v_max_f32 v28,v28,v87
v_fma_f32 v88,v88,s37,-v19
M v[164:167],a[232:235],v[44:47],0
T a[230:231],v10 offset:6400
v_fma_f32 v89,v89,s37,-v19
v_fma_f32 v90,v90,s37,-v19
M v[168:171],a[232:235],v[48:51],0
v_fma_f32 v91,v91,s37,-v19
v_fma_f32 v92,v92,s37,-v20
v_fma_f32 v93,v93,s37,-v20
M v[180:183],a[236:239],v[48:51],0
T a[232:233],v11 offset:256
L v102,s[4:7],s29 offen offset:2048 nt lds
v_max3_f32 v28,v28,v88,v89
M v[176:179],a[236:239],v[44:47],0
T a[234:235],v11 offset:6400
v_fma_f32 v94,v94,s37,-v20
v_fma_f32 v95,v95,s37,-v20
M v[172:175],a[236:239],v[40:43],0
v_max3_f32 v28,v28,v90,v91
v_fma_f32 v96,v96,s37,-v21
s_waitcnt lgkmcnt(4)
M v[184:187],a[216:219],v[40:43],0
T a[236:237],v12 offset:256
v_fma_f32 v97,v97,s37,-v21
v_max3_f32 v28,v28,v92,v93
M v[188:191],a[216:219],v[44:47],0
T a[238:239],v12 offset:6400
s_add_u32 m0,m0,0xc00
v_fma_f32 v98,v98,s37,-v21
M v[192:195],a[216:219],v[48:51],0
v_fma_f32 v99,v99,s37,-v21
v_max3_f32 v28,v28,v94,v95
v_max3_f32 v28,v28,v96,v97
M v[204:207],a[220:223],v[48:51],0
v_max3_f32 v28,v28,v98,v99
M v[200:203],a[220:223],v[44:47],0
s_add_u32 s29,s29,0x3000
M v[196:199],a[220:223],v[40:43],0
M v[208:211],a[224:227],v[40:43],0
L v100,s[4:7],s35 offen nt lds
M v[212:215],a[224:227],v[44:47],0
M v[216:219],a[224:227],v[48:51],0
s_waitcnt vmcnt(10) lgkmcnt(0)
s_barrier
M v[228:231],a[228:231],v[48:51],0
ds_read_b128 a[216:219],v3 offset:24576
ds_read_b128 a[220:223],v4 offset:24576
M v[224:227],a[228:231],v[44:47],0
ds_read_b128 a[224:227],v3 offset:24704
M v[220:223],a[228:231],v[40:43],0
L v101,s[4:7],s35 offen offset:1024 nt lds
M v[232:235],a[232:235],v[40:43],0
ds_read_b128 a[228:231],v4 offset:24704
M v[236:239],a[232:235],v[44:47],0
M v[240:243],a[232:235],v[48:51],0
ds_read_b128 a[232:235],v3 offset:24832
M v[252:255],a[236:239],v[48:51],0
L v102,s[4:7],s35 offen offset:2048 nt lds
M v[248:251],a[236:239],v[44:47],0
M v[244:247],a[236:239],v[40:43],0
s_mov_b32 s36,6
.p2align 3
C0_loop3:
v_cmp_lt_f32 vcc,0x41000000,v28
s_cbranch_vccnz C0_73_r
C0_73_b:
s_waitcnt lgkmcnt(2)
M v[52:55],a[216:219],a[144:147],0
ds_read_b128 a[236:239],v4 offset:24832
s_add_u32 m0,s28,0xc000
v_exp_f32 v76,v76
M v[56:59],a[216:219],a[148:151],0
v_exp_f32 v80,v80
v_exp_f32 v84,v84
M v[60:63],a[216:219],a[152:155],0
s_add_u32 s35,s30,0xc00
v_exp_f32 v77,v77
M v[60:63],a[220:223],a[164:167],v[60:63]
ds_read_b128 a[216:219],v3 offset:30720
v_exp_f32 v81,v81
M v[56:59],a[220:223],a[160:163],v[56:59]
v_exp_f32 v85,v85
v_add_f32 v22,v22,v76
v_add_f32 v23,v23,v80
M v[52:55],a[220:223],a[156:159],v[52:55]
L v100,s[8:11],s30 offen nt lds
v_add_f32 v24,v24,v84
v_exp_f32 v78,v78
M v[52:55],a[224:227],a[168:171],v[52:55]
ds_read_b128 a[220:223],v4 offset:30720
v_exp_f32 v82,v82
M v[56:59],a[224:227],a[172:175],v[56:59]
v_exp_f32 v86,v86
v_add_f32 v22,v22,v77
v_add_f32 v23,v23,v81
M v[60:63],a[224:227],a[176:179],v[60:63]
v_add_f32 v24,v24,v85
C v40,v76,v77
C v44,v80,v81
s_waitcnt lgkmcnt(2)
M v[60:63],a[228:231],a[188:191],v[60:63]
ds_read_b128 a[224:227],v3 offset:30848
L v101,s[8:11],s30 offen offset:1024 nt lds
C v48,v84,v85
M v[56:59],a[228:231],a[184:187],v[56:59]
v_exp_f32 v79,v79
v_exp_f32 v83,v83
M v[52:55],a[228:231],a[180:183],v[52:55]
v_exp_f32 v87,v87
v_add_f32 v22,v22,v78
v_add_f32 v23,v23,v82
M v[52:55],a[232:235],a[192:195],v[52:55]
ds_read_b128 a[228:231],v4 offset:30848
L v102,s[8:11],s30 offen offset:2048 nt lds
v_add_f32 v24,v24,v86
M v[56:59],a[232:235],a[196:199],v[56:59]
v_exp_f32 v88,v88
v_exp_f32 v92,v92
M v[60:63],a[232:235],a[200:203],v[60:63]
v_exp_f32 v96,v96
v_add_f32 v22,v22,v79
v_add_f32 v23,v23,v83
M v[60:63],a[236:239],a[212:215],v[60:63]
ds_read_b128 a[232:235],v3 offset:30976
s_add_u32 m0,m0,0xc00
v_add_f32 v24,v24,v87
C v41,v78,v79
M v[56:59],a[236:239],a[208:211],v[56:59]
C v45,v82,v83
C v49,v86,v87
v_exp_f32 v89,v89
M v[52:55],a[236:239],a[204:207],v[52:55]
v_exp_f32 v93,v93
s_waitcnt lgkmcnt(2)
M v[64:67],a[216:219],a[144:147],0
ds_read_b128 a[236:239],v4 offset:30976
v_exp_f32 v97,v97
v_add_f32 v22,v22,v88
M v[68:71],a[216:219],a[148:151],0
s_add_u32 s30,s30,0x3000
v_add_f32 v23,v23,v92
v_add_f32 v24,v24,v96
M v[72:75],a[216:219],a[152:155],0
v_exp_f32 v90,v90
v_exp_f32 v94,v94
M v[72:75],a[220:223],a[164:167],v[72:75]
L v100,s[8:11],s35 offen nt lds
v_exp_f32 v98,v98
v_add_f32 v22,v22,v89
M v[68:71],a[220:223],a[160:163],v[68:71]
v_add_f32 v23,v23,v93
v_add_f32 v24,v24,v97
C v42,v88,v89
C v46,v92,v93
M v[64:67],a[220:223],a[156:159],v[64:67]
C v50,v96,v97
v_exp_f32 v91,v91
M v[64:67],a[224:227],a[168:171],v[64:67]
L v101,s[8:11],s35 offen offset:1024 nt lds
v_exp_f32 v95,v95
M v[68:71],a[224:227],a[172:175],v[68:71]
v_exp_f32 v99,v99
v_add_f32 v22,v22,v90
v_add_f32 v23,v23,v94
M v[72:75],a[224:227],a[176:179],v[72:75]
s_waitcnt vmcnt(11) lgkmcnt(0)
s_barrier
v_add_f32 v24,v24,v98
C v43,v90,v91
M v[72:75],a[228:231],a[188:191],v[72:75]
T a[216:217],v5
T a[218:219],v5 offset:6144
C v47,v94,v95
C v51,v98,v99
M v[68:71],a[228:231],a[184:187],v[68:71]
T a[220:221],v6
T a[222:223],v6 offset:6144
v_add_f32 v22,v22,v91
v_add_f32 v23,v23,v95
M v[64:67],a[228:231],a[180:183],v[64:67]
T a[224:225],v7
T a[226:227],v7 offset:6144
v_add_f32 v24,v24,v99
M v[64:67],a[232:235],a[192:195],v[64:67]
T a[228:229],v8
T a[230:231],v8 offset:6144
M v[68:71],a[232:235],a[196:199],v[68:71]
L v102,s[8:11],s35 offen offset:2048 nt lds
M v[72:75],a[232:235],a[200:203],v[72:75]
T a[232:233],v5 offset:128
T a[234:235],v5 offset:6272
M v[72:75],a[236:239],a[212:215],v[72:75]
M v[68:71],a[236:239],a[208:211],v[68:71]
M v[64:67],a[236:239],a[204:207],v[64:67]
s_waitcnt lgkmcnt(4)
M v[112:115],a[216:219],v[40:43],v[112:115]
T a[236:237],v6 offset:128
s_add_u32 m0,s28,0x12000
M v[116:119],a[216:219],v[44:47],v[116:119]
T a[238:239],v6 offset:6272
M v[120:123],a[216:219],v[48:51],v[120:123]
M v[132:135],a[220:223],v[48:51],v[132:135]
T a[216:217],v7 offset:128
s_add_u32 s35,s29,0xc00
v_fma_f32 v52,v52,s37,-v19
M v[128:131],a[220:223],v[44:47],v[128:131]
T a[218:219],v7 offset:6272
v_fma_f32 v53,v53,s37,-v19
v_fma_f32 v54,v54,s37,-v19
M v[124:127],a[220:223],v[40:43],v[124:127]
v_fma_f32 v55,v55,s37,-v19
v_fma_f32 v56,v56,s37,-v20
v_fma_f32 v57,v57,s37,-v20
M v[136:139],a[224:227],v[40:43],v[136:139]
T a[220:221],v8 offset:128
v_max3_f32 v28,v52,v53,v54
v_fma_f32 v58,v58,s37,-v20
M v[140:143],a[224:227],v[44:47],v[140:143]
T a[222:223],v8 offset:6272
L v100,s[4:7],s29 offen nt lds
v_fma_f32 v59,v59,s37,-v20
M v[144:147],a[224:227],v[48:51],v[144:147]
v_max3_f32 v28,v28,v55,v56
v_fma_f32 v60,v60,s37,-v21
s_waitcnt lgkmcnt(4)
M v[156:159],a[228:231],v[48:51],v[156:159]
T a[224:225],v5 offset:256
v_fma_f32 v61,v61,s37,-v21
v_max3_f32 v28,v28,v57,v58
M v[152:155],a[228:231],v[44:47],v[152:155]
T a[226:227],v5 offset:6400
v_fma_f32 v62,v62,s37,-v21
v_fma_f32 v63,v63,s37,-v21
M v[148:151],a[228:231],v[40:43],v[148:151]
L v101,s[4:7],s29 offen offset:1024 nt lds
v_max3_f32 v28,v28,v59,v60
v_max3_f32 v28,v28,v61,v62
M v[160:163],a[232:235],v[40:43],v[160:163]
T a[228:229],v6 offset:256
v_max_f32 v28,v28,v63
v_fma_f32 v64,v64,s37,-v19
M v[164:167],a[232:235],v[44:47],v[164:167]
T a[230:231],v6 offset:6400
v_fma_f32 v65,v65,s37,-v19
v_fma_f32 v66,v66,s37,-v19
M v[168:171],a[232:235],v[48:51],v[168:171]
v_fma_f32 v67,v67,s37,-v19
v_fma_f32 v68,v68,s37,-v20
v_fma_f32 v69,v69,s37,-v20
M v[180:183],a[236:239],v[48:51],v[180:183]
T a[232:233],v7 offset:256
L v102,s[4:7],s29 offen offset:2048 nt lds
v_max3_f32 v28,v28,v64,v65
M v[176:179],a[236:239],v[44:47],v[176:179]
T a[234:235],v7 offset:6400
v_fma_f32 v70,v70,s37,-v20
v_fma_f32 v71,v71,s37,-v20
M v[172:175],a[236:239],v[40:43],v[172:175]
v_max3_f32 v28,v28,v66,v67
v_fma_f32 v72,v72,s37,-v21
s_waitcnt lgkmcnt(4)
M v[184:187],a[216:219],v[40:43],v[184:187]
T a[236:237],v8 offset:256
v_fma_f32 v73,v73,s37,-v21
v_max3_f32 v28,v28,v68,v69
M v[188:191],a[216:219],v[44:47],v[188:191]
T a[238:239],v8 offset:6400
s_add_u32 m0,m0,0xc00
v_fma_f32 v74,v74,s37,-v21
M v[192:195],a[216:219],v[48:51],v[192:195]
v_fma_f32 v75,v75,s37,-v21
v_max3_f32 v28,v28,v70,v71
v_max3_f32 v28,v28,v72,v73
M v[204:207],a[220:223],v[48:51],v[204:207]
v_max3_f32 v28,v28,v74,v75
M v[200:203],a[220:223],v[44:47],v[200:203]
s_add_u32 s29,s29,0x3000
M v[196:199],a[220:223],v[40:43],v[196:199]
M v[208:211],a[224:227],v[40:43],v[208:211]
L v100,s[4:7],s35 offen nt lds
M v[212:215],a[224:227],v[44:47],v[212:215]
M v[216:219],a[224:227],v[48:51],v[216:219]
s_waitcnt vmcnt(10) lgkmcnt(0)
s_barrier
M v[228:231],a[228:231],v[48:51],v[228:231]
ds_read_b128 a[216:219],v1 offset:24576
ds_read_b128 a[220:223],v2 offset:24576
M v[224:227],a[228:231],v[44:47],v[224:227]
ds_read_b128 a[224:227],v1 offset:24704
M v[220:223],a[228:231],v[40:43],v[220:223]
L v101,s[4:7],s35 offen offset:1024 nt lds
M v[232:235],a[232:235],v[40:43],v[232:235]
ds_read_b128 a[228:231],v2 offset:24704
M v[236:239],a[232:235],v[44:47],v[236:239]
M v[240:243],a[232:235],v[48:51],v[240:243]
ds_read_b128 a[232:235],v1 offset:24832
M v[252:255],a[236:239],v[48:51],v[252:255]
L v102,s[4:7],s35 offen offset:2048 nt lds
M v[248:251],a[236:239],v[44:47],v[248:251]
M v[244:247],a[236:239],v[40:43],v[244:247]
v_cmp_lt_f32 vcc,0x41000000,v28
s_cbranch_vccnz C0_75_r
C0_75_b:
s_waitcnt lgkmcnt(2)
M v[76:79],a[216:219],a[144:147],0
ds_read_b128 a[236:239],v2 offset:24832
s_add_u32 m0,s28,0
v_exp_f32 v52,v52
M v[80:83],a[216:219],a[148:151],0
v_exp_f32 v56,v56
v_exp_f32 v60,v60
M v[84:87],a[216:219],a[152:155],0
s_add_u32 s35,s30,0xc00
v_exp_f32 v53,v53
M v[84:87],a[220:223],a[164:167],v[84:87]
ds_read_b128 a[216:219],v1 offset:30720
v_exp_f32 v57,v57
M v[80:83],a[220:223],a[160:163],v[80:83]
v_exp_f32 v61,v61
v_add_f32 v22,v22,v52
v_add_f32 v23,v23,v56
M v[76:79],a[220:223],a[156:159],v[76:79]
L v100,s[8:11],s30 offen nt lds
v_add_f32 v24,v24,v60
v_exp_f32 v54,v54
M v[76:79],a[224:227],a[168:171],v[76:79]
ds_read_b128 a[220:223],v2 offset:30720
v_exp_f32 v58,v58
M v[80:83],a[224:227],a[172:175],v[80:83]
v_exp_f32 v62,v62
v_add_f32 v22,v22,v53
v_add_f32 v23,v23,v57
M v[84:87],a[224:227],a[176:179],v[84:87]
v_add_f32 v24,v24,v61
C v40,v52,v53
C v44,v56,v57
s_waitcnt lgkmcnt(2)
M v[84:87],a[228:231],a[188:191],v[84:87]
ds_read_b128 a[224:227],v1 offset:30848
L v101,s[8:11],s30 offen offset:1024 nt lds
C v48,v60,v61
M v[80:83],a[228:231],a[184:187],v[80:83]
v_exp_f32 v55,v55
v_exp_f32 v59,v59
M v[76:79],a[228:231],a[180:183],v[76:79]
v_exp_f32 v63,v63
v_add_f32 v22,v22,v54
v_add_f32 v23,v23,v58
M v[76:79],a[232:235],a[192:195],v[76:79]
ds_read_b128 a[228:231],v2 offset:30848
L v102,s[8:11],s30 offen offset:2048 nt lds
v_add_f32 v24,v24,v62
M v[80:83],a[232:235],a[196:199],v[80:83]
v_exp_f32 v64,v64
v_exp_f32 v68,v68
M v[84:87],a[232:235],a[200:203],v[84:87]
v_exp_f32 v72,v72
v_add_f32 v22,v22,v55
v_add_f32 v23,v23,v59
M v[84:87],a[236:239],a[212:215],v[84:87]
ds_read_b128 a[232:235],v1 offset:30976
s_add_u32 m0,m0,0xc00
v_add_f32 v24,v24,v63
C v41,v54,v55
M v[80:83],a[236:239],a[208:211],v[80:83]
C v45,v58,v59
C v49,v62,v63
v_exp_f32 v65,v65
M v[76:79],a[236:239],a[204:207],v[76:79]
v_exp_f32 v69,v69
s_waitcnt lgkmcnt(2)
M v[88:91],a[216:219],a[144:147],0
ds_read_b128 a[236:239],v2 offset:30976
v_exp_f32 v73,v73
v_add_f32 v22,v22,v64
M v[92:95],a[216:219],a[148:151],0
s_add_u32 s30,s30,0x3000
v_add_f32 v23,v23,v68
v_add_f32 v24,v24,v72
M v[96:99],a[216:219],a[152:155],0
v_exp_f32 v66,v66
v_exp_f32 v70,v70
M v[96:99],a[220:223],a[164:167],v[96:99]
L v100,s[8:11],s35 offen nt lds
v_exp_f32 v74,v74
v_add_f32 v22,v22,v65
M v[92:95],a[220:223],a[160:163],v[92:95]
v_add_f32 v23,v23,v69
v_add_f32 v24,v24,v73
C v42,v64,v65
C v46,v68,v69
M v[88:91],a[220:223],a[156:159],v[88:91]
C v50,v72,v73
v_exp_f32 v67,v67
M v[88:91],a[224:227],a[168:171],v[88:91]
L v101,s[8:11],s35 offen offset:1024 nt lds
v_exp_f32 v71,v71
M v[92:95],a[224:227],a[172:175],v[92:95]
v_exp_f32 v75,v75
v_add_f32 v22,v22,v66
v_add_f32 v23,v23,v70
M v[96:99],a[224:227],a[176:179],v[96:99]
s_waitcnt vmcnt(11) lgkmcnt(0)
s_barrier
v_add_f32 v24,v24,v74
C v43,v66,v67
M v[96:99],a[228:231],a[188:191],v[96:99]
T a[216:217],v9
T a[218:219],v9 offset:6144
C v47,v70,v71
C v51,v74,v75
M v[92:95],a[228:231],a[184:187],v[92:95]
T a[220:221],v10
T a[222:223],v10 offset:6144
v_add_f32 v22,v22,v67
v_add_f32 v23,v23,v71
M v[88:91],a[228:231],a[180:183],v[88:91]
T a[224:225],v11
T a[226:227],v11 offset:6144
v_add_f32 v24,v24,v75
M v[88:91],a[232:235],a[192:195],v[88:91]
T a[228:229],v12
T a[230:231],v12 offset:6144
M v[92:95],a[232:235],a[196:199],v[92:95]
L v102,s[8:11],s35 offen offset:2048 nt lds
M v[96:99],a[232:235],a[200:203],v[96:99]
T a[232:233],v9 offset:128
T a[234:235],v9 offset:6272
M v[96:99],a[236:239],a[212:215],v[96:99]
M v[92:95],a[236:239],a[208:211],v[92:95]
M v[88:91],a[236:239],a[204:207],v[88:91]
s_waitcnt lgkmcnt(4)
M v[112:115],a[216:219],v[40:43],v[112:115]
T a[236:237],v10 offset:128
s_add_u32 m0,s28,0x6000
M v[116:119],a[216:219],v[44:47],v[116:119]
T a[238:239],v10 offset:6272
M v[120:123],a[216:219],v[48:51],v[120:123]
M v[132:135],a[220:223],v[48:51],v[132:135]
T a[216:217],v11 offset:128
s_add_u32 s35,s29,0xc00
v_fma_f32 v76,v76,s37,-v19
M v[128:131],a[220:223],v[44:47],v[128:131]
T a[218:219],v11 offset:6272
v_fma_f32 v77,v77,s37,-v19
v_fma_f32 v78,v78,s37,-v19
M v[124:127],a[220:223],v[40:43],v[124:127]
v_fma_f32 v79,v79,s37,-v19
v_fma_f32 v80,v80,s37,-v20
v_fma_f32 v81,v81,s37,-v20
M v[136:139],a[224:227],v[40:43],v[136:139]
T a[220:221],v12 offset:128
v_max3_f32 v28,v76,v77,v78
v_fma_f32 v82,v82,s37,-v20
M v[140:143],a[224:227],v[44:47],v[140:143]
T a[222:223],v12 offset:6272
L v100,s[4:7],s29 offen nt lds
v_fma_f32 v83,v83,s37,-v20
M v[144:147],a[224:227],v[48:51],v[144:147]
v_max3_f32 v28,v28,v79,v80
v_fma_f32 v84,v84,s37,-v21
s_waitcnt lgkmcnt(4)
M v[156:159],a[228:231],v[48:51],v[156:159]
T a[224:225],v9 offset:256
v_fma_f32 v85,v85,s37,-v21
v_max3_f32 v28,v28,v81,v82
M v[152:155],a[228:231],v[44:47],v[152:155]
T a[226:227],v9 offset:6400
v_fma_f32 v86,v86,s37,-v21
v_fma_f32 v87,v87,s37,-v21
M v[148:151],a[228:231],v[40:43],v[148:151]
L v101,s[4:7],s29 offen offset:1024 nt lds
v_max3_f32 v28,v28,v83,v84
v_max3_f32 v28,v28,v85,v86
M v[160:163],a[232:235],v[40:43],v[160:163]
T a[228:229],v10 offset:256
v_max_f32 v28,v28,v87
v_fma_f32 v88,v88,s37,-v19
M v[164:167],a[232:235],v[44:47],v[164:167]
T a[230:231],v10 offset:6400
v_fma_f32 v89,v89,s37,-v19
v_fma_f32 v90,v90,s37,-v19
M v[168:171],a[232:235],v[48:51],v[168:171]
v_fma_f32 v91,v91,s37,-v19
v_fma_f32 v92,v92,s37,-v20
v_fma_f32 v93,v93,s37,-v20
M v[180:183],a[236:239],v[48:51],v[180:183]
T a[232:233],v11 offset:256
L v102,s[4:7],s29 offen offset:2048 nt lds
v_max3_f32 v28,v28,v88,v89
M v[176:179],a[236:239],v[44:47],v[176:179]
T a[234:235],v11 offset:6400
v_fma_f32 v94,v94,s37,-v20
v_fma_f32 v95,v95,s37,-v20
M v[172:175],a[236:239],v[40:43],v[172:175]
v_max3_f32 v28,v28,v90,v91
v_fma_f32 v96,v96,s37,-v21
s_waitcnt lgkmcnt(4)
M v[184:187],a[216:219],v[40:43],v[184:187]
T a[236:237],v12 offset:256
v_fma_f32 v97,v97,s37,-v21
v_max3_f32 v28,v28,v92,v93
M v[188:191],a[216:219],v[44:47],v[188:191]
T a[238:239],v12 offset:6400
s_add_u32 m0,m0,0xc00
v_fma_f32 v98,v98,s37,-v21
M v[192:195],a[216:219],v[48:51],v[192:195]
v_fma_f32 v99,v99,s37,-v21
v_max3_f32 v28,v28,v94,v95
v_max3_f32 v28,v28,v96,v97
M v[204:207],a[220:223],v[48:51],v[204:207]
v_max3_f32 v28,v28,v98,v99
M v[200:203],a[220:223],v[44:47],v[200:203]
s_add_u32 s29,s29,0x3000
M v[196:199],a[220:223],v[40:43],v[196:199]
M v[208:211],a[224:227],v[40:43],v[208:211]
L v100,s[4:7],s35 offen nt lds
M v[212:215],a[224:227],v[44:47],v[212:215]
M v[216:219],a[224:227],v[48:51],v[216:219]
s_waitcnt vmcnt(10) lgkmcnt(0)
s_barrier
M v[228:231],a[228:231],v[48:51],v[228:231]
ds_read_b128 a[216:219],v3 offset:24576
ds_read_b128 a[220:223],v4 offset:24576
M v[224:227],a[228:231],v[44:47],v[224:227]
ds_read_b128 a[224:227],v3 offset:24704
M v[220:223],a[228:231],v[40:43],v[220:223]
L v101,s[4:7],s35 offen offset:1024 nt lds
M v[232:235],a[232:235],v[40:43],v[232:235]
ds_read_b128 a[228:231],v4 offset:24704
M v[236:239],a[232:235],v[44:47],v[236:239]
M v[240:243],a[232:235],v[48:51],v[240:243]
ds_read_b128 a[232:235],v3 offset:24832
M v[252:255],a[236:239],v[48:51],v[252:255]
L v102,s[4:7],s35 offen offset:2048 nt lds
M v[248:251],a[236:239],v[44:47],v[248:251]
M v[244:247],a[236:239],v[40:43],v[244:247]
s_sub_u32 s36,s36,1
s_cmp_lg_u32 s36,0
s_cbranch_scc1 C0_loop3
v_cmp_lt_f32 vcc,0x41000000,v28
s_cbranch_vccnz C0_77_r
C0_77_b:
s_waitcnt lgkmcnt(2)
M v[52:55],a[216:219],a[144:147],0
ds_read_b128 a[236:239],v4 offset:24832
s_add_u32 m0,s28,0xc000
v_exp_f32 v76,v76
M v[56:59],a[216:219],a[148:151],0
v_exp_f32 v80,v80
v_exp_f32 v84,v84
M v[60:63],a[216:219],a[152:155],0
s_add_u32 s35,s30,0xc00
v_exp_f32 v77,v77
M v[60:63],a[220:223],a[164:167],v[60:63]
ds_read_b128 a[216:219],v3 offset:30720
v_exp_f32 v81,v81
M v[56:59],a[220:223],a[160:163],v[56:59]
v_exp_f32 v85,v85
v_add_f32 v22,v22,v76
v_add_f32 v23,v23,v80
M v[52:55],a[220:223],a[156:159],v[52:55]
L v100,s[8:11],s30 offen nt lds
v_add_f32 v24,v24,v84
v_exp_f32 v78,v78
M v[52:55],a[224:227],a[168:171],v[52:55]
ds_read_b128 a[220:223],v4 offset:30720
v_exp_f32 v82,v82
M v[56:59],a[224:227],a[172:175],v[56:59]
v_exp_f32 v86,v86
v_add_f32 v22,v22,v77
v_add_f32 v23,v23,v81
M v[60:63],a[224:227],a[176:179],v[60:63]
v_add_f32 v24,v24,v85
C v40,v76,v77
C v44,v80,v81
s_waitcnt lgkmcnt(2)
M v[60:63],a[228:231],a[188:191],v[60:63]
ds_read_b128 a[224:227],v3 offset:30848
L v101,s[8:11],s30 offen offset:1024 nt lds
C v48,v84,v85
M v[56:59],a[228:231],a[184:187],v[56:59]
v_exp_f32 v79,v79
v_exp_f32 v83,v83
M v[52:55],a[228:231],a[180:183],v[52:55]
v_exp_f32 v87,v87
v_add_f32 v22,v22,v78
v_add_f32 v23,v23,v82
M v[52:55],a[232:235],a[192:195],v[52:55]
ds_read_b128 a[228:231],v4 offset:30848
L v102,s[8:11],s30 offen offset:2048 nt lds
v_add_f32 v24,v24,v86
M v[56:59],a[232:235],a[196:199],v[56:59]
v_exp_f32 v88,v88
v_exp_f32 v92,v92
M v[60:63],a[232:235],a[200:203],v[60:63]
v_exp_f32 v96,v96
v_add_f32 v22,v22,v79
v_add_f32 v23,v23,v83
M v[60:63],a[236:239],a[212:215],v[60:63]
ds_read_b128 a[232:235],v3 offset:30976
s_add_u32 m0,m0,0xc00
v_add_f32 v24,v24,v87
C v41,v78,v79
M v[56:59],a[236:239],a[208:211],v[56:59]
C v45,v82,v83
C v49,v86,v87
v_exp_f32 v89,v89
M v[52:55],a[236:239],a[204:207],v[52:55]
v_exp_f32 v93,v93
s_waitcnt lgkmcnt(2)
M v[64:67],a[216:219],a[144:147],0
ds_read_b128 a[236:239],v4 offset:30976
v_exp_f32 v97,v97
v_add_f32 v22,v22,v88
M v[68:71],a[216:219],a[148:151],0
s_add_u32 s30,s30,0x3000
v_add_f32 v23,v23,v92
v_add_f32 v24,v24,v96
M v[72:75],a[216:219],a[152:155],0
v_exp_f32 v90,v90
v_exp_f32 v94,v94
M v[72:75],a[220:223],a[164:167],v[72:75]
L v100,s[8:11],s35 offen nt lds
v_exp_f32 v98,v98
v_add_f32 v22,v22,v89
M v[68:71],a[220:223],a[160:163],v[68:71]
v_add_f32 v23,v23,v93
v_add_f32 v24,v24,v97
C v42,v88,v89
C v46,v92,v93
M v[64:67],a[220:223],a[156:159],v[64:67]
C v50,v96,v97
v_exp_f32 v91,v91
M v[64:67],a[224:227],a[168:171],v[64:67]
L v101,s[8:11],s35 offen offset:1024 nt lds
v_exp_f32 v95,v95
M v[68:71],a[224:227],a[172:175],v[68:71]
v_exp_f32 v99,v99
v_add_f32 v22,v22,v90
v_add_f32 v23,v23,v94
M v[72:75],a[224:227],a[176:179],v[72:75]
s_waitcnt vmcnt(11) lgkmcnt(0)
s_barrier
v_add_f32 v24,v24,v98
C v43,v90,v91
M v[72:75],a[228:231],a[188:191],v[72:75]
T a[216:217],v5
T a[218:219],v5 offset:6144
C v47,v94,v95
C v51,v98,v99
M v[68:71],a[228:231],a[184:187],v[68:71]
T a[220:221],v6
T a[222:223],v6 offset:6144
v_add_f32 v22,v22,v91
v_add_f32 v23,v23,v95
M v[64:67],a[228:231],a[180:183],v[64:67]
T a[224:225],v7
T a[226:227],v7 offset:6144
v_add_f32 v24,v24,v99
M v[64:67],a[232:235],a[192:195],v[64:67]
T a[228:229],v8
T a[230:231],v8 offset:6144
M v[68:71],a[232:235],a[196:199],v[68:71]
L v102,s[8:11],s35 offen offset:2048 nt lds
M v[72:75],a[232:235],a[200:203],v[72:75]
T a[232:233],v5 offset:128
T a[234:235],v5 offset:6272
M v[72:75],a[236:239],a[212:215],v[72:75]
M v[68:71],a[236:239],a[208:211],v[68:71]
M v[64:67],a[236:239],a[204:207],v[64:67]
s_waitcnt lgkmcnt(4)
M v[112:115],a[216:219],v[40:43],v[112:115]
T a[236:237],v6 offset:128
s_add_u32 m0,s28,0x12000
M v[116:119],a[216:219],v[44:47],v[116:119]
T a[238:239],v6 offset:6272
M v[120:123],a[216:219],v[48:51],v[120:123]
M v[132:135],a[220:223],v[48:51],v[132:135]
T a[216:217],v7 offset:128
s_add_u32 s35,s30,0xc00
v_fma_f32 v52,v52,s37,-v19
M v[128:131],a[220:223],v[44:47],v[128:131]
T a[218:219],v7 offset:6272
v_fma_f32 v53,v53,s37,-v19
v_fma_f32 v54,v54,s37,-v19
M v[124:127],a[220:223],v[40:43],v[124:127]
v_fma_f32 v55,v55,s37,-v19
v_fma_f32 v56,v56,s37,-v20
v_fma_f32 v57,v57,s37,-v20
M v[136:139],a[224:227],v[40:43],v[136:139]
T a[220:221],v8 offset:128
v_max3_f32 v28,v52,v53,v54
v_fma_f32 v58,v58,s37,-v20
M v[140:143],a[224:227],v[44:47],v[140:143]
T a[222:223],v8 offset:6272
L v100,s[8:11],s30 offen nt lds
v_fma_f32 v59,v59,s37,-v20
M v[144:147],a[224:227],v[48:51],v[144:147]
v_max3_f32 v28,v28,v55,v56
v_fma_f32 v60,v60,s37,-v21
s_waitcnt lgkmcnt(4)
M v[156:159],a[228:231],v[48:51],v[156:159]
T a[224:225],v5 offset:256
v_fma_f32 v61,v61,s37,-v21
v_max3_f32 v28,v28,v57,v58
M v[152:155],a[228:231],v[44:47],v[152:155]
T a[226:227],v5 offset:6400
v_fma_f32 v62,v62,s37,-v21
v_fma_f32 v63,v63,s37,-v21
M v[148:151],a[228:231],v[40:43],v[148:151]
L v101,s[8:11],s30 offen offset:1024 nt lds
v_max3_f32 v28,v28,v59,v60
v_max3_f32 v28,v28,v61,v62
M v[160:163],a[232:235],v[40:43],v[160:163]
T a[228:229],v6 offset:256
v_max_f32 v28,v28,v63
v_fma_f32 v64,v64,s37,-v19
M v[164:167],a[232:235],v[44:47],v[164:167]
T a[230:231],v6 offset:6400
v_fma_f32 v65,v65,s37,-v19
v_fma_f32 v66,v66,s37,-v19
M v[168:171],a[232:235],v[48:51],v[168:171]
v_fma_f32 v67,v67,s37,-v19
v_fma_f32 v68,v68,s37,-v20
v_fma_f32 v69,v69,s37,-v20
M v[180:183],a[236:239],v[48:51],v[180:183]
T a[232:233],v7 offset:256
L v102,s[8:11],s30 offen offset:2048 nt lds
v_max3_f32 v28,v28,v64,v65
M v[176:179],a[236:239],v[44:47],v[176:179]
T a[234:235],v7 offset:6400
v_fma_f32 v70,v70,s37,-v20
v_fma_f32 v71,v71,s37,-v20
M v[172:175],a[236:239],v[40:43],v[172:175]
v_max3_f32 v28,v28,v66,v67
v_fma_f32 v72,v72,s37,-v21
s_waitcnt lgkmcnt(4)
M v[184:187],a[216:219],v[40:43],v[184:187]
T a[236:237],v8 offset:256
v_fma_f32 v73,v73,s37,-v21
v_max3_f32 v28,v28,v68,v69
M v[188:191],a[216:219],v[44:47],v[188:191]
T a[238:239],v8 offset:6400
s_add_u32 m0,m0,0xc00
v_fma_f32 v74,v74,s37,-v21
M v[192:195],a[216:219],v[48:51],v[192:195]
v_fma_f32 v75,v75,s37,-v21
v_max3_f32 v28,v28,v70,v71
v_max3_f32 v28,v28,v72,v73
M v[204:207],a[220:223],v[48:51],v[204:207]
v_max3_f32 v28,v28,v74,v75
M v[200:203],a[220:223],v[44:47],v[200:203]
s_add_u32 s30,s30,0x3000
M v[196:199],a[220:223],v[40:43],v[196:199]
M v[208:211],a[224:227],v[40:43],v[208:211]
L v100,s[8:11],s35 offen nt lds
M v[212:215],a[224:227],v[44:47],v[212:215]
M v[216:219],a[224:227],v[48:51],v[216:219]
s_waitcnt vmcnt(10) lgkmcnt(0)
s_barrier
M v[228:231],a[228:231],v[48:51],v[228:231]
ds_read_b128 a[216:219],v1 offset:24576
ds_read_b128 a[220:223],v2 offset:24576
M v[224:227],a[228:231],v[44:47],v[224:227]
ds_read_b128 a[224:227],v1 offset:24704
M v[220:223],a[228:231],v[40:43],v[220:223]
L v101,s[8:11],s35 offen offset:1024 nt lds
M v[232:235],a[232:235],v[40:43],v[232:235]
ds_read_b128 a[228:231],v2 offset:24704
M v[236:239],a[232:235],v[44:47],v[236:239]
M v[240:243],a[232:235],v[48:51],v[240:243]
ds_read_b128 a[232:235],v1 offset:24832
M v[252:255],a[236:239],v[48:51],v[252:255]
L v102,s[8:11],s35 offen offset:2048 nt lds
M v[248:251],a[236:239],v[44:47],v[248:251]
M v[244:247],a[236:239],v[40:43],v[244:247]
v_cmp_lt_f32 vcc,0x41000000,v28
s_cbranch_vccnz C0_79_r
C0_79_b:
s_waitcnt lgkmcnt(2)
M v[76:79],a[216:219],a[144:147],0
ds_read_b128 a[236:239],v2 offset:24832
s_add_u32 m0,s28,0
v_exp_f32 v52,v52
M v[80:83],a[216:219],a[148:151],0
v_exp_f32 v56,v56
v_exp_f32 v60,v60
M v[84:87],a[216:219],a[152:155],0
s_add_u32 s35,s32,0x7800
v_exp_f32 v53,v53
M v[84:87],a[220:223],a[164:167],v[84:87]
ds_read_b128 a[216:219],v1 offset:30720
v_exp_f32 v57,v57
M v[80:83],a[220:223],a[160:163],v[80:83]
v_exp_f32 v61,v61
v_add_f32 v22,v22,v52
v_add_f32 v23,v23,v56
M v[76:79],a[220:223],a[156:159],v[76:79]
L v106,s[16:19],s32 offen lds
v_add_f32 v24,v24,v60
v_exp_f32 v54,v54
M v[76:79],a[224:227],a[168:171],v[76:79]
ds_read_b128 a[220:223],v2 offset:30720
v_exp_f32 v58,v58
M v[80:83],a[224:227],a[172:175],v[80:83]
v_exp_f32 v62,v62
v_add_f32 v22,v22,v53
v_add_f32 v23,v23,v57
M v[84:87],a[224:227],a[176:179],v[84:87]
v_add_f32 v24,v24,v61
C v40,v52,v53
C v44,v56,v57
s_waitcnt lgkmcnt(2)
M v[84:87],a[228:231],a[188:191],v[84:87]
ds_read_b128 a[224:227],v1 offset:30848
L v107,s[16:19],s32 offen offset:1024 lds
C v48,v60,v61
M v[80:83],a[228:231],a[184:187],v[80:83]
v_exp_f32 v55,v55
v_exp_f32 v59,v59
M v[76:79],a[228:231],a[180:183],v[76:79]
v_exp_f32 v63,v63
v_add_f32 v22,v22,v54
v_add_f32 v23,v23,v58
M v[76:79],a[232:235],a[192:195],v[76:79]
ds_read_b128 a[228:231],v2 offset:30848
L v108,s[16:19],s32 offen offset:2048 lds
v_add_f32 v24,v24,v62
M v[80:83],a[232:235],a[196:199],v[80:83]
v_exp_f32 v64,v64
v_exp_f32 v68,v68
M v[84:87],a[232:235],a[200:203],v[84:87]
v_exp_f32 v72,v72
v_add_f32 v22,v22,v55
v_add_f32 v23,v23,v59
M v[84:87],a[236:239],a[212:215],v[84:87]
ds_read_b128 a[232:235],v1 offset:30976
s_add_u32 m0,m0,0xc00
v_add_f32 v24,v24,v63
C v41,v54,v55
M v[80:83],a[236:239],a[208:211],v[80:83]
C v45,v58,v59
C v49,v62,v63
v_exp_f32 v65,v65
M v[76:79],a[236:239],a[204:207],v[76:79]
v_exp_f32 v69,v69
s_waitcnt lgkmcnt(2)
M v[88:91],a[216:219],a[144:147],0
ds_read_b128 a[236:239],v2 offset:30976
v_exp_f32 v73,v73
v_add_f32 v22,v22,v64
M v[92:95],a[216:219],a[148:151],0
s_add_u32 s32,s32,0x78000
v_add_f32 v23,v23,v68
v_add_f32 v24,v24,v72
M v[96:99],a[216:219],a[152:155],0
v_exp_f32 v66,v66
v_exp_f32 v70,v70
M v[96:99],a[220:223],a[164:167],v[96:99]
L v106,s[16:19],s35 offen lds
v_exp_f32 v74,v74
v_add_f32 v22,v22,v65
M v[92:95],a[220:223],a[160:163],v[92:95]
v_add_f32 v23,v23,v69
v_add_f32 v24,v24,v73
C v42,v64,v65
C v46,v68,v69
M v[88:91],a[220:223],a[156:159],v[88:91]
C v50,v72,v73
v_exp_f32 v67,v67
M v[88:91],a[224:227],a[168:171],v[88:91]
L v107,s[16:19],s35 offen offset:1024 lds
v_exp_f32 v71,v71
M v[92:95],a[224:227],a[172:175],v[92:95]
v_exp_f32 v75,v75
v_add_f32 v22,v22,v66
v_add_f32 v23,v23,v70
M v[96:99],a[224:227],a[176:179],v[96:99]
s_waitcnt vmcnt(11) lgkmcnt(0)
s_barrier
v_add_f32 v24,v24,v74
C v43,v66,v67
M v[96:99],a[228:231],a[188:191],v[96:99]
T a[216:217],v9
T a[218:219],v9 offset:6144
C v47,v70,v71
C v51,v74,v75
M v[92:95],a[228:231],a[184:187],v[92:95]
T a[220:221],v10
T a[222:223],v10 offset:6144
v_add_f32 v22,v22,v67
v_add_f32 v23,v23,v71
M v[88:91],a[228:231],a[180:183],v[88:91]
T a[224:225],v11
T a[226:227],v11 offset:6144
v_add_f32 v24,v24,v75
M v[88:91],a[232:235],a[192:195],v[88:91]
T a[228:229],v12
T a[230:231],v12 offset:6144
M v[92:95],a[232:235],a[196:199],v[92:95]
L v108,s[16:19],s35 offen offset:2048 lds
M v[96:99],a[232:235],a[200:203],v[96:99]
T a[232:233],v9 offset:128
T a[234:235],v9 offset:6272
M v[96:99],a[236:239],a[212:215],v[96:99]
M v[92:95],a[236:239],a[208:211],v[92:95]
M v[88:91],a[236:239],a[204:207],v[88:91]
s_waitcnt lgkmcnt(4)
M v[112:115],a[216:219],v[40:43],v[112:115]
T a[236:237],v10 offset:128
s_add_u32 m0,s28,0x6000
M v[116:119],a[216:219],v[44:47],v[116:119]
T a[238:239],v10 offset:6272
M v[120:123],a[216:219],v[48:51],v[120:123]
s_add_u32 s35,s32,0x7800
M v[132:135],a[220:223],v[48:51],v[132:135]
T a[216:217],v11 offset:128
v_fma_f32 v76,v76,s37,-v19
v_fma_f32 v77,v77,s37,-v19
M v[128:131],a[220:223],v[44:47],v[128:131]
T a[218:219],v11 offset:6272
v_fma_f32 v78,v78,s37,-v19
v_fma_f32 v79,v79,s37,-v19
M v[124:127],a[220:223],v[40:43],v[124:127]
L v106,s[16:19],s32 offen lds
v_fma_f32 v80,v80,s37,-v20
v_fma_f32 v81,v81,s37,-v20
M v[136:139],a[224:227],v[40:43],v[136:139]
T a[220:221],v12 offset:128
v_max3_f32 v28,v76,v77,v78
v_fma_f32 v82,v82,s37,-v20
M v[140:143],a[224:227],v[44:47],v[140:143]
T a[222:223],v12 offset:6272
v_fma_f32 v83,v83,s37,-v20
v_max3_f32 v28,v28,v79,v80
M v[144:147],a[224:227],v[48:51],v[144:147]
L v107,s[16:19],s32 offen offset:1024 lds
v_fma_f32 v84,v84,s37,-v21
s_waitcnt lgkmcnt(4)
M v[156:159],a[228:231],v[48:51],v[156:159]
T a[224:225],v9 offset:256
v_fma_f32 v85,v85,s37,-v21
v_max3_f32 v28,v28,v81,v82
M v[152:155],a[228:231],v[44:47],v[152:155]
T a[226:227],v9 offset:6400
v_fma_f32 v86,v86,s37,-v21
v_fma_f32 v87,v87,s37,-v21
M v[148:151],a[228:231],v[40:43],v[148:151]
L v108,s[16:19],s32 offen offset:2048 lds
v_max3_f32 v28,v28,v83,v84
v_max3_f32 v28,v28,v85,v86
M v[160:163],a[232:235],v[40:43],v[160:163]
T a[228:229],v10 offset:256
v_max_f32 v28,v28,v87
v_fma_f32 v88,v88,s37,-v19
M v[164:167],a[232:235],v[44:47],v[164:167]
T a[230:231],v10 offset:6400
v_fma_f32 v89,v89,s37,-v19
v_fma_f32 v90,v90,s37,-v19
M v[168:171],a[232:235],v[48:51],v[168:171]
s_add_u32 m0,m0,0xc00
v_fma_f32 v91,v91,s37,-v19
v_fma_f32 v92,v92,s37,-v20
M v[180:183],a[236:239],v[48:51],v[180:183]
T a[232:233],v11 offset:256
v_fma_f32 v93,v93,s37,-v20
v_max3_f32 v28,v28,v88,v89
M v[176:179],a[236:239],v[44:47],v[176:179]
T a[234:235],v11 offset:6400
v_fma_f32 v94,v94,s37,-v20
v_fma_f32 v95,v95,s37,-v20
M v[172:175],a[236:239],v[40:43],v[172:175]
s_add_u32 s32,s32,0xfff88080
v_max3_f32 v28,v28,v90,v91
s_waitcnt lgkmcnt(4)
M v[184:187],a[216:219],v[40:43],v[184:187]
T a[236:237],v12 offset:256
v_fma_f32 v96,v96,s37,-v21
v_fma_f32 v97,v97,s37,-v21
M v[188:191],a[216:219],v[44:47],v[188:191]
T a[238:239],v12 offset:6400
v_max3_f32 v28,v28,v92,v93
v_fma_f32 v98,v98,s37,-v21
M v[192:195],a[216:219],v[48:51],v[192:195]
L v106,s[16:19],s35 offen lds
v_fma_f32 v99,v99,s37,-v21
v_max3_f32 v28,v28,v94,v95
M v[204:207],a[220:223],v[48:51],v[204:207]
v_max3_f32 v28,v28,v96,v97
v_max3_f32 v28,v28,v98,v99
M v[200:203],a[220:223],v[44:47],v[200:203]
L v107,s[16:19],s35 offen offset:1024 lds
M v[196:199],a[220:223],v[40:43],v[196:199]
M v[208:211],a[224:227],v[40:43],v[208:211]
L v108,s[16:19],s35 offen offset:2048 lds
M v[212:215],a[224:227],v[44:47],v[212:215]
M v[216:219],a[224:227],v[48:51],v[216:219]
s_waitcnt vmcnt(12) lgkmcnt(0)
s_barrier
M v[228:231],a[228:231],v[48:51],v[228:231]
T a[216:217],v9 offset:24576
T a[218:219],v9 offset:30720
M v[224:227],a[228:231],v[44:47],v[224:227]
T a[220:221],v10 offset:24576
T a[222:223],v10 offset:30720
M v[220:223],a[228:231],v[40:43],v[220:223]
T a[224:225],v11 offset:24576
T a[226:227],v11 offset:30720
M v[232:235],a[232:235],v[40:43],v[232:235]
T a[228:229],v12 offset:24576
T a[230:231],v12 offset:30720
M v[236:239],a[232:235],v[44:47],v[236:239]
M v[240:243],a[232:235],v[48:51],v[240:243]
T a[232:233],v9 offset:24704
T a[234:235],v9 offset:30848
M v[252:255],a[236:239],v[48:51],v[252:255]
s_cmp_eq_u32 s32,s43
s_cselect_b32 s32,s42,s32
M v[248:251],a[236:239],v[44:47],v[248:251]
M v[244:247],a[236:239],v[40:43],v[244:247]
v_cmp_lt_f32 vcc,0x41000000,v28
s_cbranch_vccnz C0_81_r
C0_81_b:
v_exp_f32 v76,v76
v_exp_f32 v80,v80
v_exp_f32 v84,v84
v_exp_f32 v77,v77
v_exp_f32 v81,v81
v_exp_f32 v85,v85
v_add_f32 v22,v22,v76
v_add_f32 v23,v23,v80
v_add_f32 v24,v24,v84
v_exp_f32 v78,v78
v_exp_f32 v82,v82
v_exp_f32 v86,v86
v_add_f32 v22,v22,v77
v_add_f32 v23,v23,v81
v_add_f32 v24,v24,v85
C v40,v76,v77
C v44,v80,v81
C v48,v84,v85
v_exp_f32 v79,v79
v_exp_f32 v83,v83
v_exp_f32 v87,v87
v_add_f32 v22,v22,v78
v_add_f32 v23,v23,v82
v_add_f32 v24,v24,v86
v_exp_f32 v88,v88
v_exp_f32 v92,v92
v_exp_f32 v96,v96
v_add_f32 v22,v22,v79
v_add_f32 v23,v23,v83
v_add_f32 v24,v24,v87
C v41,v78,v79
C v45,v82,v83
C v49,v86,v87
v_exp_f32 v89,v89
v_exp_f32 v93,v93
v_exp_f32 v97,v97
v_add_f32 v22,v22,v88
v_add_f32 v23,v23,v92
v_add_f32 v24,v24,v96
v_exp_f32 v90,v90
v_exp_f32 v94,v94
v_exp_f32 v98,v98
v_add_f32 v22,v22,v89
v_add_f32 v23,v23,v93
v_add_f32 v24,v24,v97
C v42,v88,v89
C v46,v92,v93
C v50,v96,v97
v_exp_f32 v91,v91
v_exp_f32 v95,v95
v_exp_f32 v99,v99
v_add_f32 v22,v22,v90
v_add_f32 v23,v23,v94
v_add_f32 v24,v24,v98
C v43,v90,v91
C v47,v94,v95
C v51,v98,v99
s_waitcnt lgkmcnt(4)
M v[112:115],a[216:219],v[40:43],v[112:115]
T a[236:237],v10 offset:24704
v_add_f32 v22,v22,v91
M v[116:119],a[216:219],v[44:47],v[116:119]
T a[238:239],v10 offset:30848
v_add_f32 v23,v23,v95
M v[120:123],a[216:219],v[48:51],v[120:123]
v_add_f32 v24,v24,v99
s_add_u32 m0,s28,0xc000
M v[132:135],a[220:223],v[48:51],v[132:135]
T a[216:217],v11 offset:24704
M v[128:131],a[220:223],v[44:47],v[128:131]
T a[218:219],v11 offset:30848
M v[124:127],a[220:223],v[40:43],v[124:127]
s_add_u32 s35,s32,0x7800
M v[136:139],a[224:227],v[40:43],v[136:139]
T a[220:221],v12 offset:24704
v_mov_b32 v25,v22
v_mov_b32 v26,v23
v_mov_b32 v27,v24
v_permlane32_swap_b32 v22,v25
M v[140:143],a[224:227],v[44:47],v[140:143]
T a[222:223],v12 offset:30848
v_permlane32_swap_b32 v23,v26
v_permlane32_swap_b32 v24,v27
v_add_f32 v22,v22,v25
v_add_f32 v23,v23,v26
M v[144:147],a[224:227],v[48:51],v[144:147]
L v106,s[16:19],s32 offen lds
v_add_f32 v24,v24,v27
v_mov_b32 v25,v22
v_mov_b32 v26,v23
s_waitcnt lgkmcnt(4)
M v[156:159],a[228:231],v[48:51],v[156:159]
T a[224:225],v9 offset:24832
v_mov_b32 v27,v24
v_permlane16_swap_b32 v22,v25
v_permlane16_swap_b32 v23,v26
v_permlane16_swap_b32 v24,v27
M v[152:155],a[228:231],v[44:47],v[152:155]
T a[226:227],v9 offset:30976
v_add_f32 v22,v22,v25
v_add_f32 v23,v23,v26
v_add_f32 v24,v24,v27
M v[148:151],a[228:231],v[40:43],v[148:151]
L v107,s[16:19],s32 offen offset:1024 lds
v_rcp_f32 v30,v22
v_rcp_f32 v32,v23
M v[160:163],a[232:235],v[40:43],v[160:163]
T a[228:229],v10 offset:24832
v_rcp_f32 v34,v24
v_mov_b32 v31,v30
v_mov_b32 v33,v32
M v[164:167],a[232:235],v[44:47],v[164:167]
T a[230:231],v10 offset:30976
v_mov_b32 v35,v34
v_add_u32 v36,s47,v0
v_add_u32 v37,s48,v0
v_add_u32 v38,s49,v0
M v[168:171],a[232:235],v[48:51],v[168:171]
L v108,s[16:19],s32 offen offset:2048 lds
v_mul_f32 v112,v112,v30
v_mul_f32 v113,v113,v30
M v[180:183],a[236:239],v[48:51],v[180:183]
T a[232:233],v11 offset:24832
v_mul_f32 v114,v114,v30
v_mul_f32 v115,v115,v30
M v[176:179],a[236:239],v[44:47],v[176:179]
T a[234:235],v11 offset:30976
v_mul_f32 v124,v124,v30
v_mul_f32 v125,v125,v30
M v[172:175],a[236:239],v[40:43],v[172:175]
v_mul_f32 v126,v126,v30
v_mul_f32 v127,v127,v30
s_waitcnt lgkmcnt(4)
M v[184:187],a[216:219],v[40:43],v[184:187]
T a[236:237],v12 offset:24832
s_add_u32 m0,m0,0xc00
v_mul_f32 v116,v116,v32
M v[188:191],a[216:219],v[44:47],v[188:191]
T a[238:239],v12 offset:30976
v_mul_f32 v117,v117,v32
v_mul_f32 v118,v118,v32
M v[192:195],a[216:219],v[48:51],v[192:195]
v_mul_f32 v119,v119,v32
v_mul_f32 v128,v128,v32
v_mul_f32 v129,v129,v32
M v[204:207],a[220:223],v[48:51],v[204:207]
s_add_u32 s32,s32,0x78000
v_mul_f32 v130,v130,v32
v_mul_f32 v131,v131,v32
M v[200:203],a[220:223],v[44:47],v[200:203]
v_mul_f32 v120,v120,v34
v_mul_f32 v121,v121,v34
v_mul_f32 v122,v122,v34
M v[196:199],a[220:223],v[40:43],v[196:199]
L v106,s[16:19],s35 offen lds
v_mul_f32 v123,v123,v34
v_mul_f32 v132,v132,v34
M v[208:211],a[224:227],v[40:43],v[208:211]
v_mul_f32 v133,v133,v34
v_mul_f32 v134,v134,v34
v_mul_f32 v135,v135,v34
M v[212:215],a[224:227],v[44:47],v[212:215]
L v107,s[16:19],s35 offen offset:1024 lds
C v52,v112,v113
C v53,v114,v115
M v[216:219],a[224:227],v[48:51],v[216:219]
s_waitcnt vmcnt(11) lgkmcnt(0)
s_barrier
C v54,v124,v125
M v[228:231],a[228:231],v[48:51],v[228:231]
T a[216:217],v13
T a[218:219],v13 offset:2048
C v55,v126,v127
M v[224:227],a[228:231],v[44:47],v[224:227]
T a[220:221],v14
T a[222:223],v14 offset:2048
C v56,v116,v117
M v[220:223],a[228:231],v[40:43],v[220:223]
T a[224:225],v13 offset:4096
T a[226:227],v13 offset:6144
C v57,v118,v119
M v[232:235],a[232:235],v[40:43],v[232:235]
T a[228:229],v14 offset:4096
T a[230:231],v14 offset:6144
C v58,v128,v129
M v[236:239],a[232:235],v[44:47],v[236:239]
C v59,v130,v131
C v60,v120,v121
C v61,v122,v123
M v[240:243],a[232:235],v[48:51],v[240:243]
T a[232:233],v13 offset:8192
T a[234:235],v13 offset:10240
C v62,v132,v133
M v[252:255],a[236:239],v[48:51],v[252:255]
L v108,s[16:19],s35 offen offset:2048 lds
C v63,v134,v135
M v[248:251],a[236:239],v[44:47],v[248:251]
M v[244:247],a[236:239],v[40:43],v[244:247]
ds_write_b128 v36,v[52:55]
ds_write_b128 v36,v[56:59] offset:1024
ds_write_b128 v36,v[60:63] offset:2048
v_pk_mul_f32 v[136:137],v[136:137],v[30:31]
v_pk_mul_f32 v[138:139],v[138:139],v[30:31]
v_pk_mul_f32 v[148:149],v[148:149],v[30:31]
v_pk_mul_f32 v[150:151],v[150:151],v[30:31]
v_pk_mul_f32 v[140:141],v[140:141],v[32:33]
v_pk_mul_f32 v[142:143],v[142:143],v[32:33]
v_pk_mul_f32 v[152:153],v[152:153],v[32:33]
v_pk_mul_f32 v[154:155],v[154:155],v[32:33]
v_pk_mul_f32 v[144:145],v[144:145],v[34:35]
v_pk_mul_f32 v[146:147],v[146:147],v[34:35]
v_pk_mul_f32 v[156:157],v[156:157],v[34:35]
v_pk_mul_f32 v[158:159],v[158:159],v[34:35]
C v64,v136,v137
C v65,v138,v139
C v66,v148,v149
C v67,v150,v151
ds_write_b128 v36,v[64:67] offset:3072
C v68,v140,v141
C v69,v142,v143
C v70,v152,v153
C v71,v154,v155
ds_write_b128 v36,v[68:71] offset:4096
C v72,v144,v145
C v73,v146,v147
C v74,v156,v157
C v75,v158,v159
ds_write_b128 v36,v[72:75] offset:5120
v_pk_mul_f32 v[160:161],v[160:161],v[30:31]
v_pk_mul_f32 v[162:163],v[162:163],v[30:31]
v_pk_mul_f32 v[172:173],v[172:173],v[30:31]
v_pk_mul_f32 v[174:175],v[174:175],v[30:31]
v_pk_mul_f32 v[164:165],v[164:165],v[32:33]
v_pk_mul_f32 v[166:167],v[166:167],v[32:33]
v_pk_mul_f32 v[176:177],v[176:177],v[32:33]
v_pk_mul_f32 v[178:179],v[178:179],v[32:33]
v_pk_mul_f32 v[168:169],v[168:169],v[34:35]
v_pk_mul_f32 v[170:171],v[170:171],v[34:35]
v_pk_mul_f32 v[180:181],v[180:181],v[34:35]
v_pk_mul_f32 v[182:183],v[182:183],v[34:35]
C v52,v160,v161
C v53,v162,v163
C v54,v172,v173
C v55,v174,v175
ds_write_b128 v36,v[52:55] offset:6144
C v56,v164,v165
C v57,v166,v167
C v58,v176,v177
C v59,v178,v179
ds_write_b128 v36,v[56:59] offset:7168
C v60,v168,v169
C v61,v170,v171
C v62,v180,v181
C v63,v182,v183
ds_write_b128 v36,v[60:63] offset:8192
v_pk_mul_f32 v[184:185],v[184:185],v[30:31]
v_pk_mul_f32 v[186:187],v[186:187],v[30:31]
v_pk_mul_f32 v[196:197],v[196:197],v[30:31]
v_pk_mul_f32 v[198:199],v[198:199],v[30:31]
v_pk_mul_f32 v[188:189],v[188:189],v[32:33]
v_pk_mul_f32 v[190:191],v[190:191],v[32:33]
v_pk_mul_f32 v[200:201],v[200:201],v[32:33]
v_pk_mul_f32 v[202:203],v[202:203],v[32:33]
v_pk_mul_f32 v[192:193],v[192:193],v[34:35]
v_pk_mul_f32 v[194:195],v[194:195],v[34:35]
v_pk_mul_f32 v[204:205],v[204:205],v[34:35]
v_pk_mul_f32 v[206:207],v[206:207],v[34:35]
C v64,v184,v185
C v65,v186,v187
C v66,v196,v197
C v67,v198,v199
ds_write_b128 v36,v[64:67] offset:9216
C v68,v188,v189
C v69,v190,v191
C v70,v200,v201
C v71,v202,v203
ds_write_b128 v36,v[68:71] offset:10240
C v72,v192,v193
C v73,v194,v195
C v74,v204,v205
C v75,v206,v207
ds_write_b128 v36,v[72:75] offset:11264
v_pk_mul_f32 v[208:209],v[208:209],v[30:31]
v_pk_mul_f32 v[210:211],v[210:211],v[30:31]
v_pk_mul_f32 v[220:221],v[220:221],v[30:31]
v_pk_mul_f32 v[222:223],v[222:223],v[30:31]
v_pk_mul_f32 v[212:213],v[212:213],v[32:33]
v_pk_mul_f32 v[214:215],v[214:215],v[32:33]
v_pk_mul_f32 v[224:225],v[224:225],v[32:33]
v_pk_mul_f32 v[226:227],v[226:227],v[32:33]
v_pk_mul_f32 v[216:217],v[216:217],v[34:35]
v_pk_mul_f32 v[218:219],v[218:219],v[34:35]
v_pk_mul_f32 v[228:229],v[228:229],v[34:35]
v_pk_mul_f32 v[230:231],v[230:231],v[34:35]
C v52,v208,v209
C v53,v210,v211
C v54,v220,v221
C v55,v222,v223
ds_write_b128 v36,v[52:55] offset:12288
C v56,v212,v213
C v57,v214,v215
C v58,v224,v225
C v59,v226,v227
ds_write_b128 v36,v[56:59] offset:13312
C v60,v216,v217
C v61,v218,v219
C v62,v228,v229
C v63,v230,v231
ds_write_b128 v36,v[60:63] offset:14336
v_pk_mul_f32 v[232:233],v[232:233],v[30:31]
v_pk_mul_f32 v[234:235],v[234:235],v[30:31]
v_pk_mul_f32 v[244:245],v[244:245],v[30:31]
v_pk_mul_f32 v[246:247],v[246:247],v[30:31]
v_pk_mul_f32 v[236:237],v[236:237],v[32:33]
v_pk_mul_f32 v[238:239],v[238:239],v[32:33]
v_pk_mul_f32 v[248:249],v[248:249],v[32:33]
v_pk_mul_f32 v[250:251],v[250:251],v[32:33]
v_pk_mul_f32 v[240:241],v[240:241],v[34:35]
v_pk_mul_f32 v[242:243],v[242:243],v[34:35]
v_pk_mul_f32 v[252:253],v[252:253],v[34:35]
v_pk_mul_f32 v[254:255],v[254:255],v[34:35]
C v64,v232,v233
C v65,v234,v235
C v66,v244,v245
C v67,v246,v247
ds_write_b128 v36,v[64:67] offset:15360
C v68,v236,v237
C v69,v238,v239
C v70,v248,v249
C v71,v250,v251
ds_write_b128 v36,v[68:71] offset:16384
C v72,v240,v241
C v73,v242,v243
C v74,v252,v253
C v75,v254,v255
ds_write_b128 v36,v[72:75] offset:17408
s_waitcnt lgkmcnt(0)
s_barrier
ds_read_b128 v[112:115],v37
ds_read_b128 v[116:119],v37 offset:1024
ds_read_b128 v[120:123],v37 offset:2048
ds_read_b128 v[124:127],v37 offset:3072
ds_read_b128 v[128:131],v37 offset:4096
ds_read_b128 v[132:135],v37 offset:5120
M v[76:79],a[242:245],a[0:3],0
M v[80:83],a[242:245],a[4:7],0
M v[84:87],a[242:245],a[8:11],0
M v[88:91],a[240:243],a[0:3],0
M v[92:95],a[240:243],a[4:7],0
M v[96:99],a[240:243],a[8:11],0
s_waitcnt lgkmcnt(3)
M v[76:79],a[216:219],v[112:115],v[76:79]
T a[236:237],v14 offset:8192
ds_read_b128 v[136:139],v37 offset:6144
M v[80:83],a[216:219],v[116:119],v[80:83]
T a[238:239],v14 offset:10240
ds_read_b128 v[140:143],v37 offset:7168
M v[84:87],a[216:219],v[120:123],v[84:87]
ds_read_b128 v[144:147],v37 offset:8192
ds_read_b128 v[148:151],v37 offset:9216
M v[96:99],a[220:223],v[120:123],v[96:99]
T a[216:217],v13 offset:12288
ds_read_b128 v[152:155],v37 offset:10240
M v[92:95],a[220:223],v[116:119],v[92:95]
T a[218:219],v13 offset:14336
ds_read_b128 v[156:159],v37 offset:11264
M v[88:91],a[220:223],v[112:115],v[88:91]
ds_read_b128 v[160:163],v37 offset:12288
ds_read_b128 v[164:167],v37 offset:13312
s_waitcnt lgkmcnt(12)
M v[76:79],a[224:227],v[124:127],v[76:79]
T a[220:221],v14 offset:12288
ds_read_b128 v[168:171],v37 offset:14336
M v[80:83],a[224:227],v[128:131],v[80:83]
T a[222:223],v14 offset:14336
ds_read_b128 v[172:175],v37 offset:15360
M v[84:87],a[224:227],v[132:135],v[84:87]
ds_read_b128 v[176:179],v37 offset:16384
s_waitcnt lgkmcnt(14)
M v[96:99],a[228:231],v[132:135],v[96:99]
T a[224:225],v13 offset:16384
ds_read_b128 v[180:183],v37 offset:17408
M v[92:95],a[228:231],v[128:131],v[92:95]
T a[226:227],v13 offset:18432
ds_read_b128 v[184:187],v38
M v[88:91],a[228:231],v[124:127],v[88:91]
ds_read_b128 v[188:191],v38 offset:1024
ds_read_b128 v[192:195],v38 offset:2048
s_waitcnt lgkmcnt(15)
M v[76:79],a[232:235],v[136:139],v[76:79]
T a[228:229],v14 offset:16384
ds_read_b128 v[196:199],v38 offset:3072
M v[80:83],a[232:235],v[140:143],v[80:83]
T a[230:231],v14 offset:18432
ds_read_b128 v[200:203],v38 offset:4096
M v[84:87],a[232:235],v[144:147],v[84:87]
ds_read_b128 v[204:207],v38 offset:5120
ds_read_b128 v[208:211],v38 offset:6144
M v[96:99],a[236:239],v[144:147],v[96:99]
T a[232:233],v13 offset:20480
ds_read_b128 v[212:215],v38 offset:7168
M v[92:95],a[236:239],v[140:143],v[92:95]
T a[234:235],v13 offset:22528
ds_read_b128 v[216:219],v38 offset:8192
M v[88:91],a[236:239],v[136:139],v[88:91]
ds_read_b128 v[220:223],v38 offset:9216
s_waitcnt lgkmcnt(14)
M v[76:79],a[216:219],v[148:151],v[76:79]
T a[236:237],v14 offset:20480
ds_read_b128 v[224:227],v38 offset:10240
M v[80:83],a[216:219],v[152:155],v[80:83]
T a[238:239],v14 offset:22528
ds_read_b128 v[228:231],v38 offset:11264
M v[84:87],a[216:219],v[156:159],v[84:87]
ds_read_b128 v[232:235],v38 offset:12288
ds_read_b128 v[236:239],v38 offset:13312
M v[96:99],a[220:223],v[156:159],v[96:99]
ds_read_b128 v[240:243],v38 offset:14336
ds_read_b128 v[244:247],v38 offset:15360
M v[92:95],a[220:223],v[152:155],v[92:95]
ds_read_b128 v[248:251],v38 offset:16384
ds_read_b128 v[252:255],v38 offset:17408
M v[88:91],a[220:223],v[148:151],v[88:91]
M v[76:79],a[224:227],v[160:163],v[76:79]
M v[80:83],a[224:227],v[164:167],v[80:83]
M v[84:87],a[224:227],v[168:171],v[84:87]
s_waitcnt vmcnt(6) lgkmcnt(0)
s_barrier
M v[96:99],a[228:231],v[168:171],v[96:99]
T a[216:217],v13 offset:24576
T a[218:219],v13 offset:26624
M v[92:95],a[228:231],v[164:167],v[92:95]
T a[220:221],v14 offset:24576
T a[222:223],v14 offset:26624
M v[88:91],a[228:231],v[160:163],v[88:91]
T a[224:225],v13 offset:28672
T a[226:227],v13 offset:30720
M v[76:79],a[232:235],v[172:175],v[76:79]
T a[228:229],v14 offset:28672
T a[230:231],v14 offset:30720
M v[80:83],a[232:235],v[176:179],v[80:83]
s_add_u32 m0,s28,0x12000
s_add_u32 s35,s32,0x7800
M v[84:87],a[232:235],v[180:183],v[84:87]
T a[232:233],v13 offset:32768
T a[234:235],v13 offset:34816
M v[96:99],a[236:239],v[180:183],v[96:99]
L v106,s[16:19],s32 offen lds
L v107,s[16:19],s32 offen offset:1024 lds
M v[92:95],a[236:239],v[176:179],v[92:95]
M v[88:91],a[236:239],v[172:175],v[88:91]
s_waitcnt lgkmcnt(4)
M v[76:79],a[216:219],v[184:187],v[76:79]
T a[236:237],v14 offset:32768
L v108,s[16:19],s32 offen offset:2048 lds
M v[80:83],a[216:219],v[188:191],v[80:83]
T a[238:239],v14 offset:34816
M v[84:87],a[216:219],v[192:195],v[84:87]
s_add_u32 m0,m0,0xc00
M v[96:99],a[220:223],v[192:195],v[96:99]
T a[216:217],v13 offset:36864
s_add_u32 s32,s32,0xfff88080
M v[92:95],a[220:223],v[188:191],v[92:95]
T a[218:219],v13 offset:38912
M v[88:91],a[220:223],v[184:187],v[88:91]
L v106,s[16:19],s35 offen lds
M v[76:79],a[224:227],v[196:199],v[76:79]
T a[220:221],v14 offset:36864
M v[80:83],a[224:227],v[200:203],v[80:83]
T a[222:223],v14 offset:38912
L v107,s[16:19],s35 offen offset:1024 lds
M v[84:87],a[224:227],v[204:207],v[84:87]
s_waitcnt lgkmcnt(4)
M v[96:99],a[228:231],v[204:207],v[96:99]
T a[224:225],v13 offset:40960
L v108,s[16:19],s35 offen offset:2048 lds
M v[92:95],a[228:231],v[200:203],v[92:95]
T a[226:227],v13 offset:43008
M v[88:91],a[228:231],v[196:199],v[88:91]
M v[76:79],a[232:235],v[208:211],v[76:79]
T a[228:229],v14 offset:40960
M v[80:83],a[232:235],v[212:215],v[80:83]
T a[230:231],v14 offset:43008
M v[84:87],a[232:235],v[216:219],v[84:87]
s_cmp_eq_u32 s32,s43
s_cselect_b32 s32,s42,s32
M v[96:99],a[236:239],v[216:219],v[96:99]
T a[232:233],v13 offset:45056
s_add_u32 m0,s28,0
M v[92:95],a[236:239],v[212:215],v[92:95]
T a[234:235],v13 offset:47104
M v[88:91],a[236:239],v[208:211],v[88:91]
s_add_u32 s35,s32,0x7800
s_waitcnt lgkmcnt(4)
M v[76:79],a[216:219],v[220:223],v[76:79]
T a[236:237],v14 offset:45056
M v[80:83],a[216:219],v[224:227],v[80:83]
T a[238:239],v14 offset:47104
L v106,s[16:19],s32 offen lds
M v[84:87],a[216:219],v[228:231],v[84:87]
M v[96:99],a[220:223],v[228:231],v[96:99]
L v107,s[16:19],s32 offen offset:1024 lds
M v[92:95],a[220:223],v[224:227],v[92:95]
L v108,s[16:19],s32 offen offset:2048 lds
M v[88:91],a[220:223],v[220:223],v[88:91]
s_add_u32 m0,m0,0xc00
M v[76:79],a[224:227],v[232:235],v[76:79]
s_add_u32 s32,s32,0x78000
M v[80:83],a[224:227],v[236:239],v[80:83]
L v106,s[16:19],s35 offen lds
M v[84:87],a[224:227],v[240:243],v[84:87]
s_waitcnt vmcnt(10) lgkmcnt(0)
s_barrier
M v[96:99],a[228:231],v[240:243],v[96:99]
T a[216:217],v15
T a[218:219],v15 offset:2048
M v[92:95],a[228:231],v[236:239],v[92:95]
T a[220:221],v16
T a[222:223],v16 offset:2048
M v[88:91],a[228:231],v[232:235],v[88:91]
T a[224:225],v15 offset:4096
T a[226:227],v15 offset:6144
M v[76:79],a[232:235],v[244:247],v[76:79]
T a[228:229],v16 offset:4096
T a[230:231],v16 offset:6144
M v[80:83],a[232:235],v[248:251],v[80:83]
M v[84:87],a[232:235],v[252:255],v[84:87]
T a[232:233],v15 offset:8192
T a[234:235],v15 offset:10240
M v[96:99],a[236:239],v[252:255],v[96:99]
L v107,s[16:19],s35 offen offset:1024 lds
M v[92:95],a[236:239],v[248:251],v[92:95]
L v108,s[16:19],s35 offen offset:2048 lds
M v[88:91],a[236:239],v[244:247],v[88:91]
M v[52:55],a[242:245],a[12:15],0
M v[56:59],a[242:245],a[16:19],0
M v[60:63],a[242:245],a[20:23],0
M v[64:67],a[240:243],a[12:15],0
M v[68:71],a[240:243],a[16:19],0
M v[72:75],a[240:243],a[20:23],0
s_waitcnt lgkmcnt(4)
M v[52:55],a[216:219],v[112:115],v[52:55]
T a[236:237],v16 offset:8192
s_add_u32 m0,s28,0x6000
M v[56:59],a[216:219],v[116:119],v[56:59]
T a[238:239],v16 offset:10240
M v[60:63],a[216:219],v[120:123],v[60:63]
s_add_u32 s35,s32,0x7800
M v[72:75],a[220:223],v[120:123],v[72:75]
T a[216:217],v15 offset:12288
C v40,v76,v77
M v[68:71],a[220:223],v[116:119],v[68:71]
T a[218:219],v15 offset:14336
M v[64:67],a[220:223],v[112:115],v[64:67]
L v106,s[16:19],s32 offen lds
M v[52:55],a[224:227],v[124:127],v[52:55]
T a[220:221],v16 offset:12288
C v41,v78,v79
M v[56:59],a[224:227],v[128:131],v[56:59]
T a[222:223],v16 offset:14336
M v[60:63],a[224:227],v[132:135],v[60:63]
L v107,s[16:19],s32 offen offset:1024 lds
s_waitcnt lgkmcnt(4)
M v[72:75],a[228:231],v[132:135],v[72:75]
T a[224:225],v15 offset:16384
M v[68:71],a[228:231],v[128:131],v[68:71]
T a[226:227],v15 offset:18432
C v42,v88,v89
M v[64:67],a[228:231],v[124:127],v[64:67]
L v108,s[16:19],s32 offen offset:2048 lds
M v[52:55],a[232:235],v[136:139],v[52:55]
T a[228:229],v16 offset:16384
M v[56:59],a[232:235],v[140:143],v[56:59]
T a[230:231],v16 offset:18432
C v43,v90,v91
M v[60:63],a[232:235],v[144:147],v[60:63]
s_add_u32 m0,m0,0xc00
M v[72:75],a[236:239],v[144:147],v[72:75]
T a[232:233],v15 offset:20480
M v[68:71],a[236:239],v[140:143],v[68:71]
T a[234:235],v15 offset:22528
s_add_u32 s32,s32,0xfff88080
M v[64:67],a[236:239],v[136:139],v[64:67]
buffer_store_dwordx4 v[40:43],v0,s[24:27],s44 offen sc1
s_waitcnt lgkmcnt(4)
M v[52:55],a[216:219],v[148:151],v[52:55]
T a[236:237],v16 offset:20480
M v[56:59],a[216:219],v[152:155],v[56:59]
T a[238:239],v16 offset:22528
M v[60:63],a[216:219],v[156:159],v[60:63]
C v44,v80,v81
L v106,s[16:19],s35 offen lds
M v[72:75],a[220:223],v[156:159],v[72:75]
L v107,s[16:19],s35 offen offset:1024 lds
M v[68:71],a[220:223],v[152:155],v[68:71]
C v45,v82,v83
M v[64:67],a[220:223],v[148:151],v[64:67]
L v108,s[16:19],s35 offen offset:2048 lds
M v[52:55],a[224:227],v[160:163],v[52:55]
C v46,v92,v93
M v[56:59],a[224:227],v[164:167],v[56:59]
M v[60:63],a[224:227],v[168:171],v[60:63]
s_waitcnt vmcnt(13) lgkmcnt(0)
s_barrier
M v[72:75],a[228:231],v[168:171],v[72:75]
T a[216:217],v15 offset:24576
T a[218:219],v15 offset:26624
M v[68:71],a[228:231],v[164:167],v[68:71]
T a[220:221],v16 offset:24576
T a[222:223],v16 offset:26624
M v[64:67],a[228:231],v[160:163],v[64:67]
T a[224:225],v15 offset:28672
T a[226:227],v15 offset:30720
M v[52:55],a[232:235],v[172:175],v[52:55]
T a[228:229],v16 offset:28672
T a[230:231],v16 offset:30720
M v[56:59],a[232:235],v[176:179],v[56:59]
M v[60:63],a[232:235],v[180:183],v[60:63]
T a[232:233],v15 offset:32768
T a[234:235],v15 offset:34816
M v[72:75],a[236:239],v[180:183],v[72:75]
C v47,v94,v95
M v[68:71],a[236:239],v[176:179],v[68:71]
s_cmp_eq_u32 s32,s43
s_cselect_b32 s32,s42,s32
M v[64:67],a[236:239],v[172:175],v[64:67]
buffer_store_dwordx4 v[44:47],v0,s[24:27],s44 offen offset:1024 sc1
s_waitcnt lgkmcnt(4)
M v[52:55],a[216:219],v[184:187],v[52:55]
T a[236:237],v16 offset:32768
s_add_u32 m0,s28,0xc000
M v[56:59],a[216:219],v[188:191],v[56:59]
T a[238:239],v16 offset:34816
M v[60:63],a[216:219],v[192:195],v[60:63]
C v48,v84,v85
M v[72:75],a[220:223],v[192:195],v[72:75]
T a[216:217],v15 offset:36864
s_add_u32 s35,s32,0x7800
M v[68:71],a[220:223],v[188:191],v[68:71]
T a[218:219],v15 offset:38912
M v[64:67],a[220:223],v[184:187],v[64:67]
L v106,s[16:19],s32 offen lds
M v[52:55],a[224:227],v[196:199],v[52:55]
T a[220:221],v16 offset:36864
C v49,v86,v87
M v[56:59],a[224:227],v[200:203],v[56:59]
T a[222:223],v16 offset:38912
M v[60:63],a[224:227],v[204:207],v[60:63]
s_waitcnt lgkmcnt(4)
M v[72:75],a[228:231],v[204:207],v[72:75]
T a[224:225],v15 offset:40960
M v[68:71],a[228:231],v[200:203],v[68:71]
T a[226:227],v15 offset:43008
C v50,v96,v97
M v[64:67],a[228:231],v[196:199],v[64:67]
L v107,s[16:19],s32 offen offset:1024 lds
M v[52:55],a[232:235],v[208:211],v[52:55]
T a[228:229],v16 offset:40960
M v[56:59],a[232:235],v[212:215],v[56:59]
T a[230:231],v16 offset:43008
C v51,v98,v99
M v[60:63],a[232:235],v[216:219],v[60:63]
L v108,s[16:19],s32 offen offset:2048 lds
M v[72:75],a[236:239],v[216:219],v[72:75]
T a[232:233],v15 offset:45056
M v[68:71],a[236:239],v[212:215],v[68:71]
T a[234:235],v15 offset:47104
buffer_store_dwordx4 v[48:51],v0,s[24:27],s44 offen offset:2048 sc1
M v[64:67],a[236:239],v[208:211],v[64:67]
s_waitcnt lgkmcnt(4)
M v[52:55],a[216:219],v[220:223],v[52:55]
T a[236:237],v16 offset:45056
s_add_u32 m0,m0,0xc00
M v[56:59],a[216:219],v[224:227],v[56:59]
T a[238:239],v16 offset:47104
M v[60:63],a[216:219],v[228:231],v[60:63]
s_add_u32 s44,s44,0x3000
M v[72:75],a[220:223],v[228:231],v[72:75]
s_add_u32 s32,s32,0x78000
M v[68:71],a[220:223],v[224:227],v[68:71]
M v[64:67],a[220:223],v[220:223],v[64:67]
L v106,s[16:19],s35 offen lds
M v[52:55],a[224:227],v[232:235],v[52:55]
s_cmp_eq_u32 s44,s46
s_cselect_b32 s44,s45,s44
M v[56:59],a[224:227],v[236:239],v[56:59]
L v107,s[16:19],s35 offen offset:1024 lds
M v[60:63],a[224:227],v[240:243],v[60:63]
s_waitcnt vmcnt(14) lgkmcnt(0)
s_barrier
M v[72:75],a[228:231],v[240:243],v[72:75]
T a[216:217],v13
T a[218:219],v13 offset:2048
M v[68:71],a[228:231],v[236:239],v[68:71]
T a[220:221],v14
T a[222:223],v14 offset:2048
M v[64:67],a[228:231],v[232:235],v[64:67]
T a[224:225],v13 offset:4096
T a[226:227],v13 offset:6144
M v[52:55],a[232:235],v[244:247],v[52:55]
T a[228:229],v14 offset:4096
T a[230:231],v14 offset:6144
M v[56:59],a[232:235],v[248:251],v[56:59]
M v[60:63],a[232:235],v[252:255],v[60:63]
T a[232:233],v13 offset:8192
T a[234:235],v13 offset:10240
M v[72:75],a[236:239],v[252:255],v[72:75]
L v108,s[16:19],s35 offen offset:2048 lds
M v[68:71],a[236:239],v[248:251],v[68:71]
M v[64:67],a[236:239],v[244:247],v[64:67]
M v[76:79],a[242:245],a[24:27],0
M v[80:83],a[242:245],a[28:31],0
M v[84:87],a[242:245],a[32:35],0
M v[88:91],a[240:243],a[24:27],0
M v[92:95],a[240:243],a[28:31],0
M v[96:99],a[240:243],a[32:35],0
s_waitcnt lgkmcnt(4)
M v[76:79],a[216:219],v[112:115],v[76:79]
T a[236:237],v14 offset:8192
s_add_u32 m0,s28,0x12000
M v[80:83],a[216:219],v[116:119],v[80:83]
T a[238:239],v14 offset:10240
M v[84:87],a[216:219],v[120:123],v[84:87]
s_add_u32 s35,s32,0x7800
M v[96:99],a[220:223],v[120:123],v[96:99]
T a[216:217],v13 offset:12288
C v40,v52,v53
M v[92:95],a[220:223],v[116:119],v[92:95]
T a[218:219],v13 offset:14336
M v[88:91],a[220:223],v[112:115],v[88:91]
L v106,s[16:19],s32 offen lds
M v[76:79],a[224:227],v[124:127],v[76:79]
T a[220:221],v14 offset:12288
C v41,v54,v55
M v[80:83],a[224:227],v[128:131],v[80:83]
T a[222:223],v14 offset:14336
M v[84:87],a[224:227],v[132:135],v[84:87]
L v107,s[16:19],s32 offen offset:1024 lds
s_waitcnt lgkmcnt(4)
M v[96:99],a[228:231],v[132:135],v[96:99]
T a[224:225],v13 offset:16384
M v[92:95],a[228:231],v[128:131],v[92:95]
T a[226:227],v13 offset:18432
C v42,v64,v65
M v[88:91],a[228:231],v[124:127],v[88:91]
L v108,s[16:19],s32 offen offset:2048 lds
M v[76:79],a[232:235],v[136:139],v[76:79]
T a[228:229],v14 offset:16384
M v[80:83],a[232:235],v[140:143],v[80:83]
T a[230:231],v14 offset:18432
C v43,v66,v67
M v[84:87],a[232:235],v[144:147],v[84:87]
s_add_u32 m0,m0,0xc00
M v[96:99],a[236:239],v[144:147],v[96:99]
T a[232:233],v13 offset:20480
M v[92:95],a[236:239],v[140:143],v[92:95]
T a[234:235],v13 offset:22528
s_add_u32 s32,s32,0xfff88080
M v[88:91],a[236:239],v[136:139],v[88:91]
buffer_store_dwordx4 v[40:43],v0,s[24:27],s44 offen sc1
s_waitcnt lgkmcnt(4)
M v[76:79],a[216:219],v[148:151],v[76:79]
T a[236:237],v14 offset:20480
M v[80:83],a[216:219],v[152:155],v[80:83]
T a[238:239],v14 offset:22528
M v[84:87],a[216:219],v[156:159],v[84:87]
C v44,v56,v57
L v106,s[16:19],s35 offen lds
M v[96:99],a[220:223],v[156:159],v[96:99]
L v107,s[16:19],s35 offen offset:1024 lds
M v[92:95],a[220:223],v[152:155],v[92:95]
C v45,v58,v59
M v[88:91],a[220:223],v[148:151],v[88:91]
L v108,s[16:19],s35 offen offset:2048 lds
M v[76:79],a[224:227],v[160:163],v[76:79]
C v46,v68,v69
M v[80:83],a[224:227],v[164:167],v[80:83]
M v[84:87],a[224:227],v[168:171],v[84:87]
s_waitcnt vmcnt(15) lgkmcnt(0)
s_barrier
M v[96:99],a[228:231],v[168:171],v[96:99]
T a[216:217],v13 offset:24576
T a[218:219],v13 offset:26624
M v[92:95],a[228:231],v[164:167],v[92:95]
T a[220:221],v14 offset:24576
T a[222:223],v14 offset:26624
M v[88:91],a[228:231],v[160:163],v[88:91]
T a[224:225],v13 offset:28672
T a[226:227],v13 offset:30720
M v[76:79],a[232:235],v[172:175],v[76:79]
T a[228:229],v14 offset:28672
T a[230:231],v14 offset:30720
M v[80:83],a[232:235],v[176:179],v[80:83]
M v[84:87],a[232:235],v[180:183],v[84:87]
T a[232:233],v13 offset:32768
T a[234:235],v13 offset:34816
M v[96:99],a[236:239],v[180:183],v[96:99]
C v47,v70,v71
M v[92:95],a[236:239],v[176:179],v[92:95]
s_cmp_eq_u32 s32,s43
s_cselect_b32 s32,s42,s32
M v[88:91],a[236:239],v[172:175],v[88:91]
buffer_store_dwordx4 v[44:47],v0,s[24:27],s44 offen offset:1024 sc1
s_waitcnt lgkmcnt(4)
M v[76:79],a[216:219],v[184:187],v[76:79]
T a[236:237],v14 offset:32768
s_add_u32 m0,s28,0
M v[80:83],a[216:219],v[188:191],v[80:83]
T a[238:239],v14 offset:34816
M v[84:87],a[216:219],v[192:195],v[84:87]
C v48,v60,v61
M v[96:99],a[220:223],v[192:195],v[96:99]
T a[216:217],v13 offset:36864
s_add_u32 s35,s32,0x7800
M v[92:95],a[220:223],v[188:191],v[92:95]
T a[218:219],v13 offset:38912
M v[88:91],a[220:223],v[184:187],v[88:91]
L v106,s[16:19],s32 offen lds
M v[76:79],a[224:227],v[196:199],v[76:79]
T a[220:221],v14 offset:36864
C v49,v62,v63
M v[80:83],a[224:227],v[200:203],v[80:83]
T a[222:223],v14 offset:38912
M v[84:87],a[224:227],v[204:207],v[84:87]
s_waitcnt lgkmcnt(4)
M v[96:99],a[228:231],v[204:207],v[96:99]
T a[224:225],v13 offset:40960
M v[92:95],a[228:231],v[200:203],v[92:95]
T a[226:227],v13 offset:43008
C v50,v72,v73
M v[88:91],a[228:231],v[196:199],v[88:91]
L v107,s[16:19],s32 offen offset:1024 lds
M v[76:79],a[232:235],v[208:211],v[76:79]
T a[228:229],v14 offset:40960
M v[80:83],a[232:235],v[212:215],v[80:83]
T a[230:231],v14 offset:43008
C v51,v74,v75
M v[84:87],a[232:235],v[216:219],v[84:87]
L v108,s[16:19],s32 offen offset:2048 lds
M v[96:99],a[236:239],v[216:219],v[96:99]
T a[232:233],v13 offset:45056
M v[92:95],a[236:239],v[212:215],v[92:95]
T a[234:235],v13 offset:47104
buffer_store_dwordx4 v[48:51],v0,s[24:27],s44 offen offset:2048 sc1
M v[88:91],a[236:239],v[208:211],v[88:91]
s_waitcnt lgkmcnt(4)
M v[76:79],a[216:219],v[220:223],v[76:79]
T a[236:237],v14 offset:45056
s_add_u32 m0,m0,0xc00
M v[80:83],a[216:219],v[224:227],v[80:83]
T a[238:239],v14 offset:47104
M v[84:87],a[216:219],v[228:231],v[84:87]
s_add_u32 s44,s44,0x3000
M v[96:99],a[220:223],v[228:231],v[96:99]
s_add_u32 s32,s32,0x78000
M v[92:95],a[220:223],v[224:227],v[92:95]
M v[88:91],a[220:223],v[220:223],v[88:91]
L v106,s[16:19],s35 offen lds
M v[76:79],a[224:227],v[232:235],v[76:79]
s_cmp_eq_u32 s44,s46
s_cselect_b32 s44,s45,s44
M v[80:83],a[224:227],v[236:239],v[80:83]
L v107,s[16:19],s35 offen offset:1024 lds
M v[84:87],a[224:227],v[240:243],v[84:87]
s_waitcnt vmcnt(14) lgkmcnt(0)
s_barrier
M v[96:99],a[228:231],v[240:243],v[96:99]
T a[216:217],v15
T a[218:219],v15 offset:2048
M v[92:95],a[228:231],v[236:239],v[92:95]
T a[220:221],v16
T a[222:223],v16 offset:2048
M v[88:91],a[228:231],v[232:235],v[88:91]
T a[224:225],v15 offset:4096
T a[226:227],v15 offset:6144
M v[76:79],a[232:235],v[244:247],v[76:79]
T a[228:229],v16 offset:4096
T a[230:231],v16 offset:6144
M v[80:83],a[232:235],v[248:251],v[80:83]
M v[84:87],a[232:235],v[252:255],v[84:87]
T a[232:233],v15 offset:8192
T a[234:235],v15 offset:10240
M v[96:99],a[236:239],v[252:255],v[96:99]
L v108,s[16:19],s35 offen offset:2048 lds
M v[92:95],a[236:239],v[248:251],v[92:95]
M v[88:91],a[236:239],v[244:247],v[88:91]
M v[52:55],a[242:245],a[36:39],0
M v[56:59],a[242:245],a[40:43],0
M v[60:63],a[242:245],a[44:47],0
M v[64:67],a[240:243],a[36:39],0
M v[68:71],a[240:243],a[40:43],0
M v[72:75],a[240:243],a[44:47],0
s_waitcnt lgkmcnt(4)
M v[52:55],a[216:219],v[112:115],v[52:55]
T a[236:237],v16 offset:8192
s_add_u32 m0,s28,0x6000
M v[56:59],a[216:219],v[116:119],v[56:59]
T a[238:239],v16 offset:10240
M v[60:63],a[216:219],v[120:123],v[60:63]
s_add_u32 s35,s32,0x7800
M v[72:75],a[220:223],v[120:123],v[72:75]
T a[216:217],v15 offset:12288
C v40,v76,v77
M v[68:71],a[220:223],v[116:119],v[68:71]
T a[218:219],v15 offset:14336
M v[64:67],a[220:223],v[112:115],v[64:67]
L v106,s[16:19],s32 offen lds
M v[52:55],a[224:227],v[124:127],v[52:55]
T a[220:221],v16 offset:12288
C v41,v78,v79
M v[56:59],a[224:227],v[128:131],v[56:59]
T a[222:223],v16 offset:14336
M v[60:63],a[224:227],v[132:135],v[60:63]
L v107,s[16:19],s32 offen offset:1024 lds
s_waitcnt lgkmcnt(4)
M v[72:75],a[228:231],v[132:135],v[72:75]
T a[224:225],v15 offset:16384
M v[68:71],a[228:231],v[128:131],v[68:71]
T a[226:227],v15 offset:18432
C v42,v88,v89
M v[64:67],a[228:231],v[124:127],v[64:67]
L v108,s[16:19],s32 offen offset:2048 lds
M v[52:55],a[232:235],v[136:139],v[52:55]
T a[228:229],v16 offset:16384
M v[56:59],a[232:235],v[140:143],v[56:59]
T a[230:231],v16 offset:18432
C v43,v90,v91
M v[60:63],a[232:235],v[144:147],v[60:63]
s_add_u32 m0,m0,0xc00
M v[72:75],a[236:239],v[144:147],v[72:75]
T a[232:233],v15 offset:20480
M v[68:71],a[236:239],v[140:143],v[68:71]
T a[234:235],v15 offset:22528
s_add_u32 s32,s32,0xfff88080
M v[64:67],a[236:239],v[136:139],v[64:67]
buffer_store_dwordx4 v[40:43],v0,s[24:27],s44 offen sc1
s_waitcnt lgkmcnt(4)
M v[52:55],a[216:219],v[148:151],v[52:55]
T a[236:237],v16 offset:20480
M v[56:59],a[216:219],v[152:155],v[56:59]
T a[238:239],v16 offset:22528
M v[60:63],a[216:219],v[156:159],v[60:63]
C v44,v80,v81
L v106,s[16:19],s35 offen lds
M v[72:75],a[220:223],v[156:159],v[72:75]
L v107,s[16:19],s35 offen offset:1024 lds
M v[68:71],a[220:223],v[152:155],v[68:71]
C v45,v82,v83
M v[64:67],a[220:223],v[148:151],v[64:67]
L v108,s[16:19],s35 offen offset:2048 lds
M v[52:55],a[224:227],v[160:163],v[52:55]
C v46,v92,v93
M v[56:59],a[224:227],v[164:167],v[56:59]
M v[60:63],a[224:227],v[168:171],v[60:63]
s_waitcnt vmcnt(15) lgkmcnt(0)
s_barrier
M v[72:75],a[228:231],v[168:171],v[72:75]
T a[216:217],v15 offset:24576
T a[218:219],v15 offset:26624
M v[68:71],a[228:231],v[164:167],v[68:71]
T a[220:221],v16 offset:24576
T a[222:223],v16 offset:26624
M v[64:67],a[228:231],v[160:163],v[64:67]
T a[224:225],v15 offset:28672
T a[226:227],v15 offset:30720
M v[52:55],a[232:235],v[172:175],v[52:55]
T a[228:229],v16 offset:28672
T a[230:231],v16 offset:30720
M v[56:59],a[232:235],v[176:179],v[56:59]
M v[60:63],a[232:235],v[180:183],v[60:63]
T a[232:233],v15 offset:32768
T a[234:235],v15 offset:34816
M v[72:75],a[236:239],v[180:183],v[72:75]
C v47,v94,v95
M v[68:71],a[236:239],v[176:179],v[68:71]
s_cmp_eq_u32 s32,s43
s_cselect_b32 s32,s42,s32
M v[64:67],a[236:239],v[172:175],v[64:67]
buffer_store_dwordx4 v[44:47],v0,s[24:27],s44 offen offset:1024 sc1
s_waitcnt lgkmcnt(4)
M v[52:55],a[216:219],v[184:187],v[52:55]
T a[236:237],v16 offset:32768
s_add_u32 m0,s28,0xc000
M v[56:59],a[216:219],v[188:191],v[56:59]
T a[238:239],v16 offset:34816
M v[60:63],a[216:219],v[192:195],v[60:63]
C v48,v84,v85
M v[72:75],a[220:223],v[192:195],v[72:75]
T a[216:217],v15 offset:36864
s_add_u32 s35,s32,0x7800
M v[68:71],a[220:223],v[188:191],v[68:71]
T a[218:219],v15 offset:38912
M v[64:67],a[220:223],v[184:187],v[64:67]
L v106,s[16:19],s32 offen lds
M v[52:55],a[224:227],v[196:199],v[52:55]
T a[220:221],v16 offset:36864
C v49,v86,v87
M v[56:59],a[224:227],v[200:203],v[56:59]
T a[222:223],v16 offset:38912
M v[60:63],a[224:227],v[204:207],v[60:63]
s_waitcnt lgkmcnt(4)
M v[72:75],a[228:231],v[204:207],v[72:75]
T a[224:225],v15 offset:40960
M v[68:71],a[228:231],v[200:203],v[68:71]
T a[226:227],v15 offset:43008
C v50,v96,v97
M v[64:67],a[228:231],v[196:199],v[64:67]
L v107,s[16:19],s32 offen offset:1024 lds
M v[52:55],a[232:235],v[208:211],v[52:55]
T a[228:229],v16 offset:40960
M v[56:59],a[232:235],v[212:215],v[56:59]
T a[230:231],v16 offset:43008
C v51,v98,v99
M v[60:63],a[232:235],v[216:219],v[60:63]
L v108,s[16:19],s32 offen offset:2048 lds
M v[72:75],a[236:239],v[216:219],v[72:75]
T a[232:233],v15 offset:45056
M v[68:71],a[236:239],v[212:215],v[68:71]
T a[234:235],v15 offset:47104
buffer_store_dwordx4 v[48:51],v0,s[24:27],s44 offen offset:2048 sc1
M v[64:67],a[236:239],v[208:211],v[64:67]
s_waitcnt lgkmcnt(4)
M v[52:55],a[216:219],v[220:223],v[52:55]
T a[236:237],v16 offset:45056
s_add_u32 m0,m0,0xc00
M v[56:59],a[216:219],v[224:227],v[56:59]
T a[238:239],v16 offset:47104
M v[60:63],a[216:219],v[228:231],v[60:63]
s_add_u32 s44,s44,0x3000
M v[72:75],a[220:223],v[228:231],v[72:75]
s_add_u32 s32,s32,0x78000
M v[68:71],a[220:223],v[224:227],v[68:71]
M v[64:67],a[220:223],v[220:223],v[64:67]
L v106,s[16:19],s35 offen lds
M v[52:55],a[224:227],v[232:235],v[52:55]
s_cmp_eq_u32 s44,s46
s_cselect_b32 s44,s45,s44
M v[56:59],a[224:227],v[236:239],v[56:59]
L v107,s[16:19],s35 offen offset:1024 lds
M v[60:63],a[224:227],v[240:243],v[60:63]
s_waitcnt vmcnt(14) lgkmcnt(0)
s_barrier
M v[72:75],a[228:231],v[240:243],v[72:75]
T a[216:217],v13
T a[218:219],v13 offset:2048
M v[68:71],a[228:231],v[236:239],v[68:71]
T a[220:221],v14
T a[222:223],v14 offset:2048
M v[64:67],a[228:231],v[232:235],v[64:67]
T a[224:225],v13 offset:4096
T a[226:227],v13 offset:6144
M v[52:55],a[232:235],v[244:247],v[52:55]
T a[228:229],v14 offset:4096
T a[230:231],v14 offset:6144
M v[56:59],a[232:235],v[248:251],v[56:59]
M v[60:63],a[232:235],v[252:255],v[60:63]
T a[232:233],v13 offset:8192
T a[234:235],v13 offset:10240
M v[72:75],a[236:239],v[252:255],v[72:75]
L v108,s[16:19],s35 offen offset:2048 lds
M v[68:71],a[236:239],v[248:251],v[68:71]
M v[64:67],a[236:239],v[244:247],v[64:67]
M v[76:79],a[242:245],a[48:51],0
M v[80:83],a[242:245],a[52:55],0
M v[84:87],a[242:245],a[56:59],0
M v[88:91],a[240:243],a[48:51],0
M v[92:95],a[240:243],a[52:55],0
M v[96:99],a[240:243],a[56:59],0
s_waitcnt lgkmcnt(4)
M v[76:79],a[216:219],v[112:115],v[76:79]
T a[236:237],v14 offset:8192
s_add_u32 m0,s28,0x12000
M v[80:83],a[216:219],v[116:119],v[80:83]
T a[238:239],v14 offset:10240
M v[84:87],a[216:219],v[120:123],v[84:87]
s_add_u32 s35,s32,0x7800
M v[96:99],a[220:223],v[120:123],v[96:99]
T a[216:217],v13 offset:12288
C v40,v52,v53
M v[92:95],a[220:223],v[116:119],v[92:95]
T a[218:219],v13 offset:14336
M v[88:91],a[220:223],v[112:115],v[88:91]
L v106,s[16:19],s32 offen lds
M v[76:79],a[224:227],v[124:127],v[76:79]
T a[220:221],v14 offset:12288
C v41,v54,v55
M v[80:83],a[224:227],v[128:131],v[80:83]
T a[222:223],v14 offset:14336
M v[84:87],a[224:227],v[132:135],v[84:87]
L v107,s[16:19],s32 offen offset:1024 lds
s_waitcnt lgkmcnt(4)
M v[96:99],a[228:231],v[132:135],v[96:99]
T a[224:225],v13 offset:16384
M v[92:95],a[228:231],v[128:131],v[92:95]
T a[226:227],v13 offset:18432
C v42,v64,v65
M v[88:91],a[228:231],v[124:127],v[88:91]
L v108,s[16:19],s32 offen offset:2048 lds
M v[76:79],a[232:235],v[136:139],v[76:79]
T a[228:229],v14 offset:16384
M v[80:83],a[232:235],v[140:143],v[80:83]
T a[230:231],v14 offset:18432
C v43,v66,v67
M v[84:87],a[232:235],v[144:147],v[84:87]
s_add_u32 m0,m0,0xc00
M v[96:99],a[236:239],v[144:147],v[96:99]
T a[232:233],v13 offset:20480
M v[92:95],a[236:239],v[140:143],v[92:95]
T a[234:235],v13 offset:22528
s_add_u32 s32,s32,0xfff88080
M v[88:91],a[236:239],v[136:139],v[88:91]
buffer_store_dwordx4 v[40:43],v0,s[24:27],s44 offen sc1
s_waitcnt lgkmcnt(4)
M v[76:79],a[216:219],v[148:151],v[76:79]
T a[236:237],v14 offset:20480
M v[80:83],a[216:219],v[152:155],v[80:83]
T a[238:239],v14 offset:22528
M v[84:87],a[216:219],v[156:159],v[84:87]
C v44,v56,v57
L v106,s[16:19],s35 offen lds
M v[96:99],a[220:223],v[156:159],v[96:99]
L v107,s[16:19],s35 offen offset:1024 lds
M v[92:95],a[220:223],v[152:155],v[92:95]
C v45,v58,v59
M v[88:91],a[220:223],v[148:151],v[88:91]
L v108,s[16:19],s35 offen offset:2048 lds
M v[76:79],a[224:227],v[160:163],v[76:79]
C v46,v68,v69
M v[80:83],a[224:227],v[164:167],v[80:83]
M v[84:87],a[224:227],v[168:171],v[84:87]
s_waitcnt vmcnt(15) lgkmcnt(0)
s_barrier
M v[96:99],a[228:231],v[168:171],v[96:99]
T a[216:217],v13 offset:24576
T a[218:219],v13 offset:26624
M v[92:95],a[228:231],v[164:167],v[92:95]
T a[220:221],v14 offset:24576
T a[222:223],v14 offset:26624
M v[88:91],a[228:231],v[160:163],v[88:91]
T a[224:225],v13 offset:28672
T a[226:227],v13 offset:30720
M v[76:79],a[232:235],v[172:175],v[76:79]
T a[228:229],v14 offset:28672
T a[230:231],v14 offset:30720
M v[80:83],a[232:235],v[176:179],v[80:83]
M v[84:87],a[232:235],v[180:183],v[84:87]
T a[232:233],v13 offset:32768
T a[234:235],v13 offset:34816
M v[96:99],a[236:239],v[180:183],v[96:99]
C v47,v70,v71
M v[92:95],a[236:239],v[176:179],v[92:95]
s_cmp_eq_u32 s32,s43
s_cselect_b32 s32,s42,s32
M v[88:91],a[236:239],v[172:175],v[88:91]
buffer_store_dwordx4 v[44:47],v0,s[24:27],s44 offen offset:1024 sc1
s_waitcnt lgkmcnt(4)
M v[76:79],a[216:219],v[184:187],v[76:79]
T a[236:237],v14 offset:32768
s_add_u32 m0,s28,0
M v[80:83],a[216:219],v[188:191],v[80:83]
T a[238:239],v14 offset:34816
M v[84:87],a[216:219],v[192:195],v[84:87]
C v48,v60,v61
M v[96:99],a[220:223],v[192:195],v[96:99]
T a[216:217],v13 offset:36864
s_add_u32 s35,s32,0x7800
M v[92:95],a[220:223],v[188:191],v[92:95]
T a[218:219],v13 offset:38912
M v[88:91],a[220:223],v[184:187],v[88:91]
L v106,s[16:19],s32 offen lds
M v[76:79],a[224:227],v[196:199],v[76:79]
T a[220:221],v14 offset:36864
C v49,v62,v63
M v[80:83],a[224:227],v[200:203],v[80:83]
T a[222:223],v14 offset:38912
M v[84:87],a[224:227],v[204:207],v[84:87]
s_waitcnt lgkmcnt(4)
M v[96:99],a[228:231],v[204:207],v[96:99]
T a[224:225],v13 offset:40960
M v[92:95],a[228:231],v[200:203],v[92:95]
T a[226:227],v13 offset:43008
C v50,v72,v73
M v[88:91],a[228:231],v[196:199],v[88:91]
L v107,s[16:19],s32 offen offset:1024 lds
M v[76:79],a[232:235],v[208:211],v[76:79]
T a[228:229],v14 offset:40960
M v[80:83],a[232:235],v[212:215],v[80:83]
T a[230:231],v14 offset:43008
C v51,v74,v75
M v[84:87],a[232:235],v[216:219],v[84:87]
L v108,s[16:19],s32 offen offset:2048 lds
M v[96:99],a[236:239],v[216:219],v[96:99]
T a[232:233],v13 offset:45056
M v[92:95],a[236:239],v[212:215],v[92:95]
T a[234:235],v13 offset:47104
buffer_store_dwordx4 v[48:51],v0,s[24:27],s44 offen offset:2048 sc1
M v[88:91],a[236:239],v[208:211],v[88:91]
s_waitcnt lgkmcnt(4)
M v[76:79],a[216:219],v[220:223],v[76:79]
T a[236:237],v14 offset:45056
s_add_u32 m0,m0,0xc00
M v[80:83],a[216:219],v[224:227],v[80:83]
T a[238:239],v14 offset:47104
M v[84:87],a[216:219],v[228:231],v[84:87]
s_add_u32 s44,s44,0x3000
M v[96:99],a[220:223],v[228:231],v[96:99]
s_add_u32 s32,s32,0x78000
M v[92:95],a[220:223],v[224:227],v[92:95]
M v[88:91],a[220:223],v[220:223],v[88:91]
L v106,s[16:19],s35 offen lds
M v[76:79],a[224:227],v[232:235],v[76:79]
s_cmp_eq_u32 s44,s46
s_cselect_b32 s44,s45,s44
M v[80:83],a[224:227],v[236:239],v[80:83]
L v107,s[16:19],s35 offen offset:1024 lds
M v[84:87],a[224:227],v[240:243],v[84:87]
s_waitcnt vmcnt(14) lgkmcnt(0)
s_barrier
M v[96:99],a[228:231],v[240:243],v[96:99]
T a[216:217],v15
T a[218:219],v15 offset:2048
M v[92:95],a[228:231],v[236:239],v[92:95]
T a[220:221],v16
T a[222:223],v16 offset:2048
M v[88:91],a[228:231],v[232:235],v[88:91]
T a[224:225],v15 offset:4096
T a[226:227],v15 offset:6144
M v[76:79],a[232:235],v[244:247],v[76:79]
T a[228:229],v16 offset:4096
T a[230:231],v16 offset:6144
M v[80:83],a[232:235],v[248:251],v[80:83]
M v[84:87],a[232:235],v[252:255],v[84:87]
T a[232:233],v15 offset:8192
T a[234:235],v15 offset:10240
M v[96:99],a[236:239],v[252:255],v[96:99]
L v108,s[16:19],s35 offen offset:2048 lds
M v[92:95],a[236:239],v[248:251],v[92:95]
M v[88:91],a[236:239],v[244:247],v[88:91]
M v[52:55],a[242:245],a[60:63],0
M v[56:59],a[242:245],a[64:67],0
M v[60:63],a[242:245],a[68:71],0
M v[64:67],a[240:243],a[60:63],0
M v[68:71],a[240:243],a[64:67],0
M v[72:75],a[240:243],a[68:71],0
s_waitcnt lgkmcnt(4)
M v[52:55],a[216:219],v[112:115],v[52:55]
T a[236:237],v16 offset:8192
s_add_u32 m0,s28,0x6000
M v[56:59],a[216:219],v[116:119],v[56:59]
T a[238:239],v16 offset:10240
M v[60:63],a[216:219],v[120:123],v[60:63]
s_add_u32 s35,s32,0x7800
M v[72:75],a[220:223],v[120:123],v[72:75]
T a[216:217],v15 offset:12288
C v40,v76,v77
M v[68:71],a[220:223],v[116:119],v[68:71]
T a[218:219],v15 offset:14336
M v[64:67],a[220:223],v[112:115],v[64:67]
L v106,s[16:19],s32 offen lds
M v[52:55],a[224:227],v[124:127],v[52:55]
T a[220:221],v16 offset:12288
C v41,v78,v79
M v[56:59],a[224:227],v[128:131],v[56:59]
T a[222:223],v16 offset:14336
M v[60:63],a[224:227],v[132:135],v[60:63]
L v107,s[16:19],s32 offen offset:1024 lds
s_waitcnt lgkmcnt(4)
M v[72:75],a[228:231],v[132:135],v[72:75]
T a[224:225],v15 offset:16384
M v[68:71],a[228:231],v[128:131],v[68:71]
T a[226:227],v15 offset:18432
C v42,v88,v89
M v[64:67],a[228:231],v[124:127],v[64:67]
L v108,s[16:19],s32 offen offset:2048 lds
M v[52:55],a[232:235],v[136:139],v[52:55]
T a[228:229],v16 offset:16384
M v[56:59],a[232:235],v[140:143],v[56:59]
T a[230:231],v16 offset:18432
C v43,v90,v91
M v[60:63],a[232:235],v[144:147],v[60:63]
s_add_u32 m0,m0,0xc00
M v[72:75],a[236:239],v[144:147],v[72:75]
T a[232:233],v15 offset:20480
M v[68:71],a[236:239],v[140:143],v[68:71]
T a[234:235],v15 offset:22528
s_add_u32 s32,s32,0xfff88080
M v[64:67],a[236:239],v[136:139],v[64:67]
buffer_store_dwordx4 v[40:43],v0,s[24:27],s44 offen sc1
s_waitcnt lgkmcnt(4)
M v[52:55],a[216:219],v[148:151],v[52:55]
T a[236:237],v16 offset:20480
M v[56:59],a[216:219],v[152:155],v[56:59]
T a[238:239],v16 offset:22528
M v[60:63],a[216:219],v[156:159],v[60:63]
C v44,v80,v81
L v106,s[16:19],s35 offen lds
M v[72:75],a[220:223],v[156:159],v[72:75]
L v107,s[16:19],s35 offen offset:1024 lds
M v[68:71],a[220:223],v[152:155],v[68:71]
C v45,v82,v83
M v[64:67],a[220:223],v[148:151],v[64:67]
L v108,s[16:19],s35 offen offset:2048 lds
M v[52:55],a[224:227],v[160:163],v[52:55]
C v46,v92,v93
M v[56:59],a[224:227],v[164:167],v[56:59]
M v[60:63],a[224:227],v[168:171],v[60:63]
s_waitcnt vmcnt(15) lgkmcnt(0)
s_barrier
M v[72:75],a[228:231],v[168:171],v[72:75]
T a[216:217],v15 offset:24576
T a[218:219],v15 offset:26624
M v[68:71],a[228:231],v[164:167],v[68:71]
T a[220:221],v16 offset:24576
T a[222:223],v16 offset:26624
M v[64:67],a[228:231],v[160:163],v[64:67]
T a[224:225],v15 offset:28672
T a[226:227],v15 offset:30720
M v[52:55],a[232:235],v[172:175],v[52:55]
T a[228:229],v16 offset:28672
T a[230:231],v16 offset:30720
M v[56:59],a[232:235],v[176:179],v[56:59]
M v[60:63],a[232:235],v[180:183],v[60:63]
T a[232:233],v15 offset:32768
T a[234:235],v15 offset:34816
M v[72:75],a[236:239],v[180:183],v[72:75]
C v47,v94,v95
M v[68:71],a[236:239],v[176:179],v[68:71]
s_cmp_eq_u32 s32,s43
s_cselect_b32 s32,s42,s32
M v[64:67],a[236:239],v[172:175],v[64:67]
buffer_store_dwordx4 v[44:47],v0,s[24:27],s44 offen offset:1024 sc1
s_waitcnt lgkmcnt(4)
M v[52:55],a[216:219],v[184:187],v[52:55]
T a[236:237],v16 offset:32768
s_add_u32 m0,s28,0xc000
M v[56:59],a[216:219],v[188:191],v[56:59]
T a[238:239],v16 offset:34816
M v[60:63],a[216:219],v[192:195],v[60:63]
C v48,v84,v85
M v[72:75],a[220:223],v[192:195],v[72:75]
T a[216:217],v15 offset:36864
s_add_u32 s35,s32,0x7800
M v[68:71],a[220:223],v[188:191],v[68:71]
T a[218:219],v15 offset:38912
M v[64:67],a[220:223],v[184:187],v[64:67]
L v106,s[16:19],s32 offen lds
M v[52:55],a[224:227],v[196:199],v[52:55]
T a[220:221],v16 offset:36864
C v49,v86,v87
M v[56:59],a[224:227],v[200:203],v[56:59]
T a[222:223],v16 offset:38912
M v[60:63],a[224:227],v[204:207],v[60:63]
s_waitcnt lgkmcnt(4)
M v[72:75],a[228:231],v[204:207],v[72:75]
T a[224:225],v15 offset:40960
M v[68:71],a[228:231],v[200:203],v[68:71]
T a[226:227],v15 offset:43008
C v50,v96,v97
M v[64:67],a[228:231],v[196:199],v[64:67]
L v107,s[16:19],s32 offen offset:1024 lds
M v[52:55],a[232:235],v[208:211],v[52:55]
T a[228:229],v16 offset:40960
M v[56:59],a[232:235],v[212:215],v[56:59]
T a[230:231],v16 offset:43008
C v51,v98,v99
M v[60:63],a[232:235],v[216:219],v[60:63]
L v108,s[16:19],s32 offen offset:2048 lds
M v[72:75],a[236:239],v[216:219],v[72:75]
T a[232:233],v15 offset:45056
M v[68:71],a[236:239],v[212:215],v[68:71]
T a[234:235],v15 offset:47104
buffer_store_dwordx4 v[48:51],v0,s[24:27],s44 offen offset:2048 sc1
M v[64:67],a[236:239],v[208:211],v[64:67]
s_waitcnt lgkmcnt(4)
M v[52:55],a[216:219],v[220:223],v[52:55]
T a[236:237],v16 offset:45056
s_add_u32 m0,m0,0xc00
M v[56:59],a[216:219],v[224:227],v[56:59]
T a[238:239],v16 offset:47104
M v[60:63],a[216:219],v[228:231],v[60:63]
s_add_u32 s44,s44,0x3000
M v[72:75],a[220:223],v[228:231],v[72:75]
s_add_u32 s32,s32,0x78000
M v[68:71],a[220:223],v[224:227],v[68:71]
M v[64:67],a[220:223],v[220:223],v[64:67]
L v106,s[16:19],s35 offen lds
M v[52:55],a[224:227],v[232:235],v[52:55]
s_cmp_eq_u32 s44,s46
s_cselect_b32 s44,s45,s44
M v[56:59],a[224:227],v[236:239],v[56:59]
L v107,s[16:19],s35 offen offset:1024 lds
M v[60:63],a[224:227],v[240:243],v[60:63]
s_waitcnt vmcnt(14) lgkmcnt(0)
s_barrier
M v[72:75],a[228:231],v[240:243],v[72:75]
T a[216:217],v13
T a[218:219],v13 offset:2048
M v[68:71],a[228:231],v[236:239],v[68:71]
T a[220:221],v14
T a[222:223],v14 offset:2048
M v[64:67],a[228:231],v[232:235],v[64:67]
T a[224:225],v13 offset:4096
T a[226:227],v13 offset:6144
M v[52:55],a[232:235],v[244:247],v[52:55]
T a[228:229],v14 offset:4096
T a[230:231],v14 offset:6144
M v[56:59],a[232:235],v[248:251],v[56:59]
M v[60:63],a[232:235],v[252:255],v[60:63]
T a[232:233],v13 offset:8192
T a[234:235],v13 offset:10240
M v[72:75],a[236:239],v[252:255],v[72:75]
L v108,s[16:19],s35 offen offset:2048 lds
M v[68:71],a[236:239],v[248:251],v[68:71]
M v[64:67],a[236:239],v[244:247],v[64:67]
M v[76:79],a[242:245],a[72:75],0
M v[80:83],a[242:245],a[76:79],0
M v[84:87],a[242:245],a[80:83],0
M v[88:91],a[240:243],a[72:75],0
M v[92:95],a[240:243],a[76:79],0
M v[96:99],a[240:243],a[80:83],0
s_waitcnt lgkmcnt(4)
M v[76:79],a[216:219],v[112:115],v[76:79]
T a[236:237],v14 offset:8192
s_add_u32 m0,s28,0x12000
M v[80:83],a[216:219],v[116:119],v[80:83]
T a[238:239],v14 offset:10240
M v[84:87],a[216:219],v[120:123],v[84:87]
s_add_u32 s35,s32,0x7800
M v[96:99],a[220:223],v[120:123],v[96:99]
T a[216:217],v13 offset:12288
C v40,v52,v53
M v[92:95],a[220:223],v[116:119],v[92:95]
T a[218:219],v13 offset:14336
M v[88:91],a[220:223],v[112:115],v[88:91]
L v106,s[16:19],s32 offen lds
M v[76:79],a[224:227],v[124:127],v[76:79]
T a[220:221],v14 offset:12288
C v41,v54,v55
M v[80:83],a[224:227],v[128:131],v[80:83]
T a[222:223],v14 offset:14336
M v[84:87],a[224:227],v[132:135],v[84:87]
L v107,s[16:19],s32 offen offset:1024 lds
s_waitcnt lgkmcnt(4)
M v[96:99],a[228:231],v[132:135],v[96:99]
T a[224:225],v13 offset:16384
M v[92:95],a[228:231],v[128:131],v[92:95]
T a[226:227],v13 offset:18432
C v42,v64,v65
M v[88:91],a[228:231],v[124:127],v[88:91]
L v108,s[16:19],s32 offen offset:2048 lds
M v[76:79],a[232:235],v[136:139],v[76:79]
T a[228:229],v14 offset:16384
M v[80:83],a[232:235],v[140:143],v[80:83]
T a[230:231],v14 offset:18432
C v43,v66,v67
M v[84:87],a[232:235],v[144:147],v[84:87]
s_add_u32 m0,m0,0xc00
M v[96:99],a[236:239],v[144:147],v[96:99]
T a[232:233],v13 offset:20480
M v[92:95],a[236:239],v[140:143],v[92:95]
T a[234:235],v13 offset:22528
s_add_u32 s32,s32,0xfff88080
M v[88:91],a[236:239],v[136:139],v[88:91]
buffer_store_dwordx4 v[40:43],v0,s[24:27],s44 offen sc1
s_waitcnt lgkmcnt(4)
M v[76:79],a[216:219],v[148:151],v[76:79]
T a[236:237],v14 offset:20480
M v[80:83],a[216:219],v[152:155],v[80:83]
T a[238:239],v14 offset:22528
M v[84:87],a[216:219],v[156:159],v[84:87]
C v44,v56,v57
L v106,s[16:19],s35 offen lds
M v[96:99],a[220:223],v[156:159],v[96:99]
L v107,s[16:19],s35 offen offset:1024 lds
M v[92:95],a[220:223],v[152:155],v[92:95]
C v45,v58,v59
M v[88:91],a[220:223],v[148:151],v[88:91]
L v108,s[16:19],s35 offen offset:2048 lds
M v[76:79],a[224:227],v[160:163],v[76:79]
C v46,v68,v69
M v[80:83],a[224:227],v[164:167],v[80:83]
M v[84:87],a[224:227],v[168:171],v[84:87]
s_waitcnt vmcnt(15) lgkmcnt(0)
s_barrier
M v[96:99],a[228:231],v[168:171],v[96:99]
T a[216:217],v13 offset:24576
T a[218:219],v13 offset:26624
M v[92:95],a[228:231],v[164:167],v[92:95]
T a[220:221],v14 offset:24576
T a[222:223],v14 offset:26624
M v[88:91],a[228:231],v[160:163],v[88:91]
T a[224:225],v13 offset:28672
T a[226:227],v13 offset:30720
M v[76:79],a[232:235],v[172:175],v[76:79]
T a[228:229],v14 offset:28672
T a[230:231],v14 offset:30720
M v[80:83],a[232:235],v[176:179],v[80:83]
M v[84:87],a[232:235],v[180:183],v[84:87]
T a[232:233],v13 offset:32768
T a[234:235],v13 offset:34816
M v[96:99],a[236:239],v[180:183],v[96:99]
C v47,v70,v71
M v[92:95],a[236:239],v[176:179],v[92:95]
s_cmp_eq_u32 s32,s43
s_cselect_b32 s32,s42,s32
M v[88:91],a[236:239],v[172:175],v[88:91]
buffer_store_dwordx4 v[44:47],v0,s[24:27],s44 offen offset:1024 sc1
s_waitcnt lgkmcnt(4)
M v[76:79],a[216:219],v[184:187],v[76:79]
T a[236:237],v14 offset:32768
s_add_u32 m0,s28,0
M v[80:83],a[216:219],v[188:191],v[80:83]
T a[238:239],v14 offset:34816
M v[84:87],a[216:219],v[192:195],v[84:87]
C v48,v60,v61
M v[96:99],a[220:223],v[192:195],v[96:99]
T a[216:217],v13 offset:36864
s_add_u32 s35,s32,0x7800
M v[92:95],a[220:223],v[188:191],v[92:95]
T a[218:219],v13 offset:38912
M v[88:91],a[220:223],v[184:187],v[88:91]
L v106,s[16:19],s32 offen lds
M v[76:79],a[224:227],v[196:199],v[76:79]
T a[220:221],v14 offset:36864
C v49,v62,v63
M v[80:83],a[224:227],v[200:203],v[80:83]
T a[222:223],v14 offset:38912
M v[84:87],a[224:227],v[204:207],v[84:87]
s_waitcnt lgkmcnt(4)
M v[96:99],a[228:231],v[204:207],v[96:99]
T a[224:225],v13 offset:40960
M v[92:95],a[228:231],v[200:203],v[92:95]
T a[226:227],v13 offset:43008
C v50,v72,v73
M v[88:91],a[228:231],v[196:199],v[88:91]
L v107,s[16:19],s32 offen offset:1024 lds
M v[76:79],a[232:235],v[208:211],v[76:79]
T a[228:229],v14 offset:40960
M v[80:83],a[232:235],v[212:215],v[80:83]
T a[230:231],v14 offset:43008
C v51,v74,v75
M v[84:87],a[232:235],v[216:219],v[84:87]
L v108,s[16:19],s32 offen offset:2048 lds
M v[96:99],a[236:239],v[216:219],v[96:99]
T a[232:233],v13 offset:45056
M v[92:95],a[236:239],v[212:215],v[92:95]
T a[234:235],v13 offset:47104
buffer_store_dwordx4 v[48:51],v0,s[24:27],s44 offen offset:2048 sc1
M v[88:91],a[236:239],v[208:211],v[88:91]
s_waitcnt lgkmcnt(4)
M v[76:79],a[216:219],v[220:223],v[76:79]
T a[236:237],v14 offset:45056
s_add_u32 m0,m0,0xc00
M v[80:83],a[216:219],v[224:227],v[80:83]
T a[238:239],v14 offset:47104
M v[84:87],a[216:219],v[228:231],v[84:87]
s_add_u32 s44,s44,0x3000
M v[96:99],a[220:223],v[228:231],v[96:99]
s_add_u32 s32,s32,0x78000
M v[92:95],a[220:223],v[224:227],v[92:95]
M v[88:91],a[220:223],v[220:223],v[88:91]
L v106,s[16:19],s35 offen lds
M v[76:79],a[224:227],v[232:235],v[76:79]
s_cmp_eq_u32 s44,s46
s_cselect_b32 s44,s45,s44
M v[80:83],a[224:227],v[236:239],v[80:83]
L v107,s[16:19],s35 offen offset:1024 lds
M v[84:87],a[224:227],v[240:243],v[84:87]
s_waitcnt vmcnt(14) lgkmcnt(0)
s_barrier
M v[96:99],a[228:231],v[240:243],v[96:99]
T a[216:217],v15
T a[218:219],v15 offset:2048
M v[92:95],a[228:231],v[236:239],v[92:95]
T a[220:221],v16
T a[222:223],v16 offset:2048
M v[88:91],a[228:231],v[232:235],v[88:91]
T a[224:225],v15 offset:4096
T a[226:227],v15 offset:6144
M v[76:79],a[232:235],v[244:247],v[76:79]
T a[228:229],v16 offset:4096
T a[230:231],v16 offset:6144
M v[80:83],a[232:235],v[248:251],v[80:83]
M v[84:87],a[232:235],v[252:255],v[84:87]
T a[232:233],v15 offset:8192
T a[234:235],v15 offset:10240
M v[96:99],a[236:239],v[252:255],v[96:99]
L v108,s[16:19],s35 offen offset:2048 lds
M v[92:95],a[236:239],v[248:251],v[92:95]
M v[88:91],a[236:239],v[244:247],v[88:91]
M v[52:55],a[242:245],a[84:87],0
M v[56:59],a[242:245],a[88:91],0
M v[60:63],a[242:245],a[92:95],0
M v[64:67],a[240:243],a[84:87],0
M v[68:71],a[240:243],a[88:91],0
M v[72:75],a[240:243],a[92:95],0
s_waitcnt lgkmcnt(4)
M v[52:55],a[216:219],v[112:115],v[52:55]
T a[236:237],v16 offset:8192
s_add_u32 m0,s28,0x6000
M v[56:59],a[216:219],v[116:119],v[56:59]
T a[238:239],v16 offset:10240
M v[60:63],a[216:219],v[120:123],v[60:63]
s_add_u32 s35,s32,0x7800
M v[72:75],a[220:223],v[120:123],v[72:75]
T a[216:217],v15 offset:12288
C v40,v76,v77
M v[68:71],a[220:223],v[116:119],v[68:71]
T a[218:219],v15 offset:14336
M v[64:67],a[220:223],v[112:115],v[64:67]
L v106,s[16:19],s32 offen lds
M v[52:55],a[224:227],v[124:127],v[52:55]
T a[220:221],v16 offset:12288
C v41,v78,v79
M v[56:59],a[224:227],v[128:131],v[56:59]
T a[222:223],v16 offset:14336
M v[60:63],a[224:227],v[132:135],v[60:63]
L v107,s[16:19],s32 offen offset:1024 lds
s_waitcnt lgkmcnt(4)
M v[72:75],a[228:231],v[132:135],v[72:75]
T a[224:225],v15 offset:16384
M v[68:71],a[228:231],v[128:131],v[68:71]
T a[226:227],v15 offset:18432
C v42,v88,v89
M v[64:67],a[228:231],v[124:127],v[64:67]
L v108,s[16:19],s32 offen offset:2048 lds
M v[52:55],a[232:235],v[136:139],v[52:55]
T a[228:229],v16 offset:16384
M v[56:59],a[232:235],v[140:143],v[56:59]
T a[230:231],v16 offset:18432
C v43,v90,v91
M v[60:63],a[232:235],v[144:147],v[60:63]
s_add_u32 m0,m0,0xc00
M v[72:75],a[236:239],v[144:147],v[72:75]
T a[232:233],v15 offset:20480
M v[68:71],a[236:239],v[140:143],v[68:71]
T a[234:235],v15 offset:22528
s_add_u32 s32,s32,0xfff88080
M v[64:67],a[236:239],v[136:139],v[64:67]
buffer_store_dwordx4 v[40:43],v0,s[24:27],s44 offen sc1
s_waitcnt lgkmcnt(4)
M v[52:55],a[216:219],v[148:151],v[52:55]
T a[236:237],v16 offset:20480
M v[56:59],a[216:219],v[152:155],v[56:59]
T a[238:239],v16 offset:22528
M v[60:63],a[216:219],v[156:159],v[60:63]
C v44,v80,v81
L v106,s[16:19],s35 offen lds
M v[72:75],a[220:223],v[156:159],v[72:75]
L v107,s[16:19],s35 offen offset:1024 lds
M v[68:71],a[220:223],v[152:155],v[68:71]
C v45,v82,v83
M v[64:67],a[220:223],v[148:151],v[64:67]
L v108,s[16:19],s35 offen offset:2048 lds
M v[52:55],a[224:227],v[160:163],v[52:55]
C v46,v92,v93
M v[56:59],a[224:227],v[164:167],v[56:59]
M v[60:63],a[224:227],v[168:171],v[60:63]
s_waitcnt vmcnt(15) lgkmcnt(0)
s_barrier
M v[72:75],a[228:231],v[168:171],v[72:75]
T a[216:217],v15 offset:24576
T a[218:219],v15 offset:26624
M v[68:71],a[228:231],v[164:167],v[68:71]
T a[220:221],v16 offset:24576
T a[222:223],v16 offset:26624
M v[64:67],a[228:231],v[160:163],v[64:67]
T a[224:225],v15 offset:28672
T a[226:227],v15 offset:30720
M v[52:55],a[232:235],v[172:175],v[52:55]
T a[228:229],v16 offset:28672
T a[230:231],v16 offset:30720
M v[56:59],a[232:235],v[176:179],v[56:59]
M v[60:63],a[232:235],v[180:183],v[60:63]
T a[232:233],v15 offset:32768
T a[234:235],v15 offset:34816
M v[72:75],a[236:239],v[180:183],v[72:75]
C v47,v94,v95
M v[68:71],a[236:239],v[176:179],v[68:71]
s_cmp_eq_u32 s32,s43
s_cselect_b32 s32,s42,s32
M v[64:67],a[236:239],v[172:175],v[64:67]
buffer_store_dwordx4 v[44:47],v0,s[24:27],s44 offen offset:1024 sc1
s_waitcnt lgkmcnt(4)
M v[52:55],a[216:219],v[184:187],v[52:55]
T a[236:237],v16 offset:32768
s_add_u32 m0,s28,0xc000
M v[56:59],a[216:219],v[188:191],v[56:59]
T a[238:239],v16 offset:34816
M v[60:63],a[216:219],v[192:195],v[60:63]
C v48,v84,v85
M v[72:75],a[220:223],v[192:195],v[72:75]
T a[216:217],v15 offset:36864
s_add_u32 s35,s32,0x7800
M v[68:71],a[220:223],v[188:191],v[68:71]
T a[218:219],v15 offset:38912
M v[64:67],a[220:223],v[184:187],v[64:67]
L v106,s[16:19],s32 offen lds
M v[52:55],a[224:227],v[196:199],v[52:55]
T a[220:221],v16 offset:36864
C v49,v86,v87
M v[56:59],a[224:227],v[200:203],v[56:59]
T a[222:223],v16 offset:38912
M v[60:63],a[224:227],v[204:207],v[60:63]
s_waitcnt lgkmcnt(4)
M v[72:75],a[228:231],v[204:207],v[72:75]
T a[224:225],v15 offset:40960
M v[68:71],a[228:231],v[200:203],v[68:71]
T a[226:227],v15 offset:43008
C v50,v96,v97
M v[64:67],a[228:231],v[196:199],v[64:67]
L v107,s[16:19],s32 offen offset:1024 lds
M v[52:55],a[232:235],v[208:211],v[52:55]
T a[228:229],v16 offset:40960
M v[56:59],a[232:235],v[212:215],v[56:59]
T a[230:231],v16 offset:43008
C v51,v98,v99
M v[60:63],a[232:235],v[216:219],v[60:63]
L v108,s[16:19],s32 offen offset:2048 lds
M v[72:75],a[236:239],v[216:219],v[72:75]
T a[232:233],v15 offset:45056
M v[68:71],a[236:239],v[212:215],v[68:71]
T a[234:235],v15 offset:47104
buffer_store_dwordx4 v[48:51],v0,s[24:27],s44 offen offset:2048 sc1
M v[64:67],a[236:239],v[208:211],v[64:67]
s_waitcnt lgkmcnt(4)
M v[52:55],a[216:219],v[220:223],v[52:55]
T a[236:237],v16 offset:45056
s_add_u32 m0,m0,0xc00
M v[56:59],a[216:219],v[224:227],v[56:59]
T a[238:239],v16 offset:47104
M v[60:63],a[216:219],v[228:231],v[60:63]
s_add_u32 s44,s44,0x3000
M v[72:75],a[220:223],v[228:231],v[72:75]
s_add_u32 s32,s32,0x78000
M v[68:71],a[220:223],v[224:227],v[68:71]
M v[64:67],a[220:223],v[220:223],v[64:67]
L v106,s[16:19],s35 offen lds
M v[52:55],a[224:227],v[232:235],v[52:55]
s_cmp_eq_u32 s44,s46
s_cselect_b32 s44,s45,s44
M v[56:59],a[224:227],v[236:239],v[56:59]
L v107,s[16:19],s35 offen offset:1024 lds
M v[60:63],a[224:227],v[240:243],v[60:63]
s_waitcnt vmcnt(14) lgkmcnt(0)
s_barrier
M v[72:75],a[228:231],v[240:243],v[72:75]
T a[216:217],v13
T a[218:219],v13 offset:2048
M v[68:71],a[228:231],v[236:239],v[68:71]
T a[220:221],v14
T a[222:223],v14 offset:2048
M v[64:67],a[228:231],v[232:235],v[64:67]
T a[224:225],v13 offset:4096
T a[226:227],v13 offset:6144
M v[52:55],a[232:235],v[244:247],v[52:55]
T a[228:229],v14 offset:4096
T a[230:231],v14 offset:6144
M v[56:59],a[232:235],v[248:251],v[56:59]
M v[60:63],a[232:235],v[252:255],v[60:63]
T a[232:233],v13 offset:8192
T a[234:235],v13 offset:10240
M v[72:75],a[236:239],v[252:255],v[72:75]
L v108,s[16:19],s35 offen offset:2048 lds
M v[68:71],a[236:239],v[248:251],v[68:71]
M v[64:67],a[236:239],v[244:247],v[64:67]
M v[76:79],a[242:245],a[96:99],0
M v[80:83],a[242:245],a[100:103],0
M v[84:87],a[242:245],a[104:107],0
M v[88:91],a[240:243],a[96:99],0
M v[92:95],a[240:243],a[100:103],0
M v[96:99],a[240:243],a[104:107],0
s_waitcnt lgkmcnt(4)
M v[76:79],a[216:219],v[112:115],v[76:79]
T a[236:237],v14 offset:8192
s_add_u32 m0,s28,0x12000
M v[80:83],a[216:219],v[116:119],v[80:83]
T a[238:239],v14 offset:10240
M v[84:87],a[216:219],v[120:123],v[84:87]
s_add_u32 s35,s32,0x7800
M v[96:99],a[220:223],v[120:123],v[96:99]
T a[216:217],v13 offset:12288
C v40,v52,v53
M v[92:95],a[220:223],v[116:119],v[92:95]
T a[218:219],v13 offset:14336
M v[88:91],a[220:223],v[112:115],v[88:91]
L v106,s[16:19],s32 offen lds
M v[76:79],a[224:227],v[124:127],v[76:79]
T a[220:221],v14 offset:12288
C v41,v54,v55
M v[80:83],a[224:227],v[128:131],v[80:83]
T a[222:223],v14 offset:14336
M v[84:87],a[224:227],v[132:135],v[84:87]
L v107,s[16:19],s32 offen offset:1024 lds
s_waitcnt lgkmcnt(4)
M v[96:99],a[228:231],v[132:135],v[96:99]
T a[224:225],v13 offset:16384
M v[92:95],a[228:231],v[128:131],v[92:95]
T a[226:227],v13 offset:18432
C v42,v64,v65
M v[88:91],a[228:231],v[124:127],v[88:91]
L v108,s[16:19],s32 offen offset:2048 lds
M v[76:79],a[232:235],v[136:139],v[76:79]
T a[228:229],v14 offset:16384
M v[80:83],a[232:235],v[140:143],v[80:83]
T a[230:231],v14 offset:18432
C v43,v66,v67
M v[84:87],a[232:235],v[144:147],v[84:87]
s_add_u32 m0,m0,0xc00
M v[96:99],a[236:239],v[144:147],v[96:99]
T a[232:233],v13 offset:20480
M v[92:95],a[236:239],v[140:143],v[92:95]
T a[234:235],v13 offset:22528
s_add_u32 s32,s32,0xfff88080
M v[88:91],a[236:239],v[136:139],v[88:91]
buffer_store_dwordx4 v[40:43],v0,s[24:27],s44 offen sc1
s_waitcnt lgkmcnt(4)
M v[76:79],a[216:219],v[148:151],v[76:79]
T a[236:237],v14 offset:20480
M v[80:83],a[216:219],v[152:155],v[80:83]
T a[238:239],v14 offset:22528
M v[84:87],a[216:219],v[156:159],v[84:87]
C v44,v56,v57
L v106,s[16:19],s35 offen lds
M v[96:99],a[220:223],v[156:159],v[96:99]
L v107,s[16:19],s35 offen offset:1024 lds
M v[92:95],a[220:223],v[152:155],v[92:95]
C v45,v58,v59
M v[88:91],a[220:223],v[148:151],v[88:91]
L v108,s[16:19],s35 offen offset:2048 lds
M v[76:79],a[224:227],v[160:163],v[76:79]
C v46,v68,v69
M v[80:83],a[224:227],v[164:167],v[80:83]
M v[84:87],a[224:227],v[168:171],v[84:87]
s_waitcnt vmcnt(15) lgkmcnt(0)
s_barrier
M v[96:99],a[228:231],v[168:171],v[96:99]
T a[216:217],v13 offset:24576
T a[218:219],v13 offset:26624
M v[92:95],a[228:231],v[164:167],v[92:95]
T a[220:221],v14 offset:24576
T a[222:223],v14 offset:26624
M v[88:91],a[228:231],v[160:163],v[88:91]
T a[224:225],v13 offset:28672
T a[226:227],v13 offset:30720
M v[76:79],a[232:235],v[172:175],v[76:79]
T a[228:229],v14 offset:28672
T a[230:231],v14 offset:30720
M v[80:83],a[232:235],v[176:179],v[80:83]
M v[84:87],a[232:235],v[180:183],v[84:87]
T a[232:233],v13 offset:32768
T a[234:235],v13 offset:34816
M v[96:99],a[236:239],v[180:183],v[96:99]
C v47,v70,v71
M v[92:95],a[236:239],v[176:179],v[92:95]
s_cmp_eq_u32 s32,s43
s_cselect_b32 s32,s42,s32
M v[88:91],a[236:239],v[172:175],v[88:91]
buffer_store_dwordx4 v[44:47],v0,s[24:27],s44 offen offset:1024 sc1
s_waitcnt lgkmcnt(4)
M v[76:79],a[216:219],v[184:187],v[76:79]
T a[236:237],v14 offset:32768
M v[80:83],a[216:219],v[188:191],v[80:83]
T a[238:239],v14 offset:34816
M v[84:87],a[216:219],v[192:195],v[84:87]
C v48,v60,v61
M v[96:99],a[220:223],v[192:195],v[96:99]
T a[216:217],v13 offset:36864
M v[92:95],a[220:223],v[188:191],v[92:95]
T a[218:219],v13 offset:38912
M v[88:91],a[220:223],v[184:187],v[88:91]
M v[76:79],a[224:227],v[196:199],v[76:79]
T a[220:221],v14 offset:36864
C v49,v62,v63
M v[80:83],a[224:227],v[200:203],v[80:83]
T a[222:223],v14 offset:38912
M v[84:87],a[224:227],v[204:207],v[84:87]
s_waitcnt lgkmcnt(4)
M v[96:99],a[228:231],v[204:207],v[96:99]
T a[224:225],v13 offset:40960
M v[92:95],a[228:231],v[200:203],v[92:95]
T a[226:227],v13 offset:43008
C v50,v72,v73
M v[88:91],a[228:231],v[196:199],v[88:91]
M v[76:79],a[232:235],v[208:211],v[76:79]
T a[228:229],v14 offset:40960
M v[80:83],a[232:235],v[212:215],v[80:83]
T a[230:231],v14 offset:43008
C v51,v74,v75
M v[84:87],a[232:235],v[216:219],v[84:87]
M v[96:99],a[236:239],v[216:219],v[96:99]
T a[232:233],v13 offset:45056
M v[92:95],a[236:239],v[212:215],v[92:95]
T a[234:235],v13 offset:47104
buffer_store_dwordx4 v[48:51],v0,s[24:27],s44 offen offset:2048 sc1
M v[88:91],a[236:239],v[208:211],v[88:91]
s_waitcnt lgkmcnt(4)
M v[76:79],a[216:219],v[220:223],v[76:79]
T a[236:237],v14 offset:45056
M v[80:83],a[216:219],v[224:227],v[80:83]
T a[238:239],v14 offset:47104
M v[84:87],a[216:219],v[228:231],v[84:87]
s_add_u32 s44,s44,0x3000
M v[96:99],a[220:223],v[228:231],v[96:99]
M v[92:95],a[220:223],v[224:227],v[92:95]
M v[88:91],a[220:223],v[220:223],v[88:91]
M v[76:79],a[224:227],v[232:235],v[76:79]
s_cmp_eq_u32 s44,s46
s_cselect_b32 s44,s45,s44
M v[80:83],a[224:227],v[236:239],v[80:83]
M v[84:87],a[224:227],v[240:243],v[84:87]
s_waitcnt vmcnt(9) lgkmcnt(0)
s_barrier
M v[96:99],a[228:231],v[240:243],v[96:99]
T a[216:217],v15
T a[218:219],v15 offset:2048
M v[92:95],a[228:231],v[236:239],v[92:95]
T a[220:221],v16
T a[222:223],v16 offset:2048
M v[88:91],a[228:231],v[232:235],v[88:91]
T a[224:225],v15 offset:4096
T a[226:227],v15 offset:6144
M v[76:79],a[232:235],v[244:247],v[76:79]
T a[228:229],v16 offset:4096
T a[230:231],v16 offset:6144
M v[80:83],a[232:235],v[248:251],v[80:83]
M v[84:87],a[232:235],v[252:255],v[84:87]
T a[232:233],v15 offset:8192
T a[234:235],v15 offset:10240
M v[96:99],a[236:239],v[252:255],v[96:99]
M v[92:95],a[236:239],v[248:251],v[92:95]
M v[88:91],a[236:239],v[244:247],v[88:91]
M v[52:55],a[242:245],a[108:111],0
M v[56:59],a[242:245],a[112:115],0
M v[60:63],a[242:245],a[116:119],0
M v[64:67],a[240:243],a[108:111],0
M v[68:71],a[240:243],a[112:115],0
M v[72:75],a[240:243],a[116:119],0
s_waitcnt lgkmcnt(4)
M v[52:55],a[216:219],v[112:115],v[52:55]
T a[236:237],v16 offset:8192
M v[56:59],a[216:219],v[116:119],v[56:59]
T a[238:239],v16 offset:10240
M v[60:63],a[216:219],v[120:123],v[60:63]
M v[72:75],a[220:223],v[120:123],v[72:75]
T a[216:217],v15 offset:12288
C v40,v76,v77
M v[68:71],a[220:223],v[116:119],v[68:71]
T a[218:219],v15 offset:14336
M v[64:67],a[220:223],v[112:115],v[64:67]
M v[52:55],a[224:227],v[124:127],v[52:55]
T a[220:221],v16 offset:12288
C v41,v78,v79
M v[56:59],a[224:227],v[128:131],v[56:59]
T a[222:223],v16 offset:14336
M v[60:63],a[224:227],v[132:135],v[60:63]
s_waitcnt lgkmcnt(4)
M v[72:75],a[228:231],v[132:135],v[72:75]
T a[224:225],v15 offset:16384
M v[68:71],a[228:231],v[128:131],v[68:71]
T a[226:227],v15 offset:18432
M v[64:67],a[228:231],v[124:127],v[64:67]
C v42,v88,v89
M v[52:55],a[232:235],v[136:139],v[52:55]
T a[228:229],v16 offset:16384
M v[56:59],a[232:235],v[140:143],v[56:59]
T a[230:231],v16 offset:18432
M v[60:63],a[232:235],v[144:147],v[60:63]
C v43,v90,v91
M v[72:75],a[236:239],v[144:147],v[72:75]
T a[232:233],v15 offset:20480
M v[68:71],a[236:239],v[140:143],v[68:71]
T a[234:235],v15 offset:22528
M v[64:67],a[236:239],v[136:139],v[64:67]
s_waitcnt lgkmcnt(4)
M v[52:55],a[216:219],v[148:151],v[52:55]
T a[236:237],v16 offset:20480
M v[56:59],a[216:219],v[152:155],v[56:59]
T a[238:239],v16 offset:22528
buffer_store_dwordx4 v[40:43],v0,s[24:27],s44 offen sc1
M v[60:63],a[216:219],v[156:159],v[60:63]
M v[72:75],a[220:223],v[156:159],v[72:75]
M v[68:71],a[220:223],v[152:155],v[68:71]
C v44,v80,v81
M v[64:67],a[220:223],v[148:151],v[64:67]
M v[52:55],a[224:227],v[160:163],v[52:55]
C v45,v82,v83
M v[56:59],a[224:227],v[164:167],v[56:59]
M v[60:63],a[224:227],v[168:171],v[60:63]
s_waitcnt vmcnt(3) lgkmcnt(0)
s_barrier
M v[72:75],a[228:231],v[168:171],v[72:75]
T a[216:217],v15 offset:24576
T a[218:219],v15 offset:26624
M v[68:71],a[228:231],v[164:167],v[68:71]
T a[220:221],v16 offset:24576
T a[222:223],v16 offset:26624
M v[64:67],a[228:231],v[160:163],v[64:67]
T a[224:225],v15 offset:28672
T a[226:227],v15 offset:30720
M v[52:55],a[232:235],v[172:175],v[52:55]
T a[228:229],v16 offset:28672
T a[230:231],v16 offset:30720
M v[56:59],a[232:235],v[176:179],v[56:59]
M v[60:63],a[232:235],v[180:183],v[60:63]
T a[232:233],v15 offset:32768
T a[234:235],v15 offset:34816
M v[72:75],a[236:239],v[180:183],v[72:75]
C v46,v92,v93
M v[68:71],a[236:239],v[176:179],v[68:71]
M v[64:67],a[236:239],v[172:175],v[64:67]
s_waitcnt lgkmcnt(4)
M v[52:55],a[216:219],v[184:187],v[52:55]
T a[236:237],v16 offset:32768
C v47,v94,v95
M v[56:59],a[216:219],v[188:191],v[56:59]
T a[238:239],v16 offset:34816
M v[60:63],a[216:219],v[192:195],v[60:63]
M v[72:75],a[220:223],v[192:195],v[72:75]
T a[216:217],v15 offset:36864
M v[68:71],a[220:223],v[188:191],v[68:71]
T a[218:219],v15 offset:38912
buffer_store_dwordx4 v[44:47],v0,s[24:27],s44 offen offset:1024 sc1
M v[64:67],a[220:223],v[184:187],v[64:67]
M v[52:55],a[224:227],v[196:199],v[52:55]
T a[220:221],v16 offset:36864
M v[56:59],a[224:227],v[200:203],v[56:59]
T a[222:223],v16 offset:38912
M v[60:63],a[224:227],v[204:207],v[60:63]
C v48,v84,v85
buffer_load_dword v39,v110,s[24:27],0 offen sc1
s_waitcnt lgkmcnt(4)
M v[72:75],a[228:231],v[204:207],v[72:75]
T a[224:225],v15 offset:40960
M v[68:71],a[228:231],v[200:203],v[68:71]
T a[226:227],v15 offset:43008
M v[64:67],a[228:231],v[196:199],v[64:67]
M v[52:55],a[232:235],v[208:211],v[52:55]
T a[228:229],v16 offset:40960
C v49,v86,v87
M v[56:59],a[232:235],v[212:215],v[56:59]
T a[230:231],v16 offset:43008
M v[60:63],a[232:235],v[216:219],v[60:63]
M v[72:75],a[236:239],v[216:219],v[72:75]
T a[232:233],v15 offset:45056
M v[68:71],a[236:239],v[212:215],v[68:71]
T a[234:235],v15 offset:47104
C v50,v96,v97
M v[64:67],a[236:239],v[208:211],v[64:67]
s_waitcnt lgkmcnt(4)
M v[52:55],a[216:219],v[220:223],v[52:55]
T a[236:237],v16 offset:45056
M v[56:59],a[216:219],v[224:227],v[56:59]
T a[238:239],v16 offset:47104
M v[60:63],a[216:219],v[228:231],v[60:63]
C v51,v98,v99
M v[72:75],a[220:223],v[228:231],v[72:75]
M v[68:71],a[220:223],v[224:227],v[68:71]
M v[64:67],a[220:223],v[220:223],v[64:67]
buffer_store_dwordx4 v[48:51],v0,s[24:27],s44 offen offset:2048 sc1
M v[52:55],a[224:227],v[232:235],v[52:55]
M v[56:59],a[224:227],v[236:239],v[56:59]
s_add_u32 s44,s44,0x3000
M v[60:63],a[224:227],v[240:243],v[60:63]
s_waitcnt lgkmcnt(0)
M v[72:75],a[228:231],v[240:243],v[72:75]
M v[68:71],a[228:231],v[236:239],v[68:71]
M v[64:67],a[228:231],v[232:235],v[64:67]
M v[52:55],a[232:235],v[244:247],v[52:55]
s_cmp_eq_u32 s44,s46
s_cselect_b32 s44,s45,s44
s_load_dwordx4 s[60:63],s[0:1],80
M v[56:59],a[232:235],v[248:251],v[56:59]
M v[60:63],a[232:235],v[252:255],v[60:63]
M v[72:75],a[236:239],v[252:255],v[72:75]
M v[68:71],a[236:239],v[248:251],v[68:71]
M v[64:67],a[236:239],v[244:247],v[64:67]
C v40,v52,v53
C v41,v54,v55
s_nop 5
C v42,v64,v65
C v43,v66,v67
buffer_store_dwordx4 v[40:43],v0,s[24:27],s44 offen sc1
C v44,v56,v57
C v45,v58,v59
C v46,v68,v69
C v47,v70,v71
buffer_store_dwordx4 v[44:47],v0,s[24:27],s44 offen offset:1024 sc1
C v48,v60,v61
C v49,v62,v63
C v50,v72,v73
C v51,v74,v75
buffer_store_dwordx4 v[48:51],v0,s[24:27],s44 offen offset:2048 sc1
s_add_u32 s44,s44,0x3000
s_cmp_eq_u32 s44,s46
s_cselect_b32 s44,s45,s44
s_waitcnt vmcnt(4)
L_r0:
v_cmp_ne_u32 vcc,v39,v109
s_bfe_u32 s28,s2,0x10002
s_lshr_b32 s29,s2,4
s_lshl_b32 s30,s29,4
s_lshl_b32 s33,s28,2
s_add_u32 s30,s30,s33
s_mul_i32 s30,s30,122880
s_mov_b32 s35,s51
s_mov_b32 s36,s50
s_mov_b32 s32,0
s_mov_b32 s37,0
s_lshl_b32 s47,1,s51
s_andn2_b32 s34,vcc_lo,s47
s_and_b32 s48,s34,0xff
s_mov_b32 s34,0
s_sub_u32 s49,0,s48
s_and_b32 s49,s49,s48
s_or_b32 s34,s34,s49
s_xor_b32 s48,s48,s49
L_r0_setup:
s_mul_i32 s33,s35,15
s_add_u32 s38,s36,0
s_add_u32 s38,s38,s33
s_lshl_b32 s42,s38,10
s_add_u32 s42,s42,s30
s_add_u32 s39,s36,4
s_add_u32 s39,s39,s33
s_lshl_b32 s43,s39,10
s_add_u32 s43,s43,s30
s_add_u32 s40,s36,8
s_add_u32 s40,s40,s33
s_lshl_b32 s44,s40,10
s_add_u32 s44,s44,s30
s_add_u32 s41,s36,12
s_min_u32 s41,s41,14
s_add_u32 s41,s41,s33
s_lshl_b32 s45,s41,10
s_add_u32 s45,s45,s30
s_mov_b32 s31,0
s_mov_b32 s33,0
s_mov_b32 s46,0
L_r0_issue:
s_bitcmp1_b32 s34,0
s_cbranch_scc0 L_r0_s0
s_add_u32 s55,s42,0
L v[112:115],v0,s[24:27],s55 offen sc1
s_add_u32 s55,s43,0
L v[144:147],v0,s[24:27],s55 offen sc1
s_add_u32 s55,s44,0
L v[176:179],v0,s[24:27],s55 offen sc1
s_add_u32 s55,s45,0
L v[208:211],v0,s[24:27],s55 offen sc1
L_r0_s0:
s_bitcmp1_b32 s34,1
s_cbranch_scc0 L_r0_s1
s_add_u32 s55,s42,983040
L v[116:119],v0,s[24:27],s55 offen sc1
s_add_u32 s55,s43,983040
L v[148:151],v0,s[24:27],s55 offen sc1
s_add_u32 s55,s44,983040
L v[180:183],v0,s[24:27],s55 offen sc1
s_add_u32 s55,s45,983040
L v[212:215],v0,s[24:27],s55 offen sc1
L_r0_s1:
s_bitcmp1_b32 s34,2
s_cbranch_scc0 L_r0_s2
s_add_u32 s55,s42,122880
L v[120:123],v0,s[24:27],s55 offen sc1
s_add_u32 s55,s43,122880
L v[152:155],v0,s[24:27],s55 offen sc1
s_add_u32 s55,s44,122880
L v[184:187],v0,s[24:27],s55 offen sc1
s_add_u32 s55,s45,122880
L v[216:219],v0,s[24:27],s55 offen sc1
L_r0_s2:
s_bitcmp1_b32 s34,3
s_cbranch_scc0 L_r0_s3
s_add_u32 s55,s42,1105920
L v[124:127],v0,s[24:27],s55 offen sc1
s_add_u32 s55,s43,1105920
L v[156:159],v0,s[24:27],s55 offen sc1
s_add_u32 s55,s44,1105920
L v[188:191],v0,s[24:27],s55 offen sc1
s_add_u32 s55,s45,1105920
L v[220:223],v0,s[24:27],s55 offen sc1
L_r0_s3:
s_bitcmp1_b32 s34,4
s_cbranch_scc0 L_r0_s4
s_add_u32 s55,s42,245760
L v[128:131],v0,s[24:27],s55 offen sc1
s_add_u32 s55,s43,245760
L v[160:163],v0,s[24:27],s55 offen sc1
s_add_u32 s55,s44,245760
L v[192:195],v0,s[24:27],s55 offen sc1
s_add_u32 s55,s45,245760
L v[224:227],v0,s[24:27],s55 offen sc1
L_r0_s4:
s_bitcmp1_b32 s34,5
s_cbranch_scc0 L_r0_s5
s_add_u32 s55,s42,1228800
L v[132:135],v0,s[24:27],s55 offen sc1
s_add_u32 s55,s43,1228800
L v[164:167],v0,s[24:27],s55 offen sc1
s_add_u32 s55,s44,1228800
L v[196:199],v0,s[24:27],s55 offen sc1
s_add_u32 s55,s45,1228800
L v[228:231],v0,s[24:27],s55 offen sc1
L_r0_s5:
s_bitcmp1_b32 s34,6
s_cbranch_scc0 L_r0_s6
s_add_u32 s55,s42,368640
L v[136:139],v0,s[24:27],s55 offen sc1
s_add_u32 s55,s43,368640
L v[168:171],v0,s[24:27],s55 offen sc1
s_add_u32 s55,s44,368640
L v[200:203],v0,s[24:27],s55 offen sc1
s_add_u32 s55,s45,368640
L v[232:235],v0,s[24:27],s55 offen sc1
L_r0_s6:
s_bitcmp1_b32 s34,7
s_cbranch_scc0 L_r0_s7
s_add_u32 s55,s42,1351680
L v[140:143],v0,s[24:27],s55 offen sc1
s_add_u32 s55,s43,1351680
L v[172:175],v0,s[24:27],s55 offen sc1
s_add_u32 s55,s44,1351680
L v[204:207],v0,s[24:27],s55 offen sc1
s_add_u32 s55,s45,1351680
L v[236:239],v0,s[24:27],s55 offen sc1
L_r0_s7:
s_or_b32 s54,s47,s33
s_cbranch_scc1 L_r0_nset
v_lshrrev_b32 v3,4,v0
v_and_b32 v2,15,v3
v_mul_u32_u24 v2,2560,v2
v_lshrrev_b32 v3,4,v3
v_lshl_add_u32 v2,v3,4,v2
s_mul_hi_u32 s54,s38,0x15555556
s_mul_i32 s55,s54,12
s_sub_u32 s55,s38,s55
s_mul_hi_u32 s56,s55,0x55555556
s_mul_i32 s57,s56,3
s_sub_u32 s57,s55,s57
s_and_b32 s12,s56,1
s_mul_i32 s12,s12,48
s_lshl_b32 s57,s57,4
s_add_u32 s12,s12,s57
s_mul_i32 s57,s29,96
s_add_u32 s12,s12,s57
s_mul_i32 s12,s12,2560
s_mul_i32 s57,s28,1280
s_add_u32 s12,s12,s57
s_lshl_b32 s57,s54,7
s_add_u32 s12,s12,s57
s_lshr_b32 s57,s56,1
s_lshl_b32 s57,s57,6
s_add_u32 s12,s12,s57
s_mul_hi_u32 s54,s39,0x15555556
s_mul_i32 s55,s54,12
s_sub_u32 s55,s39,s55
s_mul_hi_u32 s56,s55,0x55555556
s_mul_i32 s57,s56,3
s_sub_u32 s57,s55,s57
s_and_b32 s13,s56,1
s_mul_i32 s13,s13,48
s_lshl_b32 s57,s57,4
s_add_u32 s13,s13,s57
s_mul_i32 s57,s29,96
s_add_u32 s13,s13,s57
s_mul_i32 s13,s13,2560
s_mul_i32 s57,s28,1280
s_add_u32 s13,s13,s57
s_lshl_b32 s57,s54,7
s_add_u32 s13,s13,s57
s_lshr_b32 s57,s56,1
s_lshl_b32 s57,s57,6
s_add_u32 s13,s13,s57
s_mul_hi_u32 s54,s40,0x15555556
s_mul_i32 s55,s54,12
s_sub_u32 s55,s40,s55
s_mul_hi_u32 s56,s55,0x55555556
s_mul_i32 s57,s56,3
s_sub_u32 s57,s55,s57
s_and_b32 s14,s56,1
s_mul_i32 s14,s14,48
s_lshl_b32 s57,s57,4
s_add_u32 s14,s14,s57
s_mul_i32 s57,s29,96
s_add_u32 s14,s14,s57
s_mul_i32 s14,s14,2560
s_mul_i32 s57,s28,1280
s_add_u32 s14,s14,s57
s_lshl_b32 s57,s54,7
s_add_u32 s14,s14,s57
s_lshr_b32 s57,s56,1
s_lshl_b32 s57,s57,6
s_add_u32 s14,s14,s57
s_mul_hi_u32 s54,s41,0x15555556
s_mul_i32 s55,s54,12
s_sub_u32 s55,s41,s55
s_mul_hi_u32 s56,s55,0x55555556
s_mul_i32 s57,s56,3
s_sub_u32 s57,s55,s57
s_and_b32 s15,s56,1
s_mul_i32 s15,s15,48
s_lshl_b32 s57,s57,4
s_add_u32 s15,s15,s57
s_mul_i32 s57,s29,96
s_add_u32 s15,s15,s57
s_mul_i32 s15,s15,2560
s_mul_i32 s57,s28,1280
s_add_u32 s15,s15,s57
s_lshl_b32 s57,s54,7
s_add_u32 s15,s15,s57
s_lshr_b32 s57,s56,1
s_lshl_b32 s57,s57,6
s_add_u32 s15,s15,s57
v_mov_b32 v64,0
v_mov_b32 v65,0
v_mov_b32 v66,0
v_mov_b32 v67,0
v_mov_b32 v68,0
v_mov_b32 v69,0
v_mov_b32 v70,0
v_mov_b32 v71,0
v_mov_b32 v72,0
v_mov_b32 v73,0
v_mov_b32 v74,0
v_mov_b32 v75,0
v_mov_b32 v76,0
v_mov_b32 v77,0
v_mov_b32 v78,0
v_mov_b32 v79,0
v_mov_b32 v80,0
v_mov_b32 v81,0
v_mov_b32 v82,0
v_mov_b32 v83,0
v_mov_b32 v84,0
v_mov_b32 v85,0
v_mov_b32 v86,0
v_mov_b32 v87,0
v_mov_b32 v88,0
v_mov_b32 v89,0
v_mov_b32 v90,0
v_mov_b32 v91,0
v_mov_b32 v92,0
v_mov_b32 v93,0
v_mov_b32 v94,0
v_mov_b32 v95,0
s_mov_b32 s33,1
L_r0_nset:
s_or_b32 s31,s31,s34
s_or_b32 s46,s46,s34
s_cmp_eq_u32 s47,0
s_cbranch_scc1 L_r0_norm
s_lshl_b32 s54,s28,4
s_add_u32 s54,s54,s29
s_lshl_b32 s54,s54,2
v_mov_b32 v6,s54
s_waitcnt lgkmcnt(0)
s_mov_b32 s4,s60
s_mov_b32 s5,s61
s_mov_b32 s6,3932160
s_mov_b32 s7,0x20000
s_mov_b32 s8,s62
s_mov_b32 s9,s63
s_mov_b32 s10,256
s_mov_b32 s11,0x20000
s_bcnt1_i32_b32 s54,s34
s_cmp_lt_u32 s54,1
s_cbranch_scc1 L_r0_w0
s_waitcnt vmcnt(4)
s_branch L_r0_bar
L_r0_w0:
s_waitcnt vmcnt(0)
L_r0_bar:
s_barrier
s_or_b32 s34,s47,s48
s_mov_b32 s49,s47
s_mov_b32 s47,0
s_cmp_lg_u32 s50,0
s_cbranch_scc1 L_r0_issue
s_mov_b32 exec_lo,s49
s_mov_b32 exec_hi,0
v_add_u32 v8,1,v109
buffer_store_dword v8,v110,s[24:27],0 offen sc1
v_mov_b32 v7,1
buffer_atomic_add v7,v6,s[8:11],0 offen sc0
s_mov_b64 exec,-1
s_branch L_r0_issue
L_r0_norm:
s_cmp_eq_u32 s31,0xff
s_cbranch_scc1 L_r0_wait
L_r0_poll:
buffer_load_dword v39,v110,s[24:27],0 offen sc1
s_add_u32 s33,s33,1
L_r0_wait:
s_waitcnt vmcnt(0)
s_bitcmp1_b32 s46,0
s_cbranch_scc0 L_r0_a0
M v[64:67],a[242:245],v[112:115],v[64:67]
M v[68:71],a[240:243],v[112:115],v[68:71]
M v[72:75],a[242:245],v[144:147],v[72:75]
M v[76:79],a[240:243],v[144:147],v[76:79]
M v[80:83],a[242:245],v[176:179],v[80:83]
M v[84:87],a[240:243],v[176:179],v[84:87]
M v[88:91],a[242:245],v[208:211],v[88:91]
M v[92:95],a[240:243],v[208:211],v[92:95]
L_r0_a0:
s_bitcmp1_b32 s46,1
s_cbranch_scc0 L_r0_a1
M v[64:67],a[242:245],v[116:119],v[64:67]
M v[68:71],a[240:243],v[116:119],v[68:71]
M v[72:75],a[242:245],v[148:151],v[72:75]
M v[76:79],a[240:243],v[148:151],v[76:79]
M v[80:83],a[242:245],v[180:183],v[80:83]
M v[84:87],a[240:243],v[180:183],v[84:87]
M v[88:91],a[242:245],v[212:215],v[88:91]
M v[92:95],a[240:243],v[212:215],v[92:95]
L_r0_a1:
s_bitcmp1_b32 s46,2
s_cbranch_scc0 L_r0_a2
M v[64:67],a[242:245],v[120:123],v[64:67]
M v[68:71],a[240:243],v[120:123],v[68:71]
M v[72:75],a[242:245],v[152:155],v[72:75]
M v[76:79],a[240:243],v[152:155],v[76:79]
M v[80:83],a[242:245],v[184:187],v[80:83]
M v[84:87],a[240:243],v[184:187],v[84:87]
M v[88:91],a[242:245],v[216:219],v[88:91]
M v[92:95],a[240:243],v[216:219],v[92:95]
L_r0_a2:
s_bitcmp1_b32 s46,3
s_cbranch_scc0 L_r0_a3
M v[64:67],a[242:245],v[124:127],v[64:67]
M v[68:71],a[240:243],v[124:127],v[68:71]
M v[72:75],a[242:245],v[156:159],v[72:75]
M v[76:79],a[240:243],v[156:159],v[76:79]
M v[80:83],a[242:245],v[188:191],v[80:83]
M v[84:87],a[240:243],v[188:191],v[84:87]
M v[88:91],a[242:245],v[220:223],v[88:91]
M v[92:95],a[240:243],v[220:223],v[92:95]
L_r0_a3:
s_bitcmp1_b32 s46,4
s_cbranch_scc0 L_r0_a4
M v[64:67],a[242:245],v[128:131],v[64:67]
M v[68:71],a[240:243],v[128:131],v[68:71]
M v[72:75],a[242:245],v[160:163],v[72:75]
M v[76:79],a[240:243],v[160:163],v[76:79]
M v[80:83],a[242:245],v[192:195],v[80:83]
M v[84:87],a[240:243],v[192:195],v[84:87]
M v[88:91],a[242:245],v[224:227],v[88:91]
M v[92:95],a[240:243],v[224:227],v[92:95]
L_r0_a4:
s_bitcmp1_b32 s46,5
s_cbranch_scc0 L_r0_a5
M v[64:67],a[242:245],v[132:135],v[64:67]
M v[68:71],a[240:243],v[132:135],v[68:71]
M v[72:75],a[242:245],v[164:167],v[72:75]
M v[76:79],a[240:243],v[164:167],v[76:79]
M v[80:83],a[242:245],v[196:199],v[80:83]
M v[84:87],a[240:243],v[196:199],v[84:87]
M v[88:91],a[242:245],v[228:231],v[88:91]
M v[92:95],a[240:243],v[228:231],v[92:95]
L_r0_a5:
s_bitcmp1_b32 s46,6
s_cbranch_scc0 L_r0_a6
M v[64:67],a[242:245],v[136:139],v[64:67]
M v[68:71],a[240:243],v[136:139],v[68:71]
M v[72:75],a[242:245],v[168:171],v[72:75]
M v[76:79],a[240:243],v[168:171],v[76:79]
M v[80:83],a[242:245],v[200:203],v[80:83]
M v[84:87],a[240:243],v[200:203],v[84:87]
M v[88:91],a[242:245],v[232:235],v[88:91]
M v[92:95],a[240:243],v[232:235],v[92:95]
L_r0_a6:
s_bitcmp1_b32 s46,7
s_cbranch_scc0 L_r0_a7
M v[64:67],a[242:245],v[140:143],v[64:67]
M v[68:71],a[240:243],v[140:143],v[68:71]
M v[72:75],a[242:245],v[172:175],v[72:75]
M v[76:79],a[240:243],v[172:175],v[76:79]
M v[80:83],a[242:245],v[204:207],v[80:83]
M v[84:87],a[240:243],v[204:207],v[84:87]
M v[88:91],a[242:245],v[236:239],v[88:91]
M v[92:95],a[240:243],v[236:239],v[92:95]
L_r0_a7:
s_mov_b32 s46,0
s_cmp_eq_u32 s31,0xff
s_cbranch_scc1 L_r0_sum
v_cmp_ne_u32 vcc,v39,v109
s_nop 4
s_andn2_b32 s34,vcc_lo,s31
s_and_b32 s34,s34,0xff
s_cbranch_scc1 L_r0_issue
s_and_b32 s54,s33,31
s_cbranch_scc1 L_r0_poll
s_mov_b64 exec,1
s_cmp_lt_u32 s33,3000
s_cbranch_scc1 L_r0_cnt
s_lshl_b32 s34,1,s51
v_mov_b32 v8,s34
buffer_atomic_or v8,v6,s[8:11],0 offen offset:128 sc0
s_waitcnt vmcnt(0)
L_r0_cnt:
v_mov_b32 v8,0
buffer_atomic_add v8,v6,s[8:11],0 offen sc0
s_waitcnt vmcnt(0)
v_readfirstlane_b32 s54,v8
s_mov_b64 exec,-1
s_andn2_b32 s34,0xff,s31
s_nop 2
s_cmp_eq_u32 s54,8
s_cbranch_scc1 L_r0_issue
s_cmp_lt_u32 s33,3000
s_cbranch_scc1 L_r0_poll
s_branch L_r0_next
L_r0_sum:
s_or_b32 s54,s50,s32
s_cbranch_scc1 L_r0_sum2
s_mov_b64 exec,1
v_mov_b32 v9,0
buffer_atomic_or v9,v6,s[8:11],0 offen offset:128 sc0
s_mov_b64 exec,-1
L_r0_sum2:
s_nop 7
C v48,v64,v65
C v49,v66,v67
C v50,v68,v69
C v51,v70,v71
C v52,v72,v73
C v53,v74,v75
C v54,v76,v77
C v55,v78,v79
C v56,v80,v81
C v57,v82,v83
C v58,v84,v85
C v59,v86,v87
C v60,v88,v89
C v61,v90,v91
C v62,v92,v93
C v63,v94,v95
v_permlane32_swap_b32 v48,v50
v_permlane32_swap_b32 v49,v51
v_permlane32_swap_b32 v52,v54
v_permlane32_swap_b32 v53,v55
v_permlane32_swap_b32 v56,v58
v_permlane32_swap_b32 v57,v59
v_permlane32_swap_b32 v60,v62
v_permlane32_swap_b32 v61,v63
v_permlane16_swap_b32 v48,v50
v_permlane16_swap_b32 v49,v51
v_permlane16_swap_b32 v52,v54
v_permlane16_swap_b32 v53,v55
v_permlane16_swap_b32 v56,v58
v_permlane16_swap_b32 v57,v59
v_permlane16_swap_b32 v60,v62
v_permlane16_swap_b32 v61,v63
s_nop 1
buffer_store_dwordx4 v[48:51],v2,s[4:7],s12 offen sc1
buffer_store_dwordx4 v[52:55],v2,s[4:7],s13 offen sc1
buffer_store_dwordx4 v[56:59],v2,s[4:7],s14 offen sc1
buffer_store_dwordx4 v[60:63],v2,s[4:7],s15 offen sc1
L_r0_next:
s_cmp_lg_u32 s50,0
s_cbranch_scc1 L_r0_done
s_cmp_lg_u32 s32,0
s_cbranch_scc1 L_r0_more
s_waitcnt vmcnt(0)
v_readlane_b32 s32,v7,s51
v_readlane_b32 s37,v9,0
s_nop 3
s_cmp_eq_u32 s32,7
s_cbranch_scc0 L_r0_done
s_mov_b32 s36,3
L_r0_more:
s_add_u32 s36,s36,1
s_and_b32 s36,s36,3
s_cbranch_scc1 L_r0_go
s_cmp_eq_u32 s37,0
s_cbranch_scc1 L_r0_done
s_ff1_i32_b32 s35,s37
s_bitset0_b32 s37,s35
L_r0_go:
s_mov_b32 s34,0xff
s_nop 7
s_branch L_r0_setup
L_r0_done:
s_endpgm
C0_17_r:
s_call_b64 s[52:53],L_rare0_0
s_branch C0_17_b
C0_19_r:
s_call_b64 s[52:53],L_rare0_0
s_branch C0_19_b
C0_21_r:
s_call_b64 s[52:53],L_rare0_0
s_branch C0_21_b
C0_23_r:
s_call_b64 s[52:53],L_rare0_0
s_branch C0_23_b
C0_26_r:
s_call_b64 s[52:53],L_rare0_0
s_branch C0_26_b
C0_29_r:
s_call_b64 s[52:53],L_rare0_0
s_branch C0_29_b
C0_32_r:
s_call_b64 s[52:53],L_rare0_0
s_branch C0_32_b
C0_35_r:
s_call_b64 s[52:53],L_rare0_0
s_branch C0_35_b
C0_39_r:
s_call_b64 s[52:53],L_rare0_0
s_branch C0_39_b
C0_43_r:
s_call_b64 s[52:53],L_rare0_0
s_branch C0_43_b
C0_47_r:
s_call_b64 s[52:53],L_rare0_0
s_branch C0_47_b
C0_73_r:
s_call_b64 s[52:53],L_rare0_1
s_branch C0_73_b
C0_75_r:
s_call_b64 s[52:53],L_rare0_0
s_branch C0_75_b
C0_77_r:
s_call_b64 s[52:53],L_rare0_1
s_branch C0_77_b
C0_79_r:
s_call_b64 s[52:53],L_rare0_0
s_branch C0_79_b
C0_81_r:
s_call_b64 s[52:53],L_rare0_1
s_branch C0_81_b
L_rare0_0:
s_nop 7
v_max3_f32 v29,v52,v53,v54
v_max3_f32 v30,v56,v57,v58
v_max3_f32 v31,v60,v61,v62
v_max3_f32 v29,v29,v55,v64
v_max3_f32 v30,v30,v59,v68
v_max3_f32 v31,v31,v63,v72
v_max3_f32 v29,v29,v65,v66
v_max3_f32 v30,v30,v69,v70
v_max3_f32 v31,v31,v73,v74
v_max_f32 v29,v29,v67
v_max_f32 v30,v30,v71
v_max_f32 v31,v31,v75
v_mov_b32 v25,v29
v_mov_b32 v26,v30
v_mov_b32 v27,v31
v_permlane32_swap_b32 v29,v25
v_permlane32_swap_b32 v30,v26
v_permlane32_swap_b32 v31,v27
v_max_f32 v29,v29,v25
v_max_f32 v30,v30,v26
v_max_f32 v31,v31,v27
v_mov_b32 v25,v29
v_mov_b32 v26,v30
v_mov_b32 v27,v31
v_permlane16_swap_b32 v29,v25
v_permlane16_swap_b32 v30,v26
v_permlane16_swap_b32 v31,v27
v_max_f32 v29,v29,v25
v_max_f32 v30,v30,v26
v_max_f32 v31,v31,v27
v_max_f32 v29,0,v29
v_max_f32 v30,0,v30
v_max_f32 v31,0,v31
v_add_f32 v19,v19,v29
v_add_f32 v20,v20,v30
v_add_f32 v21,v21,v31
v_sub_f32 v32,0,v29
v_sub_f32 v33,0,v30
v_sub_f32 v34,0,v31
v_exp_f32 v32,v32
v_exp_f32 v33,v33
v_exp_f32 v34,v34
v_sub_f32 v52,v52,v29
v_sub_f32 v56,v56,v30
v_sub_f32 v60,v60,v31
v_sub_f32 v53,v53,v29
v_sub_f32 v57,v57,v30
v_sub_f32 v61,v61,v31
v_sub_f32 v54,v54,v29
v_sub_f32 v58,v58,v30
v_sub_f32 v62,v62,v31
v_sub_f32 v55,v55,v29
v_sub_f32 v59,v59,v30
v_sub_f32 v63,v63,v31
v_sub_f32 v64,v64,v29
v_sub_f32 v68,v68,v30
v_sub_f32 v72,v72,v31
v_sub_f32 v65,v65,v29
v_sub_f32 v69,v69,v30
v_sub_f32 v73,v73,v31
v_sub_f32 v66,v66,v29
v_sub_f32 v70,v70,v30
v_sub_f32 v74,v74,v31
v_sub_f32 v67,v67,v29
v_sub_f32 v71,v71,v30
v_sub_f32 v75,v75,v31
v_mul_f32 v22,v22,v32
v_mul_f32 v23,v23,v33
v_mul_f32 v24,v24,v34
v_mul_f32 v112,v112,v32
v_mul_f32 v116,v116,v33
v_mul_f32 v120,v120,v34
v_mul_f32 v113,v113,v32
v_mul_f32 v117,v117,v33
v_mul_f32 v121,v121,v34
v_mul_f32 v114,v114,v32
v_mul_f32 v118,v118,v33
v_mul_f32 v122,v122,v34
v_mul_f32 v115,v115,v32
v_mul_f32 v119,v119,v33
v_mul_f32 v123,v123,v34
v_mul_f32 v124,v124,v32
v_mul_f32 v128,v128,v33
v_mul_f32 v132,v132,v34
v_mul_f32 v125,v125,v32
v_mul_f32 v129,v129,v33
v_mul_f32 v133,v133,v34
v_mul_f32 v126,v126,v32
v_mul_f32 v130,v130,v33
v_mul_f32 v134,v134,v34
v_mul_f32 v127,v127,v32
v_mul_f32 v131,v131,v33
v_mul_f32 v135,v135,v34
v_mul_f32 v136,v136,v32
v_mul_f32 v140,v140,v33
v_mul_f32 v144,v144,v34
v_mul_f32 v137,v137,v32
v_mul_f32 v141,v141,v33
v_mul_f32 v145,v145,v34
v_mul_f32 v138,v138,v32
v_mul_f32 v142,v142,v33
v_mul_f32 v146,v146,v34
v_mul_f32 v139,v139,v32
v_mul_f32 v143,v143,v33
v_mul_f32 v147,v147,v34
v_mul_f32 v148,v148,v32
v_mul_f32 v152,v152,v33
v_mul_f32 v156,v156,v34
v_mul_f32 v149,v149,v32
v_mul_f32 v153,v153,v33
v_mul_f32 v157,v157,v34
v_mul_f32 v150,v150,v32
v_mul_f32 v154,v154,v33
v_mul_f32 v158,v158,v34
v_mul_f32 v151,v151,v32
v_mul_f32 v155,v155,v33
v_mul_f32 v159,v159,v34
v_mul_f32 v160,v160,v32
v_mul_f32 v164,v164,v33
v_mul_f32 v168,v168,v34
v_mul_f32 v161,v161,v32
v_mul_f32 v165,v165,v33
v_mul_f32 v169,v169,v34
v_mul_f32 v162,v162,v32
v_mul_f32 v166,v166,v33
v_mul_f32 v170,v170,v34
v_mul_f32 v163,v163,v32
v_mul_f32 v167,v167,v33
v_mul_f32 v171,v171,v34
v_mul_f32 v172,v172,v32
v_mul_f32 v176,v176,v33
v_mul_f32 v180,v180,v34
v_mul_f32 v173,v173,v32
v_mul_f32 v177,v177,v33
v_mul_f32 v181,v181,v34
v_mul_f32 v174,v174,v32
v_mul_f32 v178,v178,v33
v_mul_f32 v182,v182,v34
v_mul_f32 v175,v175,v32
v_mul_f32 v179,v179,v33
v_mul_f32 v183,v183,v34
v_mul_f32 v184,v184,v32
v_mul_f32 v188,v188,v33
v_mul_f32 v192,v192,v34
v_mul_f32 v185,v185,v32
v_mul_f32 v189,v189,v33
v_mul_f32 v193,v193,v34
v_mul_f32 v186,v186,v32
v_mul_f32 v190,v190,v33
v_mul_f32 v194,v194,v34
v_mul_f32 v187,v187,v32
v_mul_f32 v191,v191,v33
v_mul_f32 v195,v195,v34
v_mul_f32 v196,v196,v32
v_mul_f32 v200,v200,v33
v_mul_f32 v204,v204,v34
v_mul_f32 v197,v197,v32
v_mul_f32 v201,v201,v33
v_mul_f32 v205,v205,v34
v_mul_f32 v198,v198,v32
v_mul_f32 v202,v202,v33
v_mul_f32 v206,v206,v34
v_mul_f32 v199,v199,v32
v_mul_f32 v203,v203,v33
v_mul_f32 v207,v207,v34
v_mul_f32 v208,v208,v32
v_mul_f32 v212,v212,v33
v_mul_f32 v216,v216,v34
v_mul_f32 v209,v209,v32
v_mul_f32 v213,v213,v33
v_mul_f32 v217,v217,v34
v_mul_f32 v210,v210,v32
v_mul_f32 v214,v214,v33
v_mul_f32 v218,v218,v34
v_mul_f32 v211,v211,v32
v_mul_f32 v215,v215,v33
v_mul_f32 v219,v219,v34
v_mul_f32 v220,v220,v32
v_mul_f32 v224,v224,v33
v_mul_f32 v228,v228,v34
v_mul_f32 v221,v221,v32
v_mul_f32 v225,v225,v33
v_mul_f32 v229,v229,v34
v_mul_f32 v222,v222,v32
v_mul_f32 v226,v226,v33
v_mul_f32 v230,v230,v34
v_mul_f32 v223,v223,v32
v_mul_f32 v227,v227,v33
v_mul_f32 v231,v231,v34
v_mul_f32 v232,v232,v32
v_mul_f32 v236,v236,v33
v_mul_f32 v240,v240,v34
v_mul_f32 v233,v233,v32
v_mul_f32 v237,v237,v33
v_mul_f32 v241,v241,v34
v_mul_f32 v234,v234,v32
v_mul_f32 v238,v238,v33
v_mul_f32 v242,v242,v34
v_mul_f32 v235,v235,v32
v_mul_f32 v239,v239,v33
v_mul_f32 v243,v243,v34
v_mul_f32 v244,v244,v32
v_mul_f32 v248,v248,v33
v_mul_f32 v252,v252,v34
v_mul_f32 v245,v245,v32
v_mul_f32 v249,v249,v33
v_mul_f32 v253,v253,v34
v_mul_f32 v246,v246,v32
v_mul_f32 v250,v250,v33
v_mul_f32 v254,v254,v34
v_mul_f32 v247,v247,v32
v_mul_f32 v251,v251,v33
v_mul_f32 v255,v255,v34
s_nop 3
s_setpc_b64 s[52:53]
L_rare0_1:
s_nop 7
v_max3_f32 v29,v76,v77,v78
v_max3_f32 v30,v80,v81,v82
v_max3_f32 v31,v84,v85,v86
v_max3_f32 v29,v29,v79,v88
v_max3_f32 v30,v30,v83,v92
v_max3_f32 v31,v31,v87,v96
v_max3_f32 v29,v29,v89,v90
v_max3_f32 v30,v30,v93,v94
v_max3_f32 v31,v31,v97,v98
v_max_f32 v29,v29,v91
v_max_f32 v30,v30,v95
v_max_f32 v31,v31,v99
v_mov_b32 v25,v29
v_mov_b32 v26,v30
v_mov_b32 v27,v31
v_permlane32_swap_b32 v29,v25
v_permlane32_swap_b32 v30,v26
v_permlane32_swap_b32 v31,v27
v_max_f32 v29,v29,v25
v_max_f32 v30,v30,v26
v_max_f32 v31,v31,v27
v_mov_b32 v25,v29
v_mov_b32 v26,v30
v_mov_b32 v27,v31
v_permlane16_swap_b32 v29,v25
v_permlane16_swap_b32 v30,v26
v_permlane16_swap_b32 v31,v27
v_max_f32 v29,v29,v25
v_max_f32 v30,v30,v26
v_max_f32 v31,v31,v27
v_max_f32 v29,0,v29
v_max_f32 v30,0,v30
v_max_f32 v31,0,v31
v_add_f32 v19,v19,v29
v_add_f32 v20,v20,v30
v_add_f32 v21,v21,v31
v_sub_f32 v32,0,v29
v_sub_f32 v33,0,v30
v_sub_f32 v34,0,v31
v_exp_f32 v32,v32
v_exp_f32 v33,v33
v_exp_f32 v34,v34
v_sub_f32 v76,v76,v29
v_sub_f32 v80,v80,v30
v_sub_f32 v84,v84,v31
v_sub_f32 v77,v77,v29
v_sub_f32 v81,v81,v30
v_sub_f32 v85,v85,v31
v_sub_f32 v78,v78,v29
v_sub_f32 v82,v82,v30
v_sub_f32 v86,v86,v31
v_sub_f32 v79,v79,v29
v_sub_f32 v83,v83,v30
v_sub_f32 v87,v87,v31
v_sub_f32 v88,v88,v29
v_sub_f32 v92,v92,v30
v_sub_f32 v96,v96,v31
v_sub_f32 v89,v89,v29
v_sub_f32 v93,v93,v30
v_sub_f32 v97,v97,v31
v_sub_f32 v90,v90,v29
v_sub_f32 v94,v94,v30
v_sub_f32 v98,v98,v31
v_sub_f32 v91,v91,v29
v_sub_f32 v95,v95,v30
v_sub_f32 v99,v99,v31
v_mul_f32 v22,v22,v32
v_mul_f32 v23,v23,v33
v_mul_f32 v24,v24,v34
v_mul_f32 v112,v112,v32
v_mul_f32 v116,v116,v33
v_mul_f32 v120,v120,v34
v_mul_f32 v113,v113,v32
v_mul_f32 v117,v117,v33
v_mul_f32 v121,v121,v34
v_mul_f32 v114,v114,v32
v_mul_f32 v118,v118,v33
v_mul_f32 v122,v122,v34
v_mul_f32 v115,v115,v32
v_mul_f32 v119,v119,v33
v_mul_f32 v123,v123,v34
v_mul_f32 v124,v124,v32
v_mul_f32 v128,v128,v33
v_mul_f32 v132,v132,v34
v_mul_f32 v125,v125,v32
v_mul_f32 v129,v129,v33
v_mul_f32 v133,v133,v34
v_mul_f32 v126,v126,v32
v_mul_f32 v130,v130,v33
v_mul_f32 v134,v134,v34
v_mul_f32 v127,v127,v32
v_mul_f32 v131,v131,v33
v_mul_f32 v135,v135,v34
v_mul_f32 v136,v136,v32
v_mul_f32 v140,v140,v33
v_mul_f32 v144,v144,v34
v_mul_f32 v137,v137,v32
v_mul_f32 v141,v141,v33
v_mul_f32 v145,v145,v34
v_mul_f32 v138,v138,v32
v_mul_f32 v142,v142,v33
v_mul_f32 v146,v146,v34
v_mul_f32 v139,v139,v32
v_mul_f32 v143,v143,v33
v_mul_f32 v147,v147,v34
v_mul_f32 v148,v148,v32
v_mul_f32 v152,v152,v33
v_mul_f32 v156,v156,v34
v_mul_f32 v149,v149,v32
v_mul_f32 v153,v153,v33
v_mul_f32 v157,v157,v34
v_mul_f32 v150,v150,v32
v_mul_f32 v154,v154,v33
v_mul_f32 v158,v158,v34
v_mul_f32 v151,v151,v32
v_mul_f32 v155,v155,v33
v_mul_f32 v159,v159,v34
v_mul_f32 v160,v160,v32
v_mul_f32 v164,v164,v33
v_mul_f32 v168,v168,v34
v_mul_f32 v161,v161,v32
v_mul_f32 v165,v165,v33
v_mul_f32 v169,v169,v34
v_mul_f32 v162,v162,v32
v_mul_f32 v166,v166,v33
v_mul_f32 v170,v170,v34
v_mul_f32 v163,v163,v32
v_mul_f32 v167,v167,v33
v_mul_f32 v171,v171,v34
v_mul_f32 v172,v172,v32
v_mul_f32 v176,v176,v33
v_mul_f32 v180,v180,v34
v_mul_f32 v173,v173,v32
v_mul_f32 v177,v177,v33
v_mul_f32 v181,v181,v34
v_mul_f32 v174,v174,v32
v_mul_f32 v178,v178,v33
v_mul_f32 v182,v182,v34
v_mul_f32 v175,v175,v32
v_mul_f32 v179,v179,v33
v_mul_f32 v183,v183,v34
v_mul_f32 v184,v184,v32
v_mul_f32 v188,v188,v33
v_mul_f32 v192,v192,v34
v_mul_f32 v185,v185,v32
v_mul_f32 v189,v189,v33
v_mul_f32 v193,v193,v34
v_mul_f32 v186,v186,v32
v_mul_f32 v190,v190,v33
v_mul_f32 v194,v194,v34
v_mul_f32 v187,v187,v32
v_mul_f32 v191,v191,v33
v_mul_f32 v195,v195,v34
v_mul_f32 v196,v196,v32
v_mul_f32 v200,v200,v33
v_mul_f32 v204,v204,v34
v_mul_f32 v197,v197,v32
v_mul_f32 v201,v201,v33
v_mul_f32 v205,v205,v34
v_mul_f32 v198,v198,v32
v_mul_f32 v202,v202,v33
v_mul_f32 v206,v206,v34
v_mul_f32 v199,v199,v32
v_mul_f32 v203,v203,v33
v_mul_f32 v207,v207,v34
v_mul_f32 v208,v208,v32
v_mul_f32 v212,v212,v33
v_mul_f32 v216,v216,v34
v_mul_f32 v209,v209,v32
v_mul_f32 v213,v213,v33
v_mul_f32 v217,v217,v34
v_mul_f32 v210,v210,v32
v_mul_f32 v214,v214,v33
v_mul_f32 v218,v218,v34
v_mul_f32 v211,v211,v32
v_mul_f32 v215,v215,v33
v_mul_f32 v219,v219,v34
v_mul_f32 v220,v220,v32
v_mul_f32 v224,v224,v33
v_mul_f32 v228,v228,v34
v_mul_f32 v221,v221,v32
v_mul_f32 v225,v225,v33
v_mul_f32 v229,v229,v34
v_mul_f32 v222,v222,v32
v_mul_f32 v226,v226,v33
v_mul_f32 v230,v230,v34
v_mul_f32 v223,v223,v32
v_mul_f32 v227,v227,v33
v_mul_f32 v231,v231,v34
v_mul_f32 v232,v232,v32
v_mul_f32 v236,v236,v33
v_mul_f32 v240,v240,v34
v_mul_f32 v233,v233,v32
v_mul_f32 v237,v237,v33
v_mul_f32 v241,v241,v34
v_mul_f32 v234,v234,v32
v_mul_f32 v238,v238,v33
v_mul_f32 v242,v242,v34
v_mul_f32 v235,v235,v32
v_mul_f32 v239,v239,v33
v_mul_f32 v243,v243,v34
v_mul_f32 v244,v244,v32
v_mul_f32 v248,v248,v33
v_mul_f32 v252,v252,v34
v_mul_f32 v245,v245,v32
v_mul_f32 v249,v249,v33
v_mul_f32 v253,v253,v34
v_mul_f32 v246,v246,v32
v_mul_f32 v250,v250,v33
v_mul_f32 v254,v254,v34
v_mul_f32 v247,v247,v32
v_mul_f32 v251,v251,v33
v_mul_f32 v255,v255,v34
s_nop 3
s_setpc_b64 s[52:53]
L_cls1:
s_add_u32 m0,s28,0x6000
s_add_u32 s35,s31,0x30000
L v103,s[12:15],s31 offen lds
L v104,s[12:15],s31 offen offset:1024 lds
L v105,s[12:15],s31 offen offset:2048 lds
s_add_u32 m0,m0,0xc00
s_add_u32 s31,s31,0x60000
L v103,s[12:15],s35 offen lds
L v104,s[12:15],s35 offen offset:1024 lds
L v105,s[12:15],s35 offen offset:2048 lds
s_cmp_eq_u32 s31,s39
s_cselect_b32 s31,s38,s31
s_add_u32 m0,s34,0x3000
s_xor_b32 s34,s34,0x38000
L v106,s[20:23],s33 offen lds
L v107,s[20:23],s33 offen offset:1024 lds
L v108,s[20:23],s33 offen offset:2048 lds
s_add_u32 s33,s33,0x80
s_cmp_eq_u32 s33,s41
s_cselect_b32 s33,s40,s33
s_add_u32 m0,s28,0xc000
s_add_u32 s35,s31,0x30000
L v103,s[12:15],s31 offen lds
L v104,s[12:15],s31 offen offset:1024 lds
L v105,s[12:15],s31 offen offset:2048 lds
s_add_u32 m0,m0,0xc00
s_add_u32 s31,s31,0x60000
L v103,s[12:15],s35 offen lds
L v104,s[12:15],s35 offen offset:1024 lds
L v105,s[12:15],s35 offen offset:2048 lds
s_waitcnt vmcnt(17)
s_barrier
ds_read_b128 v[76:79],v17
ds_read_b128 v[80:83],v17 offset:2048
ds_read_b128 v[84:87],v17 offset:4096
T a[216:217],v5
T a[218:219],v5 offset:6144
T a[220:221],v6
T a[222:223],v6 offset:6144
T a[224:225],v7
T a[226:227],v7 offset:6144
T a[228:229],v8
T a[230:231],v8 offset:6144
T a[232:233],v5 offset:128
T a[234:235],v5 offset:6272
s_waitcnt lgkmcnt(4)
M v[112:115],a[216:219],v[76:79],0
T a[236:237],v6 offset:128
s_add_u32 m0,s28,0x12000
M v[116:119],a[216:219],v[80:83],0
T a[238:239],v6 offset:6272
M v[120:123],a[216:219],v[84:87],0
s_add_u32 s35,s31,0x30000
M v[132:135],a[220:223],v[84:87],0
T a[216:217],v7 offset:128
L v103,s[12:15],s31 offen lds
M v[128:131],a[220:223],v[80:83],0
T a[218:219],v7 offset:6272
M v[124:127],a[220:223],v[76:79],0
L v104,s[12:15],s31 offen offset:1024 lds
M v[136:139],a[224:227],v[76:79],0
T a[220:221],v8 offset:128
L v105,s[12:15],s31 offen offset:2048 lds
M v[140:143],a[224:227],v[80:83],0
T a[222:223],v8 offset:6272
M v[144:147],a[224:227],v[84:87],0
s_add_u32 m0,m0,0xc00
s_waitcnt lgkmcnt(4)
M v[156:159],a[228:231],v[84:87],0
T a[224:225],v5 offset:256
M v[152:155],a[228:231],v[80:83],0
T a[226:227],v5 offset:6400
s_add_u32 s31,s31,0x60000
M v[148:151],a[228:231],v[76:79],0
L v103,s[12:15],s35 offen lds
M v[160:163],a[232:235],v[76:79],0
T a[228:229],v6 offset:256
M v[164:167],a[232:235],v[80:83],0
T a[230:231],v6 offset:6400
L v104,s[12:15],s35 offen offset:1024 lds
M v[168:171],a[232:235],v[84:87],0
L v105,s[12:15],s35 offen offset:2048 lds
M v[180:183],a[236:239],v[84:87],0
T a[232:233],v7 offset:256
M v[176:179],a[236:239],v[80:83],0
T a[234:235],v7 offset:6400
M v[172:175],a[236:239],v[76:79],0
s_waitcnt lgkmcnt(4)
M v[184:187],a[216:219],v[76:79],0
T a[236:237],v8 offset:256
M v[188:191],a[216:219],v[80:83],0
T a[238:239],v8 offset:6400
M v[192:195],a[216:219],v[84:87],0
s_cmp_eq_u32 s31,s39
s_cselect_b32 s31,s38,s31
M v[204:207],a[220:223],v[84:87],0
s_add_u32 m0,s34,0
s_nop 0
L v106,s[20:23],s33 offen lds
M v[200:203],a[220:223],v[80:83],0
L v107,s[20:23],s33 offen offset:1024 lds
M v[196:199],a[220:223],v[76:79],0
L v108,s[20:23],s33 offen offset:2048 lds
M v[208:211],a[224:227],v[76:79],0
s_add_u32 s33,s33,0x80
M v[212:215],a[224:227],v[80:83],0
M v[216:219],a[224:227],v[84:87],0
s_waitcnt vmcnt(18) lgkmcnt(0)
s_barrier
M v[228:231],a[228:231],v[84:87],0
T a[216:217],v5 offset:24576
T a[218:219],v5 offset:30720
M v[224:227],a[228:231],v[80:83],0
ds_read_b128 v[88:91],v18
T a[220:221],v6 offset:24576
M v[220:223],a[228:231],v[76:79],0
T a[222:223],v6 offset:30720
ds_read_b128 v[92:95],v18 offset:2048
M v[232:235],a[232:235],v[76:79],0
ds_read_b128 v[96:99],v18 offset:4096
T a[224:225],v7 offset:24576
M v[236:239],a[232:235],v[80:83],0
T a[226:227],v7 offset:30720
T a[228:229],v8 offset:24576
M v[240:243],a[232:235],v[84:87],0
T a[230:231],v8 offset:30720
T a[232:233],v5 offset:24704
M v[252:255],a[236:239],v[84:87],0
T a[234:235],v5 offset:30848
M v[248:251],a[236:239],v[80:83],0
s_cmp_eq_u32 s33,s41
s_cselect_b32 s33,s40,s33
M v[244:247],a[236:239],v[76:79],0
s_mov_b32 s36,3
.p2align 3
C1_loop1:
s_waitcnt lgkmcnt(4)
M v[112:115],a[216:219],v[88:91],v[112:115]
T a[236:237],v6 offset:24704
s_add_u32 m0,s28,0
M v[116:119],a[216:219],v[92:95],v[116:119]
T a[238:239],v6 offset:30848
M v[120:123],a[216:219],v[96:99],v[120:123]
s_add_u32 s35,s31,0x30000
M v[132:135],a[220:223],v[96:99],v[132:135]
T a[216:217],v7 offset:24704
L v103,s[12:15],s31 offen lds
M v[128:131],a[220:223],v[92:95],v[128:131]
T a[218:219],v7 offset:30848
M v[124:127],a[220:223],v[88:91],v[124:127]
L v104,s[12:15],s31 offen offset:1024 lds
M v[136:139],a[224:227],v[88:91],v[136:139]
T a[220:221],v8 offset:24704
L v105,s[12:15],s31 offen offset:2048 lds
M v[140:143],a[224:227],v[92:95],v[140:143]
T a[222:223],v8 offset:30848
M v[144:147],a[224:227],v[96:99],v[144:147]
s_waitcnt lgkmcnt(4)
M v[156:159],a[228:231],v[96:99],v[156:159]
T a[224:225],v5 offset:24832
s_add_u32 m0,m0,0xc00
M v[152:155],a[228:231],v[92:95],v[152:155]
T a[226:227],v5 offset:30976
M v[148:151],a[228:231],v[88:91],v[148:151]
s_add_u32 s31,s31,0x60000
M v[160:163],a[232:235],v[88:91],v[160:163]
T a[228:229],v6 offset:24832
L v103,s[12:15],s35 offen lds
M v[164:167],a[232:235],v[92:95],v[164:167]
T a[230:231],v6 offset:30976
M v[168:171],a[232:235],v[96:99],v[168:171]
L v104,s[12:15],s35 offen offset:1024 lds
M v[180:183],a[236:239],v[96:99],v[180:183]
T a[232:233],v7 offset:24832
L v105,s[12:15],s35 offen offset:2048 lds
M v[176:179],a[236:239],v[92:95],v[176:179]
T a[234:235],v7 offset:30976
M v[172:175],a[236:239],v[88:91],v[172:175]
s_waitcnt lgkmcnt(4)
M v[184:187],a[216:219],v[88:91],v[184:187]
T a[236:237],v8 offset:24832
s_add_u32 m0,s34,0x3000
M v[188:191],a[216:219],v[92:95],v[188:191]
T a[238:239],v8 offset:30976
M v[192:195],a[216:219],v[96:99],v[192:195]
s_xor_b32 s34,s34,0x38000
M v[204:207],a[220:223],v[96:99],v[204:207]
L v106,s[20:23],s33 offen lds
M v[200:203],a[220:223],v[92:95],v[200:203]
L v107,s[20:23],s33 offen offset:1024 lds
M v[196:199],a[220:223],v[88:91],v[196:199]
L v108,s[20:23],s33 offen offset:2048 lds
M v[208:211],a[224:227],v[88:91],v[208:211]
s_add_u32 s33,s33,0x80
M v[212:215],a[224:227],v[92:95],v[212:215]
M v[216:219],a[224:227],v[96:99],v[216:219]
s_waitcnt vmcnt(18) lgkmcnt(0)
s_barrier
M v[228:231],a[228:231],v[96:99],v[228:231]
T a[216:217],v9
T a[218:219],v9 offset:6144
M v[224:227],a[228:231],v[92:95],v[224:227]
ds_read_b128 v[76:79],v17 offset:12288
T a[220:221],v10
M v[220:223],a[228:231],v[88:91],v[220:223]
T a[222:223],v10 offset:6144
ds_read_b128 v[80:83],v17 offset:14336
M v[232:235],a[232:235],v[88:91],v[232:235]
ds_read_b128 v[84:87],v17 offset:16384
T a[224:225],v11
M v[236:239],a[232:235],v[92:95],v[236:239]
T a[226:227],v11 offset:6144
T a[228:229],v12
M v[240:243],a[232:235],v[96:99],v[240:243]
T a[230:231],v12 offset:6144
T a[232:233],v9 offset:128
M v[252:255],a[236:239],v[96:99],v[252:255]
T a[234:235],v9 offset:6272
M v[248:251],a[236:239],v[92:95],v[248:251]
s_cmp_eq_u32 s33,s41
s_cselect_b32 s33,s40,s33
M v[244:247],a[236:239],v[88:91],v[244:247]
s_waitcnt lgkmcnt(4)
M v[112:115],a[216:219],v[76:79],v[112:115]
T a[236:237],v10 offset:128
s_add_u32 m0,s28,0x6000
M v[116:119],a[216:219],v[80:83],v[116:119]
T a[238:239],v10 offset:6272
M v[120:123],a[216:219],v[84:87],v[120:123]
s_add_u32 s35,s31,0x30000
M v[132:135],a[220:223],v[84:87],v[132:135]
T a[216:217],v11 offset:128
M v[128:131],a[220:223],v[80:83],v[128:131]
T a[218:219],v11 offset:6272
M v[124:127],a[220:223],v[76:79],v[124:127]
L v103,s[12:15],s31 offen lds
M v[136:139],a[224:227],v[76:79],v[136:139]
T a[220:221],v12 offset:128
M v[140:143],a[224:227],v[80:83],v[140:143]
T a[222:223],v12 offset:6272
L v104,s[12:15],s31 offen offset:1024 lds
M v[144:147],a[224:227],v[84:87],v[144:147]
s_waitcnt lgkmcnt(4)
M v[156:159],a[228:231],v[84:87],v[156:159]
T a[224:225],v9 offset:256
M v[152:155],a[228:231],v[80:83],v[152:155]
T a[226:227],v9 offset:6400
M v[148:151],a[228:231],v[76:79],v[148:151]
L v105,s[12:15],s31 offen offset:2048 lds
M v[160:163],a[232:235],v[76:79],v[160:163]
T a[228:229],v10 offset:256
M v[164:167],a[232:235],v[80:83],v[164:167]
T a[230:231],v10 offset:6400
s_add_u32 m0,m0,0xc00
M v[168:171],a[232:235],v[84:87],v[168:171]
M v[180:183],a[236:239],v[84:87],v[180:183]
T a[232:233],v11 offset:256
s_add_u32 s31,s31,0x60000
M v[176:179],a[236:239],v[80:83],v[176:179]
T a[234:235],v11 offset:6400
M v[172:175],a[236:239],v[76:79],v[172:175]
s_waitcnt lgkmcnt(4)
M v[184:187],a[216:219],v[76:79],v[184:187]
T a[236:237],v12 offset:256
M v[188:191],a[216:219],v[80:83],v[188:191]
T a[238:239],v12 offset:6400
L v103,s[12:15],s35 offen lds
M v[192:195],a[216:219],v[84:87],v[192:195]
M v[204:207],a[220:223],v[84:87],v[204:207]
L v104,s[12:15],s35 offen offset:1024 lds
M v[200:203],a[220:223],v[80:83],v[200:203]
L v105,s[12:15],s35 offen offset:2048 lds
M v[196:199],a[220:223],v[76:79],v[196:199]
M v[208:211],a[224:227],v[76:79],v[208:211]
M v[212:215],a[224:227],v[80:83],v[212:215]
M v[216:219],a[224:227],v[84:87],v[216:219]
s_waitcnt vmcnt(18) lgkmcnt(0)
s_barrier
M v[228:231],a[228:231],v[84:87],v[228:231]
T a[216:217],v9 offset:24576
T a[218:219],v9 offset:30720
M v[224:227],a[228:231],v[80:83],v[224:227]
ds_read_b128 v[88:91],v18 offset:12288
T a[220:221],v10 offset:24576
M v[220:223],a[228:231],v[76:79],v[220:223]
T a[222:223],v10 offset:30720
ds_read_b128 v[92:95],v18 offset:14336
M v[232:235],a[232:235],v[76:79],v[232:235]
ds_read_b128 v[96:99],v18 offset:16384
T a[224:225],v11 offset:24576
M v[236:239],a[232:235],v[80:83],v[236:239]
T a[226:227],v11 offset:30720
T a[228:229],v12 offset:24576
M v[240:243],a[232:235],v[84:87],v[240:243]
T a[230:231],v12 offset:30720
T a[232:233],v9 offset:24704
M v[252:255],a[236:239],v[84:87],v[252:255]
T a[234:235],v9 offset:30848
M v[248:251],a[236:239],v[80:83],v[248:251]
s_cmp_eq_u32 s31,s39
s_cselect_b32 s31,s38,s31
M v[244:247],a[236:239],v[76:79],v[244:247]
s_waitcnt lgkmcnt(4)
M v[112:115],a[216:219],v[88:91],v[112:115]
T a[236:237],v10 offset:24704
s_add_u32 m0,s28,0xc000
M v[116:119],a[216:219],v[92:95],v[116:119]
T a[238:239],v10 offset:30848
M v[120:123],a[216:219],v[96:99],v[120:123]
s_add_u32 s35,s31,0x30000
M v[132:135],a[220:223],v[96:99],v[132:135]
T a[216:217],v11 offset:24704
M v[128:131],a[220:223],v[92:95],v[128:131]
T a[218:219],v11 offset:30848
M v[124:127],a[220:223],v[88:91],v[124:127]
L v103,s[12:15],s31 offen lds
M v[136:139],a[224:227],v[88:91],v[136:139]
T a[220:221],v12 offset:24704
M v[140:143],a[224:227],v[92:95],v[140:143]
T a[222:223],v12 offset:30848
M v[144:147],a[224:227],v[96:99],v[144:147]
s_waitcnt lgkmcnt(4)
M v[156:159],a[228:231],v[96:99],v[156:159]
T a[224:225],v9 offset:24832
L v104,s[12:15],s31 offen offset:1024 lds
M v[152:155],a[228:231],v[92:95],v[152:155]
T a[226:227],v9 offset:30976
M v[148:151],a[228:231],v[88:91],v[148:151]
M v[160:163],a[232:235],v[88:91],v[160:163]
T a[228:229],v10 offset:24832
L v105,s[12:15],s31 offen offset:2048 lds
M v[164:167],a[232:235],v[92:95],v[164:167]
T a[230:231],v10 offset:30976
M v[168:171],a[232:235],v[96:99],v[168:171]
s_add_u32 m0,m0,0xc00
M v[180:183],a[236:239],v[96:99],v[180:183]
T a[232:233],v11 offset:24832
M v[176:179],a[236:239],v[92:95],v[176:179]
T a[234:235],v11 offset:30976
M v[172:175],a[236:239],v[88:91],v[172:175]
s_waitcnt lgkmcnt(4)
M v[184:187],a[216:219],v[88:91],v[184:187]
T a[236:237],v12 offset:24832
s_add_u32 s31,s31,0x60000
M v[188:191],a[216:219],v[92:95],v[188:191]
T a[238:239],v12 offset:30976
M v[192:195],a[216:219],v[96:99],v[192:195]
M v[204:207],a[220:223],v[96:99],v[204:207]
L v103,s[12:15],s35 offen lds
M v[200:203],a[220:223],v[92:95],v[200:203]
M v[196:199],a[220:223],v[88:91],v[196:199]
L v104,s[12:15],s35 offen offset:1024 lds
M v[208:211],a[224:227],v[88:91],v[208:211]
v_xor_b32 v17,0x38000,v17
M v[212:215],a[224:227],v[92:95],v[212:215]
v_xor_b32 v18,0x38000,v18
M v[216:219],a[224:227],v[96:99],v[216:219]
s_waitcnt vmcnt(14) lgkmcnt(0)
s_barrier
M v[228:231],a[228:231],v[96:99],v[228:231]
T a[216:217],v5
T a[218:219],v5 offset:6144
M v[224:227],a[228:231],v[92:95],v[224:227]
ds_read_b128 v[76:79],v17
T a[220:221],v6
M v[220:223],a[228:231],v[88:91],v[220:223]
T a[222:223],v6 offset:6144
ds_read_b128 v[80:83],v17 offset:2048
M v[232:235],a[232:235],v[88:91],v[232:235]
ds_read_b128 v[84:87],v17 offset:4096
T a[224:225],v7
M v[236:239],a[232:235],v[92:95],v[236:239]
T a[226:227],v7 offset:6144
T a[228:229],v8
M v[240:243],a[232:235],v[96:99],v[240:243]
T a[230:231],v8 offset:6144
T a[232:233],v5 offset:128
M v[252:255],a[236:239],v[96:99],v[252:255]
T a[234:235],v5 offset:6272
L v105,s[12:15],s35 offen offset:2048 lds
M v[248:251],a[236:239],v[92:95],v[248:251]
M v[244:247],a[236:239],v[88:91],v[244:247]
s_waitcnt lgkmcnt(4)
M v[112:115],a[216:219],v[76:79],v[112:115]
T a[236:237],v6 offset:128
s_add_u32 m0,s28,0x12000
M v[116:119],a[216:219],v[80:83],v[116:119]
T a[238:239],v6 offset:6272
M v[120:123],a[216:219],v[84:87],v[120:123]
s_add_u32 s35,s31,0x30000
M v[132:135],a[220:223],v[84:87],v[132:135]
T a[216:217],v7 offset:128
L v103,s[12:15],s31 offen lds
M v[128:131],a[220:223],v[80:83],v[128:131]
T a[218:219],v7 offset:6272
M v[124:127],a[220:223],v[76:79],v[124:127]
L v104,s[12:15],s31 offen offset:1024 lds
M v[136:139],a[224:227],v[76:79],v[136:139]
T a[220:221],v8 offset:128
L v105,s[12:15],s31 offen offset:2048 lds
M v[140:143],a[224:227],v[80:83],v[140:143]
T a[222:223],v8 offset:6272
M v[144:147],a[224:227],v[84:87],v[144:147]
s_add_u32 m0,m0,0xc00
s_waitcnt lgkmcnt(4)
M v[156:159],a[228:231],v[84:87],v[156:159]
T a[224:225],v5 offset:256
M v[152:155],a[228:231],v[80:83],v[152:155]
T a[226:227],v5 offset:6400
s_add_u32 s31,s31,0x60000
M v[148:151],a[228:231],v[76:79],v[148:151]
L v103,s[12:15],s35 offen lds
M v[160:163],a[232:235],v[76:79],v[160:163]
T a[228:229],v6 offset:256
M v[164:167],a[232:235],v[80:83],v[164:167]
T a[230:231],v6 offset:6400
L v104,s[12:15],s35 offen offset:1024 lds
M v[168:171],a[232:235],v[84:87],v[168:171]
L v105,s[12:15],s35 offen offset:2048 lds
M v[180:183],a[236:239],v[84:87],v[180:183]
T a[232:233],v7 offset:256
M v[176:179],a[236:239],v[80:83],v[176:179]
T a[234:235],v7 offset:6400
M v[172:175],a[236:239],v[76:79],v[172:175]
s_waitcnt lgkmcnt(4)
M v[184:187],a[216:219],v[76:79],v[184:187]
T a[236:237],v8 offset:256
M v[188:191],a[216:219],v[80:83],v[188:191]
T a[238:239],v8 offset:6400
M v[192:195],a[216:219],v[84:87],v[192:195]
s_cmp_eq_u32 s31,s39
s_cselect_b32 s31,s38,s31
M v[204:207],a[220:223],v[84:87],v[204:207]
s_add_u32 m0,s34,0
s_nop 0
L v106,s[20:23],s33 offen lds
M v[200:203],a[220:223],v[80:83],v[200:203]
L v107,s[20:23],s33 offen offset:1024 lds
M v[196:199],a[220:223],v[76:79],v[196:199]
L v108,s[20:23],s33 offen offset:2048 lds
M v[208:211],a[224:227],v[76:79],v[208:211]
s_add_u32 s33,s33,0x80
M v[212:215],a[224:227],v[80:83],v[212:215]
M v[216:219],a[224:227],v[84:87],v[216:219]
s_waitcnt vmcnt(15) lgkmcnt(0)
s_barrier
M v[228:231],a[228:231],v[84:87],v[228:231]
T a[216:217],v5 offset:24576
T a[218:219],v5 offset:30720
M v[224:227],a[228:231],v[80:83],v[224:227]
ds_read_b128 v[88:91],v18
T a[220:221],v6 offset:24576
M v[220:223],a[228:231],v[76:79],v[220:223]
T a[222:223],v6 offset:30720
ds_read_b128 v[92:95],v18 offset:2048
M v[232:235],a[232:235],v[76:79],v[232:235]
ds_read_b128 v[96:99],v18 offset:4096
T a[224:225],v7 offset:24576
M v[236:239],a[232:235],v[80:83],v[236:239]
T a[226:227],v7 offset:30720
T a[228:229],v8 offset:24576
M v[240:243],a[232:235],v[84:87],v[240:243]
T a[230:231],v8 offset:30720
T a[232:233],v5 offset:24704
M v[252:255],a[236:239],v[84:87],v[252:255]
T a[234:235],v5 offset:30848
M v[248:251],a[236:239],v[80:83],v[248:251]
s_cmp_eq_u32 s33,s41
s_cselect_b32 s33,s40,s33
M v[244:247],a[236:239],v[76:79],v[244:247]
s_sub_u32 s36,s36,1
s_cmp_lg_u32 s36,0
s_cbranch_scc1 C1_loop1
s_waitcnt lgkmcnt(4)
M v[112:115],a[216:219],v[88:91],v[112:115]
T a[236:237],v6 offset:24704
s_add_u32 m0,s28,0
M v[116:119],a[216:219],v[92:95],v[116:119]
T a[238:239],v6 offset:30848
M v[120:123],a[216:219],v[96:99],v[120:123]
s_add_u32 s35,s31,0x30000
M v[132:135],a[220:223],v[96:99],v[132:135]
T a[216:217],v7 offset:24704
L v103,s[12:15],s31 offen lds
M v[128:131],a[220:223],v[92:95],v[128:131]
T a[218:219],v7 offset:30848
M v[124:127],a[220:223],v[88:91],v[124:127]
L v104,s[12:15],s31 offen offset:1024 lds
M v[136:139],a[224:227],v[88:91],v[136:139]
T a[220:221],v8 offset:24704
L v105,s[12:15],s31 offen offset:2048 lds
M v[140:143],a[224:227],v[92:95],v[140:143]
T a[222:223],v8 offset:30848
M v[144:147],a[224:227],v[96:99],v[144:147]
s_waitcnt lgkmcnt(4)
M v[156:159],a[228:231],v[96:99],v[156:159]
T a[224:225],v5 offset:24832
s_add_u32 m0,m0,0xc00
M v[152:155],a[228:231],v[92:95],v[152:155]
T a[226:227],v5 offset:30976
M v[148:151],a[228:231],v[88:91],v[148:151]
s_add_u32 s31,s31,0x60000
M v[160:163],a[232:235],v[88:91],v[160:163]
T a[228:229],v6 offset:24832
L v103,s[12:15],s35 offen lds
M v[164:167],a[232:235],v[92:95],v[164:167]
T a[230:231],v6 offset:30976
M v[168:171],a[232:235],v[96:99],v[168:171]
L v104,s[12:15],s35 offen offset:1024 lds
M v[180:183],a[236:239],v[96:99],v[180:183]
T a[232:233],v7 offset:24832
L v105,s[12:15],s35 offen offset:2048 lds
M v[176:179],a[236:239],v[92:95],v[176:179]
T a[234:235],v7 offset:30976
M v[172:175],a[236:239],v[88:91],v[172:175]
s_waitcnt lgkmcnt(4)
M v[184:187],a[216:219],v[88:91],v[184:187]
T a[236:237],v8 offset:24832
s_add_u32 m0,s34,0x3000
M v[188:191],a[216:219],v[92:95],v[188:191]
T a[238:239],v8 offset:30976
M v[192:195],a[216:219],v[96:99],v[192:195]
s_xor_b32 s34,s34,0x38000
M v[204:207],a[220:223],v[96:99],v[204:207]
L v106,s[20:23],s33 offen lds
M v[200:203],a[220:223],v[92:95],v[200:203]
L v107,s[20:23],s33 offen offset:1024 lds
M v[196:199],a[220:223],v[88:91],v[196:199]
L v108,s[20:23],s33 offen offset:2048 lds
M v[208:211],a[224:227],v[88:91],v[208:211]
s_add_u32 s33,s33,0x80
M v[212:215],a[224:227],v[92:95],v[212:215]
M v[216:219],a[224:227],v[96:99],v[216:219]
s_waitcnt vmcnt(18) lgkmcnt(0)
s_barrier
M v[228:231],a[228:231],v[96:99],v[228:231]
T a[216:217],v9
T a[218:219],v9 offset:6144
M v[224:227],a[228:231],v[92:95],v[224:227]
ds_read_b128 v[76:79],v17 offset:12288
T a[220:221],v10
M v[220:223],a[228:231],v[88:91],v[220:223]
T a[222:223],v10 offset:6144
ds_read_b128 v[80:83],v17 offset:14336
M v[232:235],a[232:235],v[88:91],v[232:235]
ds_read_b128 v[84:87],v17 offset:16384
T a[224:225],v11
M v[236:239],a[232:235],v[92:95],v[236:239]
T a[226:227],v11 offset:6144
T a[228:229],v12
M v[240:243],a[232:235],v[96:99],v[240:243]
T a[230:231],v12 offset:6144
T a[232:233],v9 offset:128
M v[252:255],a[236:239],v[96:99],v[252:255]
T a[234:235],v9 offset:6272
M v[248:251],a[236:239],v[92:95],v[248:251]
s_cmp_eq_u32 s33,s41
s_cselect_b32 s33,s40,s33
M v[244:247],a[236:239],v[88:91],v[244:247]
s_waitcnt lgkmcnt(4)
M v[112:115],a[216:219],v[76:79],v[112:115]
T a[236:237],v10 offset:128
s_add_u32 m0,s28,0x6000
M v[116:119],a[216:219],v[80:83],v[116:119]
T a[238:239],v10 offset:6272
M v[120:123],a[216:219],v[84:87],v[120:123]
s_add_u32 s35,s31,0x30000
M v[132:135],a[220:223],v[84:87],v[132:135]
T a[216:217],v11 offset:128
M v[128:131],a[220:223],v[80:83],v[128:131]
T a[218:219],v11 offset:6272
M v[124:127],a[220:223],v[76:79],v[124:127]
L v103,s[12:15],s31 offen lds
M v[136:139],a[224:227],v[76:79],v[136:139]
T a[220:221],v12 offset:128
M v[140:143],a[224:227],v[80:83],v[140:143]
T a[222:223],v12 offset:6272
L v104,s[12:15],s31 offen offset:1024 lds
M v[144:147],a[224:227],v[84:87],v[144:147]
s_waitcnt lgkmcnt(4)
M v[156:159],a[228:231],v[84:87],v[156:159]
T a[224:225],v9 offset:256
M v[152:155],a[228:231],v[80:83],v[152:155]
T a[226:227],v9 offset:6400
M v[148:151],a[228:231],v[76:79],v[148:151]
L v105,s[12:15],s31 offen offset:2048 lds
M v[160:163],a[232:235],v[76:79],v[160:163]
T a[228:229],v10 offset:256
M v[164:167],a[232:235],v[80:83],v[164:167]
T a[230:231],v10 offset:6400
s_add_u32 m0,m0,0xc00
M v[168:171],a[232:235],v[84:87],v[168:171]
M v[180:183],a[236:239],v[84:87],v[180:183]
T a[232:233],v11 offset:256
s_add_u32 s31,s31,0x60000
M v[176:179],a[236:239],v[80:83],v[176:179]
T a[234:235],v11 offset:6400
M v[172:175],a[236:239],v[76:79],v[172:175]
s_waitcnt lgkmcnt(4)
M v[184:187],a[216:219],v[76:79],v[184:187]
T a[236:237],v12 offset:256
M v[188:191],a[216:219],v[80:83],v[188:191]
T a[238:239],v12 offset:6400
L v103,s[12:15],s35 offen lds
M v[192:195],a[216:219],v[84:87],v[192:195]
M v[204:207],a[220:223],v[84:87],v[204:207]
L v104,s[12:15],s35 offen offset:1024 lds
M v[200:203],a[220:223],v[80:83],v[200:203]
L v105,s[12:15],s35 offen offset:2048 lds
M v[196:199],a[220:223],v[76:79],v[196:199]
M v[208:211],a[224:227],v[76:79],v[208:211]
M v[212:215],a[224:227],v[80:83],v[212:215]
M v[216:219],a[224:227],v[84:87],v[216:219]
s_waitcnt vmcnt(18) lgkmcnt(0)
s_barrier
M v[228:231],a[228:231],v[84:87],v[228:231]
T a[216:217],v9 offset:24576
T a[218:219],v9 offset:30720
M v[224:227],a[228:231],v[80:83],v[224:227]
ds_read_b128 v[88:91],v18 offset:12288
T a[220:221],v10 offset:24576
M v[220:223],a[228:231],v[76:79],v[220:223]
T a[222:223],v10 offset:30720
ds_read_b128 v[92:95],v18 offset:14336
M v[232:235],a[232:235],v[76:79],v[232:235]
ds_read_b128 v[96:99],v18 offset:16384
T a[224:225],v11 offset:24576
M v[236:239],a[232:235],v[80:83],v[236:239]
T a[226:227],v11 offset:30720
T a[228:229],v12 offset:24576
M v[240:243],a[232:235],v[84:87],v[240:243]
T a[230:231],v12 offset:30720
T a[232:233],v9 offset:24704
M v[252:255],a[236:239],v[84:87],v[252:255]
T a[234:235],v9 offset:30848
M v[248:251],a[236:239],v[80:83],v[248:251]
s_cmp_eq_u32 s31,s39
s_cselect_b32 s31,s38,s31
M v[244:247],a[236:239],v[76:79],v[244:247]
s_waitcnt lgkmcnt(4)
M v[112:115],a[216:219],v[88:91],v[112:115]
T a[236:237],v10 offset:24704
s_add_u32 m0,s28,0xc000
M v[116:119],a[216:219],v[92:95],v[116:119]
T a[238:239],v10 offset:30848
M v[120:123],a[216:219],v[96:99],v[120:123]
s_add_u32 s35,s31,0x30000
M v[132:135],a[220:223],v[96:99],v[132:135]
T a[216:217],v11 offset:24704
M v[128:131],a[220:223],v[92:95],v[128:131]
T a[218:219],v11 offset:30848
M v[124:127],a[220:223],v[88:91],v[124:127]
L v103,s[12:15],s31 offen lds
M v[136:139],a[224:227],v[88:91],v[136:139]
T a[220:221],v12 offset:24704
M v[140:143],a[224:227],v[92:95],v[140:143]
T a[222:223],v12 offset:30848
M v[144:147],a[224:227],v[96:99],v[144:147]
s_waitcnt lgkmcnt(4)
M v[156:159],a[228:231],v[96:99],v[156:159]
T a[224:225],v9 offset:24832
L v104,s[12:15],s31 offen offset:1024 lds
M v[152:155],a[228:231],v[92:95],v[152:155]
T a[226:227],v9 offset:30976
M v[148:151],a[228:231],v[88:91],v[148:151]
M v[160:163],a[232:235],v[88:91],v[160:163]
T a[228:229],v10 offset:24832
L v105,s[12:15],s31 offen offset:2048 lds
M v[164:167],a[232:235],v[92:95],v[164:167]
T a[230:231],v10 offset:30976
M v[168:171],a[232:235],v[96:99],v[168:171]
s_add_u32 m0,m0,0xc00
M v[180:183],a[236:239],v[96:99],v[180:183]
T a[232:233],v11 offset:24832
M v[176:179],a[236:239],v[92:95],v[176:179]
T a[234:235],v11 offset:30976
M v[172:175],a[236:239],v[88:91],v[172:175]
s_waitcnt lgkmcnt(4)
M v[184:187],a[216:219],v[88:91],v[184:187]
T a[236:237],v12 offset:24832
s_add_u32 s31,s31,0x60000
M v[188:191],a[216:219],v[92:95],v[188:191]
T a[238:239],v12 offset:30976
M v[192:195],a[216:219],v[96:99],v[192:195]
M v[204:207],a[220:223],v[96:99],v[204:207]
L v103,s[12:15],s35 offen lds
M v[200:203],a[220:223],v[92:95],v[200:203]
M v[196:199],a[220:223],v[88:91],v[196:199]
L v104,s[12:15],s35 offen offset:1024 lds
M v[208:211],a[224:227],v[88:91],v[208:211]
v_xor_b32 v17,0x38000,v17
M v[212:215],a[224:227],v[92:95],v[212:215]
v_xor_b32 v18,0x38000,v18
M v[216:219],a[224:227],v[96:99],v[216:219]
s_waitcnt vmcnt(14) lgkmcnt(0)
s_barrier
M v[228:231],a[228:231],v[96:99],v[228:231]
T a[216:217],v5
T a[218:219],v5 offset:6144
M v[224:227],a[228:231],v[92:95],v[224:227]
ds_read_b128 v[76:79],v17
T a[220:221],v6
M v[220:223],a[228:231],v[88:91],v[220:223]
T a[222:223],v6 offset:6144
ds_read_b128 v[80:83],v17 offset:2048
M v[232:235],a[232:235],v[88:91],v[232:235]
ds_read_b128 v[84:87],v17 offset:4096
T a[224:225],v7
M v[236:239],a[232:235],v[92:95],v[236:239]
T a[226:227],v7 offset:6144
T a[228:229],v8
M v[240:243],a[232:235],v[96:99],v[240:243]
T a[230:231],v8 offset:6144
T a[232:233],v5 offset:128
M v[252:255],a[236:239],v[96:99],v[252:255]
T a[234:235],v5 offset:6272
L v105,s[12:15],s35 offen offset:2048 lds
M v[248:251],a[236:239],v[92:95],v[248:251]
M v[244:247],a[236:239],v[88:91],v[244:247]
s_waitcnt lgkmcnt(4)
M v[112:115],a[216:219],v[76:79],v[112:115]
T a[236:237],v6 offset:128
s_add_u32 m0,s28,0x12000
M v[116:119],a[216:219],v[80:83],v[116:119]
T a[238:239],v6 offset:6272
s_add_u32 s35,s31,0x30000
M v[120:123],a[216:219],v[84:87],v[120:123]
L v103,s[12:15],s31 offen lds
M v[132:135],a[220:223],v[84:87],v[132:135]
T a[216:217],v7 offset:128
M v[128:131],a[220:223],v[80:83],v[128:131]
T a[218:219],v7 offset:6272
L v104,s[12:15],s31 offen offset:1024 lds
M v[124:127],a[220:223],v[76:79],v[124:127]
L v105,s[12:15],s31 offen offset:2048 lds
M v[136:139],a[224:227],v[76:79],v[136:139]
T a[220:221],v8 offset:128
M v[140:143],a[224:227],v[80:83],v[140:143]
T a[222:223],v8 offset:6272
s_add_u32 m0,m0,0xc00
M v[144:147],a[224:227],v[84:87],v[144:147]
s_add_u32 s31,s31,0x60000
s_waitcnt lgkmcnt(4)
M v[156:159],a[228:231],v[84:87],v[156:159]
T a[224:225],v5 offset:256
M v[152:155],a[228:231],v[80:83],v[152:155]
T a[226:227],v5 offset:6400
L v103,s[12:15],s35 offen lds
M v[148:151],a[228:231],v[76:79],v[148:151]
L v104,s[12:15],s35 offen offset:1024 lds
M v[160:163],a[232:235],v[76:79],v[160:163]
T a[228:229],v6 offset:256
M v[164:167],a[232:235],v[80:83],v[164:167]
T a[230:231],v6 offset:6400
L v105,s[12:15],s35 offen offset:2048 lds
M v[168:171],a[232:235],v[84:87],v[168:171]
M v[180:183],a[236:239],v[84:87],v[180:183]
T a[232:233],v7 offset:256
M v[176:179],a[236:239],v[80:83],v[176:179]
T a[234:235],v7 offset:6400
M v[172:175],a[236:239],v[76:79],v[172:175]
s_waitcnt lgkmcnt(4)
M v[184:187],a[216:219],v[76:79],v[184:187]
T a[236:237],v8 offset:256
M v[188:191],a[216:219],v[80:83],v[188:191]
T a[238:239],v8 offset:6400
M v[192:195],a[216:219],v[84:87],v[192:195]
s_cmp_eq_u32 s31,s39
s_cselect_b32 s31,s38,s31
M v[204:207],a[220:223],v[84:87],v[204:207]
s_add_u32 s31,s31,0x180
s_add_u32 s38,s38,0x180
M v[200:203],a[220:223],v[80:83],v[200:203]
s_add_u32 s39,s39,0x180
s_add_u32 m0,s34,0
M v[196:199],a[220:223],v[76:79],v[196:199]
L v106,s[20:23],s33 offen lds
L v107,s[20:23],s33 offen offset:1024 lds
M v[208:211],a[224:227],v[76:79],v[208:211]
L v108,s[20:23],s33 offen offset:2048 lds
M v[212:215],a[224:227],v[80:83],v[212:215]
s_add_u32 s33,s33,0x80
M v[216:219],a[224:227],v[84:87],v[216:219]
s_waitcnt vmcnt(15) lgkmcnt(0)
s_barrier
M v[228:231],a[228:231],v[84:87],v[228:231]
T a[216:217],v5 offset:24576
T a[218:219],v5 offset:30720
M v[224:227],a[228:231],v[80:83],v[224:227]
ds_read_b128 v[88:91],v18
T a[220:221],v6 offset:24576
M v[220:223],a[228:231],v[76:79],v[220:223]
T a[222:223],v6 offset:30720
ds_read_b128 v[92:95],v18 offset:2048
M v[232:235],a[232:235],v[76:79],v[232:235]
ds_read_b128 v[96:99],v18 offset:4096
T a[224:225],v7 offset:24576
M v[236:239],a[232:235],v[80:83],v[236:239]
T a[226:227],v7 offset:30720
T a[228:229],v8 offset:24576
M v[240:243],a[232:235],v[84:87],v[240:243]
T a[230:231],v8 offset:30720
T a[232:233],v5 offset:24704
M v[252:255],a[236:239],v[84:87],v[252:255]
T a[234:235],v5 offset:30848
M v[248:251],a[236:239],v[80:83],v[248:251]
s_cmp_eq_u32 s33,s41
s_cselect_b32 s33,s40,s33
M v[244:247],a[236:239],v[76:79],v[244:247]
s_waitcnt lgkmcnt(4)
M v[112:115],a[216:219],v[88:91],v[112:115]
T a[236:237],v6 offset:24704
s_add_u32 m0,s28,0
M v[116:119],a[216:219],v[92:95],v[116:119]
T a[238:239],v6 offset:30848
M v[120:123],a[216:219],v[96:99],v[120:123]
s_add_u32 s35,s31,0x30000
M v[132:135],a[220:223],v[96:99],v[132:135]
T a[216:217],v7 offset:24704
L v103,s[12:15],s31 offen lds
M v[128:131],a[220:223],v[92:95],v[128:131]
T a[218:219],v7 offset:30848
M v[124:127],a[220:223],v[88:91],v[124:127]
L v104,s[12:15],s31 offen offset:1024 lds
M v[136:139],a[224:227],v[88:91],v[136:139]
T a[220:221],v8 offset:24704
L v105,s[12:15],s31 offen offset:2048 lds
M v[140:143],a[224:227],v[92:95],v[140:143]
T a[222:223],v8 offset:30848
M v[144:147],a[224:227],v[96:99],v[144:147]
s_waitcnt lgkmcnt(4)
M v[156:159],a[228:231],v[96:99],v[156:159]
T a[224:225],v5 offset:24832
s_add_u32 m0,m0,0xc00
M v[152:155],a[228:231],v[92:95],v[152:155]
T a[226:227],v5 offset:30976
M v[148:151],a[228:231],v[88:91],v[148:151]
s_add_u32 s31,s31,0x60000
M v[160:163],a[232:235],v[88:91],v[160:163]
T a[228:229],v6 offset:24832
L v103,s[12:15],s35 offen lds
M v[164:167],a[232:235],v[92:95],v[164:167]
T a[230:231],v6 offset:30976
M v[168:171],a[232:235],v[96:99],v[168:171]
L v104,s[12:15],s35 offen offset:1024 lds
M v[180:183],a[236:239],v[96:99],v[180:183]
T a[232:233],v7 offset:24832
L v105,s[12:15],s35 offen offset:2048 lds
M v[176:179],a[236:239],v[92:95],v[176:179]
T a[234:235],v7 offset:30976
M v[172:175],a[236:239],v[88:91],v[172:175]
s_waitcnt lgkmcnt(4)
M v[184:187],a[216:219],v[88:91],v[184:187]
T a[236:237],v8 offset:24832
s_add_u32 m0,s34,0x3000
M v[188:191],a[216:219],v[92:95],v[188:191]
T a[238:239],v8 offset:30976
M v[192:195],a[216:219],v[96:99],v[192:195]
s_xor_b32 s34,s34,0x38000
M v[204:207],a[220:223],v[96:99],v[204:207]
L v106,s[20:23],s33 offen lds
M v[200:203],a[220:223],v[92:95],v[200:203]
L v107,s[20:23],s33 offen offset:1024 lds
M v[196:199],a[220:223],v[88:91],v[196:199]
L v108,s[20:23],s33 offen offset:2048 lds
M v[208:211],a[224:227],v[88:91],v[208:211]
s_add_u32 s33,s33,0x80
M v[212:215],a[224:227],v[92:95],v[212:215]
M v[216:219],a[224:227],v[96:99],v[216:219]
s_waitcnt vmcnt(18) lgkmcnt(0)
s_barrier
M v[228:231],a[228:231],v[96:99],v[228:231]
T a[216:217],v9
T a[218:219],v9 offset:6144
M v[224:227],a[228:231],v[92:95],v[224:227]
ds_read_b128 v[76:79],v17 offset:12288
T a[220:221],v10
M v[220:223],a[228:231],v[88:91],v[220:223]
T a[222:223],v10 offset:6144
ds_read_b128 v[80:83],v17 offset:14336
M v[232:235],a[232:235],v[88:91],v[232:235]
ds_read_b128 v[84:87],v17 offset:16384
T a[224:225],v11
M v[236:239],a[232:235],v[92:95],v[236:239]
T a[226:227],v11 offset:6144
T a[228:229],v12
M v[240:243],a[232:235],v[96:99],v[240:243]
T a[230:231],v12 offset:6144
T a[232:233],v9 offset:128
M v[252:255],a[236:239],v[96:99],v[252:255]
T a[234:235],v9 offset:6272
M v[248:251],a[236:239],v[92:95],v[248:251]
s_cmp_eq_u32 s33,s41
s_cselect_b32 s33,s40,s33
M v[244:247],a[236:239],v[88:91],v[244:247]
s_waitcnt lgkmcnt(4)
M v[112:115],a[216:219],v[76:79],v[112:115]
T a[236:237],v10 offset:128
s_add_u32 m0,s28,0x6000
M v[116:119],a[216:219],v[80:83],v[116:119]
T a[238:239],v10 offset:6272
M v[120:123],a[216:219],v[84:87],v[120:123]
s_add_u32 s35,s31,0x30000
M v[132:135],a[220:223],v[84:87],v[132:135]
T a[216:217],v11 offset:128
M v[128:131],a[220:223],v[80:83],v[128:131]
T a[218:219],v11 offset:6272
M v[124:127],a[220:223],v[76:79],v[124:127]
L v103,s[12:15],s31 offen lds
M v[136:139],a[224:227],v[76:79],v[136:139]
T a[220:221],v12 offset:128
M v[140:143],a[224:227],v[80:83],v[140:143]
T a[222:223],v12 offset:6272
L v104,s[12:15],s31 offen offset:1024 lds
M v[144:147],a[224:227],v[84:87],v[144:147]
s_waitcnt lgkmcnt(4)
M v[156:159],a[228:231],v[84:87],v[156:159]
T a[224:225],v9 offset:256
M v[152:155],a[228:231],v[80:83],v[152:155]
T a[226:227],v9 offset:6400
M v[148:151],a[228:231],v[76:79],v[148:151]
L v105,s[12:15],s31 offen offset:2048 lds
M v[160:163],a[232:235],v[76:79],v[160:163]
T a[228:229],v10 offset:256
M v[164:167],a[232:235],v[80:83],v[164:167]
T a[230:231],v10 offset:6400
s_add_u32 m0,m0,0xc00
M v[168:171],a[232:235],v[84:87],v[168:171]
M v[180:183],a[236:239],v[84:87],v[180:183]
T a[232:233],v11 offset:256
s_add_u32 s31,s31,0x60000
M v[176:179],a[236:239],v[80:83],v[176:179]
T a[234:235],v11 offset:6400
M v[172:175],a[236:239],v[76:79],v[172:175]
s_waitcnt lgkmcnt(4)
M v[184:187],a[216:219],v[76:79],v[184:187]
T a[236:237],v12 offset:256
M v[188:191],a[216:219],v[80:83],v[188:191]
T a[238:239],v12 offset:6400
L v103,s[12:15],s35 offen lds
M v[192:195],a[216:219],v[84:87],v[192:195]
M v[204:207],a[220:223],v[84:87],v[204:207]
L v104,s[12:15],s35 offen offset:1024 lds
M v[200:203],a[220:223],v[80:83],v[200:203]
L v105,s[12:15],s35 offen offset:2048 lds
M v[196:199],a[220:223],v[76:79],v[196:199]
M v[208:211],a[224:227],v[76:79],v[208:211]
M v[212:215],a[224:227],v[80:83],v[212:215]
M v[216:219],a[224:227],v[84:87],v[216:219]
s_waitcnt vmcnt(18) lgkmcnt(0)
s_barrier
M v[228:231],a[228:231],v[84:87],v[228:231]
T a[216:217],v9 offset:24576
T a[218:219],v9 offset:30720
M v[224:227],a[228:231],v[80:83],v[224:227]
ds_read_b128 v[88:91],v18 offset:12288
T a[220:221],v10 offset:24576
M v[220:223],a[228:231],v[76:79],v[220:223]
T a[222:223],v10 offset:30720
ds_read_b128 v[92:95],v18 offset:14336
M v[232:235],a[232:235],v[76:79],v[232:235]
ds_read_b128 v[96:99],v18 offset:16384
T a[224:225],v11 offset:24576
M v[236:239],a[232:235],v[80:83],v[236:239]
T a[226:227],v11 offset:30720
T a[228:229],v12 offset:24576
M v[240:243],a[232:235],v[84:87],v[240:243]
T a[230:231],v12 offset:30720
T a[232:233],v9 offset:24704
M v[252:255],a[236:239],v[84:87],v[252:255]
T a[234:235],v9 offset:30848
M v[248:251],a[236:239],v[80:83],v[248:251]
s_cmp_eq_u32 s31,s39
s_cselect_b32 s31,s38,s31
M v[244:247],a[236:239],v[76:79],v[244:247]
s_waitcnt lgkmcnt(4)
M v[112:115],a[216:219],v[88:91],v[112:115]
T a[236:237],v10 offset:24704
s_add_u32 m0,s28,0xc000
M v[116:119],a[216:219],v[92:95],v[116:119]
T a[238:239],v10 offset:30848
M v[120:123],a[216:219],v[96:99],v[120:123]
s_add_u32 s35,s31,0x30000
M v[132:135],a[220:223],v[96:99],v[132:135]
T a[216:217],v11 offset:24704
M v[128:131],a[220:223],v[92:95],v[128:131]
T a[218:219],v11 offset:30848
M v[124:127],a[220:223],v[88:91],v[124:127]
L v103,s[12:15],s31 offen lds
M v[136:139],a[224:227],v[88:91],v[136:139]
T a[220:221],v12 offset:24704
M v[140:143],a[224:227],v[92:95],v[140:143]
T a[222:223],v12 offset:30848
M v[144:147],a[224:227],v[96:99],v[144:147]
s_waitcnt lgkmcnt(4)
M v[156:159],a[228:231],v[96:99],v[156:159]
T a[224:225],v9 offset:24832
L v104,s[12:15],s31 offen offset:1024 lds
C v52,v112,v113
C v53,v114,v115
C v54,v124,v125
M v[152:155],a[228:231],v[92:95],v[152:155]
T a[226:227],v9 offset:30976
C v55,v126,v127
C v56,v116,v117
C v57,v118,v119
C v58,v128,v129
M v[148:151],a[228:231],v[88:91],v[148:151]
C v59,v130,v131
C v60,v120,v121
C v61,v122,v123
C v62,v132,v133
C v63,v134,v135
M v[160:163],a[232:235],v[88:91],v[160:163]
T a[228:229],v10 offset:24832
L v105,s[12:15],s31 offen offset:2048 lds
v_permlane32_swap_b32 v52,v54
v_permlane32_swap_b32 v53,v55
v_permlane32_swap_b32 v56,v58
M v[164:167],a[232:235],v[92:95],v[164:167]
T a[230:231],v10 offset:30976
v_permlane32_swap_b32 v57,v59
v_permlane32_swap_b32 v60,v62
v_permlane32_swap_b32 v61,v63
v_permlane16_swap_b32 v52,v54
M v[168:171],a[232:235],v[96:99],v[168:171]
s_add_u32 m0,m0,0xc00
v_permlane16_swap_b32 v53,v55
v_permlane16_swap_b32 v56,v58
v_permlane16_swap_b32 v57,v59
v_permlane16_swap_b32 v60,v62
M v[180:183],a[236:239],v[96:99],v[180:183]
T a[232:233],v11 offset:24832
v_permlane16_swap_b32 v61,v63
AW a144,v52
AW a145,v53
AW a146,v54
M v[176:179],a[236:239],v[92:95],v[176:179]
T a[234:235],v11 offset:30976
AW a147,v55
AW a148,v56
AW a149,v57
AW a150,v58
M v[172:175],a[236:239],v[88:91],v[172:175]
AW a151,v59
AW a152,v60
AW a153,v61
AW a154,v62
s_waitcnt lgkmcnt(4)
M v[184:187],a[216:219],v[88:91],v[184:187]
T a[236:237],v12 offset:24832
s_add_u32 s31,s31,0x60000
AW a155,v63
M v[188:191],a[216:219],v[92:95],v[188:191]
T a[238:239],v12 offset:30976
M v[192:195],a[216:219],v[96:99],v[192:195]
C v64,v136,v137
C v65,v138,v139
C v66,v148,v149
C v67,v150,v151
M v[204:207],a[220:223],v[96:99],v[204:207]
L v103,s[12:15],s35 offen lds
C v68,v140,v141
C v69,v142,v143
C v70,v152,v153
M v[200:203],a[220:223],v[92:95],v[200:203]
C v71,v154,v155
C v72,v144,v145
C v73,v146,v147
C v74,v156,v157
M v[196:199],a[220:223],v[88:91],v[196:199]
L v104,s[12:15],s35 offen offset:1024 lds
C v75,v158,v159
v_permlane32_swap_b32 v64,v66
v_permlane32_swap_b32 v65,v67
M v[208:211],a[224:227],v[88:91],v[208:211]
v_xor_b32 v17,0x38000,v17
v_permlane32_swap_b32 v68,v70
v_permlane32_swap_b32 v69,v71
v_permlane32_swap_b32 v72,v74
M v[212:215],a[224:227],v[92:95],v[212:215]
v_xor_b32 v18,0x38000,v18
v_permlane32_swap_b32 v73,v75
v_permlane16_swap_b32 v64,v66
v_permlane16_swap_b32 v65,v67
M v[216:219],a[224:227],v[96:99],v[216:219]
s_waitcnt vmcnt(14) lgkmcnt(0)
s_barrier
v_permlane16_swap_b32 v68,v70
v_permlane16_swap_b32 v69,v71
M v[228:231],a[228:231],v[96:99],v[228:231]
T a[216:217],v5
T a[218:219],v5 offset:6144
v_permlane16_swap_b32 v72,v74
v_permlane16_swap_b32 v73,v75
M v[224:227],a[228:231],v[92:95],v[224:227]
ds_read_b128 v[76:79],v17
T a[220:221],v6
AW a156,v64
AW a157,v65
M v[220:223],a[228:231],v[88:91],v[220:223]
T a[222:223],v6 offset:6144
ds_read_b128 v[80:83],v17 offset:2048
AW a158,v66
AW a159,v67
M v[232:235],a[232:235],v[88:91],v[232:235]
ds_read_b128 v[84:87],v17 offset:4096
T a[224:225],v7
AW a160,v68
AW a161,v69
M v[236:239],a[232:235],v[92:95],v[236:239]
T a[226:227],v7 offset:6144
T a[228:229],v8
AW a162,v70
AW a163,v71
M v[240:243],a[232:235],v[96:99],v[240:243]
T a[230:231],v8 offset:6144
T a[232:233],v5 offset:128
AW a164,v72
AW a165,v73
M v[252:255],a[236:239],v[96:99],v[252:255]
T a[234:235],v5 offset:6272
L v105,s[12:15],s35 offen offset:2048 lds
AW a166,v74
AW a167,v75
M v[248:251],a[236:239],v[92:95],v[248:251]
M v[244:247],a[236:239],v[88:91],v[244:247]
C v52,v160,v161
C v53,v162,v163
C v54,v172,v173
C v55,v174,v175
C v56,v164,v165
C v57,v166,v167
C v58,v176,v177
C v59,v178,v179
C v60,v168,v169
C v61,v170,v171
C v62,v180,v181
C v63,v182,v183
v_permlane32_swap_b32 v52,v54
v_permlane32_swap_b32 v53,v55
v_permlane32_swap_b32 v56,v58
v_permlane32_swap_b32 v57,v59
v_permlane32_swap_b32 v60,v62
v_permlane32_swap_b32 v61,v63
v_permlane16_swap_b32 v52,v54
v_permlane16_swap_b32 v53,v55
v_permlane16_swap_b32 v56,v58
v_permlane16_swap_b32 v57,v59
v_permlane16_swap_b32 v60,v62
v_permlane16_swap_b32 v61,v63
AW a168,v52
AW a169,v53
AW a170,v54
AW a171,v55
AW a172,v56
AW a173,v57
AW a174,v58
AW a175,v59
AW a176,v60
AW a177,v61
AW a178,v62
AW a179,v63
C v64,v184,v185
C v65,v186,v187
C v66,v196,v197
C v67,v198,v199
C v68,v188,v189
C v69,v190,v191
C v70,v200,v201
C v71,v202,v203
C v72,v192,v193
C v73,v194,v195
C v74,v204,v205
C v75,v206,v207
v_permlane32_swap_b32 v64,v66
v_permlane32_swap_b32 v65,v67
v_permlane32_swap_b32 v68,v70
v_permlane32_swap_b32 v69,v71
v_permlane32_swap_b32 v72,v74
v_permlane32_swap_b32 v73,v75
v_permlane16_swap_b32 v64,v66
v_permlane16_swap_b32 v65,v67
v_permlane16_swap_b32 v68,v70
v_permlane16_swap_b32 v69,v71
v_permlane16_swap_b32 v72,v74
v_permlane16_swap_b32 v73,v75
AW a180,v64
AW a181,v65
AW a182,v66
AW a183,v67
AW a184,v68
AW a185,v69
AW a186,v70
AW a187,v71
AW a188,v72
AW a189,v73
AW a190,v74
AW a191,v75
C v52,v208,v209
C v53,v210,v211
C v54,v220,v221
C v55,v222,v223
C v56,v212,v213
C v57,v214,v215
C v58,v224,v225
C v59,v226,v227
C v60,v216,v217
C v61,v218,v219
C v62,v228,v229
C v63,v230,v231
v_permlane32_swap_b32 v52,v54
v_permlane32_swap_b32 v53,v55
v_permlane32_swap_b32 v56,v58
v_permlane32_swap_b32 v57,v59
v_permlane32_swap_b32 v60,v62
v_permlane32_swap_b32 v61,v63
v_permlane16_swap_b32 v52,v54
v_permlane16_swap_b32 v53,v55
v_permlane16_swap_b32 v56,v58
v_permlane16_swap_b32 v57,v59
v_permlane16_swap_b32 v60,v62
v_permlane16_swap_b32 v61,v63
AW a192,v52
AW a193,v53
AW a194,v54
AW a195,v55
AW a196,v56
AW a197,v57
AW a198,v58
AW a199,v59
AW a200,v60
AW a201,v61
AW a202,v62
AW a203,v63
C v64,v232,v233
C v65,v234,v235
C v66,v244,v245
C v67,v246,v247
C v68,v236,v237
C v69,v238,v239
C v70,v248,v249
C v71,v250,v251
C v72,v240,v241
C v73,v242,v243
C v74,v252,v253
C v75,v254,v255
v_permlane32_swap_b32 v64,v66
v_permlane32_swap_b32 v65,v67
v_permlane32_swap_b32 v68,v70
v_permlane32_swap_b32 v69,v71
v_permlane32_swap_b32 v72,v74
v_permlane32_swap_b32 v73,v75
v_permlane16_swap_b32 v64,v66
v_permlane16_swap_b32 v65,v67
v_permlane16_swap_b32 v68,v70
v_permlane16_swap_b32 v69,v71
v_permlane16_swap_b32 v72,v74
v_permlane16_swap_b32 v73,v75
AW a204,v64
AW a205,v65
AW a206,v66
AW a207,v67
AW a208,v68
AW a209,v69
AW a210,v70
AW a211,v71
AW a212,v72
AW a213,v73
AW a214,v74
AW a215,v75
s_waitcnt lgkmcnt(4)
M v[112:115],a[216:219],v[76:79],0
T a[236:237],v6 offset:128
s_add_u32 m0,s28,0x12000
M v[116:119],a[216:219],v[80:83],0
T a[238:239],v6 offset:6272
M v[120:123],a[216:219],v[84:87],0
s_add_u32 s35,s31,0x30000
M v[132:135],a[220:223],v[84:87],0
T a[216:217],v7 offset:128
L v103,s[12:15],s31 offen lds
M v[128:131],a[220:223],v[80:83],0
T a[218:219],v7 offset:6272
M v[124:127],a[220:223],v[76:79],0
L v104,s[12:15],s31 offen offset:1024 lds
M v[136:139],a[224:227],v[76:79],0
T a[220:221],v8 offset:128
L v105,s[12:15],s31 offen offset:2048 lds
M v[140:143],a[224:227],v[80:83],0
T a[222:223],v8 offset:6272
M v[144:147],a[224:227],v[84:87],0
s_add_u32 m0,m0,0xc00
s_waitcnt lgkmcnt(4)
M v[156:159],a[228:231],v[84:87],0
T a[224:225],v5 offset:256
M v[152:155],a[228:231],v[80:83],0
T a[226:227],v5 offset:6400
s_add_u32 s31,s31,0x60000
M v[148:151],a[228:231],v[76:79],0
L v103,s[12:15],s35 offen lds
M v[160:163],a[232:235],v[76:79],0
T a[228:229],v6 offset:256
M v[164:167],a[232:235],v[80:83],0
T a[230:231],v6 offset:6400
L v104,s[12:15],s35 offen offset:1024 lds
M v[168:171],a[232:235],v[84:87],0
L v105,s[12:15],s35 offen offset:2048 lds
M v[180:183],a[236:239],v[84:87],0
T a[232:233],v7 offset:256
M v[176:179],a[236:239],v[80:83],0
T a[234:235],v7 offset:6400
M v[172:175],a[236:239],v[76:79],0
s_waitcnt lgkmcnt(4)
M v[184:187],a[216:219],v[76:79],0
T a[236:237],v8 offset:256
M v[188:191],a[216:219],v[80:83],0
T a[238:239],v8 offset:6400
M v[192:195],a[216:219],v[84:87],0
s_cmp_eq_u32 s31,s39
s_cselect_b32 s31,s38,s31
M v[204:207],a[220:223],v[84:87],0
s_add_u32 m0,s34,0
s_nop 0
L v106,s[20:23],s33 offen lds
M v[200:203],a[220:223],v[80:83],0
L v107,s[20:23],s33 offen offset:1024 lds
M v[196:199],a[220:223],v[76:79],0
L v108,s[20:23],s33 offen offset:2048 lds
M v[208:211],a[224:227],v[76:79],0
s_add_u32 s33,s33,0x80
M v[212:215],a[224:227],v[80:83],0
M v[216:219],a[224:227],v[84:87],0
s_waitcnt vmcnt(15) lgkmcnt(0)
s_barrier
M v[228:231],a[228:231],v[84:87],0
T a[216:217],v5 offset:24576
T a[218:219],v5 offset:30720
M v[224:227],a[228:231],v[80:83],0
ds_read_b128 v[88:91],v18
T a[220:221],v6 offset:24576
M v[220:223],a[228:231],v[76:79],0
T a[222:223],v6 offset:30720
ds_read_b128 v[92:95],v18 offset:2048
M v[232:235],a[232:235],v[76:79],0
ds_read_b128 v[96:99],v18 offset:4096
T a[224:225],v7 offset:24576
M v[236:239],a[232:235],v[80:83],0
T a[226:227],v7 offset:30720
T a[228:229],v8 offset:24576
M v[240:243],a[232:235],v[84:87],0
T a[230:231],v8 offset:30720
T a[232:233],v5 offset:24704
M v[252:255],a[236:239],v[84:87],0
T a[234:235],v5 offset:30848
M v[248:251],a[236:239],v[80:83],0
s_cmp_eq_u32 s33,s41
s_cselect_b32 s33,s40,s33
M v[244:247],a[236:239],v[76:79],0
s_mov_b32 s36,3
.p2align 3
C1_loop2:
s_waitcnt lgkmcnt(4)
M v[112:115],a[216:219],v[88:91],v[112:115]
T a[236:237],v6 offset:24704
s_add_u32 m0,s28,0
M v[116:119],a[216:219],v[92:95],v[116:119]
T a[238:239],v6 offset:30848
M v[120:123],a[216:219],v[96:99],v[120:123]
s_add_u32 s35,s31,0x30000
M v[132:135],a[220:223],v[96:99],v[132:135]
T a[216:217],v7 offset:24704
L v103,s[12:15],s31 offen lds
M v[128:131],a[220:223],v[92:95],v[128:131]
T a[218:219],v7 offset:30848
M v[124:127],a[220:223],v[88:91],v[124:127]
L v104,s[12:15],s31 offen offset:1024 lds
M v[136:139],a[224:227],v[88:91],v[136:139]
T a[220:221],v8 offset:24704
L v105,s[12:15],s31 offen offset:2048 lds
M v[140:143],a[224:227],v[92:95],v[140:143]
T a[222:223],v8 offset:30848
M v[144:147],a[224:227],v[96:99],v[144:147]
s_waitcnt lgkmcnt(4)
M v[156:159],a[228:231],v[96:99],v[156:159]
T a[224:225],v5 offset:24832
s_add_u32 m0,m0,0xc00
M v[152:155],a[228:231],v[92:95],v[152:155]
T a[226:227],v5 offset:30976
M v[148:151],a[228:231],v[88:91],v[148:151]
s_add_u32 s31,s31,0x60000
M v[160:163],a[232:235],v[88:91],v[160:163]
T a[228:229],v6 offset:24832
L v103,s[12:15],s35 offen lds
M v[164:167],a[232:235],v[92:95],v[164:167]
T a[230:231],v6 offset:30976
M v[168:171],a[232:235],v[96:99],v[168:171]
L v104,s[12:15],s35 offen offset:1024 lds
M v[180:183],a[236:239],v[96:99],v[180:183]
T a[232:233],v7 offset:24832
L v105,s[12:15],s35 offen offset:2048 lds
M v[176:179],a[236:239],v[92:95],v[176:179]
T a[234:235],v7 offset:30976
M v[172:175],a[236:239],v[88:91],v[172:175]
s_waitcnt lgkmcnt(4)
M v[184:187],a[216:219],v[88:91],v[184:187]
T a[236:237],v8 offset:24832
s_add_u32 m0,s34,0x3000
M v[188:191],a[216:219],v[92:95],v[188:191]
T a[238:239],v8 offset:30976
M v[192:195],a[216:219],v[96:99],v[192:195]
s_xor_b32 s34,s34,0x38000
M v[204:207],a[220:223],v[96:99],v[204:207]
L v106,s[20:23],s33 offen lds
M v[200:203],a[220:223],v[92:95],v[200:203]
L v107,s[20:23],s33 offen offset:1024 lds
M v[196:199],a[220:223],v[88:91],v[196:199]
L v108,s[20:23],s33 offen offset:2048 lds
M v[208:211],a[224:227],v[88:91],v[208:211]
s_add_u32 s33,s33,0x80
M v[212:215],a[224:227],v[92:95],v[212:215]
M v[216:219],a[224:227],v[96:99],v[216:219]
s_waitcnt vmcnt(18) lgkmcnt(0)
s_barrier
M v[228:231],a[228:231],v[96:99],v[228:231]
T a[216:217],v9
T a[218:219],v9 offset:6144
M v[224:227],a[228:231],v[92:95],v[224:227]
ds_read_b128 v[76:79],v17 offset:12288
T a[220:221],v10
M v[220:223],a[228:231],v[88:91],v[220:223]
T a[222:223],v10 offset:6144
ds_read_b128 v[80:83],v17 offset:14336
M v[232:235],a[232:235],v[88:91],v[232:235]
ds_read_b128 v[84:87],v17 offset:16384
T a[224:225],v11
M v[236:239],a[232:235],v[92:95],v[236:239]
T a[226:227],v11 offset:6144
T a[228:229],v12
M v[240:243],a[232:235],v[96:99],v[240:243]
T a[230:231],v12 offset:6144
T a[232:233],v9 offset:128
M v[252:255],a[236:239],v[96:99],v[252:255]
T a[234:235],v9 offset:6272
M v[248:251],a[236:239],v[92:95],v[248:251]
s_cmp_eq_u32 s33,s41
s_cselect_b32 s33,s40,s33
M v[244:247],a[236:239],v[88:91],v[244:247]
s_waitcnt lgkmcnt(4)
M v[112:115],a[216:219],v[76:79],v[112:115]
T a[236:237],v10 offset:128
s_add_u32 m0,s28,0x6000
M v[116:119],a[216:219],v[80:83],v[116:119]
T a[238:239],v10 offset:6272
M v[120:123],a[216:219],v[84:87],v[120:123]
s_add_u32 s35,s31,0x30000
M v[132:135],a[220:223],v[84:87],v[132:135]
T a[216:217],v11 offset:128
M v[128:131],a[220:223],v[80:83],v[128:131]
T a[218:219],v11 offset:6272
M v[124:127],a[220:223],v[76:79],v[124:127]
L v103,s[12:15],s31 offen lds
M v[136:139],a[224:227],v[76:79],v[136:139]
T a[220:221],v12 offset:128
M v[140:143],a[224:227],v[80:83],v[140:143]
T a[222:223],v12 offset:6272
L v104,s[12:15],s31 offen offset:1024 lds
M v[144:147],a[224:227],v[84:87],v[144:147]
s_waitcnt lgkmcnt(4)
M v[156:159],a[228:231],v[84:87],v[156:159]
T a[224:225],v9 offset:256
M v[152:155],a[228:231],v[80:83],v[152:155]
T a[226:227],v9 offset:6400
M v[148:151],a[228:231],v[76:79],v[148:151]
L v105,s[12:15],s31 offen offset:2048 lds
M v[160:163],a[232:235],v[76:79],v[160:163]
T a[228:229],v10 offset:256
M v[164:167],a[232:235],v[80:83],v[164:167]
T a[230:231],v10 offset:6400
s_add_u32 m0,m0,0xc00
M v[168:171],a[232:235],v[84:87],v[168:171]
M v[180:183],a[236:239],v[84:87],v[180:183]
T a[232:233],v11 offset:256
s_add_u32 s31,s31,0x60000
M v[176:179],a[236:239],v[80:83],v[176:179]
T a[234:235],v11 offset:6400
M v[172:175],a[236:239],v[76:79],v[172:175]
s_waitcnt lgkmcnt(4)
M v[184:187],a[216:219],v[76:79],v[184:187]
T a[236:237],v12 offset:256
M v[188:191],a[216:219],v[80:83],v[188:191]
T a[238:239],v12 offset:6400
L v103,s[12:15],s35 offen lds
M v[192:195],a[216:219],v[84:87],v[192:195]
M v[204:207],a[220:223],v[84:87],v[204:207]
L v104,s[12:15],s35 offen offset:1024 lds
M v[200:203],a[220:223],v[80:83],v[200:203]
L v105,s[12:15],s35 offen offset:2048 lds
M v[196:199],a[220:223],v[76:79],v[196:199]
M v[208:211],a[224:227],v[76:79],v[208:211]
M v[212:215],a[224:227],v[80:83],v[212:215]
M v[216:219],a[224:227],v[84:87],v[216:219]
s_waitcnt vmcnt(18) lgkmcnt(0)
s_barrier
M v[228:231],a[228:231],v[84:87],v[228:231]
T a[216:217],v9 offset:24576
T a[218:219],v9 offset:30720
M v[224:227],a[228:231],v[80:83],v[224:227]
ds_read_b128 v[88:91],v18 offset:12288
T a[220:221],v10 offset:24576
M v[220:223],a[228:231],v[76:79],v[220:223]
T a[222:223],v10 offset:30720
ds_read_b128 v[92:95],v18 offset:14336
M v[232:235],a[232:235],v[76:79],v[232:235]
ds_read_b128 v[96:99],v18 offset:16384
T a[224:225],v11 offset:24576
M v[236:239],a[232:235],v[80:83],v[236:239]
T a[226:227],v11 offset:30720
T a[228:229],v12 offset:24576
M v[240:243],a[232:235],v[84:87],v[240:243]
T a[230:231],v12 offset:30720
T a[232:233],v9 offset:24704
M v[252:255],a[236:239],v[84:87],v[252:255]
T a[234:235],v9 offset:30848
M v[248:251],a[236:239],v[80:83],v[248:251]
s_cmp_eq_u32 s31,s39
s_cselect_b32 s31,s38,s31
M v[244:247],a[236:239],v[76:79],v[244:247]
s_waitcnt lgkmcnt(4)
M v[112:115],a[216:219],v[88:91],v[112:115]
T a[236:237],v10 offset:24704
s_add_u32 m0,s28,0xc000
M v[116:119],a[216:219],v[92:95],v[116:119]
T a[238:239],v10 offset:30848
M v[120:123],a[216:219],v[96:99],v[120:123]
s_add_u32 s35,s31,0x30000
M v[132:135],a[220:223],v[96:99],v[132:135]
T a[216:217],v11 offset:24704
M v[128:131],a[220:223],v[92:95],v[128:131]
T a[218:219],v11 offset:30848
M v[124:127],a[220:223],v[88:91],v[124:127]
L v103,s[12:15],s31 offen lds
M v[136:139],a[224:227],v[88:91],v[136:139]
T a[220:221],v12 offset:24704
M v[140:143],a[224:227],v[92:95],v[140:143]
T a[222:223],v12 offset:30848
M v[144:147],a[224:227],v[96:99],v[144:147]
s_waitcnt lgkmcnt(4)
M v[156:159],a[228:231],v[96:99],v[156:159]
T a[224:225],v9 offset:24832
L v104,s[12:15],s31 offen offset:1024 lds
M v[152:155],a[228:231],v[92:95],v[152:155]
T a[226:227],v9 offset:30976
M v[148:151],a[228:231],v[88:91],v[148:151]
M v[160:163],a[232:235],v[88:91],v[160:163]
T a[228:229],v10 offset:24832
L v105,s[12:15],s31 offen offset:2048 lds
M v[164:167],a[232:235],v[92:95],v[164:167]
T a[230:231],v10 offset:30976
M v[168:171],a[232:235],v[96:99],v[168:171]
s_add_u32 m0,m0,0xc00
M v[180:183],a[236:239],v[96:99],v[180:183]
T a[232:233],v11 offset:24832
M v[176:179],a[236:239],v[92:95],v[176:179]
T a[234:235],v11 offset:30976
M v[172:175],a[236:239],v[88:91],v[172:175]
s_waitcnt lgkmcnt(4)
M v[184:187],a[216:219],v[88:91],v[184:187]
T a[236:237],v12 offset:24832
s_add_u32 s31,s31,0x60000
M v[188:191],a[216:219],v[92:95],v[188:191]
T a[238:239],v12 offset:30976
M v[192:195],a[216:219],v[96:99],v[192:195]
M v[204:207],a[220:223],v[96:99],v[204:207]
L v103,s[12:15],s35 offen lds
M v[200:203],a[220:223],v[92:95],v[200:203]
M v[196:199],a[220:223],v[88:91],v[196:199]
L v104,s[12:15],s35 offen offset:1024 lds
M v[208:211],a[224:227],v[88:91],v[208:211]
v_xor_b32 v17,0x38000,v17
M v[212:215],a[224:227],v[92:95],v[212:215]
v_xor_b32 v18,0x38000,v18
M v[216:219],a[224:227],v[96:99],v[216:219]
s_waitcnt vmcnt(14) lgkmcnt(0)
s_barrier
M v[228:231],a[228:231],v[96:99],v[228:231]
T a[216:217],v5
T a[218:219],v5 offset:6144
M v[224:227],a[228:231],v[92:95],v[224:227]
ds_read_b128 v[76:79],v17
T a[220:221],v6
M v[220:223],a[228:231],v[88:91],v[220:223]
T a[222:223],v6 offset:6144
ds_read_b128 v[80:83],v17 offset:2048
M v[232:235],a[232:235],v[88:91],v[232:235]
ds_read_b128 v[84:87],v17 offset:4096
T a[224:225],v7
M v[236:239],a[232:235],v[92:95],v[236:239]
T a[226:227],v7 offset:6144
T a[228:229],v8
M v[240:243],a[232:235],v[96:99],v[240:243]
T a[230:231],v8 offset:6144
T a[232:233],v5 offset:128
M v[252:255],a[236:239],v[96:99],v[252:255]
T a[234:235],v5 offset:6272
L v105,s[12:15],s35 offen offset:2048 lds
M v[248:251],a[236:239],v[92:95],v[248:251]
M v[244:247],a[236:239],v[88:91],v[244:247]
s_waitcnt lgkmcnt(4)
M v[112:115],a[216:219],v[76:79],v[112:115]
T a[236:237],v6 offset:128
s_add_u32 m0,s28,0x12000
M v[116:119],a[216:219],v[80:83],v[116:119]
T a[238:239],v6 offset:6272
M v[120:123],a[216:219],v[84:87],v[120:123]
s_add_u32 s35,s31,0x30000
M v[132:135],a[220:223],v[84:87],v[132:135]
T a[216:217],v7 offset:128
L v103,s[12:15],s31 offen lds
M v[128:131],a[220:223],v[80:83],v[128:131]
T a[218:219],v7 offset:6272
M v[124:127],a[220:223],v[76:79],v[124:127]
L v104,s[12:15],s31 offen offset:1024 lds
M v[136:139],a[224:227],v[76:79],v[136:139]
T a[220:221],v8 offset:128
L v105,s[12:15],s31 offen offset:2048 lds
M v[140:143],a[224:227],v[80:83],v[140:143]
T a[222:223],v8 offset:6272
M v[144:147],a[224:227],v[84:87],v[144:147]
s_add_u32 m0,m0,0xc00
s_waitcnt lgkmcnt(4)
M v[156:159],a[228:231],v[84:87],v[156:159]
T a[224:225],v5 offset:256
M v[152:155],a[228:231],v[80:83],v[152:155]
T a[226:227],v5 offset:6400
s_add_u32 s31,s31,0x60000
M v[148:151],a[228:231],v[76:79],v[148:151]
L v103,s[12:15],s35 offen lds
M v[160:163],a[232:235],v[76:79],v[160:163]
T a[228:229],v6 offset:256
M v[164:167],a[232:235],v[80:83],v[164:167]
T a[230:231],v6 offset:6400
L v104,s[12:15],s35 offen offset:1024 lds
M v[168:171],a[232:235],v[84:87],v[168:171]
L v105,s[12:15],s35 offen offset:2048 lds
M v[180:183],a[236:239],v[84:87],v[180:183]
T a[232:233],v7 offset:256
M v[176:179],a[236:239],v[80:83],v[176:179]
T a[234:235],v7 offset:6400
M v[172:175],a[236:239],v[76:79],v[172:175]
s_waitcnt lgkmcnt(4)
M v[184:187],a[216:219],v[76:79],v[184:187]
T a[236:237],v8 offset:256
M v[188:191],a[216:219],v[80:83],v[188:191]
T a[238:239],v8 offset:6400
M v[192:195],a[216:219],v[84:87],v[192:195]
s_cmp_eq_u32 s31,s39
s_cselect_b32 s31,s38,s31
M v[204:207],a[220:223],v[84:87],v[204:207]
s_add_u32 m0,s34,0
s_nop 0
L v106,s[20:23],s33 offen lds
M v[200:203],a[220:223],v[80:83],v[200:203]
L v107,s[20:23],s33 offen offset:1024 lds
M v[196:199],a[220:223],v[76:79],v[196:199]
L v108,s[20:23],s33 offen offset:2048 lds
M v[208:211],a[224:227],v[76:79],v[208:211]
s_add_u32 s33,s33,0x80
M v[212:215],a[224:227],v[80:83],v[212:215]
M v[216:219],a[224:227],v[84:87],v[216:219]
s_waitcnt vmcnt(15) lgkmcnt(0)
s_barrier
M v[228:231],a[228:231],v[84:87],v[228:231]
T a[216:217],v5 offset:24576
T a[218:219],v5 offset:30720
M v[224:227],a[228:231],v[80:83],v[224:227]
ds_read_b128 v[88:91],v18
T a[220:221],v6 offset:24576
M v[220:223],a[228:231],v[76:79],v[220:223]
T a[222:223],v6 offset:30720
ds_read_b128 v[92:95],v18 offset:2048
M v[232:235],a[232:235],v[76:79],v[232:235]
ds_read_b128 v[96:99],v18 offset:4096
T a[224:225],v7 offset:24576
M v[236:239],a[232:235],v[80:83],v[236:239]
T a[226:227],v7 offset:30720
T a[228:229],v8 offset:24576
M v[240:243],a[232:235],v[84:87],v[240:243]
T a[230:231],v8 offset:30720
T a[232:233],v5 offset:24704
M v[252:255],a[236:239],v[84:87],v[252:255]
T a[234:235],v5 offset:30848
M v[248:251],a[236:239],v[80:83],v[248:251]
s_cmp_eq_u32 s33,s41
s_cselect_b32 s33,s40,s33
M v[244:247],a[236:239],v[76:79],v[244:247]
s_sub_u32 s36,s36,1
s_cmp_lg_u32 s36,0
s_cbranch_scc1 C1_loop2
s_waitcnt lgkmcnt(4)
M v[112:115],a[216:219],v[88:91],v[112:115]
T a[236:237],v6 offset:24704
s_add_u32 m0,s28,0
M v[116:119],a[216:219],v[92:95],v[116:119]
T a[238:239],v6 offset:30848
M v[120:123],a[216:219],v[96:99],v[120:123]
s_add_u32 s35,s31,0x30000
M v[132:135],a[220:223],v[96:99],v[132:135]
T a[216:217],v7 offset:24704
L v103,s[12:15],s31 offen lds
M v[128:131],a[220:223],v[92:95],v[128:131]
T a[218:219],v7 offset:30848
M v[124:127],a[220:223],v[88:91],v[124:127]
L v104,s[12:15],s31 offen offset:1024 lds
M v[136:139],a[224:227],v[88:91],v[136:139]
T a[220:221],v8 offset:24704
L v105,s[12:15],s31 offen offset:2048 lds
M v[140:143],a[224:227],v[92:95],v[140:143]
T a[222:223],v8 offset:30848
M v[144:147],a[224:227],v[96:99],v[144:147]
s_waitcnt lgkmcnt(4)
M v[156:159],a[228:231],v[96:99],v[156:159]
T a[224:225],v5 offset:24832
s_add_u32 m0,m0,0xc00
M v[152:155],a[228:231],v[92:95],v[152:155]
T a[226:227],v5 offset:30976
M v[148:151],a[228:231],v[88:91],v[148:151]
s_add_u32 s31,s31,0x60000
M v[160:163],a[232:235],v[88:91],v[160:163]
T a[228:229],v6 offset:24832
L v103,s[12:15],s35 offen lds
M v[164:167],a[232:235],v[92:95],v[164:167]
T a[230:231],v6 offset:30976
M v[168:171],a[232:235],v[96:99],v[168:171]
L v104,s[12:15],s35 offen offset:1024 lds
M v[180:183],a[236:239],v[96:99],v[180:183]
T a[232:233],v7 offset:24832
L v105,s[12:15],s35 offen offset:2048 lds
M v[176:179],a[236:239],v[92:95],v[176:179]
T a[234:235],v7 offset:30976
M v[172:175],a[236:239],v[88:91],v[172:175]
s_waitcnt lgkmcnt(4)
M v[184:187],a[216:219],v[88:91],v[184:187]
T a[236:237],v8 offset:24832
s_add_u32 m0,s34,0x3000
M v[188:191],a[216:219],v[92:95],v[188:191]
T a[238:239],v8 offset:30976
M v[192:195],a[216:219],v[96:99],v[192:195]
s_xor_b32 s34,s34,0x38000
M v[204:207],a[220:223],v[96:99],v[204:207]
L v106,s[20:23],s33 offen lds
M v[200:203],a[220:223],v[92:95],v[200:203]
L v107,s[20:23],s33 offen offset:1024 lds
M v[196:199],a[220:223],v[88:91],v[196:199]
L v108,s[20:23],s33 offen offset:2048 lds
M v[208:211],a[224:227],v[88:91],v[208:211]
s_add_u32 s33,s33,0x80
M v[212:215],a[224:227],v[92:95],v[212:215]
M v[216:219],a[224:227],v[96:99],v[216:219]
s_waitcnt vmcnt(18) lgkmcnt(0)
s_barrier
M v[228:231],a[228:231],v[96:99],v[228:231]
T a[216:217],v9
T a[218:219],v9 offset:6144
M v[224:227],a[228:231],v[92:95],v[224:227]
ds_read_b128 v[76:79],v17 offset:12288
T a[220:221],v10
M v[220:223],a[228:231],v[88:91],v[220:223]
T a[222:223],v10 offset:6144
ds_read_b128 v[80:83],v17 offset:14336
M v[232:235],a[232:235],v[88:91],v[232:235]
ds_read_b128 v[84:87],v17 offset:16384
T a[224:225],v11
M v[236:239],a[232:235],v[92:95],v[236:239]
T a[226:227],v11 offset:6144
T a[228:229],v12
M v[240:243],a[232:235],v[96:99],v[240:243]
T a[230:231],v12 offset:6144
T a[232:233],v9 offset:128
M v[252:255],a[236:239],v[96:99],v[252:255]
T a[234:235],v9 offset:6272
M v[248:251],a[236:239],v[92:95],v[248:251]
s_cmp_eq_u32 s33,s41
s_cselect_b32 s33,s40,s33
M v[244:247],a[236:239],v[88:91],v[244:247]
s_waitcnt lgkmcnt(4)
M v[112:115],a[216:219],v[76:79],v[112:115]
T a[236:237],v10 offset:128
s_add_u32 m0,s28,0x6000
M v[116:119],a[216:219],v[80:83],v[116:119]
T a[238:239],v10 offset:6272
M v[120:123],a[216:219],v[84:87],v[120:123]
s_add_u32 s35,s31,0x30000
M v[132:135],a[220:223],v[84:87],v[132:135]
T a[216:217],v11 offset:128
M v[128:131],a[220:223],v[80:83],v[128:131]
T a[218:219],v11 offset:6272
M v[124:127],a[220:223],v[76:79],v[124:127]
L v103,s[12:15],s31 offen lds
M v[136:139],a[224:227],v[76:79],v[136:139]
T a[220:221],v12 offset:128
M v[140:143],a[224:227],v[80:83],v[140:143]
T a[222:223],v12 offset:6272
L v104,s[12:15],s31 offen offset:1024 lds
M v[144:147],a[224:227],v[84:87],v[144:147]
s_waitcnt lgkmcnt(4)
M v[156:159],a[228:231],v[84:87],v[156:159]
T a[224:225],v9 offset:256
M v[152:155],a[228:231],v[80:83],v[152:155]
T a[226:227],v9 offset:6400
M v[148:151],a[228:231],v[76:79],v[148:151]
L v105,s[12:15],s31 offen offset:2048 lds
M v[160:163],a[232:235],v[76:79],v[160:163]
T a[228:229],v10 offset:256
M v[164:167],a[232:235],v[80:83],v[164:167]
T a[230:231],v10 offset:6400
s_add_u32 m0,m0,0xc00
M v[168:171],a[232:235],v[84:87],v[168:171]
M v[180:183],a[236:239],v[84:87],v[180:183]
T a[232:233],v11 offset:256
s_add_u32 s31,s31,0x60000
M v[176:179],a[236:239],v[80:83],v[176:179]
T a[234:235],v11 offset:6400
M v[172:175],a[236:239],v[76:79],v[172:175]
s_waitcnt lgkmcnt(4)
M v[184:187],a[216:219],v[76:79],v[184:187]
T a[236:237],v12 offset:256
M v[188:191],a[216:219],v[80:83],v[188:191]
T a[238:239],v12 offset:6400
L v103,s[12:15],s35 offen lds
M v[192:195],a[216:219],v[84:87],v[192:195]
M v[204:207],a[220:223],v[84:87],v[204:207]
L v104,s[12:15],s35 offen offset:1024 lds
M v[200:203],a[220:223],v[80:83],v[200:203]
L v105,s[12:15],s35 offen offset:2048 lds
M v[196:199],a[220:223],v[76:79],v[196:199]
M v[208:211],a[224:227],v[76:79],v[208:211]
M v[212:215],a[224:227],v[80:83],v[212:215]
M v[216:219],a[224:227],v[84:87],v[216:219]
s_waitcnt vmcnt(18) lgkmcnt(0)
s_barrier
M v[228:231],a[228:231],v[84:87],v[228:231]
T a[216:217],v9 offset:24576
T a[218:219],v9 offset:30720
M v[224:227],a[228:231],v[80:83],v[224:227]
ds_read_b128 v[88:91],v18 offset:12288
T a[220:221],v10 offset:24576
M v[220:223],a[228:231],v[76:79],v[220:223]
T a[222:223],v10 offset:30720
ds_read_b128 v[92:95],v18 offset:14336
M v[232:235],a[232:235],v[76:79],v[232:235]
ds_read_b128 v[96:99],v18 offset:16384
T a[224:225],v11 offset:24576
M v[236:239],a[232:235],v[80:83],v[236:239]
T a[226:227],v11 offset:30720
T a[228:229],v12 offset:24576
M v[240:243],a[232:235],v[84:87],v[240:243]
T a[230:231],v12 offset:30720
T a[232:233],v9 offset:24704
M v[252:255],a[236:239],v[84:87],v[252:255]
T a[234:235],v9 offset:30848
M v[248:251],a[236:239],v[80:83],v[248:251]
s_cmp_eq_u32 s31,s39
s_cselect_b32 s31,s38,s31
M v[244:247],a[236:239],v[76:79],v[244:247]
s_waitcnt lgkmcnt(4)
M v[112:115],a[216:219],v[88:91],v[112:115]
T a[236:237],v10 offset:24704
s_add_u32 m0,s28,0xc000
M v[116:119],a[216:219],v[92:95],v[116:119]
T a[238:239],v10 offset:30848
M v[120:123],a[216:219],v[96:99],v[120:123]
s_add_u32 s35,s31,0x30000
M v[132:135],a[220:223],v[96:99],v[132:135]
T a[216:217],v11 offset:24704
M v[128:131],a[220:223],v[92:95],v[128:131]
T a[218:219],v11 offset:30848
M v[124:127],a[220:223],v[88:91],v[124:127]
L v103,s[12:15],s31 offen lds
M v[136:139],a[224:227],v[88:91],v[136:139]
T a[220:221],v12 offset:24704
M v[140:143],a[224:227],v[92:95],v[140:143]
T a[222:223],v12 offset:30848
M v[144:147],a[224:227],v[96:99],v[144:147]
s_waitcnt lgkmcnt(4)
M v[156:159],a[228:231],v[96:99],v[156:159]
T a[224:225],v9 offset:24832
L v104,s[12:15],s31 offen offset:1024 lds
M v[152:155],a[228:231],v[92:95],v[152:155]
T a[226:227],v9 offset:30976
M v[148:151],a[228:231],v[88:91],v[148:151]
M v[160:163],a[232:235],v[88:91],v[160:163]
T a[228:229],v10 offset:24832
L v105,s[12:15],s31 offen offset:2048 lds
M v[164:167],a[232:235],v[92:95],v[164:167]
T a[230:231],v10 offset:30976
M v[168:171],a[232:235],v[96:99],v[168:171]
s_add_u32 m0,m0,0xc00
M v[180:183],a[236:239],v[96:99],v[180:183]
T a[232:233],v11 offset:24832
M v[176:179],a[236:239],v[92:95],v[176:179]
T a[234:235],v11 offset:30976
M v[172:175],a[236:239],v[88:91],v[172:175]
s_waitcnt lgkmcnt(4)
M v[184:187],a[216:219],v[88:91],v[184:187]
T a[236:237],v12 offset:24832
s_add_u32 s31,s31,0x60000
M v[188:191],a[216:219],v[92:95],v[188:191]
T a[238:239],v12 offset:30976
M v[192:195],a[216:219],v[96:99],v[192:195]
M v[204:207],a[220:223],v[96:99],v[204:207]
L v103,s[12:15],s35 offen lds
M v[200:203],a[220:223],v[92:95],v[200:203]
M v[196:199],a[220:223],v[88:91],v[196:199]
L v104,s[12:15],s35 offen offset:1024 lds
M v[208:211],a[224:227],v[88:91],v[208:211]
v_xor_b32 v17,0x38000,v17
M v[212:215],a[224:227],v[92:95],v[212:215]
v_xor_b32 v18,0x38000,v18
M v[216:219],a[224:227],v[96:99],v[216:219]
s_waitcnt vmcnt(14) lgkmcnt(0)
s_barrier
M v[228:231],a[228:231],v[96:99],v[228:231]
T a[216:217],v5
T a[218:219],v5 offset:6144
M v[224:227],a[228:231],v[92:95],v[224:227]
ds_read_b128 v[76:79],v17
T a[220:221],v6
M v[220:223],a[228:231],v[88:91],v[220:223]
T a[222:223],v6 offset:6144
ds_read_b128 v[80:83],v17 offset:2048
M v[232:235],a[232:235],v[88:91],v[232:235]
ds_read_b128 v[84:87],v17 offset:4096
T a[224:225],v7
M v[236:239],a[232:235],v[92:95],v[236:239]
T a[226:227],v7 offset:6144
T a[228:229],v8
M v[240:243],a[232:235],v[96:99],v[240:243]
T a[230:231],v8 offset:6144
T a[232:233],v5 offset:128
M v[252:255],a[236:239],v[96:99],v[252:255]
T a[234:235],v5 offset:6272
L v105,s[12:15],s35 offen offset:2048 lds
M v[248:251],a[236:239],v[92:95],v[248:251]
M v[244:247],a[236:239],v[88:91],v[244:247]
s_waitcnt lgkmcnt(4)
M v[112:115],a[216:219],v[76:79],v[112:115]
T a[236:237],v6 offset:128
s_add_u32 m0,s28,0x12000
M v[116:119],a[216:219],v[80:83],v[116:119]
T a[238:239],v6 offset:6272
M v[120:123],a[216:219],v[84:87],v[120:123]
s_add_u32 s35,s31,0x30000
M v[132:135],a[220:223],v[84:87],v[132:135]
T a[216:217],v7 offset:128
M v[128:131],a[220:223],v[80:83],v[128:131]
T a[218:219],v7 offset:6272
L v103,s[12:15],s31 offen lds
M v[124:127],a[220:223],v[76:79],v[124:127]
L v104,s[12:15],s31 offen offset:1024 lds
M v[136:139],a[224:227],v[76:79],v[136:139]
T a[220:221],v8 offset:128
M v[140:143],a[224:227],v[80:83],v[140:143]
T a[222:223],v8 offset:6272
M v[144:147],a[224:227],v[84:87],v[144:147]
L v105,s[12:15],s31 offen offset:2048 lds
s_waitcnt lgkmcnt(4)
M v[156:159],a[228:231],v[84:87],v[156:159]
T a[224:225],v5 offset:256
M v[152:155],a[228:231],v[80:83],v[152:155]
T a[226:227],v5 offset:6400
M v[148:151],a[228:231],v[76:79],v[148:151]
s_add_u32 m0,m0,0xc00
M v[160:163],a[232:235],v[76:79],v[160:163]
T a[228:229],v6 offset:256
s_add_u32 s31,s31,0x60000
M v[164:167],a[232:235],v[80:83],v[164:167]
T a[230:231],v6 offset:6400
M v[168:171],a[232:235],v[84:87],v[168:171]
L v103,s[12:15],s35 offen lds
M v[180:183],a[236:239],v[84:87],v[180:183]
T a[232:233],v7 offset:256
M v[176:179],a[236:239],v[80:83],v[176:179]
T a[234:235],v7 offset:6400
M v[172:175],a[236:239],v[76:79],v[172:175]
L v104,s[12:15],s35 offen offset:1024 lds
s_waitcnt lgkmcnt(4)
M v[184:187],a[216:219],v[76:79],v[184:187]
T a[236:237],v8 offset:256
M v[188:191],a[216:219],v[80:83],v[188:191]
T a[238:239],v8 offset:6400
L v105,s[12:15],s35 offen offset:2048 lds
M v[192:195],a[216:219],v[84:87],v[192:195]
M v[204:207],a[220:223],v[84:87],v[204:207]
M v[200:203],a[220:223],v[80:83],v[200:203]
s_cmp_eq_u32 s31,s39
s_cselect_b32 s31,s38,s31
M v[196:199],a[220:223],v[76:79],v[196:199]
s_add_u32 s31,s31,0x180
M v[208:211],a[224:227],v[76:79],v[208:211]
M v[212:215],a[224:227],v[80:83],v[212:215]
s_add_u32 s38,s38,0x180
M v[216:219],a[224:227],v[84:87],v[216:219]
s_waitcnt vmcnt(12) lgkmcnt(0)
s_barrier
M v[228:231],a[228:231],v[84:87],v[228:231]
T a[216:217],v5 offset:24576
T a[218:219],v5 offset:30720
M v[224:227],a[228:231],v[80:83],v[224:227]
ds_read_b128 v[88:91],v18
T a[220:221],v6 offset:24576
M v[220:223],a[228:231],v[76:79],v[220:223]
T a[222:223],v6 offset:30720
ds_read_b128 v[92:95],v18 offset:2048
M v[232:235],a[232:235],v[76:79],v[232:235]
ds_read_b128 v[96:99],v18 offset:4096
T a[224:225],v7 offset:24576
M v[236:239],a[232:235],v[80:83],v[236:239]
T a[226:227],v7 offset:30720
T a[228:229],v8 offset:24576
M v[240:243],a[232:235],v[84:87],v[240:243]
T a[230:231],v8 offset:30720
T a[232:233],v5 offset:24704
M v[252:255],a[236:239],v[84:87],v[252:255]
T a[234:235],v5 offset:30848
M v[248:251],a[236:239],v[80:83],v[248:251]
s_add_u32 s39,s39,0x180
M v[244:247],a[236:239],v[76:79],v[244:247]
s_waitcnt lgkmcnt(4)
M v[112:115],a[216:219],v[88:91],v[112:115]
T a[236:237],v6 offset:24704
s_add_u32 m0,s28,0
M v[116:119],a[216:219],v[92:95],v[116:119]
T a[238:239],v6 offset:30848
M v[120:123],a[216:219],v[96:99],v[120:123]
s_add_u32 s35,s29,0xc00
M v[132:135],a[220:223],v[96:99],v[132:135]
T a[216:217],v7 offset:24704
M v[128:131],a[220:223],v[92:95],v[128:131]
T a[218:219],v7 offset:30848
M v[124:127],a[220:223],v[88:91],v[124:127]
L v100,s[4:7],s29 offen nt lds
M v[136:139],a[224:227],v[88:91],v[136:139]
T a[220:221],v8 offset:24704
M v[140:143],a[224:227],v[92:95],v[140:143]
T a[222:223],v8 offset:30848
M v[144:147],a[224:227],v[96:99],v[144:147]
s_waitcnt lgkmcnt(4)
M v[156:159],a[228:231],v[96:99],v[156:159]
T a[224:225],v5 offset:24832
L v101,s[4:7],s29 offen offset:1024 nt lds
M v[152:155],a[228:231],v[92:95],v[152:155]
T a[226:227],v5 offset:30976
M v[148:151],a[228:231],v[88:91],v[148:151]
M v[160:163],a[232:235],v[88:91],v[160:163]
T a[228:229],v6 offset:24832
L v102,s[4:7],s29 offen offset:2048 nt lds
M v[164:167],a[232:235],v[92:95],v[164:167]
T a[230:231],v6 offset:30976
M v[168:171],a[232:235],v[96:99],v[168:171]
M v[180:183],a[236:239],v[96:99],v[180:183]
T a[232:233],v7 offset:24832
s_add_u32 m0,m0,0xc00
M v[176:179],a[236:239],v[92:95],v[176:179]
T a[234:235],v7 offset:30976
M v[172:175],a[236:239],v[88:91],v[172:175]
s_waitcnt lgkmcnt(4)
M v[184:187],a[216:219],v[88:91],v[184:187]
T a[236:237],v8 offset:24832
M v[188:191],a[216:219],v[92:95],v[188:191]
T a[238:239],v8 offset:30976
s_add_u32 s29,s29,0x3000
M v[192:195],a[216:219],v[96:99],v[192:195]
M v[204:207],a[220:223],v[96:99],v[204:207]
L v100,s[4:7],s35 offen nt lds
M v[200:203],a[220:223],v[92:95],v[200:203]
M v[196:199],a[220:223],v[88:91],v[196:199]
L v101,s[4:7],s35 offen offset:1024 nt lds
M v[208:211],a[224:227],v[88:91],v[208:211]
M v[212:215],a[224:227],v[92:95],v[212:215]
L v102,s[4:7],s35 offen offset:2048 nt lds
M v[216:219],a[224:227],v[96:99],v[216:219]
s_waitcnt vmcnt(12) lgkmcnt(0)
s_barrier
M v[228:231],a[228:231],v[96:99],v[228:231]
T a[216:217],v9
T a[218:219],v9 offset:6144
M v[224:227],a[228:231],v[92:95],v[224:227]
ds_read_b128 v[76:79],v17 offset:12288
T a[220:221],v10
M v[220:223],a[228:231],v[88:91],v[220:223]
T a[222:223],v10 offset:6144
ds_read_b128 v[80:83],v17 offset:14336
M v[232:235],a[232:235],v[88:91],v[232:235]
ds_read_b128 v[84:87],v17 offset:16384
T a[224:225],v11
M v[236:239],a[232:235],v[92:95],v[236:239]
T a[226:227],v11 offset:6144
T a[228:229],v12
M v[240:243],a[232:235],v[96:99],v[240:243]
T a[230:231],v12 offset:6144
T a[232:233],v9 offset:128
M v[252:255],a[236:239],v[96:99],v[252:255]
T a[234:235],v9 offset:6272
M v[248:251],a[236:239],v[92:95],v[248:251]
M v[244:247],a[236:239],v[88:91],v[244:247]
s_waitcnt lgkmcnt(4)
M v[112:115],a[216:219],v[76:79],v[112:115]
T a[236:237],v10 offset:128
s_add_u32 m0,s28,0x6000
M v[116:119],a[216:219],v[80:83],v[116:119]
T a[238:239],v10 offset:6272
M v[120:123],a[216:219],v[84:87],v[120:123]
s_add_u32 s35,s29,0xc00
M v[132:135],a[220:223],v[84:87],v[132:135]
T a[216:217],v11 offset:128
M v[128:131],a[220:223],v[80:83],v[128:131]
T a[218:219],v11 offset:6272
M v[124:127],a[220:223],v[76:79],v[124:127]
L v100,s[4:7],s29 offen nt lds
M v[136:139],a[224:227],v[76:79],v[136:139]
T a[220:221],v12 offset:128
M v[140:143],a[224:227],v[80:83],v[140:143]
T a[222:223],v12 offset:6272
M v[144:147],a[224:227],v[84:87],v[144:147]
s_waitcnt lgkmcnt(4)
M v[156:159],a[228:231],v[84:87],v[156:159]
T a[224:225],v9 offset:256
L v101,s[4:7],s29 offen offset:1024 nt lds
M v[152:155],a[228:231],v[80:83],v[152:155]
T a[226:227],v9 offset:6400
M v[148:151],a[228:231],v[76:79],v[148:151]
M v[160:163],a[232:235],v[76:79],v[160:163]
T a[228:229],v10 offset:256
L v102,s[4:7],s29 offen offset:2048 nt lds
M v[164:167],a[232:235],v[80:83],v[164:167]
T a[230:231],v10 offset:6400
M v[168:171],a[232:235],v[84:87],v[168:171]
M v[180:183],a[236:239],v[84:87],v[180:183]
T a[232:233],v11 offset:256
s_add_u32 m0,m0,0xc00
M v[176:179],a[236:239],v[80:83],v[176:179]
T a[234:235],v11 offset:6400
M v[172:175],a[236:239],v[76:79],v[172:175]
s_waitcnt lgkmcnt(4)
M v[184:187],a[216:219],v[76:79],v[184:187]
T a[236:237],v12 offset:256
M v[188:191],a[216:219],v[80:83],v[188:191]
T a[238:239],v12 offset:6400
s_add_u32 s29,s29,0x3000
M v[192:195],a[216:219],v[84:87],v[192:195]
M v[204:207],a[220:223],v[84:87],v[204:207]
L v100,s[4:7],s35 offen nt lds
M v[200:203],a[220:223],v[80:83],v[200:203]
M v[196:199],a[220:223],v[76:79],v[196:199]
L v101,s[4:7],s35 offen offset:1024 nt lds
M v[208:211],a[224:227],v[76:79],v[208:211]
M v[212:215],a[224:227],v[80:83],v[212:215]
L v102,s[4:7],s35 offen offset:2048 nt lds
M v[216:219],a[224:227],v[84:87],v[216:219]
s_waitcnt vmcnt(12) lgkmcnt(0)
s_barrier
M v[228:231],a[228:231],v[84:87],v[228:231]
T a[216:217],v9 offset:24576
T a[218:219],v9 offset:30720
M v[224:227],a[228:231],v[80:83],v[224:227]
ds_read_b128 v[88:91],v18 offset:12288
T a[220:221],v10 offset:24576
M v[220:223],a[228:231],v[76:79],v[220:223]
T a[222:223],v10 offset:30720
ds_read_b128 v[92:95],v18 offset:14336
M v[232:235],a[232:235],v[76:79],v[232:235]
ds_read_b128 v[96:99],v18 offset:16384
T a[224:225],v11 offset:24576
M v[236:239],a[232:235],v[80:83],v[236:239]
T a[226:227],v11 offset:30720
T a[228:229],v12 offset:24576
M v[240:243],a[232:235],v[84:87],v[240:243]
T a[230:231],v12 offset:30720
T a[232:233],v9 offset:24704
M v[252:255],a[236:239],v[84:87],v[252:255]
T a[234:235],v9 offset:30848
M v[248:251],a[236:239],v[80:83],v[248:251]
M v[244:247],a[236:239],v[76:79],v[244:247]
s_waitcnt lgkmcnt(4)
M v[112:115],a[216:219],v[88:91],v[112:115]
T a[236:237],v10 offset:24704
s_add_u32 m0,s28,0xc000
M v[116:119],a[216:219],v[92:95],v[116:119]
T a[238:239],v10 offset:30848
M v[120:123],a[216:219],v[96:99],v[120:123]
M v[132:135],a[220:223],v[96:99],v[132:135]
T a[216:217],v11 offset:24704
s_add_u32 s35,s30,0xc00
M v[128:131],a[220:223],v[92:95],v[128:131]
T a[218:219],v11 offset:30848
M v[124:127],a[220:223],v[88:91],v[124:127]
M v[136:139],a[224:227],v[88:91],v[136:139]
T a[220:221],v12 offset:24704
M v[140:143],a[224:227],v[92:95],v[140:143]
T a[222:223],v12 offset:30848
L v100,s[8:11],s30 offen nt lds
M v[144:147],a[224:227],v[96:99],v[144:147]
s_waitcnt lgkmcnt(4)
M v[156:159],a[228:231],v[96:99],v[156:159]
T a[224:225],v9 offset:24832
C v52,v112,v113
C v53,v114,v115
C v54,v124,v125
C v55,v126,v127
M v[152:155],a[228:231],v[92:95],v[152:155]
T a[226:227],v9 offset:30976
C v56,v116,v117
C v57,v118,v119
C v58,v128,v129
C v59,v130,v131
M v[148:151],a[228:231],v[88:91],v[148:151]
L v101,s[8:11],s30 offen offset:1024 nt lds
C v60,v120,v121
C v61,v122,v123
C v62,v132,v133
C v63,v134,v135
M v[160:163],a[232:235],v[88:91],v[160:163]
T a[228:229],v10 offset:24832
v_permlane32_swap_b32 v52,v54
v_permlane32_swap_b32 v53,v55
v_permlane32_swap_b32 v56,v58
v_permlane32_swap_b32 v57,v59
M v[164:167],a[232:235],v[92:95],v[164:167]
T a[230:231],v10 offset:30976
v_permlane32_swap_b32 v60,v62
v_permlane32_swap_b32 v61,v63
v_permlane16_swap_b32 v52,v54
v_permlane16_swap_b32 v53,v55
M v[168:171],a[232:235],v[96:99],v[168:171]
v_permlane16_swap_b32 v56,v58
v_permlane16_swap_b32 v57,v59
v_permlane16_swap_b32 v60,v62
v_permlane16_swap_b32 v61,v63
AW a0,v52
M v[180:183],a[236:239],v[96:99],v[180:183]
T a[232:233],v11 offset:24832
L v102,s[8:11],s30 offen offset:2048 nt lds
AW a1,v53
AW a2,v54
AW a3,v55
M v[176:179],a[236:239],v[92:95],v[176:179]
T a[234:235],v11 offset:30976
AW a4,v56
AW a5,v57
AW a6,v58
AW a7,v59
M v[172:175],a[236:239],v[88:91],v[172:175]
AW a8,v60
AW a9,v61
AW a10,v62
AW a11,v63
s_waitcnt lgkmcnt(4)
M v[184:187],a[216:219],v[88:91],v[184:187]
T a[236:237],v12 offset:24832
M v[188:191],a[216:219],v[92:95],v[188:191]
T a[238:239],v12 offset:30976
s_add_u32 m0,m0,0xc00
M v[192:195],a[216:219],v[96:99],v[192:195]
C v64,v136,v137
C v65,v138,v139
C v66,v148,v149
M v[204:207],a[220:223],v[96:99],v[204:207]
C v67,v150,v151
C v68,v140,v141
C v69,v142,v143
M v[200:203],a[220:223],v[92:95],v[200:203]
s_add_u32 s30,s30,0x3000
C v70,v152,v153
C v71,v154,v155
M v[196:199],a[220:223],v[88:91],v[196:199]
C v72,v144,v145
C v73,v146,v147
C v74,v156,v157
M v[208:211],a[224:227],v[88:91],v[208:211]
L v100,s[8:11],s35 offen nt lds
C v75,v158,v159
v_permlane32_swap_b32 v64,v66
M v[212:215],a[224:227],v[92:95],v[212:215]
v_permlane32_swap_b32 v65,v67
v_permlane32_swap_b32 v68,v70
v_permlane32_swap_b32 v69,v71
M v[216:219],a[224:227],v[96:99],v[216:219]
s_waitcnt vmcnt(10) lgkmcnt(0)
s_barrier
v_permlane32_swap_b32 v72,v74
M v[228:231],a[228:231],v[96:99],v[228:231]
ds_read_b128 a[216:219],v1
ds_read_b128 a[220:223],v2
v_permlane32_swap_b32 v73,v75
M v[224:227],a[228:231],v[92:95],v[224:227]
ds_read_b128 a[224:227],v1 offset:128
v_permlane16_swap_b32 v64,v66
v_permlane16_swap_b32 v65,v67
M v[220:223],a[228:231],v[88:91],v[220:223]
L v101,s[8:11],s35 offen offset:1024 nt lds
v_permlane16_swap_b32 v68,v70
v_permlane16_swap_b32 v69,v71
M v[232:235],a[232:235],v[88:91],v[232:235]
ds_read_b128 a[228:231],v2 offset:128
v_permlane16_swap_b32 v72,v74
v_permlane16_swap_b32 v73,v75
M v[236:239],a[232:235],v[92:95],v[236:239]
AW a12,v64
AW a13,v65
AW a14,v66
M v[240:243],a[232:235],v[96:99],v[240:243]
ds_read_b128 a[232:235],v1 offset:256
AW a15,v67
AW a16,v68
M v[252:255],a[236:239],v[96:99],v[252:255]
L v102,s[8:11],s35 offen offset:2048 nt lds
AW a17,v69
AW a18,v70
M v[248:251],a[236:239],v[92:95],v[248:251]
AW a19,v71
AW a20,v72
AW a21,v73
M v[244:247],a[236:239],v[88:91],v[244:247]
AW a22,v74
AW a23,v75
C v52,v160,v161
C v53,v162,v163
C v54,v172,v173
C v55,v174,v175
C v56,v164,v165
C v57,v166,v167
C v58,v176,v177
C v59,v178,v179
C v60,v168,v169
C v61,v170,v171
C v62,v180,v181
C v63,v182,v183
v_permlane32_swap_b32 v52,v54
v_permlane32_swap_b32 v53,v55
v_permlane32_swap_b32 v56,v58
v_permlane32_swap_b32 v57,v59
v_permlane32_swap_b32 v60,v62
v_permlane32_swap_b32 v61,v63
v_permlane16_swap_b32 v52,v54
v_permlane16_swap_b32 v53,v55
v_permlane16_swap_b32 v56,v58
v_permlane16_swap_b32 v57,v59
v_permlane16_swap_b32 v60,v62
v_permlane16_swap_b32 v61,v63
AW a24,v52
AW a25,v53
AW a26,v54
AW a27,v55
AW a28,v56
AW a29,v57
AW a30,v58
AW a31,v59
AW a32,v60
AW a33,v61
AW a34,v62
AW a35,v63
C v64,v184,v185
C v65,v186,v187
C v66,v196,v197
C v67,v198,v199
C v68,v188,v189
C v69,v190,v191
C v70,v200,v201
C v71,v202,v203
C v72,v192,v193
C v73,v194,v195
C v74,v204,v205
C v75,v206,v207
v_permlane32_swap_b32 v64,v66
v_permlane32_swap_b32 v65,v67
v_permlane32_swap_b32 v68,v70
v_permlane32_swap_b32 v69,v71
v_permlane32_swap_b32 v72,v74
v_permlane32_swap_b32 v73,v75
v_permlane16_swap_b32 v64,v66
v_permlane16_swap_b32 v65,v67
v_permlane16_swap_b32 v68,v70
v_permlane16_swap_b32 v69,v71
v_permlane16_swap_b32 v72,v74
v_permlane16_swap_b32 v73,v75
AW a36,v64
AW a37,v65
AW a38,v66
AW a39,v67
AW a40,v68
AW a41,v69
AW a42,v70
AW a43,v71
AW a44,v72
AW a45,v73
AW a46,v74
AW a47,v75
C v52,v208,v209
C v53,v210,v211
C v54,v220,v221
C v55,v222,v223
C v56,v212,v213
C v57,v214,v215
C v58,v224,v225
C v59,v226,v227
C v60,v216,v217
C v61,v218,v219
C v62,v228,v229
C v63,v230,v231
v_permlane32_swap_b32 v52,v54
v_permlane32_swap_b32 v53,v55
v_permlane32_swap_b32 v56,v58
v_permlane32_swap_b32 v57,v59
v_permlane32_swap_b32 v60,v62
v_permlane32_swap_b32 v61,v63
v_permlane16_swap_b32 v52,v54
v_permlane16_swap_b32 v53,v55
v_permlane16_swap_b32 v56,v58
v_permlane16_swap_b32 v57,v59
v_permlane16_swap_b32 v60,v62
v_permlane16_swap_b32 v61,v63
AW a48,v52
AW a49,v53
AW a50,v54
AW a51,v55
AW a52,v56
AW a53,v57
AW a54,v58
AW a55,v59
AW a56,v60
AW a57,v61
AW a58,v62
AW a59,v63
C v64,v232,v233
C v65,v234,v235
C v66,v244,v245
C v67,v246,v247
C v68,v236,v237
C v69,v238,v239
C v70,v248,v249
C v71,v250,v251
C v72,v240,v241
C v73,v242,v243
C v74,v252,v253
C v75,v254,v255
v_permlane32_swap_b32 v64,v66
v_permlane32_swap_b32 v65,v67
v_permlane32_swap_b32 v68,v70
v_permlane32_swap_b32 v69,v71
v_permlane32_swap_b32 v72,v74
v_permlane32_swap_b32 v73,v75
v_permlane16_swap_b32 v64,v66
v_permlane16_swap_b32 v65,v67
v_permlane16_swap_b32 v68,v70
v_permlane16_swap_b32 v69,v71
v_permlane16_swap_b32 v72,v74
v_permlane16_swap_b32 v73,v75
AW a60,v64
AW a61,v65
AW a62,v66
AW a63,v67
AW a64,v68
AW a65,v69
AW a66,v70
AW a67,v71
AW a68,v72
AW a69,v73
AW a70,v74
AW a71,v75
s_waitcnt lgkmcnt(2)
M v[52:55],a[216:219],a[144:147],0
ds_read_b128 a[236:239],v2 offset:256
s_add_u32 m0,s28,0x12000
M v[56:59],a[216:219],a[148:151],0
M v[60:63],a[216:219],a[152:155],0
M v[60:63],a[220:223],a[164:167],v[60:63]
ds_read_b128 a[216:219],v1 offset:6144
s_add_u32 s35,s29,0xc00
M v[56:59],a[220:223],a[160:163],v[56:59]
M v[52:55],a[220:223],a[156:159],v[52:55]
M v[52:55],a[224:227],a[168:171],v[52:55]
ds_read_b128 a[220:223],v2 offset:6144
L v100,s[4:7],s29 offen nt lds
M v[56:59],a[224:227],a[172:175],v[56:59]
M v[60:63],a[224:227],a[176:179],v[60:63]
s_waitcnt lgkmcnt(2)
M v[60:63],a[228:231],a[188:191],v[60:63]
ds_read_b128 a[224:227],v1 offset:6272
M v[56:59],a[228:231],a[184:187],v[56:59]
L v101,s[4:7],s29 offen offset:1024 nt lds
M v[52:55],a[228:231],a[180:183],v[52:55]
M v[52:55],a[232:235],a[192:195],v[52:55]
ds_read_b128 a[228:231],v2 offset:6272
M v[56:59],a[232:235],a[196:199],v[56:59]
L v102,s[4:7],s29 offen offset:2048 nt lds
M v[60:63],a[232:235],a[200:203],v[60:63]
M v[60:63],a[236:239],a[212:215],v[60:63]
ds_read_b128 a[232:235],v1 offset:6400
M v[56:59],a[236:239],a[208:211],v[56:59]
M v[52:55],a[236:239],a[204:207],v[52:55]
s_add_u32 m0,m0,0xc00
s_waitcnt lgkmcnt(2)
M v[64:67],a[216:219],a[144:147],0
ds_read_b128 a[236:239],v2 offset:6400
M v[68:71],a[216:219],a[148:151],0
M v[72:75],a[216:219],a[152:155],0
s_add_u32 s29,s29,0x3000
M v[72:75],a[220:223],a[164:167],v[72:75]
M v[68:71],a[220:223],a[160:163],v[68:71]
M v[64:67],a[220:223],a[156:159],v[64:67]
L v100,s[4:7],s35 offen nt lds
M v[64:67],a[224:227],a[168:171],v[64:67]
M v[68:71],a[224:227],a[172:175],v[68:71]
M v[72:75],a[224:227],a[176:179],v[72:75]
s_waitcnt vmcnt(10) lgkmcnt(0)
s_barrier
M v[72:75],a[228:231],a[188:191],v[72:75]
ds_read_b128 a[216:219],v1 offset:24576
ds_read_b128 a[220:223],v2 offset:24576
M v[68:71],a[228:231],a[184:187],v[68:71]
ds_read_b128 a[224:227],v1 offset:24704
L v101,s[4:7],s35 offen offset:1024 nt lds
M v[64:67],a[228:231],a[180:183],v[64:67]
M v[64:67],a[232:235],a[192:195],v[64:67]
ds_read_b128 a[228:231],v2 offset:24704
M v[68:71],a[232:235],a[196:199],v[68:71]
M v[72:75],a[232:235],a[200:203],v[72:75]
ds_read_b128 a[232:235],v1 offset:24832
L v102,s[4:7],s35 offen offset:2048 nt lds
M v[72:75],a[236:239],a[212:215],v[72:75]
M v[68:71],a[236:239],a[208:211],v[68:71]
M v[64:67],a[236:239],a[204:207],v[64:67]
v_max3_f32 v19,v52,v53,v54
v_max3_f32 v20,v56,v57,v58
v_max3_f32 v21,v60,v61,v62
s_nop 4
v_max3_f32 v19,v19,v55,v64
v_max3_f32 v20,v20,v59,v68
v_max3_f32 v21,v21,v63,v72
v_max3_f32 v19,v19,v65,v66
v_max3_f32 v20,v20,v69,v70
v_max3_f32 v21,v21,v73,v74
v_max_f32 v19,v19,v67
v_max_f32 v20,v20,v71
v_max_f32 v21,v21,v75
v_mov_b32 v25,v19
v_mov_b32 v26,v20
v_mov_b32 v27,v21
v_permlane32_swap_b32 v19,v25
v_permlane32_swap_b32 v20,v26
v_permlane32_swap_b32 v21,v27
v_max_f32 v19,v19,v25
v_max_f32 v20,v20,v26
v_max_f32 v21,v21,v27
v_mov_b32 v25,v19
v_mov_b32 v26,v20
v_mov_b32 v27,v21
v_permlane16_swap_b32 v19,v25
v_permlane16_swap_b32 v20,v26
v_permlane16_swap_b32 v21,v27
v_max_f32 v19,v19,v25
v_max_f32 v20,v20,v26
v_max_f32 v21,v21,v27
v_mul_f32 v19,s37,v19
v_mul_f32 v20,s37,v20
v_mul_f32 v21,s37,v21
v_mov_b32 v22,0
v_mov_b32 v23,0
v_mov_b32 v24,0
v_fma_f32 v52,v52,s37,-v19
v_fma_f32 v53,v53,s37,-v19
v_fma_f32 v54,v54,s37,-v19
v_fma_f32 v55,v55,s37,-v19
v_fma_f32 v56,v56,s37,-v20
v_fma_f32 v57,v57,s37,-v20
v_fma_f32 v58,v58,s37,-v20
v_fma_f32 v59,v59,s37,-v20
v_fma_f32 v60,v60,s37,-v21
v_fma_f32 v61,v61,s37,-v21
v_fma_f32 v62,v62,s37,-v21
v_fma_f32 v63,v63,s37,-v21
v_fma_f32 v64,v64,s37,-v19
v_fma_f32 v65,v65,s37,-v19
v_fma_f32 v66,v66,s37,-v19
v_fma_f32 v67,v67,s37,-v19
v_fma_f32 v68,v68,s37,-v20
v_fma_f32 v69,v69,s37,-v20
v_fma_f32 v70,v70,s37,-v20
v_fma_f32 v71,v71,s37,-v20
v_fma_f32 v72,v72,s37,-v21
v_fma_f32 v73,v73,s37,-v21
v_fma_f32 v74,v74,s37,-v21
v_fma_f32 v75,v75,s37,-v21
s_waitcnt lgkmcnt(2)
M v[76:79],a[216:219],a[144:147],0
ds_read_b128 a[236:239],v2 offset:24832
s_add_u32 m0,s28,0
v_exp_f32 v52,v52
M v[80:83],a[216:219],a[148:151],0
v_exp_f32 v56,v56
v_exp_f32 v60,v60
M v[84:87],a[216:219],a[152:155],0
s_add_u32 s35,s30,0xc00
v_exp_f32 v53,v53
M v[84:87],a[220:223],a[164:167],v[84:87]
ds_read_b128 a[216:219],v1 offset:30720
v_exp_f32 v57,v57
M v[80:83],a[220:223],a[160:163],v[80:83]
v_exp_f32 v61,v61
v_add_f32 v22,v22,v52
v_add_f32 v23,v23,v56
M v[76:79],a[220:223],a[156:159],v[76:79]
L v100,s[8:11],s30 offen nt lds
v_add_f32 v24,v24,v60
v_exp_f32 v54,v54
M v[76:79],a[224:227],a[168:171],v[76:79]
ds_read_b128 a[220:223],v2 offset:30720
v_exp_f32 v58,v58
M v[80:83],a[224:227],a[172:175],v[80:83]
v_exp_f32 v62,v62
v_add_f32 v22,v22,v53
v_add_f32 v23,v23,v57
M v[84:87],a[224:227],a[176:179],v[84:87]
v_add_f32 v24,v24,v61
C v40,v52,v53
C v44,v56,v57
s_waitcnt lgkmcnt(2)
M v[84:87],a[228:231],a[188:191],v[84:87]
ds_read_b128 a[224:227],v1 offset:30848
L v101,s[8:11],s30 offen offset:1024 nt lds
C v48,v60,v61
M v[80:83],a[228:231],a[184:187],v[80:83]
v_exp_f32 v55,v55
v_exp_f32 v59,v59
M v[76:79],a[228:231],a[180:183],v[76:79]
v_exp_f32 v63,v63
v_add_f32 v22,v22,v54
v_add_f32 v23,v23,v58
M v[76:79],a[232:235],a[192:195],v[76:79]
ds_read_b128 a[228:231],v2 offset:30848
L v102,s[8:11],s30 offen offset:2048 nt lds
v_add_f32 v24,v24,v62
M v[80:83],a[232:235],a[196:199],v[80:83]
v_exp_f32 v64,v64
v_exp_f32 v68,v68
M v[84:87],a[232:235],a[200:203],v[84:87]
v_exp_f32 v72,v72
v_add_f32 v22,v22,v55
v_add_f32 v23,v23,v59
M v[84:87],a[236:239],a[212:215],v[84:87]
ds_read_b128 a[232:235],v1 offset:30976
s_add_u32 m0,m0,0xc00
v_add_f32 v24,v24,v63
C v41,v54,v55
M v[80:83],a[236:239],a[208:211],v[80:83]
C v45,v58,v59
C v49,v62,v63
v_exp_f32 v65,v65
M v[76:79],a[236:239],a[204:207],v[76:79]
v_exp_f32 v69,v69
s_waitcnt lgkmcnt(2)
M v[88:91],a[216:219],a[144:147],0
ds_read_b128 a[236:239],v2 offset:30976
v_exp_f32 v73,v73
v_add_f32 v22,v22,v64
M v[92:95],a[216:219],a[148:151],0
s_add_u32 s30,s30,0x3000
v_add_f32 v23,v23,v68
v_add_f32 v24,v24,v72
M v[96:99],a[216:219],a[152:155],0
v_exp_f32 v66,v66
v_exp_f32 v70,v70
M v[96:99],a[220:223],a[164:167],v[96:99]
L v100,s[8:11],s35 offen nt lds
v_exp_f32 v74,v74
v_add_f32 v22,v22,v65
M v[92:95],a[220:223],a[160:163],v[92:95]
v_add_f32 v23,v23,v69
v_add_f32 v24,v24,v73
C v42,v64,v65
C v46,v68,v69
M v[88:91],a[220:223],a[156:159],v[88:91]
C v50,v72,v73
v_exp_f32 v67,v67
M v[88:91],a[224:227],a[168:171],v[88:91]
L v101,s[8:11],s35 offen offset:1024 nt lds
v_exp_f32 v71,v71
M v[92:95],a[224:227],a[172:175],v[92:95]
v_exp_f32 v75,v75
v_add_f32 v22,v22,v66
v_add_f32 v23,v23,v70
M v[96:99],a[224:227],a[176:179],v[96:99]
s_waitcnt vmcnt(11) lgkmcnt(0)
s_barrier
v_add_f32 v24,v24,v74
C v43,v66,v67
M v[96:99],a[228:231],a[188:191],v[96:99]
T a[216:217],v9
T a[218:219],v9 offset:6144
C v47,v70,v71
C v51,v74,v75
M v[92:95],a[228:231],a[184:187],v[92:95]
T a[220:221],v10
T a[222:223],v10 offset:6144
v_add_f32 v22,v22,v67
v_add_f32 v23,v23,v71
M v[88:91],a[228:231],a[180:183],v[88:91]
T a[224:225],v11
T a[226:227],v11 offset:6144
v_add_f32 v24,v24,v75
M v[88:91],a[232:235],a[192:195],v[88:91]
T a[228:229],v12
T a[230:231],v12 offset:6144
M v[92:95],a[232:235],a[196:199],v[92:95]
L v102,s[8:11],s35 offen offset:2048 nt lds
M v[96:99],a[232:235],a[200:203],v[96:99]
T a[232:233],v9 offset:128
T a[234:235],v9 offset:6272
M v[96:99],a[236:239],a[212:215],v[96:99]
M v[92:95],a[236:239],a[208:211],v[92:95]
M v[88:91],a[236:239],a[204:207],v[88:91]
s_waitcnt lgkmcnt(4)
M v[112:115],a[216:219],v[40:43],0
T a[236:237],v10 offset:128
s_add_u32 m0,s28,0x6000
M v[116:119],a[216:219],v[44:47],0
T a[238:239],v10 offset:6272
M v[120:123],a[216:219],v[48:51],0
M v[132:135],a[220:223],v[48:51],0
T a[216:217],v11 offset:128
s_add_u32 s35,s29,0xc00
v_fma_f32 v76,v76,s37,-v19
M v[128:131],a[220:223],v[44:47],0
T a[218:219],v11 offset:6272
v_fma_f32 v77,v77,s37,-v19
v_fma_f32 v78,v78,s37,-v19
M v[124:127],a[220:223],v[40:43],0
v_fma_f32 v79,v79,s37,-v19
v_fma_f32 v80,v80,s37,-v20
v_fma_f32 v81,v81,s37,-v20
M v[136:139],a[224:227],v[40:43],0
T a[220:221],v12 offset:128
v_max3_f32 v28,v76,v77,v78
v_fma_f32 v82,v82,s37,-v20
M v[140:143],a[224:227],v[44:47],0
T a[222:223],v12 offset:6272
L v100,s[4:7],s29 offen nt lds
v_fma_f32 v83,v83,s37,-v20
M v[144:147],a[224:227],v[48:51],0
v_max3_f32 v28,v28,v79,v80
v_fma_f32 v84,v84,s37,-v21
s_waitcnt lgkmcnt(4)
M v[156:159],a[228:231],v[48:51],0
T a[224:225],v9 offset:256
v_fma_f32 v85,v85,s37,-v21
v_max3_f32 v28,v28,v81,v82
M v[152:155],a[228:231],v[44:47],0
T a[226:227],v9 offset:6400
v_fma_f32 v86,v86,s37,-v21
v_fma_f32 v87,v87,s37,-v21
M v[148:151],a[228:231],v[40:43],0
L v101,s[4:7],s29 offen offset:1024 nt lds
v_max3_f32 v28,v28,v83,v84
v_max3_f32 v28,v28,v85,v86
M v[160:163],a[232:235],v[40:43],0
T a[228:229],v10 offset:256
v_max_f32 v28,v28,v87
v_fma_f32 v88,v88,s37,-v19
M v[164:167],a[232:235],v[44:47],0
T a[230:231],v10 offset:6400
v_fma_f32 v89,v89,s37,-v19
v_fma_f32 v90,v90,s37,-v19
M v[168:171],a[232:235],v[48:51],0
v_fma_f32 v91,v91,s37,-v19
v_fma_f32 v92,v92,s37,-v20
v_fma_f32 v93,v93,s37,-v20
M v[180:183],a[236:239],v[48:51],0
T a[232:233],v11 offset:256
L v102,s[4:7],s29 offen offset:2048 nt lds
v_max3_f32 v28,v28,v88,v89
M v[176:179],a[236:239],v[44:47],0
T a[234:235],v11 offset:6400
v_fma_f32 v94,v94,s37,-v20
v_fma_f32 v95,v95,s37,-v20
M v[172:175],a[236:239],v[40:43],0
v_max3_f32 v28,v28,v90,v91
v_fma_f32 v96,v96,s37,-v21
s_waitcnt lgkmcnt(4)
M v[184:187],a[216:219],v[40:43],0
T a[236:237],v12 offset:256
v_fma_f32 v97,v97,s37,-v21
v_max3_f32 v28,v28,v92,v93
M v[188:191],a[216:219],v[44:47],0
T a[238:239],v12 offset:6400
s_add_u32 m0,m0,0xc00
v_fma_f32 v98,v98,s37,-v21
M v[192:195],a[216:219],v[48:51],0
v_fma_f32 v99,v99,s37,-v21
v_max3_f32 v28,v28,v94,v95
v_max3_f32 v28,v28,v96,v97
M v[204:207],a[220:223],v[48:51],0
v_max3_f32 v28,v28,v98,v99
M v[200:203],a[220:223],v[44:47],0
s_add_u32 s29,s29,0x3000
M v[196:199],a[220:223],v[40:43],0
M v[208:211],a[224:227],v[40:43],0
L v100,s[4:7],s35 offen nt lds
M v[212:215],a[224:227],v[44:47],0
M v[216:219],a[224:227],v[48:51],0
s_waitcnt vmcnt(10) lgkmcnt(0)
s_barrier
M v[228:231],a[228:231],v[48:51],0
ds_read_b128 a[216:219],v3 offset:24576
ds_read_b128 a[220:223],v4 offset:24576
M v[224:227],a[228:231],v[44:47],0
ds_read_b128 a[224:227],v3 offset:24704
M v[220:223],a[228:231],v[40:43],0
L v101,s[4:7],s35 offen offset:1024 nt lds
M v[232:235],a[232:235],v[40:43],0
ds_read_b128 a[228:231],v4 offset:24704
M v[236:239],a[232:235],v[44:47],0
M v[240:243],a[232:235],v[48:51],0
ds_read_b128 a[232:235],v3 offset:24832
M v[252:255],a[236:239],v[48:51],0
L v102,s[4:7],s35 offen offset:2048 nt lds
M v[248:251],a[236:239],v[44:47],0
M v[244:247],a[236:239],v[40:43],0
s_mov_b32 s36,6
.p2align 3
C1_loop3:
v_cmp_lt_f32 vcc,0x41000000,v28
s_cbranch_vccnz C1_29_r
C1_29_b:
s_waitcnt lgkmcnt(2)
M v[52:55],a[216:219],a[144:147],0
ds_read_b128 a[236:239],v4 offset:24832
s_add_u32 m0,s28,0xc000
v_exp_f32 v76,v76
M v[56:59],a[216:219],a[148:151],0
v_exp_f32 v80,v80
v_exp_f32 v84,v84
M v[60:63],a[216:219],a[152:155],0
s_add_u32 s35,s30,0xc00
v_exp_f32 v77,v77
M v[60:63],a[220:223],a[164:167],v[60:63]
ds_read_b128 a[216:219],v3 offset:30720
v_exp_f32 v81,v81
M v[56:59],a[220:223],a[160:163],v[56:59]
v_exp_f32 v85,v85
v_add_f32 v22,v22,v76
v_add_f32 v23,v23,v80
M v[52:55],a[220:223],a[156:159],v[52:55]
L v100,s[8:11],s30 offen nt lds
v_add_f32 v24,v24,v84
v_exp_f32 v78,v78
M v[52:55],a[224:227],a[168:171],v[52:55]
ds_read_b128 a[220:223],v4 offset:30720
v_exp_f32 v82,v82
M v[56:59],a[224:227],a[172:175],v[56:59]
v_exp_f32 v86,v86
v_add_f32 v22,v22,v77
v_add_f32 v23,v23,v81
M v[60:63],a[224:227],a[176:179],v[60:63]
v_add_f32 v24,v24,v85
C v40,v76,v77
C v44,v80,v81
s_waitcnt lgkmcnt(2)
M v[60:63],a[228:231],a[188:191],v[60:63]
ds_read_b128 a[224:227],v3 offset:30848
L v101,s[8:11],s30 offen offset:1024 nt lds
C v48,v84,v85
M v[56:59],a[228:231],a[184:187],v[56:59]
v_exp_f32 v79,v79
v_exp_f32 v83,v83
M v[52:55],a[228:231],a[180:183],v[52:55]
v_exp_f32 v87,v87
v_add_f32 v22,v22,v78
v_add_f32 v23,v23,v82
M v[52:55],a[232:235],a[192:195],v[52:55]
ds_read_b128 a[228:231],v4 offset:30848
L v102,s[8:11],s30 offen offset:2048 nt lds
v_add_f32 v24,v24,v86
M v[56:59],a[232:235],a[196:199],v[56:59]
v_exp_f32 v88,v88
v_exp_f32 v92,v92
M v[60:63],a[232:235],a[200:203],v[60:63]
v_exp_f32 v96,v96
v_add_f32 v22,v22,v79
v_add_f32 v23,v23,v83
M v[60:63],a[236:239],a[212:215],v[60:63]
ds_read_b128 a[232:235],v3 offset:30976
s_add_u32 m0,m0,0xc00
v_add_f32 v24,v24,v87
C v41,v78,v79
M v[56:59],a[236:239],a[208:211],v[56:59]
C v45,v82,v83
C v49,v86,v87
v_exp_f32 v89,v89
M v[52:55],a[236:239],a[204:207],v[52:55]
v_exp_f32 v93,v93
s_waitcnt lgkmcnt(2)
M v[64:67],a[216:219],a[144:147],0
ds_read_b128 a[236:239],v4 offset:30976
v_exp_f32 v97,v97
v_add_f32 v22,v22,v88
M v[68:71],a[216:219],a[148:151],0
s_add_u32 s30,s30,0x3000
v_add_f32 v23,v23,v92
v_add_f32 v24,v24,v96
M v[72:75],a[216:219],a[152:155],0
v_exp_f32 v90,v90
v_exp_f32 v94,v94
M v[72:75],a[220:223],a[164:167],v[72:75]
L v100,s[8:11],s35 offen nt lds
v_exp_f32 v98,v98
v_add_f32 v22,v22,v89
M v[68:71],a[220:223],a[160:163],v[68:71]
v_add_f32 v23,v23,v93
v_add_f32 v24,v24,v97
C v42,v88,v89
C v46,v92,v93
M v[64:67],a[220:223],a[156:159],v[64:67]
C v50,v96,v97
v_exp_f32 v91,v91
M v[64:67],a[224:227],a[168:171],v[64:67]
L v101,s[8:11],s35 offen offset:1024 nt lds
v_exp_f32 v95,v95
M v[68:71],a[224:227],a[172:175],v[68:71]
v_exp_f32 v99,v99
v_add_f32 v22,v22,v90
v_add_f32 v23,v23,v94
M v[72:75],a[224:227],a[176:179],v[72:75]
s_waitcnt vmcnt(11) lgkmcnt(0)
s_barrier
v_add_f32 v24,v24,v98
C v43,v90,v91
M v[72:75],a[228:231],a[188:191],v[72:75]
T a[216:217],v5
T a[218:219],v5 offset:6144
C v47,v94,v95
C v51,v98,v99
M v[68:71],a[228:231],a[184:187],v[68:71]
T a[220:221],v6
T a[222:223],v6 offset:6144
v_add_f32 v22,v22,v91
v_add_f32 v23,v23,v95
M v[64:67],a[228:231],a[180:183],v[64:67]
T a[224:225],v7
T a[226:227],v7 offset:6144
v_add_f32 v24,v24,v99
M v[64:67],a[232:235],a[192:195],v[64:67]
T a[228:229],v8
T a[230:231],v8 offset:6144
M v[68:71],a[232:235],a[196:199],v[68:71]
L v102,s[8:11],s35 offen offset:2048 nt lds
M v[72:75],a[232:235],a[200:203],v[72:75]
T a[232:233],v5 offset:128
T a[234:235],v5 offset:6272
M v[72:75],a[236:239],a[212:215],v[72:75]
M v[68:71],a[236:239],a[208:211],v[68:71]
M v[64:67],a[236:239],a[204:207],v[64:67]
s_waitcnt lgkmcnt(4)
M v[112:115],a[216:219],v[40:43],v[112:115]
T a[236:237],v6 offset:128
s_add_u32 m0,s28,0x12000
M v[116:119],a[216:219],v[44:47],v[116:119]
T a[238:239],v6 offset:6272
M v[120:123],a[216:219],v[48:51],v[120:123]
M v[132:135],a[220:223],v[48:51],v[132:135]
T a[216:217],v7 offset:128
s_add_u32 s35,s29,0xc00
v_fma_f32 v52,v52,s37,-v19
M v[128:131],a[220:223],v[44:47],v[128:131]
T a[218:219],v7 offset:6272
v_fma_f32 v53,v53,s37,-v19
v_fma_f32 v54,v54,s37,-v19
M v[124:127],a[220:223],v[40:43],v[124:127]
v_fma_f32 v55,v55,s37,-v19
v_fma_f32 v56,v56,s37,-v20
v_fma_f32 v57,v57,s37,-v20
M v[136:139],a[224:227],v[40:43],v[136:139]
T a[220:221],v8 offset:128
v_max3_f32 v28,v52,v53,v54
v_fma_f32 v58,v58,s37,-v20
M v[140:143],a[224:227],v[44:47],v[140:143]
T a[222:223],v8 offset:6272
L v100,s[4:7],s29 offen nt lds
v_fma_f32 v59,v59,s37,-v20
M v[144:147],a[224:227],v[48:51],v[144:147]
v_max3_f32 v28,v28,v55,v56
v_fma_f32 v60,v60,s37,-v21
s_waitcnt lgkmcnt(4)
M v[156:159],a[228:231],v[48:51],v[156:159]
T a[224:225],v5 offset:256
v_fma_f32 v61,v61,s37,-v21
v_max3_f32 v28,v28,v57,v58
M v[152:155],a[228:231],v[44:47],v[152:155]
T a[226:227],v5 offset:6400
v_fma_f32 v62,v62,s37,-v21
v_fma_f32 v63,v63,s37,-v21
M v[148:151],a[228:231],v[40:43],v[148:151]
L v101,s[4:7],s29 offen offset:1024 nt lds
v_max3_f32 v28,v28,v59,v60
v_max3_f32 v28,v28,v61,v62
M v[160:163],a[232:235],v[40:43],v[160:163]
T a[228:229],v6 offset:256
v_max_f32 v28,v28,v63
v_fma_f32 v64,v64,s37,-v19
M v[164:167],a[232:235],v[44:47],v[164:167]
T a[230:231],v6 offset:6400
v_fma_f32 v65,v65,s37,-v19
v_fma_f32 v66,v66,s37,-v19
M v[168:171],a[232:235],v[48:51],v[168:171]
v_fma_f32 v67,v67,s37,-v19
v_fma_f32 v68,v68,s37,-v20
v_fma_f32 v69,v69,s37,-v20
M v[180:183],a[236:239],v[48:51],v[180:183]
T a[232:233],v7 offset:256
L v102,s[4:7],s29 offen offset:2048 nt lds
v_max3_f32 v28,v28,v64,v65
M v[176:179],a[236:239],v[44:47],v[176:179]
T a[234:235],v7 offset:6400
v_fma_f32 v70,v70,s37,-v20
v_fma_f32 v71,v71,s37,-v20
M v[172:175],a[236:239],v[40:43],v[172:175]
v_max3_f32 v28,v28,v66,v67
v_fma_f32 v72,v72,s37,-v21
s_waitcnt lgkmcnt(4)
M v[184:187],a[216:219],v[40:43],v[184:187]
T a[236:237],v8 offset:256
v_fma_f32 v73,v73,s37,-v21
v_max3_f32 v28,v28,v68,v69
M v[188:191],a[216:219],v[44:47],v[188:191]
T a[238:239],v8 offset:6400
s_add_u32 m0,m0,0xc00
v_fma_f32 v74,v74,s37,-v21
M v[192:195],a[216:219],v[48:51],v[192:195]
v_fma_f32 v75,v75,s37,-v21
v_max3_f32 v28,v28,v70,v71
v_max3_f32 v28,v28,v72,v73
M v[204:207],a[220:223],v[48:51],v[204:207]
v_max3_f32 v28,v28,v74,v75
M v[200:203],a[220:223],v[44:47],v[200:203]
s_add_u32 s29,s29,0x3000
M v[196:199],a[220:223],v[40:43],v[196:199]
M v[208:211],a[224:227],v[40:43],v[208:211]
L v100,s[4:7],s35 offen nt lds
M v[212:215],a[224:227],v[44:47],v[212:215]
M v[216:219],a[224:227],v[48:51],v[216:219]
s_waitcnt vmcnt(10) lgkmcnt(0)
s_barrier
M v[228:231],a[228:231],v[48:51],v[228:231]
ds_read_b128 a[216:219],v1 offset:24576
ds_read_b128 a[220:223],v2 offset:24576
M v[224:227],a[228:231],v[44:47],v[224:227]
ds_read_b128 a[224:227],v1 offset:24704
M v[220:223],a[228:231],v[40:43],v[220:223]
L v101,s[4:7],s35 offen offset:1024 nt lds
M v[232:235],a[232:235],v[40:43],v[232:235]
ds_read_b128 a[228:231],v2 offset:24704
M v[236:239],a[232:235],v[44:47],v[236:239]
M v[240:243],a[232:235],v[48:51],v[240:243]
ds_read_b128 a[232:235],v1 offset:24832
M v[252:255],a[236:239],v[48:51],v[252:255]
L v102,s[4:7],s35 offen offset:2048 nt lds
M v[248:251],a[236:239],v[44:47],v[248:251]
M v[244:247],a[236:239],v[40:43],v[244:247]
v_cmp_lt_f32 vcc,0x41000000,v28
s_cbranch_vccnz C1_31_r
C1_31_b:
s_waitcnt lgkmcnt(2)
M v[76:79],a[216:219],a[144:147],0
ds_read_b128 a[236:239],v2 offset:24832
s_add_u32 m0,s28,0
v_exp_f32 v52,v52
M v[80:83],a[216:219],a[148:151],0
v_exp_f32 v56,v56
v_exp_f32 v60,v60
M v[84:87],a[216:219],a[152:155],0
s_add_u32 s35,s30,0xc00
v_exp_f32 v53,v53
M v[84:87],a[220:223],a[164:167],v[84:87]
ds_read_b128 a[216:219],v1 offset:30720
v_exp_f32 v57,v57
M v[80:83],a[220:223],a[160:163],v[80:83]
v_exp_f32 v61,v61
v_add_f32 v22,v22,v52
v_add_f32 v23,v23,v56
M v[76:79],a[220:223],a[156:159],v[76:79]
L v100,s[8:11],s30 offen nt lds
v_add_f32 v24,v24,v60
v_exp_f32 v54,v54
M v[76:79],a[224:227],a[168:171],v[76:79]
ds_read_b128 a[220:223],v2 offset:30720
v_exp_f32 v58,v58
M v[80:83],a[224:227],a[172:175],v[80:83]
v_exp_f32 v62,v62
v_add_f32 v22,v22,v53
v_add_f32 v23,v23,v57
M v[84:87],a[224:227],a[176:179],v[84:87]
v_add_f32 v24,v24,v61
C v40,v52,v53
C v44,v56,v57
s_waitcnt lgkmcnt(2)
M v[84:87],a[228:231],a[188:191],v[84:87]
ds_read_b128 a[224:227],v1 offset:30848
L v101,s[8:11],s30 offen offset:1024 nt lds
C v48,v60,v61
M v[80:83],a[228:231],a[184:187],v[80:83]
v_exp_f32 v55,v55
v_exp_f32 v59,v59
M v[76:79],a[228:231],a[180:183],v[76:79]
v_exp_f32 v63,v63
v_add_f32 v22,v22,v54
v_add_f32 v23,v23,v58
M v[76:79],a[232:235],a[192:195],v[76:79]
ds_read_b128 a[228:231],v2 offset:30848
L v102,s[8:11],s30 offen offset:2048 nt lds
v_add_f32 v24,v24,v62
M v[80:83],a[232:235],a[196:199],v[80:83]
v_exp_f32 v64,v64
v_exp_f32 v68,v68
M v[84:87],a[232:235],a[200:203],v[84:87]
v_exp_f32 v72,v72
v_add_f32 v22,v22,v55
v_add_f32 v23,v23,v59
M v[84:87],a[236:239],a[212:215],v[84:87]
ds_read_b128 a[232:235],v1 offset:30976
s_add_u32 m0,m0,0xc00
v_add_f32 v24,v24,v63
C v41,v54,v55
M v[80:83],a[236:239],a[208:211],v[80:83]
C v45,v58,v59
C v49,v62,v63
v_exp_f32 v65,v65
M v[76:79],a[236:239],a[204:207],v[76:79]
v_exp_f32 v69,v69
s_waitcnt lgkmcnt(2)
M v[88:91],a[216:219],a[144:147],0
ds_read_b128 a[236:239],v2 offset:30976
v_exp_f32 v73,v73
v_add_f32 v22,v22,v64
M v[92:95],a[216:219],a[148:151],0
s_add_u32 s30,s30,0x3000
v_add_f32 v23,v23,v68
v_add_f32 v24,v24,v72
M v[96:99],a[216:219],a[152:155],0
v_exp_f32 v66,v66
v_exp_f32 v70,v70
M v[96:99],a[220:223],a[164:167],v[96:99]
L v100,s[8:11],s35 offen nt lds
v_exp_f32 v74,v74
v_add_f32 v22,v22,v65
M v[92:95],a[220:223],a[160:163],v[92:95]
v_add_f32 v23,v23,v69
v_add_f32 v24,v24,v73
C v42,v64,v65
C v46,v68,v69
M v[88:91],a[220:223],a[156:159],v[88:91]
C v50,v72,v73
v_exp_f32 v67,v67
M v[88:91],a[224:227],a[168:171],v[88:91]
L v101,s[8:11],s35 offen offset:1024 nt lds
v_exp_f32 v71,v71
M v[92:95],a[224:227],a[172:175],v[92:95]
v_exp_f32 v75,v75
v_add_f32 v22,v22,v66
v_add_f32 v23,v23,v70
M v[96:99],a[224:227],a[176:179],v[96:99]
s_waitcnt vmcnt(11) lgkmcnt(0)
s_barrier
v_add_f32 v24,v24,v74
C v43,v66,v67
M v[96:99],a[228:231],a[188:191],v[96:99]
T a[216:217],v9
T a[218:219],v9 offset:6144
C v47,v70,v71
C v51,v74,v75
M v[92:95],a[228:231],a[184:187],v[92:95]
T a[220:221],v10
T a[222:223],v10 offset:6144
v_add_f32 v22,v22,v67
v_add_f32 v23,v23,v71
M v[88:91],a[228:231],a[180:183],v[88:91]
T a[224:225],v11
T a[226:227],v11 offset:6144
v_add_f32 v24,v24,v75
M v[88:91],a[232:235],a[192:195],v[88:91]
T a[228:229],v12
T a[230:231],v12 offset:6144
M v[92:95],a[232:235],a[196:199],v[92:95]
L v102,s[8:11],s35 offen offset:2048 nt lds
M v[96:99],a[232:235],a[200:203],v[96:99]
T a[232:233],v9 offset:128
T a[234:235],v9 offset:6272
M v[96:99],a[236:239],a[212:215],v[96:99]
M v[92:95],a[236:239],a[208:211],v[92:95]
M v[88:91],a[236:239],a[204:207],v[88:91]
s_waitcnt lgkmcnt(4)
M v[112:115],a[216:219],v[40:43],v[112:115]
T a[236:237],v10 offset:128
s_add_u32 m0,s28,0x6000
M v[116:119],a[216:219],v[44:47],v[116:119]
T a[238:239],v10 offset:6272
M v[120:123],a[216:219],v[48:51],v[120:123]
M v[132:135],a[220:223],v[48:51],v[132:135]
T a[216:217],v11 offset:128
s_add_u32 s35,s29,0xc00
v_fma_f32 v76,v76,s37,-v19
M v[128:131],a[220:223],v[44:47],v[128:131]
T a[218:219],v11 offset:6272
v_fma_f32 v77,v77,s37,-v19
v_fma_f32 v78,v78,s37,-v19
M v[124:127],a[220:223],v[40:43],v[124:127]
v_fma_f32 v79,v79,s37,-v19
v_fma_f32 v80,v80,s37,-v20
v_fma_f32 v81,v81,s37,-v20
M v[136:139],a[224:227],v[40:43],v[136:139]
T a[220:221],v12 offset:128
v_max3_f32 v28,v76,v77,v78
v_fma_f32 v82,v82,s37,-v20
M v[140:143],a[224:227],v[44:47],v[140:143]
T a[222:223],v12 offset:6272
L v100,s[4:7],s29 offen nt lds
v_fma_f32 v83,v83,s37,-v20
M v[144:147],a[224:227],v[48:51],v[144:147]
v_max3_f32 v28,v28,v79,v80
v_fma_f32 v84,v84,s37,-v21
s_waitcnt lgkmcnt(4)
M v[156:159],a[228:231],v[48:51],v[156:159]
T a[224:225],v9 offset:256
v_fma_f32 v85,v85,s37,-v21
v_max3_f32 v28,v28,v81,v82
M v[152:155],a[228:231],v[44:47],v[152:155]
T a[226:227],v9 offset:6400
v_fma_f32 v86,v86,s37,-v21
v_fma_f32 v87,v87,s37,-v21
M v[148:151],a[228:231],v[40:43],v[148:151]
L v101,s[4:7],s29 offen offset:1024 nt lds
v_max3_f32 v28,v28,v83,v84
v_max3_f32 v28,v28,v85,v86
M v[160:163],a[232:235],v[40:43],v[160:163]
T a[228:229],v10 offset:256
v_max_f32 v28,v28,v87
v_fma_f32 v88,v88,s37,-v19
M v[164:167],a[232:235],v[44:47],v[164:167]
T a[230:231],v10 offset:6400
v_fma_f32 v89,v89,s37,-v19
v_fma_f32 v90,v90,s37,-v19
M v[168:171],a[232:235],v[48:51],v[168:171]
v_fma_f32 v91,v91,s37,-v19
v_fma_f32 v92,v92,s37,-v20
v_fma_f32 v93,v93,s37,-v20
M v[180:183],a[236:239],v[48:51],v[180:183]
T a[232:233],v11 offset:256
L v102,s[4:7],s29 offen offset:2048 nt lds
v_max3_f32 v28,v28,v88,v89
M v[176:179],a[236:239],v[44:47],v[176:179]
T a[234:235],v11 offset:6400
v_fma_f32 v94,v94,s37,-v20
v_fma_f32 v95,v95,s37,-v20
M v[172:175],a[236:239],v[40:43],v[172:175]
v_max3_f32 v28,v28,v90,v91
v_fma_f32 v96,v96,s37,-v21
s_waitcnt lgkmcnt(4)
M v[184:187],a[216:219],v[40:43],v[184:187]
T a[236:237],v12 offset:256
v_fma_f32 v97,v97,s37,-v21
v_max3_f32 v28,v28,v92,v93
M v[188:191],a[216:219],v[44:47],v[188:191]
T a[238:239],v12 offset:6400
s_add_u32 m0,m0,0xc00
v_fma_f32 v98,v98,s37,-v21
M v[192:195],a[216:219],v[48:51],v[192:195]
v_fma_f32 v99,v99,s37,-v21
v_max3_f32 v28,v28,v94,v95
v_max3_f32 v28,v28,v96,v97
M v[204:207],a[220:223],v[48:51],v[204:207]
v_max3_f32 v28,v28,v98,v99
M v[200:203],a[220:223],v[44:47],v[200:203]
s_add_u32 s29,s29,0x3000
M v[196:199],a[220:223],v[40:43],v[196:199]
M v[208:211],a[224:227],v[40:43],v[208:211]
L v100,s[4:7],s35 offen nt lds
M v[212:215],a[224:227],v[44:47],v[212:215]
M v[216:219],a[224:227],v[48:51],v[216:219]
s_waitcnt vmcnt(10) lgkmcnt(0)
s_barrier
M v[228:231],a[228:231],v[48:51],v[228:231]
ds_read_b128 a[216:219],v3 offset:24576
ds_read_b128 a[220:223],v4 offset:24576
M v[224:227],a[228:231],v[44:47],v[224:227]
ds_read_b128 a[224:227],v3 offset:24704
M v[220:223],a[228:231],v[40:43],v[220:223]
L v101,s[4:7],s35 offen offset:1024 nt lds
M v[232:235],a[232:235],v[40:43],v[232:235]
ds_read_b128 a[228:231],v4 offset:24704
M v[236:239],a[232:235],v[44:47],v[236:239]
M v[240:243],a[232:235],v[48:51],v[240:243]
ds_read_b128 a[232:235],v3 offset:24832
M v[252:255],a[236:239],v[48:51],v[252:255]
L v102,s[4:7],s35 offen offset:2048 nt lds
M v[248:251],a[236:239],v[44:47],v[248:251]
M v[244:247],a[236:239],v[40:43],v[244:247]
s_sub_u32 s36,s36,1
s_cmp_lg_u32 s36,0
s_cbranch_scc1 C1_loop3
v_cmp_lt_f32 vcc,0x41000000,v28
s_cbranch_vccnz C1_33_r
C1_33_b:
s_waitcnt lgkmcnt(2)
M v[52:55],a[216:219],a[144:147],0
ds_read_b128 a[236:239],v4 offset:24832
s_add_u32 m0,s28,0xc000
v_exp_f32 v76,v76
M v[56:59],a[216:219],a[148:151],0
v_exp_f32 v80,v80
v_exp_f32 v84,v84
M v[60:63],a[216:219],a[152:155],0
s_add_u32 s35,s30,0xc00
v_exp_f32 v77,v77
M v[60:63],a[220:223],a[164:167],v[60:63]
ds_read_b128 a[216:219],v3 offset:30720
v_exp_f32 v81,v81
M v[56:59],a[220:223],a[160:163],v[56:59]
v_exp_f32 v85,v85
v_add_f32 v22,v22,v76
v_add_f32 v23,v23,v80
M v[52:55],a[220:223],a[156:159],v[52:55]
L v100,s[8:11],s30 offen nt lds
v_add_f32 v24,v24,v84
v_exp_f32 v78,v78
M v[52:55],a[224:227],a[168:171],v[52:55]
ds_read_b128 a[220:223],v4 offset:30720
v_exp_f32 v82,v82
M v[56:59],a[224:227],a[172:175],v[56:59]
v_exp_f32 v86,v86
v_add_f32 v22,v22,v77
v_add_f32 v23,v23,v81
M v[60:63],a[224:227],a[176:179],v[60:63]
v_add_f32 v24,v24,v85
C v40,v76,v77
C v44,v80,v81
s_waitcnt lgkmcnt(2)
M v[60:63],a[228:231],a[188:191],v[60:63]
ds_read_b128 a[224:227],v3 offset:30848
L v101,s[8:11],s30 offen offset:1024 nt lds
C v48,v84,v85
M v[56:59],a[228:231],a[184:187],v[56:59]
v_exp_f32 v79,v79
v_exp_f32 v83,v83
M v[52:55],a[228:231],a[180:183],v[52:55]
v_exp_f32 v87,v87
v_add_f32 v22,v22,v78
v_add_f32 v23,v23,v82
M v[52:55],a[232:235],a[192:195],v[52:55]
ds_read_b128 a[228:231],v4 offset:30848
L v102,s[8:11],s30 offen offset:2048 nt lds
v_add_f32 v24,v24,v86
M v[56:59],a[232:235],a[196:199],v[56:59]
v_exp_f32 v88,v88
v_exp_f32 v92,v92
M v[60:63],a[232:235],a[200:203],v[60:63]
v_exp_f32 v96,v96
v_add_f32 v22,v22,v79
v_add_f32 v23,v23,v83
M v[60:63],a[236:239],a[212:215],v[60:63]
ds_read_b128 a[232:235],v3 offset:30976
s_add_u32 m0,m0,0xc00
v_add_f32 v24,v24,v87
C v41,v78,v79
M v[56:59],a[236:239],a[208:211],v[56:59]
C v45,v82,v83
C v49,v86,v87
v_exp_f32 v89,v89
M v[52:55],a[236:239],a[204:207],v[52:55]
v_exp_f32 v93,v93
s_waitcnt lgkmcnt(2)
M v[64:67],a[216:219],a[144:147],0
ds_read_b128 a[236:239],v4 offset:30976
v_exp_f32 v97,v97
v_add_f32 v22,v22,v88
M v[68:71],a[216:219],a[148:151],0
s_add_u32 s30,s30,0x3000
v_add_f32 v23,v23,v92
v_add_f32 v24,v24,v96
M v[72:75],a[216:219],a[152:155],0
v_exp_f32 v90,v90
v_exp_f32 v94,v94
M v[72:75],a[220:223],a[164:167],v[72:75]
L v100,s[8:11],s35 offen nt lds
v_exp_f32 v98,v98
v_add_f32 v22,v22,v89
M v[68:71],a[220:223],a[160:163],v[68:71]
v_add_f32 v23,v23,v93
v_add_f32 v24,v24,v97
C v42,v88,v89
C v46,v92,v93
M v[64:67],a[220:223],a[156:159],v[64:67]
C v50,v96,v97
v_exp_f32 v91,v91
M v[64:67],a[224:227],a[168:171],v[64:67]
L v101,s[8:11],s35 offen offset:1024 nt lds
v_exp_f32 v95,v95
M v[68:71],a[224:227],a[172:175],v[68:71]
v_exp_f32 v99,v99
v_add_f32 v22,v22,v90
v_add_f32 v23,v23,v94
M v[72:75],a[224:227],a[176:179],v[72:75]
s_waitcnt vmcnt(11) lgkmcnt(0)
s_barrier
v_add_f32 v24,v24,v98
C v43,v90,v91
M v[72:75],a[228:231],a[188:191],v[72:75]
T a[216:217],v5
T a[218:219],v5 offset:6144
C v47,v94,v95
C v51,v98,v99
M v[68:71],a[228:231],a[184:187],v[68:71]
T a[220:221],v6
T a[222:223],v6 offset:6144
v_add_f32 v22,v22,v91
v_add_f32 v23,v23,v95
M v[64:67],a[228:231],a[180:183],v[64:67]
T a[224:225],v7
T a[226:227],v7 offset:6144
v_add_f32 v24,v24,v99
M v[64:67],a[232:235],a[192:195],v[64:67]
T a[228:229],v8
T a[230:231],v8 offset:6144
M v[68:71],a[232:235],a[196:199],v[68:71]
L v102,s[8:11],s35 offen offset:2048 nt lds
M v[72:75],a[232:235],a[200:203],v[72:75]
T a[232:233],v5 offset:128
T a[234:235],v5 offset:6272
M v[72:75],a[236:239],a[212:215],v[72:75]
M v[68:71],a[236:239],a[208:211],v[68:71]
M v[64:67],a[236:239],a[204:207],v[64:67]
s_waitcnt lgkmcnt(4)
M v[112:115],a[216:219],v[40:43],v[112:115]
T a[236:237],v6 offset:128
s_add_u32 m0,s28,0x12000
M v[116:119],a[216:219],v[44:47],v[116:119]
T a[238:239],v6 offset:6272
M v[120:123],a[216:219],v[48:51],v[120:123]
M v[132:135],a[220:223],v[48:51],v[132:135]
T a[216:217],v7 offset:128
s_add_u32 s35,s30,0xc00
v_fma_f32 v52,v52,s37,-v19
M v[128:131],a[220:223],v[44:47],v[128:131]
T a[218:219],v7 offset:6272
v_fma_f32 v53,v53,s37,-v19
v_fma_f32 v54,v54,s37,-v19
M v[124:127],a[220:223],v[40:43],v[124:127]
v_fma_f32 v55,v55,s37,-v19
v_fma_f32 v56,v56,s37,-v20
v_fma_f32 v57,v57,s37,-v20
M v[136:139],a[224:227],v[40:43],v[136:139]
T a[220:221],v8 offset:128
v_max3_f32 v28,v52,v53,v54
v_fma_f32 v58,v58,s37,-v20
M v[140:143],a[224:227],v[44:47],v[140:143]
T a[222:223],v8 offset:6272
L v100,s[8:11],s30 offen nt lds
v_fma_f32 v59,v59,s37,-v20
M v[144:147],a[224:227],v[48:51],v[144:147]
v_max3_f32 v28,v28,v55,v56
v_fma_f32 v60,v60,s37,-v21
s_waitcnt lgkmcnt(4)
M v[156:159],a[228:231],v[48:51],v[156:159]
T a[224:225],v5 offset:256
v_fma_f32 v61,v61,s37,-v21
v_max3_f32 v28,v28,v57,v58
M v[152:155],a[228:231],v[44:47],v[152:155]
T a[226:227],v5 offset:6400
v_fma_f32 v62,v62,s37,-v21
v_fma_f32 v63,v63,s37,-v21
M v[148:151],a[228:231],v[40:43],v[148:151]
L v101,s[8:11],s30 offen offset:1024 nt lds
v_max3_f32 v28,v28,v59,v60
v_max3_f32 v28,v28,v61,v62
M v[160:163],a[232:235],v[40:43],v[160:163]
T a[228:229],v6 offset:256
v_max_f32 v28,v28,v63
v_fma_f32 v64,v64,s37,-v19
M v[164:167],a[232:235],v[44:47],v[164:167]
T a[230:231],v6 offset:6400
v_fma_f32 v65,v65,s37,-v19
v_fma_f32 v66,v66,s37,-v19
M v[168:171],a[232:235],v[48:51],v[168:171]
v_fma_f32 v67,v67,s37,-v19
v_fma_f32 v68,v68,s37,-v20
v_fma_f32 v69,v69,s37,-v20
M v[180:183],a[236:239],v[48:51],v[180:183]
T a[232:233],v7 offset:256
L v102,s[8:11],s30 offen offset:2048 nt lds
v_max3_f32 v28,v28,v64,v65
M v[176:179],a[236:239],v[44:47],v[176:179]
T a[234:235],v7 offset:6400
v_fma_f32 v70,v70,s37,-v20
v_fma_f32 v71,v71,s37,-v20
M v[172:175],a[236:239],v[40:43],v[172:175]
v_max3_f32 v28,v28,v66,v67
v_fma_f32 v72,v72,s37,-v21
s_waitcnt lgkmcnt(4)
M v[184:187],a[216:219],v[40:43],v[184:187]
T a[236:237],v8 offset:256
v_fma_f32 v73,v73,s37,-v21
v_max3_f32 v28,v28,v68,v69
M v[188:191],a[216:219],v[44:47],v[188:191]
T a[238:239],v8 offset:6400
s_add_u32 m0,m0,0xc00
v_fma_f32 v74,v74,s37,-v21
M v[192:195],a[216:219],v[48:51],v[192:195]
v_fma_f32 v75,v75,s37,-v21
v_max3_f32 v28,v28,v70,v71
v_max3_f32 v28,v28,v72,v73
M v[204:207],a[220:223],v[48:51],v[204:207]
v_max3_f32 v28,v28,v74,v75
M v[200:203],a[220:223],v[44:47],v[200:203]
s_add_u32 s30,s30,0x3000
M v[196:199],a[220:223],v[40:43],v[196:199]
M v[208:211],a[224:227],v[40:43],v[208:211]
L v100,s[8:11],s35 offen nt lds
M v[212:215],a[224:227],v[44:47],v[212:215]
M v[216:219],a[224:227],v[48:51],v[216:219]
s_waitcnt vmcnt(10) lgkmcnt(0)
s_barrier
M v[228:231],a[228:231],v[48:51],v[228:231]
ds_read_b128 a[216:219],v1 offset:24576
ds_read_b128 a[220:223],v2 offset:24576
M v[224:227],a[228:231],v[44:47],v[224:227]
ds_read_b128 a[224:227],v1 offset:24704
M v[220:223],a[228:231],v[40:43],v[220:223]
L v101,s[8:11],s35 offen offset:1024 nt lds
M v[232:235],a[232:235],v[40:43],v[232:235]
ds_read_b128 a[228:231],v2 offset:24704
M v[236:239],a[232:235],v[44:47],v[236:239]
M v[240:243],a[232:235],v[48:51],v[240:243]
ds_read_b128 a[232:235],v1 offset:24832
M v[252:255],a[236:239],v[48:51],v[252:255]
L v102,s[8:11],s35 offen offset:2048 nt lds
M v[248:251],a[236:239],v[44:47],v[248:251]
M v[244:247],a[236:239],v[40:43],v[244:247]
v_cmp_lt_f32 vcc,0x41000000,v28
s_cbranch_vccnz C1_35_r
C1_35_b:
s_waitcnt lgkmcnt(2)
M v[76:79],a[216:219],a[144:147],0
ds_read_b128 a[236:239],v2 offset:24832
s_add_u32 m0,s28,0
v_exp_f32 v52,v52
M v[80:83],a[216:219],a[148:151],0
v_exp_f32 v56,v56
v_exp_f32 v60,v60
M v[84:87],a[216:219],a[152:155],0
s_add_u32 s35,s29,0xc00
v_exp_f32 v53,v53
M v[84:87],a[220:223],a[164:167],v[84:87]
ds_read_b128 a[216:219],v1 offset:30720
v_exp_f32 v57,v57
M v[80:83],a[220:223],a[160:163],v[80:83]
v_exp_f32 v61,v61
v_add_f32 v22,v22,v52
v_add_f32 v23,v23,v56
M v[76:79],a[220:223],a[156:159],v[76:79]
L v100,s[4:7],s29 offen nt lds
v_add_f32 v24,v24,v60
v_exp_f32 v54,v54
M v[76:79],a[224:227],a[168:171],v[76:79]
ds_read_b128 a[220:223],v2 offset:30720
v_exp_f32 v58,v58
M v[80:83],a[224:227],a[172:175],v[80:83]
v_exp_f32 v62,v62
v_add_f32 v22,v22,v53
v_add_f32 v23,v23,v57
M v[84:87],a[224:227],a[176:179],v[84:87]
v_add_f32 v24,v24,v61
C v40,v52,v53
C v44,v56,v57
s_waitcnt lgkmcnt(2)
M v[84:87],a[228:231],a[188:191],v[84:87]
ds_read_b128 a[224:227],v1 offset:30848
L v101,s[4:7],s29 offen offset:1024 nt lds
C v48,v60,v61
M v[80:83],a[228:231],a[184:187],v[80:83]
v_exp_f32 v55,v55
v_exp_f32 v59,v59
M v[76:79],a[228:231],a[180:183],v[76:79]
v_exp_f32 v63,v63
v_add_f32 v22,v22,v54
v_add_f32 v23,v23,v58
M v[76:79],a[232:235],a[192:195],v[76:79]
ds_read_b128 a[228:231],v2 offset:30848
L v102,s[4:7],s29 offen offset:2048 nt lds
v_add_f32 v24,v24,v62
M v[80:83],a[232:235],a[196:199],v[80:83]
v_exp_f32 v64,v64
v_exp_f32 v68,v68
M v[84:87],a[232:235],a[200:203],v[84:87]
v_exp_f32 v72,v72
v_add_f32 v22,v22,v55
v_add_f32 v23,v23,v59
M v[84:87],a[236:239],a[212:215],v[84:87]
ds_read_b128 a[232:235],v1 offset:30976
s_add_u32 m0,m0,0xc00
v_add_f32 v24,v24,v63
C v41,v54,v55
M v[80:83],a[236:239],a[208:211],v[80:83]
C v45,v58,v59
C v49,v62,v63
v_exp_f32 v65,v65
M v[76:79],a[236:239],a[204:207],v[76:79]
v_exp_f32 v69,v69
s_waitcnt lgkmcnt(2)
M v[88:91],a[216:219],a[144:147],0
ds_read_b128 a[236:239],v2 offset:30976
v_exp_f32 v73,v73
v_add_f32 v22,v22,v64
M v[92:95],a[216:219],a[148:151],0
s_add_u32 s29,s29,0x3000
v_add_f32 v23,v23,v68
v_add_f32 v24,v24,v72
M v[96:99],a[216:219],a[152:155],0
v_exp_f32 v66,v66
v_exp_f32 v70,v70
M v[96:99],a[220:223],a[164:167],v[96:99]
L v100,s[4:7],s35 offen nt lds
v_exp_f32 v74,v74
v_add_f32 v22,v22,v65
M v[92:95],a[220:223],a[160:163],v[92:95]
v_add_f32 v23,v23,v69
v_add_f32 v24,v24,v73
C v42,v64,v65
C v46,v68,v69
M v[88:91],a[220:223],a[156:159],v[88:91]
C v50,v72,v73
v_exp_f32 v67,v67
M v[88:91],a[224:227],a[168:171],v[88:91]
L v101,s[4:7],s35 offen offset:1024 nt lds
v_exp_f32 v71,v71
M v[92:95],a[224:227],a[172:175],v[92:95]
v_exp_f32 v75,v75
v_add_f32 v22,v22,v66
v_add_f32 v23,v23,v70
M v[96:99],a[224:227],a[176:179],v[96:99]
s_waitcnt vmcnt(11) lgkmcnt(0)
s_barrier
v_add_f32 v24,v24,v74
C v43,v66,v67
M v[96:99],a[228:231],a[188:191],v[96:99]
T a[216:217],v9
T a[218:219],v9 offset:6144
C v47,v70,v71
C v51,v74,v75
M v[92:95],a[228:231],a[184:187],v[92:95]
T a[220:221],v10
T a[222:223],v10 offset:6144
v_add_f32 v22,v22,v67
v_add_f32 v23,v23,v71
M v[88:91],a[228:231],a[180:183],v[88:91]
T a[224:225],v11
T a[226:227],v11 offset:6144
v_add_f32 v24,v24,v75
M v[88:91],a[232:235],a[192:195],v[88:91]
T a[228:229],v12
T a[230:231],v12 offset:6144
M v[92:95],a[232:235],a[196:199],v[92:95]
L v102,s[4:7],s35 offen offset:2048 nt lds
M v[96:99],a[232:235],a[200:203],v[96:99]
T a[232:233],v9 offset:128
T a[234:235],v9 offset:6272
M v[96:99],a[236:239],a[212:215],v[96:99]
M v[92:95],a[236:239],a[208:211],v[92:95]
M v[88:91],a[236:239],a[204:207],v[88:91]
s_waitcnt lgkmcnt(4)
M v[112:115],a[216:219],v[40:43],v[112:115]
T a[236:237],v10 offset:128
s_add_u32 m0,s28,0x6000
M v[116:119],a[216:219],v[44:47],v[116:119]
T a[238:239],v10 offset:6272
M v[120:123],a[216:219],v[48:51],v[120:123]
M v[132:135],a[220:223],v[48:51],v[132:135]
T a[216:217],v11 offset:128
s_add_u32 s35,s29,0xc00
v_fma_f32 v76,v76,s37,-v19
M v[128:131],a[220:223],v[44:47],v[128:131]
T a[218:219],v11 offset:6272
v_fma_f32 v77,v77,s37,-v19
v_fma_f32 v78,v78,s37,-v19
M v[124:127],a[220:223],v[40:43],v[124:127]
v_fma_f32 v79,v79,s37,-v19
v_fma_f32 v80,v80,s37,-v20
v_fma_f32 v81,v81,s37,-v20
M v[136:139],a[224:227],v[40:43],v[136:139]
T a[220:221],v12 offset:128
L v100,s[4:7],s29 offen nt lds
v_max3_f32 v28,v76,v77,v78
M v[140:143],a[224:227],v[44:47],v[140:143]
T a[222:223],v12 offset:6272
v_fma_f32 v82,v82,s37,-v20
v_fma_f32 v83,v83,s37,-v20
M v[144:147],a[224:227],v[48:51],v[144:147]
v_max3_f32 v28,v28,v79,v80
v_fma_f32 v84,v84,s37,-v21
s_waitcnt lgkmcnt(4)
M v[156:159],a[228:231],v[48:51],v[156:159]
T a[224:225],v9 offset:256
v_fma_f32 v85,v85,s37,-v21
v_max3_f32 v28,v28,v81,v82
M v[152:155],a[228:231],v[44:47],v[152:155]
T a[226:227],v9 offset:6400
L v101,s[4:7],s29 offen offset:1024 nt lds
v_fma_f32 v86,v86,s37,-v21
M v[148:151],a[228:231],v[40:43],v[148:151]
v_fma_f32 v87,v87,s37,-v21
v_max3_f32 v28,v28,v83,v84
v_max3_f32 v28,v28,v85,v86
M v[160:163],a[232:235],v[40:43],v[160:163]
T a[228:229],v10 offset:256
v_max_f32 v28,v28,v87
v_fma_f32 v88,v88,s37,-v19
M v[164:167],a[232:235],v[44:47],v[164:167]
T a[230:231],v10 offset:6400
v_fma_f32 v89,v89,s37,-v19
v_fma_f32 v90,v90,s37,-v19
M v[168:171],a[232:235],v[48:51],v[168:171]
L v102,s[4:7],s29 offen offset:2048 nt lds
v_fma_f32 v91,v91,s37,-v19
v_fma_f32 v92,v92,s37,-v20
M v[180:183],a[236:239],v[48:51],v[180:183]
T a[232:233],v11 offset:256
v_fma_f32 v93,v93,s37,-v20
v_max3_f32 v28,v28,v88,v89
M v[176:179],a[236:239],v[44:47],v[176:179]
T a[234:235],v11 offset:6400
v_fma_f32 v94,v94,s37,-v20
v_fma_f32 v95,v95,s37,-v20
M v[172:175],a[236:239],v[40:43],v[172:175]
s_add_u32 m0,m0,0xc00
v_max3_f32 v28,v28,v90,v91
s_waitcnt lgkmcnt(4)
M v[184:187],a[216:219],v[40:43],v[184:187]
T a[236:237],v12 offset:256
v_fma_f32 v96,v96,s37,-v21
v_fma_f32 v97,v97,s37,-v21
M v[188:191],a[216:219],v[44:47],v[188:191]
T a[238:239],v12 offset:6400
v_max3_f32 v28,v28,v92,v93
v_fma_f32 v98,v98,s37,-v21
M v[192:195],a[216:219],v[48:51],v[192:195]
s_add_u32 s29,s29,0x3000
v_fma_f32 v99,v99,s37,-v21
v_max3_f32 v28,v28,v94,v95
M v[204:207],a[220:223],v[48:51],v[204:207]
v_max3_f32 v28,v28,v96,v97
v_max3_f32 v28,v28,v98,v99
M v[200:203],a[220:223],v[44:47],v[200:203]
M v[196:199],a[220:223],v[40:43],v[196:199]
L v100,s[4:7],s35 offen nt lds
M v[208:211],a[224:227],v[40:43],v[208:211]
M v[212:215],a[224:227],v[44:47],v[212:215]
L v101,s[4:7],s35 offen offset:1024 nt lds
M v[216:219],a[224:227],v[48:51],v[216:219]
s_waitcnt vmcnt(11) lgkmcnt(0)
s_barrier
M v[228:231],a[228:231],v[48:51],v[228:231]
T a[216:217],v9 offset:24576
T a[218:219],v9 offset:30720
M v[224:227],a[228:231],v[44:47],v[224:227]
T a[220:221],v10 offset:24576
T a[222:223],v10 offset:30720
M v[220:223],a[228:231],v[40:43],v[220:223]
T a[224:225],v11 offset:24576
T a[226:227],v11 offset:30720
M v[232:235],a[232:235],v[40:43],v[232:235]
T a[228:229],v12 offset:24576
T a[230:231],v12 offset:30720
M v[236:239],a[232:235],v[44:47],v[236:239]
M v[240:243],a[232:235],v[48:51],v[240:243]
T a[232:233],v9 offset:24704
T a[234:235],v9 offset:30848
M v[252:255],a[236:239],v[48:51],v[252:255]
L v102,s[4:7],s35 offen offset:2048 nt lds
M v[248:251],a[236:239],v[44:47],v[248:251]
M v[244:247],a[236:239],v[40:43],v[244:247]
v_cmp_lt_f32 vcc,0x41000000,v28
s_cbranch_vccnz C1_37_r
C1_37_b:
v_exp_f32 v76,v76
v_exp_f32 v80,v80
v_exp_f32 v84,v84
v_exp_f32 v77,v77
v_exp_f32 v81,v81
v_exp_f32 v85,v85
v_add_f32 v22,v22,v76
v_add_f32 v23,v23,v80
v_add_f32 v24,v24,v84
v_exp_f32 v78,v78
v_exp_f32 v82,v82
v_exp_f32 v86,v86
v_add_f32 v22,v22,v77
v_add_f32 v23,v23,v81
v_add_f32 v24,v24,v85
C v40,v76,v77
C v44,v80,v81
C v48,v84,v85
v_exp_f32 v79,v79
v_exp_f32 v83,v83
v_exp_f32 v87,v87
v_add_f32 v22,v22,v78
v_add_f32 v23,v23,v82
v_add_f32 v24,v24,v86
v_exp_f32 v88,v88
v_exp_f32 v92,v92
v_exp_f32 v96,v96
v_add_f32 v22,v22,v79
v_add_f32 v23,v23,v83
v_add_f32 v24,v24,v87
C v41,v78,v79
C v45,v82,v83
C v49,v86,v87
v_exp_f32 v89,v89
v_exp_f32 v93,v93
v_exp_f32 v97,v97
v_add_f32 v22,v22,v88
v_add_f32 v23,v23,v92
v_add_f32 v24,v24,v96
v_exp_f32 v90,v90
v_exp_f32 v94,v94
v_exp_f32 v98,v98
v_add_f32 v22,v22,v89
v_add_f32 v23,v23,v93
v_add_f32 v24,v24,v97
C v42,v88,v89
C v46,v92,v93
C v50,v96,v97
v_exp_f32 v91,v91
v_exp_f32 v95,v95
v_exp_f32 v99,v99
v_add_f32 v22,v22,v90
v_add_f32 v23,v23,v94
v_add_f32 v24,v24,v98
C v43,v90,v91
C v47,v94,v95
C v51,v98,v99
s_waitcnt lgkmcnt(4)
M v[112:115],a[216:219],v[40:43],v[112:115]
T a[236:237],v10 offset:24704
v_add_f32 v22,v22,v91
M v[116:119],a[216:219],v[44:47],v[116:119]
T a[238:239],v10 offset:30848
v_add_f32 v23,v23,v95
M v[120:123],a[216:219],v[48:51],v[120:123]
v_add_f32 v24,v24,v99
s_add_u32 m0,s28,0xc000
M v[132:135],a[220:223],v[48:51],v[132:135]
T a[216:217],v11 offset:24704
M v[128:131],a[220:223],v[44:47],v[128:131]
T a[218:219],v11 offset:30848
M v[124:127],a[220:223],v[40:43],v[124:127]
s_add_u32 s35,s30,0xc00
M v[136:139],a[224:227],v[40:43],v[136:139]
T a[220:221],v12 offset:24704
v_mov_b32 v25,v22
v_mov_b32 v26,v23
v_mov_b32 v27,v24
v_permlane32_swap_b32 v22,v25
v_permlane32_swap_b32 v23,v26
M v[140:143],a[224:227],v[44:47],v[140:143]
T a[222:223],v12 offset:30848
v_permlane32_swap_b32 v24,v27
v_add_f32 v22,v22,v25
v_add_f32 v23,v23,v26
v_add_f32 v24,v24,v27
v_mov_b32 v25,v22
M v[144:147],a[224:227],v[48:51],v[144:147]
v_mov_b32 v26,v23
v_mov_b32 v27,v24
v_permlane16_swap_b32 v22,v25
v_permlane16_swap_b32 v23,v26
v_permlane16_swap_b32 v24,v27
s_waitcnt lgkmcnt(4)
M v[156:159],a[228:231],v[48:51],v[156:159]
T a[224:225],v9 offset:24832
L v100,s[8:11],s30 offen nt lds
v_add_f32 v22,v22,v25
v_add_f32 v23,v23,v26
v_add_f32 v24,v24,v27
M v[152:155],a[228:231],v[44:47],v[152:155]
T a[226:227],v9 offset:30976
v_rcp_f32 v30,v22
v_rcp_f32 v32,v23
M v[148:151],a[228:231],v[40:43],v[148:151]
v_rcp_f32 v34,v24
v_mov_b32 v31,v30
v_mov_b32 v33,v32
v_mov_b32 v35,v34
v_add_u32 v36,s47,v0
M v[160:163],a[232:235],v[40:43],v[160:163]
T a[228:229],v10 offset:24832
v_add_u32 v37,s48,v0
v_add_u32 v38,s49,v0
M v[164:167],a[232:235],v[44:47],v[164:167]
T a[230:231],v10 offset:30976
L v101,s[8:11],s30 offen offset:1024 nt lds
M v[168:171],a[232:235],v[48:51],v[168:171]
v_mul_f32 v112,v112,v30
v_mul_f32 v113,v113,v30
v_mul_f32 v114,v114,v30
M v[180:183],a[236:239],v[48:51],v[180:183]
T a[232:233],v11 offset:24832
v_mul_f32 v115,v115,v30
v_mul_f32 v124,v124,v30
M v[176:179],a[236:239],v[44:47],v[176:179]
T a[234:235],v11 offset:30976
L v102,s[8:11],s30 offen offset:2048 nt lds
v_mul_f32 v125,v125,v30
M v[172:175],a[236:239],v[40:43],v[172:175]
v_mul_f32 v126,v126,v30
v_mul_f32 v127,v127,v30
s_waitcnt lgkmcnt(4)
M v[184:187],a[216:219],v[40:43],v[184:187]
T a[236:237],v12 offset:24832
v_mul_f32 v116,v116,v32
v_mul_f32 v117,v117,v32
M v[188:191],a[216:219],v[44:47],v[188:191]
T a[238:239],v12 offset:30976
v_mul_f32 v118,v118,v32
v_mul_f32 v119,v119,v32
M v[192:195],a[216:219],v[48:51],v[192:195]
s_add_u32 m0,m0,0xc00
v_mul_f32 v128,v128,v32
v_mul_f32 v129,v129,v32
M v[204:207],a[220:223],v[48:51],v[204:207]
v_mul_f32 v130,v130,v32
v_mul_f32 v131,v131,v32
v_mul_f32 v120,v120,v34
M v[200:203],a[220:223],v[44:47],v[200:203]
s_add_u32 s30,s30,0x3000
v_mul_f32 v121,v121,v34
v_mul_f32 v122,v122,v34
M v[196:199],a[220:223],v[40:43],v[196:199]
v_mul_f32 v123,v123,v34
v_mul_f32 v132,v132,v34
v_mul_f32 v133,v133,v34
M v[208:211],a[224:227],v[40:43],v[208:211]
v_mul_f32 v134,v134,v34
v_mul_f32 v135,v135,v34
C v52,v112,v113
M v[212:215],a[224:227],v[44:47],v[212:215]
L v100,s[8:11],s35 offen nt lds
C v53,v114,v115
C v54,v124,v125
M v[216:219],a[224:227],v[48:51],v[216:219]
s_waitcnt vmcnt(10) lgkmcnt(0)
s_barrier
C v55,v126,v127
M v[228:231],a[228:231],v[48:51],v[228:231]
ds_read_b128 a[216:219],v1
ds_read_b128 a[220:223],v2
C v56,v116,v117
M v[224:227],a[228:231],v[44:47],v[224:227]
ds_read_b128 a[224:227],v1 offset:128
C v57,v118,v119
C v58,v128,v129
M v[220:223],a[228:231],v[40:43],v[220:223]
L v101,s[8:11],s35 offen offset:1024 nt lds
C v59,v130,v131
C v60,v120,v121
M v[232:235],a[232:235],v[40:43],v[232:235]
ds_read_b128 a[228:231],v2 offset:128
C v61,v122,v123
C v62,v132,v133
M v[236:239],a[232:235],v[44:47],v[236:239]
C v63,v134,v135
M v[240:243],a[232:235],v[48:51],v[240:243]
ds_read_b128 a[232:235],v1 offset:256
M v[252:255],a[236:239],v[48:51],v[252:255]
L v102,s[8:11],s35 offen offset:2048 nt lds
M v[248:251],a[236:239],v[44:47],v[248:251]
M v[244:247],a[236:239],v[40:43],v[244:247]
v_accvgpr_mov_b32 a144,a0
v_accvgpr_mov_b32 a145,a1
v_accvgpr_mov_b32 a146,a2
v_accvgpr_mov_b32 a147,a3
v_accvgpr_mov_b32 a148,a4
v_accvgpr_mov_b32 a149,a5
v_accvgpr_mov_b32 a150,a6
v_accvgpr_mov_b32 a151,a7
v_accvgpr_mov_b32 a152,a8
v_accvgpr_mov_b32 a153,a9
v_accvgpr_mov_b32 a154,a10
v_accvgpr_mov_b32 a155,a11
v_accvgpr_mov_b32 a156,a12
v_accvgpr_mov_b32 a157,a13
v_accvgpr_mov_b32 a158,a14
v_accvgpr_mov_b32 a159,a15
v_accvgpr_mov_b32 a160,a16
v_accvgpr_mov_b32 a161,a17
v_accvgpr_mov_b32 a162,a18
v_accvgpr_mov_b32 a163,a19
v_accvgpr_mov_b32 a164,a20
v_accvgpr_mov_b32 a165,a21
v_accvgpr_mov_b32 a166,a22
v_accvgpr_mov_b32 a167,a23
v_accvgpr_mov_b32 a168,a24
v_accvgpr_mov_b32 a169,a25
v_accvgpr_mov_b32 a170,a26
v_accvgpr_mov_b32 a171,a27
v_accvgpr_mov_b32 a172,a28
v_accvgpr_mov_b32 a173,a29
v_accvgpr_mov_b32 a174,a30
v_accvgpr_mov_b32 a175,a31
v_accvgpr_mov_b32 a176,a32
v_accvgpr_mov_b32 a177,a33
v_accvgpr_mov_b32 a178,a34
v_accvgpr_mov_b32 a179,a35
v_accvgpr_mov_b32 a180,a36
v_accvgpr_mov_b32 a181,a37
v_accvgpr_mov_b32 a182,a38
v_accvgpr_mov_b32 a183,a39
v_accvgpr_mov_b32 a184,a40
v_accvgpr_mov_b32 a185,a41
v_accvgpr_mov_b32 a186,a42
v_accvgpr_mov_b32 a187,a43
v_accvgpr_mov_b32 a188,a44
v_accvgpr_mov_b32 a189,a45
v_accvgpr_mov_b32 a190,a46
v_accvgpr_mov_b32 a191,a47
v_accvgpr_mov_b32 a192,a48
v_accvgpr_mov_b32 a193,a49
v_accvgpr_mov_b32 a194,a50
v_accvgpr_mov_b32 a195,a51
v_accvgpr_mov_b32 a196,a52
v_accvgpr_mov_b32 a197,a53
v_accvgpr_mov_b32 a198,a54
v_accvgpr_mov_b32 a199,a55
v_accvgpr_mov_b32 a200,a56
v_accvgpr_mov_b32 a201,a57
v_accvgpr_mov_b32 a202,a58
v_accvgpr_mov_b32 a203,a59
v_accvgpr_mov_b32 a204,a60
v_accvgpr_mov_b32 a205,a61
v_accvgpr_mov_b32 a206,a62
v_accvgpr_mov_b32 a207,a63
v_accvgpr_mov_b32 a208,a64
v_accvgpr_mov_b32 a209,a65
v_accvgpr_mov_b32 a210,a66
v_accvgpr_mov_b32 a211,a67
v_accvgpr_mov_b32 a212,a68
v_accvgpr_mov_b32 a213,a69
v_accvgpr_mov_b32 a214,a70
v_accvgpr_mov_b32 a215,a71
ds_write_b128 v36,v[52:55]
ds_write_b128 v36,v[56:59] offset:1024
ds_write_b128 v36,v[60:63] offset:2048
v_pk_mul_f32 v[136:137],v[136:137],v[30:31]
v_pk_mul_f32 v[138:139],v[138:139],v[30:31]
v_pk_mul_f32 v[148:149],v[148:149],v[30:31]
v_pk_mul_f32 v[150:151],v[150:151],v[30:31]
v_pk_mul_f32 v[140:141],v[140:141],v[32:33]
v_pk_mul_f32 v[142:143],v[142:143],v[32:33]
v_pk_mul_f32 v[152:153],v[152:153],v[32:33]
v_pk_mul_f32 v[154:155],v[154:155],v[32:33]
v_pk_mul_f32 v[144:145],v[144:145],v[34:35]
v_pk_mul_f32 v[146:147],v[146:147],v[34:35]
v_pk_mul_f32 v[156:157],v[156:157],v[34:35]
v_pk_mul_f32 v[158:159],v[158:159],v[34:35]
C v64,v136,v137
C v65,v138,v139
C v66,v148,v149
C v67,v150,v151
ds_write_b128 v36,v[64:67] offset:3072
C v68,v140,v141
C v69,v142,v143
C v70,v152,v153
C v71,v154,v155
ds_write_b128 v36,v[68:71] offset:4096
C v72,v144,v145
C v73,v146,v147
C v74,v156,v157
C v75,v158,v159
ds_write_b128 v36,v[72:75] offset:5120
v_pk_mul_f32 v[160:161],v[160:161],v[30:31]
v_pk_mul_f32 v[162:163],v[162:163],v[30:31]
v_pk_mul_f32 v[172:173],v[172:173],v[30:31]
v_pk_mul_f32 v[174:175],v[174:175],v[30:31]
v_pk_mul_f32 v[164:165],v[164:165],v[32:33]
v_pk_mul_f32 v[166:167],v[166:167],v[32:33]
v_pk_mul_f32 v[176:177],v[176:177],v[32:33]
v_pk_mul_f32 v[178:179],v[178:179],v[32:33]
v_pk_mul_f32 v[168:169],v[168:169],v[34:35]
v_pk_mul_f32 v[170:171],v[170:171],v[34:35]
v_pk_mul_f32 v[180:181],v[180:181],v[34:35]
v_pk_mul_f32 v[182:183],v[182:183],v[34:35]
C v52,v160,v161
C v53,v162,v163
C v54,v172,v173
C v55,v174,v175
ds_write_b128 v36,v[52:55] offset:6144
C v56,v164,v165
C v57,v166,v167
C v58,v176,v177
C v59,v178,v179
ds_write_b128 v36,v[56:59] offset:7168
C v60,v168,v169
C v61,v170,v171
C v62,v180,v181
C v63,v182,v183
ds_write_b128 v36,v[60:63] offset:8192
v_pk_mul_f32 v[184:185],v[184:185],v[30:31]
v_pk_mul_f32 v[186:187],v[186:187],v[30:31]
v_pk_mul_f32 v[196:197],v[196:197],v[30:31]
v_pk_mul_f32 v[198:199],v[198:199],v[30:31]
v_pk_mul_f32 v[188:189],v[188:189],v[32:33]
v_pk_mul_f32 v[190:191],v[190:191],v[32:33]
v_pk_mul_f32 v[200:201],v[200:201],v[32:33]
v_pk_mul_f32 v[202:203],v[202:203],v[32:33]
v_pk_mul_f32 v[192:193],v[192:193],v[34:35]
v_pk_mul_f32 v[194:195],v[194:195],v[34:35]
v_pk_mul_f32 v[204:205],v[204:205],v[34:35]
v_pk_mul_f32 v[206:207],v[206:207],v[34:35]
C v64,v184,v185
C v65,v186,v187
C v66,v196,v197
C v67,v198,v199
ds_write_b128 v36,v[64:67] offset:9216
C v68,v188,v189
C v69,v190,v191
C v70,v200,v201
C v71,v202,v203
ds_write_b128 v36,v[68:71] offset:10240
C v72,v192,v193
C v73,v194,v195
C v74,v204,v205
C v75,v206,v207
ds_write_b128 v36,v[72:75] offset:11264
v_pk_mul_f32 v[208:209],v[208:209],v[30:31]
v_pk_mul_f32 v[210:211],v[210:211],v[30:31]
v_pk_mul_f32 v[220:221],v[220:221],v[30:31]
v_pk_mul_f32 v[222:223],v[222:223],v[30:31]
v_pk_mul_f32 v[212:213],v[212:213],v[32:33]
v_pk_mul_f32 v[214:215],v[214:215],v[32:33]
v_pk_mul_f32 v[224:225],v[224:225],v[32:33]
v_pk_mul_f32 v[226:227],v[226:227],v[32:33]
v_pk_mul_f32 v[216:217],v[216:217],v[34:35]
v_pk_mul_f32 v[218:219],v[218:219],v[34:35]
v_pk_mul_f32 v[228:229],v[228:229],v[34:35]
v_pk_mul_f32 v[230:231],v[230:231],v[34:35]
C v52,v208,v209
C v53,v210,v211
C v54,v220,v221
C v55,v222,v223
ds_write_b128 v36,v[52:55] offset:12288
C v56,v212,v213
C v57,v214,v215
C v58,v224,v225
C v59,v226,v227
ds_write_b128 v36,v[56:59] offset:13312
C v60,v216,v217
C v61,v218,v219
C v62,v228,v229
C v63,v230,v231
ds_write_b128 v36,v[60:63] offset:14336
v_pk_mul_f32 v[232:233],v[232:233],v[30:31]
v_pk_mul_f32 v[234:235],v[234:235],v[30:31]
v_pk_mul_f32 v[244:245],v[244:245],v[30:31]
v_pk_mul_f32 v[246:247],v[246:247],v[30:31]
v_pk_mul_f32 v[236:237],v[236:237],v[32:33]
v_pk_mul_f32 v[238:239],v[238:239],v[32:33]
v_pk_mul_f32 v[248:249],v[248:249],v[32:33]
v_pk_mul_f32 v[250:251],v[250:251],v[32:33]
v_pk_mul_f32 v[240:241],v[240:241],v[34:35]
v_pk_mul_f32 v[242:243],v[242:243],v[34:35]
v_pk_mul_f32 v[252:253],v[252:253],v[34:35]
v_pk_mul_f32 v[254:255],v[254:255],v[34:35]
C v64,v232,v233
C v65,v234,v235
C v66,v244,v245
C v67,v246,v247
ds_write_b128 v36,v[64:67] offset:15360
C v68,v236,v237
C v69,v238,v239
C v70,v248,v249
C v71,v250,v251
ds_write_b128 v36,v[68:71] offset:16384
C v72,v240,v241
C v73,v242,v243
C v74,v252,v253
C v75,v254,v255
ds_write_b128 v36,v[72:75] offset:17408
s_waitcnt lgkmcnt(0)
s_barrier
M v[52:55],a[216:219],a[144:147],0
ds_read_b128 a[236:239],v2 offset:256
ds_read_b128 a[0:3],v37
M v[56:59],a[216:219],a[148:151],0
ds_read_b128 a[4:7],v37 offset:1024
ds_read_b128 a[8:11],v37 offset:2048
M v[60:63],a[216:219],a[152:155],0
ds_read_b128 a[12:15],v37 offset:3072
ds_read_b128 a[16:19],v37 offset:4096
M v[60:63],a[220:223],a[164:167],v[60:63]
ds_read_b128 a[216:219],v1 offset:6144
ds_read_b128 a[20:23],v37 offset:5120
M v[56:59],a[220:223],a[160:163],v[56:59]
ds_read_b128 a[24:27],v37 offset:6144
ds_read_b128 a[28:31],v37 offset:7168
M v[52:55],a[220:223],a[156:159],v[52:55]
ds_read_b128 a[32:35],v37 offset:8192
ds_read_b128 a[36:39],v37 offset:9216
M v[52:55],a[224:227],a[168:171],v[52:55]
ds_read_b128 a[220:223],v2 offset:6144
ds_read_b128 a[40:43],v37 offset:10240
M v[56:59],a[224:227],a[172:175],v[56:59]
ds_read_b128 a[44:47],v37 offset:11264
ds_read_b128 a[48:51],v37 offset:12288
M v[60:63],a[224:227],a[176:179],v[60:63]
ds_read_b128 a[52:55],v37 offset:13312
s_waitcnt lgkmcnt(15)
M v[60:63],a[228:231],a[188:191],v[60:63]
ds_read_b128 a[224:227],v1 offset:6272
ds_read_b128 a[56:59],v37 offset:14336
M v[56:59],a[228:231],a[184:187],v[56:59]
ds_read_b128 a[60:63],v37 offset:15360
ds_read_b128 a[64:67],v37 offset:16384
M v[52:55],a[228:231],a[180:183],v[52:55]
ds_read_b128 a[68:71],v37 offset:17408
ds_read_b128 a[72:75],v38
M v[52:55],a[232:235],a[192:195],v[52:55]
ds_read_b128 a[228:231],v2 offset:6272
ds_read_b128 a[76:79],v38 offset:1024
M v[56:59],a[232:235],a[196:199],v[56:59]
ds_read_b128 a[80:83],v38 offset:2048
ds_read_b128 a[84:87],v38 offset:3072
M v[60:63],a[232:235],a[200:203],v[60:63]
ds_read_b128 a[88:91],v38 offset:4096
ds_read_b128 a[92:95],v38 offset:5120
M v[60:63],a[236:239],a[212:215],v[60:63]
ds_read_b128 a[232:235],v1 offset:6400
ds_read_b128 a[96:99],v38 offset:6144
M v[56:59],a[236:239],a[208:211],v[56:59]
ds_read_b128 a[100:103],v38 offset:7168
ds_read_b128 a[104:107],v38 offset:8192
M v[52:55],a[236:239],a[204:207],v[52:55]
ds_read_b128 a[108:111],v38 offset:9216
s_waitcnt lgkmcnt(15)
M v[64:67],a[216:219],a[144:147],0
ds_read_b128 a[236:239],v2 offset:6400
ds_read_b128 a[112:115],v38 offset:10240
M v[68:71],a[216:219],a[148:151],0
ds_read_b128 a[116:119],v38 offset:11264
ds_read_b128 a[120:123],v38 offset:12288
M v[72:75],a[216:219],a[152:155],0
ds_read_b128 a[124:127],v38 offset:13312
ds_read_b128 a[128:131],v38 offset:14336
M v[72:75],a[220:223],a[164:167],v[72:75]
ds_read_b128 a[132:135],v38 offset:15360
ds_read_b128 a[136:139],v38 offset:16384
M v[68:71],a[220:223],a[160:163],v[68:71]
ds_read_b128 a[140:143],v38 offset:17408
M v[64:67],a[220:223],a[156:159],v[64:67]
M v[64:67],a[224:227],a[168:171],v[64:67]
M v[68:71],a[224:227],a[172:175],v[68:71]
M v[72:75],a[224:227],a[176:179],v[72:75]
s_waitcnt vmcnt(6) lgkmcnt(0)
s_barrier
M v[72:75],a[228:231],a[188:191],v[72:75]
ds_read_b128 a[216:219],v1 offset:24576
ds_read_b128 a[220:223],v2 offset:24576
M v[68:71],a[228:231],a[184:187],v[68:71]
ds_read_b128 a[224:227],v1 offset:24704
s_add_u32 m0,s28,0x12000
M v[64:67],a[228:231],a[180:183],v[64:67]
s_add_u32 s35,s29,0xc00
L v100,s[4:7],s29 offen nt lds
M v[64:67],a[232:235],a[192:195],v[64:67]
ds_read_b128 a[228:231],v2 offset:24704
L v101,s[4:7],s29 offen offset:1024 nt lds
M v[68:71],a[232:235],a[196:199],v[68:71]
M v[72:75],a[232:235],a[200:203],v[72:75]
ds_read_b128 a[232:235],v1 offset:24832
M v[72:75],a[236:239],a[212:215],v[72:75]
M v[68:71],a[236:239],a[208:211],v[68:71]
M v[64:67],a[236:239],a[204:207],v[64:67]
v_max3_f32 v19,v52,v53,v54
v_max3_f32 v20,v56,v57,v58
v_max3_f32 v21,v60,v61,v62
s_nop 4
v_max3_f32 v19,v19,v55,v64
v_max3_f32 v20,v20,v59,v68
v_max3_f32 v21,v21,v63,v72
v_max3_f32 v19,v19,v65,v66
v_max3_f32 v20,v20,v69,v70
v_max3_f32 v21,v21,v73,v74
v_max_f32 v19,v19,v67
v_max_f32 v20,v20,v71
v_max_f32 v21,v21,v75
v_mov_b32 v25,v19
v_mov_b32 v26,v20
v_mov_b32 v27,v21
v_permlane32_swap_b32 v19,v25
v_permlane32_swap_b32 v20,v26
v_permlane32_swap_b32 v21,v27
v_max_f32 v19,v19,v25
v_max_f32 v20,v20,v26
v_max_f32 v21,v21,v27
v_mov_b32 v25,v19
v_mov_b32 v26,v20
v_mov_b32 v27,v21
v_permlane16_swap_b32 v19,v25
v_permlane16_swap_b32 v20,v26
v_permlane16_swap_b32 v21,v27
v_max_f32 v19,v19,v25
v_max_f32 v20,v20,v26
v_max_f32 v21,v21,v27
v_mul_f32 v19,s37,v19
v_mul_f32 v20,s37,v20
v_mul_f32 v21,s37,v21
v_mov_b32 v22,0
v_mov_b32 v23,0
v_mov_b32 v24,0
v_fma_f32 v52,v52,s37,-v19
v_fma_f32 v53,v53,s37,-v19
v_fma_f32 v54,v54,s37,-v19
v_fma_f32 v55,v55,s37,-v19
v_fma_f32 v56,v56,s37,-v20
v_fma_f32 v57,v57,s37,-v20
v_fma_f32 v58,v58,s37,-v20
v_fma_f32 v59,v59,s37,-v20
v_fma_f32 v60,v60,s37,-v21
v_fma_f32 v61,v61,s37,-v21
v_fma_f32 v62,v62,s37,-v21
v_fma_f32 v63,v63,s37,-v21
v_fma_f32 v64,v64,s37,-v19
v_fma_f32 v65,v65,s37,-v19
v_fma_f32 v66,v66,s37,-v19
v_fma_f32 v67,v67,s37,-v19
v_fma_f32 v68,v68,s37,-v20
v_fma_f32 v69,v69,s37,-v20
v_fma_f32 v70,v70,s37,-v20
v_fma_f32 v71,v71,s37,-v20
v_fma_f32 v72,v72,s37,-v21
v_fma_f32 v73,v73,s37,-v21
v_fma_f32 v74,v74,s37,-v21
v_fma_f32 v75,v75,s37,-v21
s_waitcnt lgkmcnt(2)
M v[76:79],a[216:219],a[144:147],0
ds_read_b128 a[236:239],v2 offset:24832
L v102,s[4:7],s29 offen offset:2048 nt lds
v_exp_f32 v52,v52
M v[80:83],a[216:219],a[148:151],0
v_exp_f32 v56,v56
v_exp_f32 v60,v60
M v[84:87],a[216:219],a[152:155],0
s_add_u32 m0,m0,0xc00
v_exp_f32 v53,v53
M v[84:87],a[220:223],a[164:167],v[84:87]
ds_read_b128 a[216:219],v1 offset:30720
v_exp_f32 v57,v57
M v[80:83],a[220:223],a[160:163],v[80:83]
s_add_u32 s29,s29,0x3000
v_exp_f32 v61,v61
v_add_f32 v22,v22,v52
M v[76:79],a[220:223],a[156:159],v[76:79]
L v100,s[4:7],s35 offen nt lds
v_add_f32 v23,v23,v56
v_add_f32 v24,v24,v60
M v[76:79],a[224:227],a[168:171],v[76:79]
ds_read_b128 a[220:223],v2 offset:30720
v_exp_f32 v54,v54
M v[80:83],a[224:227],a[172:175],v[80:83]
L v101,s[4:7],s35 offen offset:1024 nt lds
v_exp_f32 v58,v58
M v[84:87],a[224:227],a[176:179],v[84:87]
v_exp_f32 v62,v62
v_add_f32 v22,v22,v53
s_waitcnt lgkmcnt(2)
M v[84:87],a[228:231],a[188:191],v[84:87]
ds_read_b128 a[224:227],v1 offset:30848
v_add_f32 v23,v23,v57
v_add_f32 v24,v24,v61
C v40,v52,v53
M v[80:83],a[228:231],a[184:187],v[80:83]
L v102,s[4:7],s35 offen offset:2048 nt lds
C v44,v56,v57
C v48,v60,v61
M v[76:79],a[228:231],a[180:183],v[76:79]
s_add_u32 m0,s28,0
v_exp_f32 v55,v55
M v[76:79],a[232:235],a[192:195],v[76:79]
ds_read_b128 a[228:231],v2 offset:30848
v_exp_f32 v59,v59
M v[80:83],a[232:235],a[196:199],v[80:83]
s_add_u32 s35,s30,0xc00
v_exp_f32 v63,v63
v_add_f32 v22,v22,v54
M v[84:87],a[232:235],a[200:203],v[84:87]
v_add_f32 v23,v23,v58
v_add_f32 v24,v24,v62
v_exp_f32 v64,v64
M v[84:87],a[236:239],a[212:215],v[84:87]
ds_read_b128 a[232:235],v1 offset:30976
L v100,s[8:11],s30 offen nt lds
v_exp_f32 v68,v68
M v[80:83],a[236:239],a[208:211],v[80:83]
v_exp_f32 v72,v72
v_add_f32 v22,v22,v55
v_add_f32 v23,v23,v59
M v[76:79],a[236:239],a[204:207],v[76:79]
v_add_f32 v24,v24,v63
C v41,v54,v55
C v45,v58,v59
s_waitcnt lgkmcnt(2)
M v[88:91],a[216:219],a[144:147],0
ds_read_b128 a[236:239],v2 offset:30976
L v101,s[8:11],s30 offen offset:1024 nt lds
C v49,v62,v63
M v[92:95],a[216:219],a[148:151],0
v_exp_f32 v65,v65
v_exp_f32 v69,v69
M v[96:99],a[216:219],a[152:155],0
L v102,s[8:11],s30 offen offset:2048 nt lds
v_exp_f32 v73,v73
v_add_f32 v22,v22,v64
M v[96:99],a[220:223],a[164:167],v[96:99]
s_add_u32 m0,m0,0xc00
v_add_f32 v23,v23,v68
v_add_f32 v24,v24,v72
M v[92:95],a[220:223],a[160:163],v[92:95]
v_exp_f32 v66,v66
v_exp_f32 v70,v70
M v[88:91],a[220:223],a[156:159],v[88:91]
s_add_u32 s30,s30,0x3000
v_exp_f32 v74,v74
v_add_f32 v22,v22,v65
M v[88:91],a[224:227],a[168:171],v[88:91]
L v100,s[8:11],s35 offen nt lds
v_add_f32 v23,v23,v69
v_add_f32 v24,v24,v73
C v42,v64,v65
M v[92:95],a[224:227],a[172:175],v[92:95]
C v46,v68,v69
C v50,v72,v73
v_exp_f32 v67,v67
M v[96:99],a[224:227],a[176:179],v[96:99]
s_waitcnt vmcnt(10) lgkmcnt(0)
s_barrier
v_exp_f32 v71,v71
M v[96:99],a[228:231],a[188:191],v[96:99]
T a[216:217],v9
T a[218:219],v9 offset:6144
v_exp_f32 v75,v75
M v[92:95],a[228:231],a[184:187],v[92:95]
T a[220:221],v10
T a[222:223],v10 offset:6144
v_add_f32 v22,v22,v66
v_add_f32 v23,v23,v70
M v[88:91],a[228:231],a[180:183],v[88:91]
T a[224:225],v11
T a[226:227],v11 offset:6144
v_add_f32 v24,v24,v74
C v43,v66,v67
M v[88:91],a[232:235],a[192:195],v[88:91]
T a[228:229],v12
T a[230:231],v12 offset:6144
C v47,v70,v71
C v51,v74,v75
M v[92:95],a[232:235],a[196:199],v[92:95]
L v101,s[8:11],s35 offen offset:1024 nt lds
v_add_f32 v22,v22,v67
v_add_f32 v23,v23,v71
v_add_f32 v24,v24,v75
M v[96:99],a[232:235],a[200:203],v[96:99]
T a[232:233],v9 offset:128
T a[234:235],v9 offset:6272
M v[96:99],a[236:239],a[212:215],v[96:99]
L v102,s[8:11],s35 offen offset:2048 nt lds
M v[92:95],a[236:239],a[208:211],v[92:95]
M v[88:91],a[236:239],a[204:207],v[88:91]
s_waitcnt lgkmcnt(4)
M v[112:115],a[216:219],v[40:43],0
T a[236:237],v10 offset:128
s_add_u32 m0,s28,0x6000
M v[116:119],a[216:219],v[44:47],0
T a[238:239],v10 offset:6272
M v[120:123],a[216:219],v[48:51],0
M v[132:135],a[220:223],v[48:51],0
T a[216:217],v11 offset:128
s_add_u32 s35,s29,0xc00
v_fma_f32 v76,v76,s37,-v19
M v[128:131],a[220:223],v[44:47],0
T a[218:219],v11 offset:6272
v_fma_f32 v77,v77,s37,-v19
v_fma_f32 v78,v78,s37,-v19
M v[124:127],a[220:223],v[40:43],0
v_fma_f32 v79,v79,s37,-v19
v_fma_f32 v80,v80,s37,-v20
v_fma_f32 v81,v81,s37,-v20
M v[136:139],a[224:227],v[40:43],0
T a[220:221],v12 offset:128
v_max3_f32 v28,v76,v77,v78
v_fma_f32 v82,v82,s37,-v20
M v[140:143],a[224:227],v[44:47],0
T a[222:223],v12 offset:6272
L v100,s[4:7],s29 offen nt lds
v_fma_f32 v83,v83,s37,-v20
M v[144:147],a[224:227],v[48:51],0
v_max3_f32 v28,v28,v79,v80
v_fma_f32 v84,v84,s37,-v21
s_waitcnt lgkmcnt(4)
M v[156:159],a[228:231],v[48:51],0
T a[224:225],v9 offset:256
v_fma_f32 v85,v85,s37,-v21
v_max3_f32 v28,v28,v81,v82
M v[152:155],a[228:231],v[44:47],0
T a[226:227],v9 offset:6400
v_fma_f32 v86,v86,s37,-v21
v_fma_f32 v87,v87,s37,-v21
M v[148:151],a[228:231],v[40:43],0
L v101,s[4:7],s29 offen offset:1024 nt lds
v_max3_f32 v28,v28,v83,v84
v_max3_f32 v28,v28,v85,v86
M v[160:163],a[232:235],v[40:43],0
T a[228:229],v10 offset:256
v_max_f32 v28,v28,v87
v_fma_f32 v88,v88,s37,-v19
M v[164:167],a[232:235],v[44:47],0
T a[230:231],v10 offset:6400
v_fma_f32 v89,v89,s37,-v19
v_fma_f32 v90,v90,s37,-v19
M v[168:171],a[232:235],v[48:51],0
v_fma_f32 v91,v91,s37,-v19
v_fma_f32 v92,v92,s37,-v20
v_fma_f32 v93,v93,s37,-v20
M v[180:183],a[236:239],v[48:51],0
T a[232:233],v11 offset:256
L v102,s[4:7],s29 offen offset:2048 nt lds
v_max3_f32 v28,v28,v88,v89
M v[176:179],a[236:239],v[44:47],0
T a[234:235],v11 offset:6400
v_fma_f32 v94,v94,s37,-v20
v_fma_f32 v95,v95,s37,-v20
M v[172:175],a[236:239],v[40:43],0
v_max3_f32 v28,v28,v90,v91
v_fma_f32 v96,v96,s37,-v21
s_waitcnt lgkmcnt(4)
M v[184:187],a[216:219],v[40:43],0
T a[236:237],v12 offset:256
v_fma_f32 v97,v97,s37,-v21
v_max3_f32 v28,v28,v92,v93
M v[188:191],a[216:219],v[44:47],0
T a[238:239],v12 offset:6400
s_add_u32 m0,m0,0xc00
v_fma_f32 v98,v98,s37,-v21
M v[192:195],a[216:219],v[48:51],0
v_fma_f32 v99,v99,s37,-v21
v_max3_f32 v28,v28,v94,v95
v_max3_f32 v28,v28,v96,v97
M v[204:207],a[220:223],v[48:51],0
v_max3_f32 v28,v28,v98,v99
M v[200:203],a[220:223],v[44:47],0
s_add_u32 s29,s29,0x3000
M v[196:199],a[220:223],v[40:43],0
M v[208:211],a[224:227],v[40:43],0
L v100,s[4:7],s35 offen nt lds
M v[212:215],a[224:227],v[44:47],0
M v[216:219],a[224:227],v[48:51],0
s_waitcnt vmcnt(10) lgkmcnt(0)
s_barrier
M v[228:231],a[228:231],v[48:51],0
ds_read_b128 a[216:219],v3 offset:24576
ds_read_b128 a[220:223],v4 offset:24576
M v[224:227],a[228:231],v[44:47],0
ds_read_b128 a[224:227],v3 offset:24704
M v[220:223],a[228:231],v[40:43],0
L v101,s[4:7],s35 offen offset:1024 nt lds
M v[232:235],a[232:235],v[40:43],0
ds_read_b128 a[228:231],v4 offset:24704
M v[236:239],a[232:235],v[44:47],0
M v[240:243],a[232:235],v[48:51],0
ds_read_b128 a[232:235],v3 offset:24832
M v[252:255],a[236:239],v[48:51],0
L v102,s[4:7],s35 offen offset:2048 nt lds
M v[248:251],a[236:239],v[44:47],0
M v[244:247],a[236:239],v[40:43],0
s_mov_b32 s36,6
.p2align 3
C1_loop4:
v_cmp_lt_f32 vcc,0x41000000,v28
s_cbranch_vccnz C1_41_r
C1_41_b:
s_waitcnt lgkmcnt(2)
M v[52:55],a[216:219],a[144:147],0
ds_read_b128 a[236:239],v4 offset:24832
s_add_u32 m0,s28,0xc000
v_exp_f32 v76,v76
M v[56:59],a[216:219],a[148:151],0
v_exp_f32 v80,v80
v_exp_f32 v84,v84
M v[60:63],a[216:219],a[152:155],0
s_add_u32 s35,s30,0xc00
v_exp_f32 v77,v77
M v[60:63],a[220:223],a[164:167],v[60:63]
ds_read_b128 a[216:219],v3 offset:30720
v_exp_f32 v81,v81
M v[56:59],a[220:223],a[160:163],v[56:59]
v_exp_f32 v85,v85
v_add_f32 v22,v22,v76
v_add_f32 v23,v23,v80
M v[52:55],a[220:223],a[156:159],v[52:55]
L v100,s[8:11],s30 offen nt lds
v_add_f32 v24,v24,v84
v_exp_f32 v78,v78
M v[52:55],a[224:227],a[168:171],v[52:55]
ds_read_b128 a[220:223],v4 offset:30720
v_exp_f32 v82,v82
M v[56:59],a[224:227],a[172:175],v[56:59]
v_exp_f32 v86,v86
v_add_f32 v22,v22,v77
v_add_f32 v23,v23,v81
M v[60:63],a[224:227],a[176:179],v[60:63]
v_add_f32 v24,v24,v85
C v40,v76,v77
C v44,v80,v81
s_waitcnt lgkmcnt(2)
M v[60:63],a[228:231],a[188:191],v[60:63]
ds_read_b128 a[224:227],v3 offset:30848
L v101,s[8:11],s30 offen offset:1024 nt lds
C v48,v84,v85
M v[56:59],a[228:231],a[184:187],v[56:59]
v_exp_f32 v79,v79
v_exp_f32 v83,v83
M v[52:55],a[228:231],a[180:183],v[52:55]
v_exp_f32 v87,v87
v_add_f32 v22,v22,v78
v_add_f32 v23,v23,v82
M v[52:55],a[232:235],a[192:195],v[52:55]
ds_read_b128 a[228:231],v4 offset:30848
L v102,s[8:11],s30 offen offset:2048 nt lds
v_add_f32 v24,v24,v86
M v[56:59],a[232:235],a[196:199],v[56:59]
v_exp_f32 v88,v88
v_exp_f32 v92,v92
M v[60:63],a[232:235],a[200:203],v[60:63]
v_exp_f32 v96,v96
v_add_f32 v22,v22,v79
v_add_f32 v23,v23,v83
M v[60:63],a[236:239],a[212:215],v[60:63]
ds_read_b128 a[232:235],v3 offset:30976
s_add_u32 m0,m0,0xc00
v_add_f32 v24,v24,v87
C v41,v78,v79
M v[56:59],a[236:239],a[208:211],v[56:59]
C v45,v82,v83
C v49,v86,v87
v_exp_f32 v89,v89
M v[52:55],a[236:239],a[204:207],v[52:55]
v_exp_f32 v93,v93
s_waitcnt lgkmcnt(2)
M v[64:67],a[216:219],a[144:147],0
ds_read_b128 a[236:239],v4 offset:30976
v_exp_f32 v97,v97
v_add_f32 v22,v22,v88
M v[68:71],a[216:219],a[148:151],0
s_add_u32 s30,s30,0x3000
v_add_f32 v23,v23,v92
v_add_f32 v24,v24,v96
M v[72:75],a[216:219],a[152:155],0
v_exp_f32 v90,v90
v_exp_f32 v94,v94
M v[72:75],a[220:223],a[164:167],v[72:75]
L v100,s[8:11],s35 offen nt lds
v_exp_f32 v98,v98
v_add_f32 v22,v22,v89
M v[68:71],a[220:223],a[160:163],v[68:71]
v_add_f32 v23,v23,v93
v_add_f32 v24,v24,v97
C v42,v88,v89
C v46,v92,v93
M v[64:67],a[220:223],a[156:159],v[64:67]
C v50,v96,v97
v_exp_f32 v91,v91
M v[64:67],a[224:227],a[168:171],v[64:67]
L v101,s[8:11],s35 offen offset:1024 nt lds
v_exp_f32 v95,v95
M v[68:71],a[224:227],a[172:175],v[68:71]
v_exp_f32 v99,v99
v_add_f32 v22,v22,v90
v_add_f32 v23,v23,v94
M v[72:75],a[224:227],a[176:179],v[72:75]
s_waitcnt vmcnt(11) lgkmcnt(0)
s_barrier
v_add_f32 v24,v24,v98
C v43,v90,v91
M v[72:75],a[228:231],a[188:191],v[72:75]
T a[216:217],v5
T a[218:219],v5 offset:6144
C v47,v94,v95
C v51,v98,v99
M v[68:71],a[228:231],a[184:187],v[68:71]
T a[220:221],v6
T a[222:223],v6 offset:6144
v_add_f32 v22,v22,v91
v_add_f32 v23,v23,v95
M v[64:67],a[228:231],a[180:183],v[64:67]
T a[224:225],v7
T a[226:227],v7 offset:6144
v_add_f32 v24,v24,v99
M v[64:67],a[232:235],a[192:195],v[64:67]
T a[228:229],v8
T a[230:231],v8 offset:6144
M v[68:71],a[232:235],a[196:199],v[68:71]
L v102,s[8:11],s35 offen offset:2048 nt lds
M v[72:75],a[232:235],a[200:203],v[72:75]
T a[232:233],v5 offset:128
T a[234:235],v5 offset:6272
M v[72:75],a[236:239],a[212:215],v[72:75]
M v[68:71],a[236:239],a[208:211],v[68:71]
M v[64:67],a[236:239],a[204:207],v[64:67]
s_waitcnt lgkmcnt(4)
M v[112:115],a[216:219],v[40:43],v[112:115]
T a[236:237],v6 offset:128
s_add_u32 m0,s28,0x12000
M v[116:119],a[216:219],v[44:47],v[116:119]
T a[238:239],v6 offset:6272
M v[120:123],a[216:219],v[48:51],v[120:123]
M v[132:135],a[220:223],v[48:51],v[132:135]
T a[216:217],v7 offset:128
s_add_u32 s35,s29,0xc00
v_fma_f32 v52,v52,s37,-v19
M v[128:131],a[220:223],v[44:47],v[128:131]
T a[218:219],v7 offset:6272
v_fma_f32 v53,v53,s37,-v19
v_fma_f32 v54,v54,s37,-v19
M v[124:127],a[220:223],v[40:43],v[124:127]
v_fma_f32 v55,v55,s37,-v19
v_fma_f32 v56,v56,s37,-v20
v_fma_f32 v57,v57,s37,-v20
M v[136:139],a[224:227],v[40:43],v[136:139]
T a[220:221],v8 offset:128
v_max3_f32 v28,v52,v53,v54
v_fma_f32 v58,v58,s37,-v20
M v[140:143],a[224:227],v[44:47],v[140:143]
T a[222:223],v8 offset:6272
L v100,s[4:7],s29 offen nt lds
v_fma_f32 v59,v59,s37,-v20
M v[144:147],a[224:227],v[48:51],v[144:147]
v_max3_f32 v28,v28,v55,v56
v_fma_f32 v60,v60,s37,-v21
s_waitcnt lgkmcnt(4)
M v[156:159],a[228:231],v[48:51],v[156:159]
T a[224:225],v5 offset:256
v_fma_f32 v61,v61,s37,-v21
v_max3_f32 v28,v28,v57,v58
M v[152:155],a[228:231],v[44:47],v[152:155]
T a[226:227],v5 offset:6400
v_fma_f32 v62,v62,s37,-v21
v_fma_f32 v63,v63,s37,-v21
M v[148:151],a[228:231],v[40:43],v[148:151]
L v101,s[4:7],s29 offen offset:1024 nt lds
v_max3_f32 v28,v28,v59,v60
v_max3_f32 v28,v28,v61,v62
M v[160:163],a[232:235],v[40:43],v[160:163]
T a[228:229],v6 offset:256
v_max_f32 v28,v28,v63
v_fma_f32 v64,v64,s37,-v19
M v[164:167],a[232:235],v[44:47],v[164:167]
T a[230:231],v6 offset:6400
v_fma_f32 v65,v65,s37,-v19
v_fma_f32 v66,v66,s37,-v19
M v[168:171],a[232:235],v[48:51],v[168:171]
v_fma_f32 v67,v67,s37,-v19
v_fma_f32 v68,v68,s37,-v20
v_fma_f32 v69,v69,s37,-v20
M v[180:183],a[236:239],v[48:51],v[180:183]
T a[232:233],v7 offset:256
L v102,s[4:7],s29 offen offset:2048 nt lds
v_max3_f32 v28,v28,v64,v65
M v[176:179],a[236:239],v[44:47],v[176:179]
T a[234:235],v7 offset:6400
v_fma_f32 v70,v70,s37,-v20
v_fma_f32 v71,v71,s37,-v20
M v[172:175],a[236:239],v[40:43],v[172:175]
v_max3_f32 v28,v28,v66,v67
v_fma_f32 v72,v72,s37,-v21
s_waitcnt lgkmcnt(4)
M v[184:187],a[216:219],v[40:43],v[184:187]
T a[236:237],v8 offset:256
v_fma_f32 v73,v73,s37,-v21
v_max3_f32 v28,v28,v68,v69
M v[188:191],a[216:219],v[44:47],v[188:191]
T a[238:239],v8 offset:6400
s_add_u32 m0,m0,0xc00
v_fma_f32 v74,v74,s37,-v21
M v[192:195],a[216:219],v[48:51],v[192:195]
v_fma_f32 v75,v75,s37,-v21
v_max3_f32 v28,v28,v70,v71
v_max3_f32 v28,v28,v72,v73
M v[204:207],a[220:223],v[48:51],v[204:207]
v_max3_f32 v28,v28,v74,v75
M v[200:203],a[220:223],v[44:47],v[200:203]
s_add_u32 s29,s29,0x3000
M v[196:199],a[220:223],v[40:43],v[196:199]
M v[208:211],a[224:227],v[40:43],v[208:211]
L v100,s[4:7],s35 offen nt lds
M v[212:215],a[224:227],v[44:47],v[212:215]
M v[216:219],a[224:227],v[48:51],v[216:219]
s_waitcnt vmcnt(10) lgkmcnt(0)
s_barrier
M v[228:231],a[228:231],v[48:51],v[228:231]
ds_read_b128 a[216:219],v1 offset:24576
ds_read_b128 a[220:223],v2 offset:24576
M v[224:227],a[228:231],v[44:47],v[224:227]
ds_read_b128 a[224:227],v1 offset:24704
M v[220:223],a[228:231],v[40:43],v[220:223]
L v101,s[4:7],s35 offen offset:1024 nt lds
M v[232:235],a[232:235],v[40:43],v[232:235]
ds_read_b128 a[228:231],v2 offset:24704
M v[236:239],a[232:235],v[44:47],v[236:239]
M v[240:243],a[232:235],v[48:51],v[240:243]
ds_read_b128 a[232:235],v1 offset:24832
M v[252:255],a[236:239],v[48:51],v[252:255]
L v102,s[4:7],s35 offen offset:2048 nt lds
M v[248:251],a[236:239],v[44:47],v[248:251]
M v[244:247],a[236:239],v[40:43],v[244:247]
v_cmp_lt_f32 vcc,0x41000000,v28
s_cbranch_vccnz C1_43_r
C1_43_b:
s_waitcnt lgkmcnt(2)
M v[76:79],a[216:219],a[144:147],0
ds_read_b128 a[236:239],v2 offset:24832
s_add_u32 m0,s28,0
v_exp_f32 v52,v52
M v[80:83],a[216:219],a[148:151],0
v_exp_f32 v56,v56
v_exp_f32 v60,v60
M v[84:87],a[216:219],a[152:155],0
s_add_u32 s35,s30,0xc00
v_exp_f32 v53,v53
M v[84:87],a[220:223],a[164:167],v[84:87]
ds_read_b128 a[216:219],v1 offset:30720
v_exp_f32 v57,v57
M v[80:83],a[220:223],a[160:163],v[80:83]
v_exp_f32 v61,v61
v_add_f32 v22,v22,v52
v_add_f32 v23,v23,v56
M v[76:79],a[220:223],a[156:159],v[76:79]
L v100,s[8:11],s30 offen nt lds
v_add_f32 v24,v24,v60
v_exp_f32 v54,v54
M v[76:79],a[224:227],a[168:171],v[76:79]
ds_read_b128 a[220:223],v2 offset:30720
v_exp_f32 v58,v58
M v[80:83],a[224:227],a[172:175],v[80:83]
v_exp_f32 v62,v62
v_add_f32 v22,v22,v53
v_add_f32 v23,v23,v57
M v[84:87],a[224:227],a[176:179],v[84:87]
v_add_f32 v24,v24,v61
C v40,v52,v53
C v44,v56,v57
s_waitcnt lgkmcnt(2)
M v[84:87],a[228:231],a[188:191],v[84:87]
ds_read_b128 a[224:227],v1 offset:30848
L v101,s[8:11],s30 offen offset:1024 nt lds
C v48,v60,v61
M v[80:83],a[228:231],a[184:187],v[80:83]
v_exp_f32 v55,v55
v_exp_f32 v59,v59
M v[76:79],a[228:231],a[180:183],v[76:79]
v_exp_f32 v63,v63
v_add_f32 v22,v22,v54
v_add_f32 v23,v23,v58
M v[76:79],a[232:235],a[192:195],v[76:79]
ds_read_b128 a[228:231],v2 offset:30848
L v102,s[8:11],s30 offen offset:2048 nt lds
v_add_f32 v24,v24,v62
M v[80:83],a[232:235],a[196:199],v[80:83]
v_exp_f32 v64,v64
v_exp_f32 v68,v68
M v[84:87],a[232:235],a[200:203],v[84:87]
v_exp_f32 v72,v72
v_add_f32 v22,v22,v55
v_add_f32 v23,v23,v59
M v[84:87],a[236:239],a[212:215],v[84:87]
ds_read_b128 a[232:235],v1 offset:30976
s_add_u32 m0,m0,0xc00
v_add_f32 v24,v24,v63
C v41,v54,v55
M v[80:83],a[236:239],a[208:211],v[80:83]
C v45,v58,v59
C v49,v62,v63
v_exp_f32 v65,v65
M v[76:79],a[236:239],a[204:207],v[76:79]
v_exp_f32 v69,v69
s_waitcnt lgkmcnt(2)
M v[88:91],a[216:219],a[144:147],0
ds_read_b128 a[236:239],v2 offset:30976
v_exp_f32 v73,v73
v_add_f32 v22,v22,v64
M v[92:95],a[216:219],a[148:151],0
s_add_u32 s30,s30,0x3000
v_add_f32 v23,v23,v68
v_add_f32 v24,v24,v72
M v[96:99],a[216:219],a[152:155],0
v_exp_f32 v66,v66
v_exp_f32 v70,v70
M v[96:99],a[220:223],a[164:167],v[96:99]
L v100,s[8:11],s35 offen nt lds
v_exp_f32 v74,v74
v_add_f32 v22,v22,v65
M v[92:95],a[220:223],a[160:163],v[92:95]
v_add_f32 v23,v23,v69
v_add_f32 v24,v24,v73
C v42,v64,v65
C v46,v68,v69
M v[88:91],a[220:223],a[156:159],v[88:91]
C v50,v72,v73
v_exp_f32 v67,v67
M v[88:91],a[224:227],a[168:171],v[88:91]
L v101,s[8:11],s35 offen offset:1024 nt lds
v_exp_f32 v71,v71
M v[92:95],a[224:227],a[172:175],v[92:95]
v_exp_f32 v75,v75
v_add_f32 v22,v22,v66
v_add_f32 v23,v23,v70
M v[96:99],a[224:227],a[176:179],v[96:99]
s_waitcnt vmcnt(11) lgkmcnt(0)
s_barrier
v_add_f32 v24,v24,v74
C v43,v66,v67
M v[96:99],a[228:231],a[188:191],v[96:99]
T a[216:217],v9
T a[218:219],v9 offset:6144
C v47,v70,v71
C v51,v74,v75
M v[92:95],a[228:231],a[184:187],v[92:95]
T a[220:221],v10
T a[222:223],v10 offset:6144
v_add_f32 v22,v22,v67
v_add_f32 v23,v23,v71
M v[88:91],a[228:231],a[180:183],v[88:91]
T a[224:225],v11
T a[226:227],v11 offset:6144
v_add_f32 v24,v24,v75
M v[88:91],a[232:235],a[192:195],v[88:91]
T a[228:229],v12
T a[230:231],v12 offset:6144
M v[92:95],a[232:235],a[196:199],v[92:95]
L v102,s[8:11],s35 offen offset:2048 nt lds
M v[96:99],a[232:235],a[200:203],v[96:99]
T a[232:233],v9 offset:128
T a[234:235],v9 offset:6272
M v[96:99],a[236:239],a[212:215],v[96:99]
M v[92:95],a[236:239],a[208:211],v[92:95]
M v[88:91],a[236:239],a[204:207],v[88:91]
s_waitcnt lgkmcnt(4)
M v[112:115],a[216:219],v[40:43],v[112:115]
T a[236:237],v10 offset:128
s_add_u32 m0,s28,0x6000
M v[116:119],a[216:219],v[44:47],v[116:119]
T a[238:239],v10 offset:6272
M v[120:123],a[216:219],v[48:51],v[120:123]
M v[132:135],a[220:223],v[48:51],v[132:135]
T a[216:217],v11 offset:128
s_add_u32 s35,s29,0xc00
v_fma_f32 v76,v76,s37,-v19
M v[128:131],a[220:223],v[44:47],v[128:131]
T a[218:219],v11 offset:6272
v_fma_f32 v77,v77,s37,-v19
v_fma_f32 v78,v78,s37,-v19
M v[124:127],a[220:223],v[40:43],v[124:127]
v_fma_f32 v79,v79,s37,-v19
v_fma_f32 v80,v80,s37,-v20
v_fma_f32 v81,v81,s37,-v20
M v[136:139],a[224:227],v[40:43],v[136:139]
T a[220:221],v12 offset:128
v_max3_f32 v28,v76,v77,v78
v_fma_f32 v82,v82,s37,-v20
M v[140:143],a[224:227],v[44:47],v[140:143]
T a[222:223],v12 offset:6272
L v100,s[4:7],s29 offen nt lds
v_fma_f32 v83,v83,s37,-v20
M v[144:147],a[224:227],v[48:51],v[144:147]
v_max3_f32 v28,v28,v79,v80
v_fma_f32 v84,v84,s37,-v21
s_waitcnt lgkmcnt(4)
M v[156:159],a[228:231],v[48:51],v[156:159]
T a[224:225],v9 offset:256
v_fma_f32 v85,v85,s37,-v21
v_max3_f32 v28,v28,v81,v82
M v[152:155],a[228:231],v[44:47],v[152:155]
T a[226:227],v9 offset:6400
v_fma_f32 v86,v86,s37,-v21
v_fma_f32 v87,v87,s37,-v21
M v[148:151],a[228:231],v[40:43],v[148:151]
L v101,s[4:7],s29 offen offset:1024 nt lds
v_max3_f32 v28,v28,v83,v84
v_max3_f32 v28,v28,v85,v86
M v[160:163],a[232:235],v[40:43],v[160:163]
T a[228:229],v10 offset:256
v_max_f32 v28,v28,v87
v_fma_f32 v88,v88,s37,-v19
M v[164:167],a[232:235],v[44:47],v[164:167]
T a[230:231],v10 offset:6400
v_fma_f32 v89,v89,s37,-v19
v_fma_f32 v90,v90,s37,-v19
M v[168:171],a[232:235],v[48:51],v[168:171]
v_fma_f32 v91,v91,s37,-v19
v_fma_f32 v92,v92,s37,-v20
v_fma_f32 v93,v93,s37,-v20
M v[180:183],a[236:239],v[48:51],v[180:183]
T a[232:233],v11 offset:256
L v102,s[4:7],s29 offen offset:2048 nt lds
v_max3_f32 v28,v28,v88,v89
M v[176:179],a[236:239],v[44:47],v[176:179]
T a[234:235],v11 offset:6400
v_fma_f32 v94,v94,s37,-v20
v_fma_f32 v95,v95,s37,-v20
M v[172:175],a[236:239],v[40:43],v[172:175]
v_max3_f32 v28,v28,v90,v91
v_fma_f32 v96,v96,s37,-v21
s_waitcnt lgkmcnt(4)
M v[184:187],a[216:219],v[40:43],v[184:187]
T a[236:237],v12 offset:256
v_fma_f32 v97,v97,s37,-v21
v_max3_f32 v28,v28,v92,v93
M v[188:191],a[216:219],v[44:47],v[188:191]
T a[238:239],v12 offset:6400
s_add_u32 m0,m0,0xc00
v_fma_f32 v98,v98,s37,-v21
M v[192:195],a[216:219],v[48:51],v[192:195]
v_fma_f32 v99,v99,s37,-v21
v_max3_f32 v28,v28,v94,v95
v_max3_f32 v28,v28,v96,v97
M v[204:207],a[220:223],v[48:51],v[204:207]
v_max3_f32 v28,v28,v98,v99
M v[200:203],a[220:223],v[44:47],v[200:203]
s_add_u32 s29,s29,0x3000
M v[196:199],a[220:223],v[40:43],v[196:199]
M v[208:211],a[224:227],v[40:43],v[208:211]
L v100,s[4:7],s35 offen nt lds
M v[212:215],a[224:227],v[44:47],v[212:215]
M v[216:219],a[224:227],v[48:51],v[216:219]
s_waitcnt vmcnt(10) lgkmcnt(0)
s_barrier
M v[228:231],a[228:231],v[48:51],v[228:231]
ds_read_b128 a[216:219],v3 offset:24576
ds_read_b128 a[220:223],v4 offset:24576
M v[224:227],a[228:231],v[44:47],v[224:227]
ds_read_b128 a[224:227],v3 offset:24704
M v[220:223],a[228:231],v[40:43],v[220:223]
L v101,s[4:7],s35 offen offset:1024 nt lds
M v[232:235],a[232:235],v[40:43],v[232:235]
ds_read_b128 a[228:231],v4 offset:24704
M v[236:239],a[232:235],v[44:47],v[236:239]
M v[240:243],a[232:235],v[48:51],v[240:243]
ds_read_b128 a[232:235],v3 offset:24832
M v[252:255],a[236:239],v[48:51],v[252:255]
L v102,s[4:7],s35 offen offset:2048 nt lds
M v[248:251],a[236:239],v[44:47],v[248:251]
M v[244:247],a[236:239],v[40:43],v[244:247]
s_sub_u32 s36,s36,1
s_cmp_lg_u32 s36,0
s_cbranch_scc1 C1_loop4
v_cmp_lt_f32 vcc,0x41000000,v28
s_cbranch_vccnz C1_45_r
C1_45_b:
s_waitcnt lgkmcnt(2)
M v[52:55],a[216:219],a[144:147],0
ds_read_b128 a[236:239],v4 offset:24832
s_add_u32 m0,s28,0xc000
v_exp_f32 v76,v76
M v[56:59],a[216:219],a[148:151],0
v_exp_f32 v80,v80
v_exp_f32 v84,v84
M v[60:63],a[216:219],a[152:155],0
s_add_u32 s35,s30,0xc00
v_exp_f32 v77,v77
M v[60:63],a[220:223],a[164:167],v[60:63]
ds_read_b128 a[216:219],v3 offset:30720
v_exp_f32 v81,v81
M v[56:59],a[220:223],a[160:163],v[56:59]
v_exp_f32 v85,v85
v_add_f32 v22,v22,v76
v_add_f32 v23,v23,v80
M v[52:55],a[220:223],a[156:159],v[52:55]
L v100,s[8:11],s30 offen nt lds
v_add_f32 v24,v24,v84
v_exp_f32 v78,v78
M v[52:55],a[224:227],a[168:171],v[52:55]
ds_read_b128 a[220:223],v4 offset:30720
v_exp_f32 v82,v82
M v[56:59],a[224:227],a[172:175],v[56:59]
v_exp_f32 v86,v86
v_add_f32 v22,v22,v77
v_add_f32 v23,v23,v81
M v[60:63],a[224:227],a[176:179],v[60:63]
v_add_f32 v24,v24,v85
C v40,v76,v77
C v44,v80,v81
s_waitcnt lgkmcnt(2)
M v[60:63],a[228:231],a[188:191],v[60:63]
ds_read_b128 a[224:227],v3 offset:30848
L v101,s[8:11],s30 offen offset:1024 nt lds
C v48,v84,v85
M v[56:59],a[228:231],a[184:187],v[56:59]
v_exp_f32 v79,v79
v_exp_f32 v83,v83
M v[52:55],a[228:231],a[180:183],v[52:55]
v_exp_f32 v87,v87
v_add_f32 v22,v22,v78
v_add_f32 v23,v23,v82
M v[52:55],a[232:235],a[192:195],v[52:55]
ds_read_b128 a[228:231],v4 offset:30848
L v102,s[8:11],s30 offen offset:2048 nt lds
v_add_f32 v24,v24,v86
M v[56:59],a[232:235],a[196:199],v[56:59]
v_exp_f32 v88,v88
v_exp_f32 v92,v92
M v[60:63],a[232:235],a[200:203],v[60:63]
v_exp_f32 v96,v96
v_add_f32 v22,v22,v79
v_add_f32 v23,v23,v83
M v[60:63],a[236:239],a[212:215],v[60:63]
ds_read_b128 a[232:235],v3 offset:30976
s_add_u32 m0,m0,0xc00
v_add_f32 v24,v24,v87
C v41,v78,v79
M v[56:59],a[236:239],a[208:211],v[56:59]
C v45,v82,v83
C v49,v86,v87
v_exp_f32 v89,v89
M v[52:55],a[236:239],a[204:207],v[52:55]
v_exp_f32 v93,v93
s_waitcnt lgkmcnt(2)
M v[64:67],a[216:219],a[144:147],0
ds_read_b128 a[236:239],v4 offset:30976
v_exp_f32 v97,v97
v_add_f32 v22,v22,v88
M v[68:71],a[216:219],a[148:151],0
s_add_u32 s30,s30,0x3000
v_add_f32 v23,v23,v92
v_add_f32 v24,v24,v96
M v[72:75],a[216:219],a[152:155],0
v_exp_f32 v90,v90
v_exp_f32 v94,v94
M v[72:75],a[220:223],a[164:167],v[72:75]
L v100,s[8:11],s35 offen nt lds
v_exp_f32 v98,v98
v_add_f32 v22,v22,v89
M v[68:71],a[220:223],a[160:163],v[68:71]
v_add_f32 v23,v23,v93
v_add_f32 v24,v24,v97
C v42,v88,v89
C v46,v92,v93
M v[64:67],a[220:223],a[156:159],v[64:67]
C v50,v96,v97
v_exp_f32 v91,v91
M v[64:67],a[224:227],a[168:171],v[64:67]
L v101,s[8:11],s35 offen offset:1024 nt lds
v_exp_f32 v95,v95
M v[68:71],a[224:227],a[172:175],v[68:71]
v_exp_f32 v99,v99
v_add_f32 v22,v22,v90
v_add_f32 v23,v23,v94
M v[72:75],a[224:227],a[176:179],v[72:75]
s_waitcnt vmcnt(11) lgkmcnt(0)
s_barrier
v_add_f32 v24,v24,v98
C v43,v90,v91
M v[72:75],a[228:231],a[188:191],v[72:75]
T a[216:217],v5
T a[218:219],v5 offset:6144
C v47,v94,v95
C v51,v98,v99
M v[68:71],a[228:231],a[184:187],v[68:71]
T a[220:221],v6
T a[222:223],v6 offset:6144
v_add_f32 v22,v22,v91
v_add_f32 v23,v23,v95
M v[64:67],a[228:231],a[180:183],v[64:67]
T a[224:225],v7
T a[226:227],v7 offset:6144
v_add_f32 v24,v24,v99
M v[64:67],a[232:235],a[192:195],v[64:67]
T a[228:229],v8
T a[230:231],v8 offset:6144
M v[68:71],a[232:235],a[196:199],v[68:71]
L v102,s[8:11],s35 offen offset:2048 nt lds
M v[72:75],a[232:235],a[200:203],v[72:75]
T a[232:233],v5 offset:128
T a[234:235],v5 offset:6272
M v[72:75],a[236:239],a[212:215],v[72:75]
M v[68:71],a[236:239],a[208:211],v[68:71]
M v[64:67],a[236:239],a[204:207],v[64:67]
s_waitcnt lgkmcnt(4)
M v[112:115],a[216:219],v[40:43],v[112:115]
T a[236:237],v6 offset:128
s_add_u32 m0,s28,0x12000
M v[116:119],a[216:219],v[44:47],v[116:119]
T a[238:239],v6 offset:6272
M v[120:123],a[216:219],v[48:51],v[120:123]
M v[132:135],a[220:223],v[48:51],v[132:135]
T a[216:217],v7 offset:128
s_add_u32 s35,s30,0xc00
v_fma_f32 v52,v52,s37,-v19
M v[128:131],a[220:223],v[44:47],v[128:131]
T a[218:219],v7 offset:6272
v_fma_f32 v53,v53,s37,-v19
v_fma_f32 v54,v54,s37,-v19
M v[124:127],a[220:223],v[40:43],v[124:127]
v_fma_f32 v55,v55,s37,-v19
v_fma_f32 v56,v56,s37,-v20
v_fma_f32 v57,v57,s37,-v20
M v[136:139],a[224:227],v[40:43],v[136:139]
T a[220:221],v8 offset:128
v_max3_f32 v28,v52,v53,v54
v_fma_f32 v58,v58,s37,-v20
M v[140:143],a[224:227],v[44:47],v[140:143]
T a[222:223],v8 offset:6272
L v100,s[8:11],s30 offen nt lds
v_fma_f32 v59,v59,s37,-v20
M v[144:147],a[224:227],v[48:51],v[144:147]
v_max3_f32 v28,v28,v55,v56
v_fma_f32 v60,v60,s37,-v21
s_waitcnt lgkmcnt(4)
M v[156:159],a[228:231],v[48:51],v[156:159]
T a[224:225],v5 offset:256
v_fma_f32 v61,v61,s37,-v21
v_max3_f32 v28,v28,v57,v58
M v[152:155],a[228:231],v[44:47],v[152:155]
T a[226:227],v5 offset:6400
v_fma_f32 v62,v62,s37,-v21
v_fma_f32 v63,v63,s37,-v21
M v[148:151],a[228:231],v[40:43],v[148:151]
L v101,s[8:11],s30 offen offset:1024 nt lds
v_max3_f32 v28,v28,v59,v60
v_max3_f32 v28,v28,v61,v62
M v[160:163],a[232:235],v[40:43],v[160:163]
T a[228:229],v6 offset:256
v_max_f32 v28,v28,v63
v_fma_f32 v64,v64,s37,-v19
M v[164:167],a[232:235],v[44:47],v[164:167]
T a[230:231],v6 offset:6400
v_fma_f32 v65,v65,s37,-v19
v_fma_f32 v66,v66,s37,-v19
M v[168:171],a[232:235],v[48:51],v[168:171]
v_fma_f32 v67,v67,s37,-v19
v_fma_f32 v68,v68,s37,-v20
v_fma_f32 v69,v69,s37,-v20
M v[180:183],a[236:239],v[48:51],v[180:183]
T a[232:233],v7 offset:256
L v102,s[8:11],s30 offen offset:2048 nt lds
v_max3_f32 v28,v28,v64,v65
M v[176:179],a[236:239],v[44:47],v[176:179]
T a[234:235],v7 offset:6400
v_fma_f32 v70,v70,s37,-v20
v_fma_f32 v71,v71,s37,-v20
M v[172:175],a[236:239],v[40:43],v[172:175]
v_max3_f32 v28,v28,v66,v67
v_fma_f32 v72,v72,s37,-v21
s_waitcnt lgkmcnt(4)
M v[184:187],a[216:219],v[40:43],v[184:187]
T a[236:237],v8 offset:256
v_fma_f32 v73,v73,s37,-v21
v_max3_f32 v28,v28,v68,v69
M v[188:191],a[216:219],v[44:47],v[188:191]
T a[238:239],v8 offset:6400
s_add_u32 m0,m0,0xc00
v_fma_f32 v74,v74,s37,-v21
M v[192:195],a[216:219],v[48:51],v[192:195]
v_fma_f32 v75,v75,s37,-v21
v_max3_f32 v28,v28,v70,v71
v_max3_f32 v28,v28,v72,v73
M v[204:207],a[220:223],v[48:51],v[204:207]
v_max3_f32 v28,v28,v74,v75
M v[200:203],a[220:223],v[44:47],v[200:203]
s_add_u32 s30,s30,0x3000
M v[196:199],a[220:223],v[40:43],v[196:199]
M v[208:211],a[224:227],v[40:43],v[208:211]
L v100,s[8:11],s35 offen nt lds
M v[212:215],a[224:227],v[44:47],v[212:215]
M v[216:219],a[224:227],v[48:51],v[216:219]
s_waitcnt vmcnt(10) lgkmcnt(0)
s_barrier
M v[228:231],a[228:231],v[48:51],v[228:231]
ds_read_b128 a[216:219],v1 offset:24576
ds_read_b128 a[220:223],v2 offset:24576
M v[224:227],a[228:231],v[44:47],v[224:227]
ds_read_b128 a[224:227],v1 offset:24704
M v[220:223],a[228:231],v[40:43],v[220:223]
L v101,s[8:11],s35 offen offset:1024 nt lds
M v[232:235],a[232:235],v[40:43],v[232:235]
ds_read_b128 a[228:231],v2 offset:24704
M v[236:239],a[232:235],v[44:47],v[236:239]
M v[240:243],a[232:235],v[48:51],v[240:243]
ds_read_b128 a[232:235],v1 offset:24832
M v[252:255],a[236:239],v[48:51],v[252:255]
L v102,s[8:11],s35 offen offset:2048 nt lds
M v[248:251],a[236:239],v[44:47],v[248:251]
M v[244:247],a[236:239],v[40:43],v[244:247]
v_cmp_lt_f32 vcc,0x41000000,v28
s_cbranch_vccnz C1_47_r
C1_47_b:
s_waitcnt lgkmcnt(2)
M v[76:79],a[216:219],a[144:147],0
ds_read_b128 a[236:239],v2 offset:24832
s_add_u32 m0,s28,0
v_exp_f32 v52,v52
M v[80:83],a[216:219],a[148:151],0
v_exp_f32 v56,v56
v_exp_f32 v60,v60
M v[84:87],a[216:219],a[152:155],0
s_add_u32 s35,s32,0x7800
v_exp_f32 v53,v53
M v[84:87],a[220:223],a[164:167],v[84:87]
ds_read_b128 a[216:219],v1 offset:30720
v_exp_f32 v57,v57
M v[80:83],a[220:223],a[160:163],v[80:83]
v_exp_f32 v61,v61
v_add_f32 v22,v22,v52
v_add_f32 v23,v23,v56
M v[76:79],a[220:223],a[156:159],v[76:79]
L v106,s[16:19],s32 offen lds
v_add_f32 v24,v24,v60
v_exp_f32 v54,v54
M v[76:79],a[224:227],a[168:171],v[76:79]
ds_read_b128 a[220:223],v2 offset:30720
v_exp_f32 v58,v58
M v[80:83],a[224:227],a[172:175],v[80:83]
v_exp_f32 v62,v62
v_add_f32 v22,v22,v53
v_add_f32 v23,v23,v57
M v[84:87],a[224:227],a[176:179],v[84:87]
v_add_f32 v24,v24,v61
C v40,v52,v53
C v44,v56,v57
s_waitcnt lgkmcnt(2)
M v[84:87],a[228:231],a[188:191],v[84:87]
ds_read_b128 a[224:227],v1 offset:30848
L v107,s[16:19],s32 offen offset:1024 lds
C v48,v60,v61
M v[80:83],a[228:231],a[184:187],v[80:83]
v_exp_f32 v55,v55
v_exp_f32 v59,v59
M v[76:79],a[228:231],a[180:183],v[76:79]
v_exp_f32 v63,v63
v_add_f32 v22,v22,v54
v_add_f32 v23,v23,v58
M v[76:79],a[232:235],a[192:195],v[76:79]
ds_read_b128 a[228:231],v2 offset:30848
L v108,s[16:19],s32 offen offset:2048 lds
v_add_f32 v24,v24,v62
M v[80:83],a[232:235],a[196:199],v[80:83]
v_exp_f32 v64,v64
v_exp_f32 v68,v68
M v[84:87],a[232:235],a[200:203],v[84:87]
v_exp_f32 v72,v72
v_add_f32 v22,v22,v55
v_add_f32 v23,v23,v59
M v[84:87],a[236:239],a[212:215],v[84:87]
ds_read_b128 a[232:235],v1 offset:30976
s_add_u32 m0,m0,0xc00
v_add_f32 v24,v24,v63
C v41,v54,v55
M v[80:83],a[236:239],a[208:211],v[80:83]
C v45,v58,v59
C v49,v62,v63
v_exp_f32 v65,v65
M v[76:79],a[236:239],a[204:207],v[76:79]
v_exp_f32 v69,v69
s_waitcnt lgkmcnt(2)
M v[88:91],a[216:219],a[144:147],0
ds_read_b128 a[236:239],v2 offset:30976
v_exp_f32 v73,v73
v_add_f32 v22,v22,v64
M v[92:95],a[216:219],a[148:151],0
s_add_u32 s32,s32,0x78000
v_add_f32 v23,v23,v68
v_add_f32 v24,v24,v72
M v[96:99],a[216:219],a[152:155],0
v_exp_f32 v66,v66
v_exp_f32 v70,v70
M v[96:99],a[220:223],a[164:167],v[96:99]
L v106,s[16:19],s35 offen lds
v_exp_f32 v74,v74
v_add_f32 v22,v22,v65
M v[92:95],a[220:223],a[160:163],v[92:95]
v_add_f32 v23,v23,v69
v_add_f32 v24,v24,v73
C v42,v64,v65
C v46,v68,v69
M v[88:91],a[220:223],a[156:159],v[88:91]
C v50,v72,v73
v_exp_f32 v67,v67
M v[88:91],a[224:227],a[168:171],v[88:91]
L v107,s[16:19],s35 offen offset:1024 lds
v_exp_f32 v71,v71
M v[92:95],a[224:227],a[172:175],v[92:95]
v_exp_f32 v75,v75
v_add_f32 v22,v22,v66
v_add_f32 v23,v23,v70
M v[96:99],a[224:227],a[176:179],v[96:99]
s_waitcnt vmcnt(11) lgkmcnt(0)
s_barrier
v_add_f32 v24,v24,v74
C v43,v66,v67
M v[96:99],a[228:231],a[188:191],v[96:99]
T a[216:217],v9
T a[218:219],v9 offset:6144
C v47,v70,v71
C v51,v74,v75
M v[92:95],a[228:231],a[184:187],v[92:95]
T a[220:221],v10
T a[222:223],v10 offset:6144
v_add_f32 v22,v22,v67
v_add_f32 v23,v23,v71
M v[88:91],a[228:231],a[180:183],v[88:91]
T a[224:225],v11
T a[226:227],v11 offset:6144
v_add_f32 v24,v24,v75
M v[88:91],a[232:235],a[192:195],v[88:91]
T a[228:229],v12
T a[230:231],v12 offset:6144
M v[92:95],a[232:235],a[196:199],v[92:95]
L v108,s[16:19],s35 offen offset:2048 lds
M v[96:99],a[232:235],a[200:203],v[96:99]
T a[232:233],v9 offset:128
T a[234:235],v9 offset:6272
M v[96:99],a[236:239],a[212:215],v[96:99]
M v[92:95],a[236:239],a[208:211],v[92:95]
M v[88:91],a[236:239],a[204:207],v[88:91]
s_waitcnt lgkmcnt(4)
M v[112:115],a[216:219],v[40:43],v[112:115]
T a[236:237],v10 offset:128
s_add_u32 m0,s28,0x6000
M v[116:119],a[216:219],v[44:47],v[116:119]
T a[238:239],v10 offset:6272
M v[120:123],a[216:219],v[48:51],v[120:123]
M v[132:135],a[220:223],v[48:51],v[132:135]
T a[216:217],v11 offset:128
s_add_u32 s35,s32,0x7800
v_fma_f32 v76,v76,s37,-v19
M v[128:131],a[220:223],v[44:47],v[128:131]
T a[218:219],v11 offset:6272
v_fma_f32 v77,v77,s37,-v19
v_fma_f32 v78,v78,s37,-v19
M v[124:127],a[220:223],v[40:43],v[124:127]
v_fma_f32 v79,v79,s37,-v19
v_fma_f32 v80,v80,s37,-v20
v_fma_f32 v81,v81,s37,-v20
M v[136:139],a[224:227],v[40:43],v[136:139]
T a[220:221],v12 offset:128
L v106,s[16:19],s32 offen lds
v_max3_f32 v28,v76,v77,v78
M v[140:143],a[224:227],v[44:47],v[140:143]
T a[222:223],v12 offset:6272
v_fma_f32 v82,v82,s37,-v20
v_fma_f32 v83,v83,s37,-v20
M v[144:147],a[224:227],v[48:51],v[144:147]
v_max3_f32 v28,v28,v79,v80
v_fma_f32 v84,v84,s37,-v21
s_waitcnt lgkmcnt(4)
M v[156:159],a[228:231],v[48:51],v[156:159]
T a[224:225],v9 offset:256
v_fma_f32 v85,v85,s37,-v21
v_max3_f32 v28,v28,v81,v82
M v[152:155],a[228:231],v[44:47],v[152:155]
T a[226:227],v9 offset:6400
L v107,s[16:19],s32 offen offset:1024 lds
v_fma_f32 v86,v86,s37,-v21
M v[148:151],a[228:231],v[40:43],v[148:151]
v_fma_f32 v87,v87,s37,-v21
v_max3_f32 v28,v28,v83,v84
v_max3_f32 v28,v28,v85,v86
M v[160:163],a[232:235],v[40:43],v[160:163]
T a[228:229],v10 offset:256
v_max_f32 v28,v28,v87
v_fma_f32 v88,v88,s37,-v19
M v[164:167],a[232:235],v[44:47],v[164:167]
T a[230:231],v10 offset:6400
v_fma_f32 v89,v89,s37,-v19
v_fma_f32 v90,v90,s37,-v19
M v[168:171],a[232:235],v[48:51],v[168:171]
L v108,s[16:19],s32 offen offset:2048 lds
v_fma_f32 v91,v91,s37,-v19
v_fma_f32 v92,v92,s37,-v20
M v[180:183],a[236:239],v[48:51],v[180:183]
T a[232:233],v11 offset:256
v_fma_f32 v93,v93,s37,-v20
v_max3_f32 v28,v28,v88,v89
M v[176:179],a[236:239],v[44:47],v[176:179]
T a[234:235],v11 offset:6400
v_fma_f32 v94,v94,s37,-v20
v_fma_f32 v95,v95,s37,-v20
M v[172:175],a[236:239],v[40:43],v[172:175]
s_add_u32 m0,m0,0xc00
v_max3_f32 v28,v28,v90,v91
s_waitcnt lgkmcnt(4)
M v[184:187],a[216:219],v[40:43],v[184:187]
T a[236:237],v12 offset:256
v_fma_f32 v96,v96,s37,-v21
v_fma_f32 v97,v97,s37,-v21
M v[188:191],a[216:219],v[44:47],v[188:191]
T a[238:239],v12 offset:6400
v_max3_f32 v28,v28,v92,v93
v_fma_f32 v98,v98,s37,-v21
M v[192:195],a[216:219],v[48:51],v[192:195]
s_add_u32 s32,s32,0xfffc4000
v_fma_f32 v99,v99,s37,-v21
v_max3_f32 v28,v28,v94,v95
M v[204:207],a[220:223],v[48:51],v[204:207]
v_max3_f32 v28,v28,v96,v97
v_max3_f32 v28,v28,v98,v99
M v[200:203],a[220:223],v[44:47],v[200:203]
M v[196:199],a[220:223],v[40:43],v[196:199]
L v106,s[16:19],s35 offen lds
M v[208:211],a[224:227],v[40:43],v[208:211]
M v[212:215],a[224:227],v[44:47],v[212:215]
L v107,s[16:19],s35 offen offset:1024 lds
M v[216:219],a[224:227],v[48:51],v[216:219]
s_waitcnt vmcnt(11) lgkmcnt(0)
s_barrier
M v[228:231],a[228:231],v[48:51],v[228:231]
T a[216:217],v9 offset:24576
T a[218:219],v9 offset:30720
M v[224:227],a[228:231],v[44:47],v[224:227]
T a[220:221],v10 offset:24576
T a[222:223],v10 offset:30720
M v[220:223],a[228:231],v[40:43],v[220:223]
T a[224:225],v11 offset:24576
T a[226:227],v11 offset:30720
M v[232:235],a[232:235],v[40:43],v[232:235]
T a[228:229],v12 offset:24576
T a[230:231],v12 offset:30720
M v[236:239],a[232:235],v[44:47],v[236:239]
M v[240:243],a[232:235],v[48:51],v[240:243]
T a[232:233],v9 offset:24704
T a[234:235],v9 offset:30848
M v[252:255],a[236:239],v[48:51],v[252:255]
L v108,s[16:19],s35 offen offset:2048 lds
M v[248:251],a[236:239],v[44:47],v[248:251]
M v[244:247],a[236:239],v[40:43],v[244:247]
v_cmp_lt_f32 vcc,0x41000000,v28
s_cbranch_vccnz C1_49_r
C1_49_b:
v_exp_f32 v76,v76
v_exp_f32 v80,v80
v_exp_f32 v84,v84
v_exp_f32 v77,v77
v_exp_f32 v81,v81
v_exp_f32 v85,v85
v_add_f32 v22,v22,v76
v_add_f32 v23,v23,v80
v_add_f32 v24,v24,v84
v_exp_f32 v78,v78
v_exp_f32 v82,v82
v_exp_f32 v86,v86
v_add_f32 v22,v22,v77
v_add_f32 v23,v23,v81
v_add_f32 v24,v24,v85
C v40,v76,v77
C v44,v80,v81
C v48,v84,v85
v_exp_f32 v79,v79
v_exp_f32 v83,v83
v_exp_f32 v87,v87
v_add_f32 v22,v22,v78
v_add_f32 v23,v23,v82
v_add_f32 v24,v24,v86
v_exp_f32 v88,v88
v_exp_f32 v92,v92
v_exp_f32 v96,v96
v_add_f32 v22,v22,v79
v_add_f32 v23,v23,v83
v_add_f32 v24,v24,v87
C v41,v78,v79
C v45,v82,v83
C v49,v86,v87
v_exp_f32 v89,v89
v_exp_f32 v93,v93
v_exp_f32 v97,v97
v_add_f32 v22,v22,v88
v_add_f32 v23,v23,v92
v_add_f32 v24,v24,v96
v_exp_f32 v90,v90
v_exp_f32 v94,v94
v_exp_f32 v98,v98
v_add_f32 v22,v22,v89
v_add_f32 v23,v23,v93
v_add_f32 v24,v24,v97
C v42,v88,v89
C v46,v92,v93
C v50,v96,v97
v_exp_f32 v91,v91
v_exp_f32 v95,v95
v_exp_f32 v99,v99
v_add_f32 v22,v22,v90
v_add_f32 v23,v23,v94
v_add_f32 v24,v24,v98
C v43,v90,v91
C v47,v94,v95
C v51,v98,v99
s_waitcnt lgkmcnt(4)
M v[112:115],a[216:219],v[40:43],v[112:115]
T a[236:237],v10 offset:24704
v_add_f32 v22,v22,v91
M v[116:119],a[216:219],v[44:47],v[116:119]
T a[238:239],v10 offset:30848
v_add_f32 v23,v23,v95
M v[120:123],a[216:219],v[48:51],v[120:123]
v_add_f32 v24,v24,v99
s_add_u32 m0,s28,0xc000
M v[132:135],a[220:223],v[48:51],v[132:135]
T a[216:217],v11 offset:24704
M v[128:131],a[220:223],v[44:47],v[128:131]
T a[218:219],v11 offset:30848
M v[124:127],a[220:223],v[40:43],v[124:127]
s_add_u32 s35,s32,0x7800
M v[136:139],a[224:227],v[40:43],v[136:139]
T a[220:221],v12 offset:24704
v_mov_b32 v25,v22
v_mov_b32 v26,v23
v_mov_b32 v27,v24
v_permlane32_swap_b32 v22,v25
M v[140:143],a[224:227],v[44:47],v[140:143]
T a[222:223],v12 offset:30848
v_permlane32_swap_b32 v23,v26
v_permlane32_swap_b32 v24,v27
v_add_f32 v22,v22,v25
v_add_f32 v23,v23,v26
M v[144:147],a[224:227],v[48:51],v[144:147]
L v106,s[16:19],s32 offen lds
v_add_f32 v24,v24,v27
v_mov_b32 v25,v22
v_mov_b32 v26,v23
s_waitcnt lgkmcnt(4)
M v[156:159],a[228:231],v[48:51],v[156:159]
T a[224:225],v9 offset:24832
v_mov_b32 v27,v24
v_permlane16_swap_b32 v22,v25
v_permlane16_swap_b32 v23,v26
v_permlane16_swap_b32 v24,v27
M v[152:155],a[228:231],v[44:47],v[152:155]
T a[226:227],v9 offset:30976
v_add_f32 v22,v22,v25
v_add_f32 v23,v23,v26
v_add_f32 v24,v24,v27
M v[148:151],a[228:231],v[40:43],v[148:151]
L v107,s[16:19],s32 offen offset:1024 lds
v_rcp_f32 v30,v22
v_rcp_f32 v32,v23
M v[160:163],a[232:235],v[40:43],v[160:163]
T a[228:229],v10 offset:24832
v_rcp_f32 v34,v24
v_mov_b32 v31,v30
v_mov_b32 v33,v32
M v[164:167],a[232:235],v[44:47],v[164:167]
T a[230:231],v10 offset:30976
v_mov_b32 v35,v34
v_add_u32 v36,s47,v0
v_add_u32 v37,s48,v0
v_add_u32 v38,s49,v0
M v[168:171],a[232:235],v[48:51],v[168:171]
L v108,s[16:19],s32 offen offset:2048 lds
v_mul_f32 v112,v112,v30
v_mul_f32 v113,v113,v30
M v[180:183],a[236:239],v[48:51],v[180:183]
T a[232:233],v11 offset:24832
v_mul_f32 v114,v114,v30
v_mul_f32 v115,v115,v30
M v[176:179],a[236:239],v[44:47],v[176:179]
T a[234:235],v11 offset:30976
v_mul_f32 v124,v124,v30
v_mul_f32 v125,v125,v30
M v[172:175],a[236:239],v[40:43],v[172:175]
v_mul_f32 v126,v126,v30
v_mul_f32 v127,v127,v30
s_waitcnt lgkmcnt(4)
M v[184:187],a[216:219],v[40:43],v[184:187]
T a[236:237],v12 offset:24832
s_add_u32 m0,m0,0xc00
v_mul_f32 v116,v116,v32
M v[188:191],a[216:219],v[44:47],v[188:191]
T a[238:239],v12 offset:30976
v_mul_f32 v117,v117,v32
v_mul_f32 v118,v118,v32
M v[192:195],a[216:219],v[48:51],v[192:195]
v_mul_f32 v119,v119,v32
v_mul_f32 v128,v128,v32
v_mul_f32 v129,v129,v32
M v[204:207],a[220:223],v[48:51],v[204:207]
s_add_u32 s32,s32,0x78000
v_mul_f32 v130,v130,v32
v_mul_f32 v131,v131,v32
M v[200:203],a[220:223],v[44:47],v[200:203]
v_mul_f32 v120,v120,v34
v_mul_f32 v121,v121,v34
v_mul_f32 v122,v122,v34
M v[196:199],a[220:223],v[40:43],v[196:199]
L v106,s[16:19],s35 offen lds
v_mul_f32 v123,v123,v34
v_mul_f32 v132,v132,v34
M v[208:211],a[224:227],v[40:43],v[208:211]
v_mul_f32 v133,v133,v34
v_mul_f32 v134,v134,v34
v_mul_f32 v135,v135,v34
M v[212:215],a[224:227],v[44:47],v[212:215]
L v107,s[16:19],s35 offen offset:1024 lds
C v52,v112,v113
C v53,v114,v115
M v[216:219],a[224:227],v[48:51],v[216:219]
s_waitcnt vmcnt(11) lgkmcnt(0)
s_barrier
C v54,v124,v125
M v[228:231],a[228:231],v[48:51],v[228:231]
T a[216:217],v13
T a[218:219],v13 offset:2048
C v55,v126,v127
M v[224:227],a[228:231],v[44:47],v[224:227]
T a[220:221],v14
T a[222:223],v14 offset:2048
C v56,v116,v117
M v[220:223],a[228:231],v[40:43],v[220:223]
T a[224:225],v13 offset:4096
T a[226:227],v13 offset:6144
C v57,v118,v119
M v[232:235],a[232:235],v[40:43],v[232:235]
T a[228:229],v14 offset:4096
T a[230:231],v14 offset:6144
C v58,v128,v129
M v[236:239],a[232:235],v[44:47],v[236:239]
C v59,v130,v131
C v60,v120,v121
C v61,v122,v123
M v[240:243],a[232:235],v[48:51],v[240:243]
T a[232:233],v13 offset:8192
T a[234:235],v13 offset:10240
C v62,v132,v133
M v[252:255],a[236:239],v[48:51],v[252:255]
L v108,s[16:19],s35 offen offset:2048 lds
C v63,v134,v135
M v[248:251],a[236:239],v[44:47],v[248:251]
M v[244:247],a[236:239],v[40:43],v[244:247]
ds_write_b128 v36,v[52:55]
ds_write_b128 v36,v[56:59] offset:1024
ds_write_b128 v36,v[60:63] offset:2048
v_pk_mul_f32 v[136:137],v[136:137],v[30:31]
v_pk_mul_f32 v[138:139],v[138:139],v[30:31]
v_pk_mul_f32 v[148:149],v[148:149],v[30:31]
v_pk_mul_f32 v[150:151],v[150:151],v[30:31]
v_pk_mul_f32 v[140:141],v[140:141],v[32:33]
v_pk_mul_f32 v[142:143],v[142:143],v[32:33]
v_pk_mul_f32 v[152:153],v[152:153],v[32:33]
v_pk_mul_f32 v[154:155],v[154:155],v[32:33]
v_pk_mul_f32 v[144:145],v[144:145],v[34:35]
v_pk_mul_f32 v[146:147],v[146:147],v[34:35]
v_pk_mul_f32 v[156:157],v[156:157],v[34:35]
v_pk_mul_f32 v[158:159],v[158:159],v[34:35]
C v64,v136,v137
C v65,v138,v139
C v66,v148,v149
C v67,v150,v151
ds_write_b128 v36,v[64:67] offset:3072
C v68,v140,v141
C v69,v142,v143
C v70,v152,v153
C v71,v154,v155
ds_write_b128 v36,v[68:71] offset:4096
C v72,v144,v145
C v73,v146,v147
C v74,v156,v157
C v75,v158,v159
ds_write_b128 v36,v[72:75] offset:5120
v_pk_mul_f32 v[160:161],v[160:161],v[30:31]
v_pk_mul_f32 v[162:163],v[162:163],v[30:31]
v_pk_mul_f32 v[172:173],v[172:173],v[30:31]
v_pk_mul_f32 v[174:175],v[174:175],v[30:31]
v_pk_mul_f32 v[164:165],v[164:165],v[32:33]
v_pk_mul_f32 v[166:167],v[166:167],v[32:33]
v_pk_mul_f32 v[176:177],v[176:177],v[32:33]
v_pk_mul_f32 v[178:179],v[178:179],v[32:33]
v_pk_mul_f32 v[168:169],v[168:169],v[34:35]
v_pk_mul_f32 v[170:171],v[170:171],v[34:35]
v_pk_mul_f32 v[180:181],v[180:181],v[34:35]
v_pk_mul_f32 v[182:183],v[182:183],v[34:35]
C v52,v160,v161
C v53,v162,v163
C v54,v172,v173
C v55,v174,v175
ds_write_b128 v36,v[52:55] offset:6144
C v56,v164,v165
C v57,v166,v167
C v58,v176,v177
C v59,v178,v179
ds_write_b128 v36,v[56:59] offset:7168
C v60,v168,v169
C v61,v170,v171
C v62,v180,v181
C v63,v182,v183
ds_write_b128 v36,v[60:63] offset:8192
v_pk_mul_f32 v[184:185],v[184:185],v[30:31]
v_pk_mul_f32 v[186:187],v[186:187],v[30:31]
v_pk_mul_f32 v[196:197],v[196:197],v[30:31]
v_pk_mul_f32 v[198:199],v[198:199],v[30:31]
v_pk_mul_f32 v[188:189],v[188:189],v[32:33]
v_pk_mul_f32 v[190:191],v[190:191],v[32:33]
v_pk_mul_f32 v[200:201],v[200:201],v[32:33]
v_pk_mul_f32 v[202:203],v[202:203],v[32:33]
v_pk_mul_f32 v[192:193],v[192:193],v[34:35]
v_pk_mul_f32 v[194:195],v[194:195],v[34:35]
v_pk_mul_f32 v[204:205],v[204:205],v[34:35]
v_pk_mul_f32 v[206:207],v[206:207],v[34:35]
C v64,v184,v185
C v65,v186,v187
C v66,v196,v197
C v67,v198,v199
ds_write_b128 v36,v[64:67] offset:9216
C v68,v188,v189
C v69,v190,v191
C v70,v200,v201
C v71,v202,v203
ds_write_b128 v36,v[68:71] offset:10240
C v72,v192,v193
C v73,v194,v195
C v74,v204,v205
C v75,v206,v207
ds_write_b128 v36,v[72:75] offset:11264
v_pk_mul_f32 v[208:209],v[208:209],v[30:31]
v_pk_mul_f32 v[210:211],v[210:211],v[30:31]
v_pk_mul_f32 v[220:221],v[220:221],v[30:31]
v_pk_mul_f32 v[222:223],v[222:223],v[30:31]
v_pk_mul_f32 v[212:213],v[212:213],v[32:33]
v_pk_mul_f32 v[214:215],v[214:215],v[32:33]
v_pk_mul_f32 v[224:225],v[224:225],v[32:33]
v_pk_mul_f32 v[226:227],v[226:227],v[32:33]
v_pk_mul_f32 v[216:217],v[216:217],v[34:35]
v_pk_mul_f32 v[218:219],v[218:219],v[34:35]
v_pk_mul_f32 v[228:229],v[228:229],v[34:35]
v_pk_mul_f32 v[230:231],v[230:231],v[34:35]
C v52,v208,v209
C v53,v210,v211
C v54,v220,v221
C v55,v222,v223
ds_write_b128 v36,v[52:55] offset:12288
C v56,v212,v213
C v57,v214,v215
C v58,v224,v225
C v59,v226,v227
ds_write_b128 v36,v[56:59] offset:13312
C v60,v216,v217
C v61,v218,v219
C v62,v228,v229
C v63,v230,v231
ds_write_b128 v36,v[60:63] offset:14336
v_pk_mul_f32 v[232:233],v[232:233],v[30:31]
v_pk_mul_f32 v[234:235],v[234:235],v[30:31]
v_pk_mul_f32 v[244:245],v[244:245],v[30:31]
v_pk_mul_f32 v[246:247],v[246:247],v[30:31]
v_pk_mul_f32 v[236:237],v[236:237],v[32:33]
v_pk_mul_f32 v[238:239],v[238:239],v[32:33]
v_pk_mul_f32 v[248:249],v[248:249],v[32:33]
v_pk_mul_f32 v[250:251],v[250:251],v[32:33]
v_pk_mul_f32 v[240:241],v[240:241],v[34:35]
v_pk_mul_f32 v[242:243],v[242:243],v[34:35]
v_pk_mul_f32 v[252:253],v[252:253],v[34:35]
v_pk_mul_f32 v[254:255],v[254:255],v[34:35]
C v64,v232,v233
C v65,v234,v235
C v66,v244,v245
C v67,v246,v247
ds_write_b128 v36,v[64:67] offset:15360
C v68,v236,v237
C v69,v238,v239
C v70,v248,v249
C v71,v250,v251
ds_write_b128 v36,v[68:71] offset:16384
C v72,v240,v241
C v73,v242,v243
C v74,v252,v253
C v75,v254,v255
ds_write_b128 v36,v[72:75] offset:17408
s_waitcnt lgkmcnt(0)
s_barrier
ds_read_b128 v[112:115],v37
ds_read_b128 v[116:119],v37 offset:1024
ds_read_b128 v[120:123],v37 offset:2048
ds_read_b128 v[124:127],v37 offset:3072
ds_read_b128 v[128:131],v37 offset:4096
ds_read_b128 v[132:135],v37 offset:5120
M v[76:79],a[216:219],a[0:3],0
T a[236:237],v14 offset:8192
ds_read_b128 v[136:139],v37 offset:6144
M v[80:83],a[216:219],a[4:7],0
T a[238:239],v14 offset:10240
ds_read_b128 v[140:143],v37 offset:7168
M v[84:87],a[216:219],a[8:11],0
ds_read_b128 v[144:147],v37 offset:8192
ds_read_b128 v[148:151],v37 offset:9216
M v[96:99],a[220:223],a[8:11],0
T a[216:217],v13 offset:12288
ds_read_b128 v[152:155],v37 offset:10240
M v[92:95],a[220:223],a[4:7],0
T a[218:219],v13 offset:14336
ds_read_b128 v[156:159],v37 offset:11264
M v[88:91],a[220:223],a[0:3],0
ds_read_b128 v[160:163],v37 offset:12288
ds_read_b128 v[164:167],v37 offset:13312
M v[76:79],a[224:227],a[12:15],v[76:79]
T a[220:221],v14 offset:12288
ds_read_b128 v[168:171],v37 offset:14336
M v[80:83],a[224:227],a[16:19],v[80:83]
T a[222:223],v14 offset:14336
ds_read_b128 v[172:175],v37 offset:15360
M v[84:87],a[224:227],a[20:23],v[84:87]
ds_read_b128 v[176:179],v37 offset:16384
s_waitcnt lgkmcnt(14)
M v[96:99],a[228:231],a[20:23],v[96:99]
T a[224:225],v13 offset:16384
ds_read_b128 v[180:183],v37 offset:17408
M v[92:95],a[228:231],a[16:19],v[92:95]
T a[226:227],v13 offset:18432
ds_read_b128 v[184:187],v38
M v[88:91],a[228:231],a[12:15],v[88:91]
ds_read_b128 v[188:191],v38 offset:1024
ds_read_b128 v[192:195],v38 offset:2048
M v[76:79],a[232:235],a[24:27],v[76:79]
T a[228:229],v14 offset:16384
ds_read_b128 v[196:199],v38 offset:3072
M v[80:83],a[232:235],a[28:31],v[80:83]
T a[230:231],v14 offset:18432
ds_read_b128 v[200:203],v38 offset:4096
M v[84:87],a[232:235],a[32:35],v[84:87]
ds_read_b128 v[204:207],v38 offset:5120
ds_read_b128 v[208:211],v38 offset:6144
M v[96:99],a[236:239],a[32:35],v[96:99]
T a[232:233],v13 offset:20480
ds_read_b128 v[212:215],v38 offset:7168
M v[92:95],a[236:239],a[28:31],v[92:95]
T a[234:235],v13 offset:22528
ds_read_b128 v[216:219],v38 offset:8192
M v[88:91],a[236:239],a[24:27],v[88:91]
ds_read_b128 v[220:223],v38 offset:9216
s_waitcnt lgkmcnt(14)
M v[76:79],a[216:219],a[36:39],v[76:79]
T a[236:237],v14 offset:20480
ds_read_b128 v[224:227],v38 offset:10240
M v[80:83],a[216:219],a[40:43],v[80:83]
T a[238:239],v14 offset:22528
ds_read_b128 v[228:231],v38 offset:11264
M v[84:87],a[216:219],a[44:47],v[84:87]
ds_read_b128 v[232:235],v38 offset:12288
ds_read_b128 v[236:239],v38 offset:13312
M v[96:99],a[220:223],a[44:47],v[96:99]
ds_read_b128 v[240:243],v38 offset:14336
ds_read_b128 v[244:247],v38 offset:15360
M v[92:95],a[220:223],a[40:43],v[92:95]
ds_read_b128 v[248:251],v38 offset:16384
ds_read_b128 v[252:255],v38 offset:17408
M v[88:91],a[220:223],a[36:39],v[88:91]
M v[76:79],a[224:227],a[48:51],v[76:79]
M v[80:83],a[224:227],a[52:55],v[80:83]
M v[84:87],a[224:227],a[56:59],v[84:87]
s_waitcnt vmcnt(6) lgkmcnt(0)
s_barrier
M v[96:99],a[228:231],a[56:59],v[96:99]
T a[216:217],v13 offset:24576
T a[218:219],v13 offset:26624
M v[92:95],a[228:231],a[52:55],v[92:95]
T a[220:221],v14 offset:24576
T a[222:223],v14 offset:26624
M v[88:91],a[228:231],a[48:51],v[88:91]
T a[224:225],v13 offset:28672
T a[226:227],v13 offset:30720
M v[76:79],a[232:235],a[60:63],v[76:79]
T a[228:229],v14 offset:28672
T a[230:231],v14 offset:30720
M v[80:83],a[232:235],a[64:67],v[80:83]
s_add_u32 m0,s28,0x12000
s_add_u32 s35,s32,0x7800
M v[84:87],a[232:235],a[68:71],v[84:87]
T a[232:233],v13 offset:32768
T a[234:235],v13 offset:34816
M v[96:99],a[236:239],a[68:71],v[96:99]
L v106,s[16:19],s32 offen lds
L v107,s[16:19],s32 offen offset:1024 lds
M v[92:95],a[236:239],a[64:67],v[92:95]
M v[88:91],a[236:239],a[60:63],v[88:91]
s_waitcnt lgkmcnt(4)
M v[76:79],a[216:219],a[72:75],v[76:79]
T a[236:237],v14 offset:32768
L v108,s[16:19],s32 offen offset:2048 lds
M v[80:83],a[216:219],a[76:79],v[80:83]
T a[238:239],v14 offset:34816
M v[84:87],a[216:219],a[80:83],v[84:87]
s_add_u32 m0,m0,0xc00
M v[96:99],a[220:223],a[80:83],v[96:99]
T a[216:217],v13 offset:36864
s_add_u32 s32,s32,0xfff4c080
M v[92:95],a[220:223],a[76:79],v[92:95]
T a[218:219],v13 offset:38912
M v[88:91],a[220:223],a[72:75],v[88:91]
L v106,s[16:19],s35 offen lds
M v[76:79],a[224:227],a[84:87],v[76:79]
T a[220:221],v14 offset:36864
M v[80:83],a[224:227],a[88:91],v[80:83]
T a[222:223],v14 offset:38912
L v107,s[16:19],s35 offen offset:1024 lds
M v[84:87],a[224:227],a[92:95],v[84:87]
s_waitcnt lgkmcnt(4)
M v[96:99],a[228:231],a[92:95],v[96:99]
T a[224:225],v13 offset:40960
L v108,s[16:19],s35 offen offset:2048 lds
M v[92:95],a[228:231],a[88:91],v[92:95]
T a[226:227],v13 offset:43008
M v[88:91],a[228:231],a[84:87],v[88:91]
M v[76:79],a[232:235],a[96:99],v[76:79]
T a[228:229],v14 offset:40960
M v[80:83],a[232:235],a[100:103],v[80:83]
T a[230:231],v14 offset:43008
M v[84:87],a[232:235],a[104:107],v[84:87]
s_cmp_eq_u32 s32,s43
s_cselect_b32 s32,s42,s32
M v[96:99],a[236:239],a[104:107],v[96:99]
T a[232:233],v13 offset:45056
s_add_u32 m0,s28,0
M v[92:95],a[236:239],a[100:103],v[92:95]
T a[234:235],v13 offset:47104
M v[88:91],a[236:239],a[96:99],v[88:91]
s_add_u32 s35,s32,0x7800
s_waitcnt lgkmcnt(4)
M v[76:79],a[216:219],a[108:111],v[76:79]
T a[236:237],v14 offset:45056
M v[80:83],a[216:219],a[112:115],v[80:83]
T a[238:239],v14 offset:47104
L v106,s[16:19],s32 offen lds
M v[84:87],a[216:219],a[116:119],v[84:87]
M v[96:99],a[220:223],a[116:119],v[96:99]
L v107,s[16:19],s32 offen offset:1024 lds
M v[92:95],a[220:223],a[112:115],v[92:95]
L v108,s[16:19],s32 offen offset:2048 lds
M v[88:91],a[220:223],a[108:111],v[88:91]
s_add_u32 m0,m0,0xc00
M v[76:79],a[224:227],a[120:123],v[76:79]
s_add_u32 s32,s32,0x78000
M v[80:83],a[224:227],a[124:127],v[80:83]
L v106,s[16:19],s35 offen lds
M v[84:87],a[224:227],a[128:131],v[84:87]
s_waitcnt vmcnt(10) lgkmcnt(0)
s_barrier
M v[96:99],a[228:231],a[128:131],v[96:99]
T a[216:217],v15
T a[218:219],v15 offset:2048
M v[92:95],a[228:231],a[124:127],v[92:95]
T a[220:221],v16
T a[222:223],v16 offset:2048
M v[88:91],a[228:231],a[120:123],v[88:91]
T a[224:225],v15 offset:4096
T a[226:227],v15 offset:6144
M v[76:79],a[232:235],a[132:135],v[76:79]
T a[228:229],v16 offset:4096
T a[230:231],v16 offset:6144
M v[80:83],a[232:235],a[136:139],v[80:83]
M v[84:87],a[232:235],a[140:143],v[84:87]
T a[232:233],v15 offset:8192
T a[234:235],v15 offset:10240
M v[96:99],a[236:239],a[140:143],v[96:99]
L v107,s[16:19],s35 offen offset:1024 lds
M v[92:95],a[236:239],a[136:139],v[92:95]
L v108,s[16:19],s35 offen offset:2048 lds
M v[88:91],a[236:239],a[132:135],v[88:91]
s_waitcnt lgkmcnt(4)
M v[76:79],a[216:219],v[112:115],v[76:79]
T a[236:237],v16 offset:8192
s_add_u32 m0,s28,0x6000
M v[80:83],a[216:219],v[116:119],v[80:83]
T a[238:239],v16 offset:10240
M v[84:87],a[216:219],v[120:123],v[84:87]
M v[96:99],a[220:223],v[120:123],v[96:99]
T a[216:217],v15 offset:12288
s_add_u32 s35,s32,0x7800
M v[92:95],a[220:223],v[116:119],v[92:95]
T a[218:219],v15 offset:14336
M v[88:91],a[220:223],v[112:115],v[88:91]
M v[76:79],a[224:227],v[124:127],v[76:79]
T a[220:221],v16 offset:12288
L v106,s[16:19],s32 offen lds
M v[80:83],a[224:227],v[128:131],v[80:83]
T a[222:223],v16 offset:14336
M v[84:87],a[224:227],v[132:135],v[84:87]
s_waitcnt lgkmcnt(4)
M v[96:99],a[228:231],v[132:135],v[96:99]
T a[224:225],v15 offset:16384
M v[92:95],a[228:231],v[128:131],v[92:95]
T a[226:227],v15 offset:18432
L v107,s[16:19],s32 offen offset:1024 lds
M v[88:91],a[228:231],v[124:127],v[88:91]
M v[76:79],a[232:235],v[136:139],v[76:79]
T a[228:229],v16 offset:16384
M v[80:83],a[232:235],v[140:143],v[80:83]
T a[230:231],v16 offset:18432
M v[84:87],a[232:235],v[144:147],v[84:87]
L v108,s[16:19],s32 offen offset:2048 lds
M v[96:99],a[236:239],v[144:147],v[96:99]
T a[232:233],v15 offset:20480
M v[92:95],a[236:239],v[140:143],v[92:95]
T a[234:235],v15 offset:22528
M v[88:91],a[236:239],v[136:139],v[88:91]
s_add_u32 m0,m0,0xc00
s_waitcnt lgkmcnt(4)
M v[76:79],a[216:219],v[148:151],v[76:79]
T a[236:237],v16 offset:20480
M v[80:83],a[216:219],v[152:155],v[80:83]
T a[238:239],v16 offset:22528
M v[84:87],a[216:219],v[156:159],v[84:87]
s_add_u32 s32,s32,0xfffc4000
M v[96:99],a[220:223],v[156:159],v[96:99]
M v[92:95],a[220:223],v[152:155],v[92:95]
M v[88:91],a[220:223],v[148:151],v[88:91]
L v106,s[16:19],s35 offen lds
M v[76:79],a[224:227],v[160:163],v[76:79]
M v[80:83],a[224:227],v[164:167],v[80:83]
L v107,s[16:19],s35 offen offset:1024 lds
M v[84:87],a[224:227],v[168:171],v[84:87]
s_waitcnt vmcnt(11) lgkmcnt(0)
s_barrier
M v[96:99],a[228:231],v[168:171],v[96:99]
T a[216:217],v15 offset:24576
T a[218:219],v15 offset:26624
M v[92:95],a[228:231],v[164:167],v[92:95]
T a[220:221],v16 offset:24576
T a[222:223],v16 offset:26624
M v[88:91],a[228:231],v[160:163],v[88:91]
T a[224:225],v15 offset:28672
T a[226:227],v15 offset:30720
M v[76:79],a[232:235],v[172:175],v[76:79]
T a[228:229],v16 offset:28672
T a[230:231],v16 offset:30720
M v[80:83],a[232:235],v[176:179],v[80:83]
M v[84:87],a[232:235],v[180:183],v[84:87]
T a[232:233],v15 offset:32768
T a[234:235],v15 offset:34816
M v[96:99],a[236:239],v[180:183],v[96:99]
L v108,s[16:19],s35 offen offset:2048 lds
M v[92:95],a[236:239],v[176:179],v[92:95]
M v[88:91],a[236:239],v[172:175],v[88:91]
s_waitcnt lgkmcnt(4)
M v[76:79],a[216:219],v[184:187],v[76:79]
T a[236:237],v16 offset:32768
s_add_u32 m0,s28,0xc000
M v[80:83],a[216:219],v[188:191],v[80:83]
T a[238:239],v16 offset:34816
M v[84:87],a[216:219],v[192:195],v[84:87]
M v[96:99],a[220:223],v[192:195],v[96:99]
T a[216:217],v15 offset:36864
s_add_u32 s35,s32,0x7800
M v[92:95],a[220:223],v[188:191],v[92:95]
T a[218:219],v15 offset:38912
M v[88:91],a[220:223],v[184:187],v[88:91]
M v[76:79],a[224:227],v[196:199],v[76:79]
T a[220:221],v16 offset:36864
L v106,s[16:19],s32 offen lds
M v[80:83],a[224:227],v[200:203],v[80:83]
T a[222:223],v16 offset:38912
M v[84:87],a[224:227],v[204:207],v[84:87]
s_waitcnt lgkmcnt(4)
M v[96:99],a[228:231],v[204:207],v[96:99]
T a[224:225],v15 offset:40960
M v[92:95],a[228:231],v[200:203],v[92:95]
T a[226:227],v15 offset:43008
L v107,s[16:19],s32 offen offset:1024 lds
M v[88:91],a[228:231],v[196:199],v[88:91]
M v[76:79],a[232:235],v[208:211],v[76:79]
T a[228:229],v16 offset:40960
M v[80:83],a[232:235],v[212:215],v[80:83]
T a[230:231],v16 offset:43008
M v[84:87],a[232:235],v[216:219],v[84:87]
L v108,s[16:19],s32 offen offset:2048 lds
M v[96:99],a[236:239],v[216:219],v[96:99]
T a[232:233],v15 offset:45056
M v[92:95],a[236:239],v[212:215],v[92:95]
T a[234:235],v15 offset:47104
M v[88:91],a[236:239],v[208:211],v[88:91]
s_add_u32 m0,m0,0xc00
s_waitcnt lgkmcnt(4)
M v[76:79],a[216:219],v[220:223],v[76:79]
T a[236:237],v16 offset:45056
M v[80:83],a[216:219],v[224:227],v[80:83]
T a[238:239],v16 offset:47104
M v[84:87],a[216:219],v[228:231],v[84:87]
s_add_u32 s32,s32,0x78000
M v[96:99],a[220:223],v[228:231],v[96:99]
M v[92:95],a[220:223],v[224:227],v[92:95]
M v[88:91],a[220:223],v[220:223],v[88:91]
L v106,s[16:19],s35 offen lds
M v[76:79],a[224:227],v[232:235],v[76:79]
M v[80:83],a[224:227],v[236:239],v[80:83]
L v107,s[16:19],s35 offen offset:1024 lds
M v[84:87],a[224:227],v[240:243],v[84:87]
s_waitcnt vmcnt(11) lgkmcnt(0)
s_barrier
M v[96:99],a[228:231],v[240:243],v[96:99]
T a[216:217],v13
T a[218:219],v13 offset:2048
M v[92:95],a[228:231],v[236:239],v[92:95]
T a[220:221],v14
T a[222:223],v14 offset:2048
M v[88:91],a[228:231],v[232:235],v[88:91]
T a[224:225],v13 offset:4096
T a[226:227],v13 offset:6144
M v[76:79],a[232:235],v[244:247],v[76:79]
T a[228:229],v14 offset:4096
T a[230:231],v14 offset:6144
M v[80:83],a[232:235],v[248:251],v[80:83]
M v[84:87],a[232:235],v[252:255],v[84:87]
T a[232:233],v13 offset:8192
T a[234:235],v13 offset:10240
M v[96:99],a[236:239],v[252:255],v[96:99]
L v108,s[16:19],s35 offen offset:2048 lds
M v[92:95],a[236:239],v[248:251],v[92:95]
M v[88:91],a[236:239],v[244:247],v[88:91]
s_waitcnt lgkmcnt(4)
M v[52:55],a[216:219],a[0:3],0
T a[236:237],v14 offset:8192
s_add_u32 m0,s28,0x12000
M v[56:59],a[216:219],a[4:7],0
T a[238:239],v14 offset:10240
M v[60:63],a[216:219],a[8:11],0
s_add_u32 s35,s32,0x7800
M v[72:75],a[220:223],a[8:11],0
T a[216:217],v13 offset:12288
C v40,v76,v77
M v[68:71],a[220:223],a[4:7],0
T a[218:219],v13 offset:14336
M v[64:67],a[220:223],a[0:3],0
L v106,s[16:19],s32 offen lds
M v[52:55],a[224:227],a[12:15],v[52:55]
T a[220:221],v14 offset:12288
M v[56:59],a[224:227],a[16:19],v[56:59]
T a[222:223],v14 offset:14336
C v41,v78,v79
M v[60:63],a[224:227],a[20:23],v[60:63]
L v107,s[16:19],s32 offen offset:1024 lds
s_waitcnt lgkmcnt(4)
M v[72:75],a[228:231],a[20:23],v[72:75]
T a[224:225],v13 offset:16384
M v[68:71],a[228:231],a[16:19],v[68:71]
T a[226:227],v13 offset:18432
M v[64:67],a[228:231],a[12:15],v[64:67]
L v108,s[16:19],s32 offen offset:2048 lds
M v[52:55],a[232:235],a[24:27],v[52:55]
T a[228:229],v14 offset:16384
C v42,v88,v89
M v[56:59],a[232:235],a[28:31],v[56:59]
T a[230:231],v14 offset:18432
M v[60:63],a[232:235],a[32:35],v[60:63]
s_add_u32 m0,m0,0xc00
M v[72:75],a[236:239],a[32:35],v[72:75]
T a[232:233],v13 offset:20480
M v[68:71],a[236:239],a[28:31],v[68:71]
T a[234:235],v13 offset:22528
s_add_u32 s32,s32,0xfff4c080
M v[64:67],a[236:239],a[24:27],v[64:67]
C v43,v90,v91
s_waitcnt lgkmcnt(4)
M v[52:55],a[216:219],a[36:39],v[52:55]
T a[236:237],v14 offset:20480
M v[56:59],a[216:219],a[40:43],v[56:59]
T a[238:239],v14 offset:22528
M v[60:63],a[216:219],a[44:47],v[60:63]
L v106,s[16:19],s35 offen lds
M v[72:75],a[220:223],a[44:47],v[72:75]
C v44,v80,v81
M v[68:71],a[220:223],a[40:43],v[68:71]
L v107,s[16:19],s35 offen offset:1024 lds
M v[64:67],a[220:223],a[36:39],v[64:67]
L v108,s[16:19],s35 offen offset:2048 lds
M v[52:55],a[224:227],a[48:51],v[52:55]
C v45,v82,v83
M v[56:59],a[224:227],a[52:55],v[56:59]
M v[60:63],a[224:227],a[56:59],v[60:63]
s_waitcnt vmcnt(12) lgkmcnt(0)
s_barrier
M v[72:75],a[228:231],a[56:59],v[72:75]
T a[216:217],v13 offset:24576
T a[218:219],v13 offset:26624
M v[68:71],a[228:231],a[52:55],v[68:71]
T a[220:221],v14 offset:24576
T a[222:223],v14 offset:26624
M v[64:67],a[228:231],a[48:51],v[64:67]
T a[224:225],v13 offset:28672
T a[226:227],v13 offset:30720
M v[52:55],a[232:235],a[60:63],v[52:55]
T a[228:229],v14 offset:28672
T a[230:231],v14 offset:30720
M v[56:59],a[232:235],a[64:67],v[56:59]
M v[60:63],a[232:235],a[68:71],v[60:63]
T a[232:233],v13 offset:32768
T a[234:235],v13 offset:34816
M v[72:75],a[236:239],a[68:71],v[72:75]
C v46,v92,v93
M v[68:71],a[236:239],a[64:67],v[68:71]
s_cmp_eq_u32 s32,s43
s_cselect_b32 s32,s42,s32
M v[64:67],a[236:239],a[60:63],v[64:67]
s_waitcnt lgkmcnt(4)
M v[52:55],a[216:219],a[72:75],v[52:55]
T a[236:237],v14 offset:32768
s_add_u32 m0,s28,0
M v[56:59],a[216:219],a[76:79],v[56:59]
T a[238:239],v14 offset:34816
C v47,v94,v95
M v[60:63],a[216:219],a[80:83],v[60:63]
M v[72:75],a[220:223],a[80:83],v[72:75]
T a[216:217],v13 offset:36864
s_add_u32 s35,s32,0x7800
M v[68:71],a[220:223],a[76:79],v[68:71]
T a[218:219],v13 offset:38912
M v[64:67],a[220:223],a[72:75],v[64:67]
C v48,v84,v85
M v[52:55],a[224:227],a[84:87],v[52:55]
T a[220:221],v14 offset:36864
L v106,s[16:19],s32 offen lds
M v[56:59],a[224:227],a[88:91],v[56:59]
T a[222:223],v14 offset:38912
M v[60:63],a[224:227],a[92:95],v[60:63]
s_waitcnt lgkmcnt(4)
M v[72:75],a[228:231],a[92:95],v[72:75]
T a[224:225],v13 offset:40960
M v[68:71],a[228:231],a[88:91],v[68:71]
T a[226:227],v13 offset:43008
L v107,s[16:19],s32 offen offset:1024 lds
M v[64:67],a[228:231],a[84:87],v[64:67]
C v49,v86,v87
M v[52:55],a[232:235],a[96:99],v[52:55]
T a[228:229],v14 offset:40960
M v[56:59],a[232:235],a[100:103],v[56:59]
T a[230:231],v14 offset:43008
L v108,s[16:19],s32 offen offset:2048 lds
M v[60:63],a[232:235],a[104:107],v[60:63]
M v[72:75],a[236:239],a[104:107],v[72:75]
T a[232:233],v13 offset:45056
C v50,v96,v97
M v[68:71],a[236:239],a[100:103],v[68:71]
T a[234:235],v13 offset:47104
M v[64:67],a[236:239],a[96:99],v[64:67]
s_add_u32 m0,m0,0xc00
s_waitcnt lgkmcnt(4)
M v[52:55],a[216:219],a[108:111],v[52:55]
T a[236:237],v14 offset:45056
M v[56:59],a[216:219],a[112:115],v[56:59]
T a[238:239],v14 offset:47104
M v[60:63],a[216:219],a[116:119],v[60:63]
C v51,v98,v99
s_add_u32 s32,s32,0x78000
M v[72:75],a[220:223],a[116:119],v[72:75]
M v[68:71],a[220:223],a[112:115],v[68:71]
L v106,s[16:19],s35 offen lds
M v[64:67],a[220:223],a[108:111],v[64:67]
AW a144,v40
M v[52:55],a[224:227],a[120:123],v[52:55]
L v107,s[16:19],s35 offen offset:1024 lds
M v[56:59],a[224:227],a[124:127],v[56:59]
M v[60:63],a[224:227],a[128:131],v[60:63]
s_waitcnt vmcnt(11) lgkmcnt(0)
s_barrier
M v[72:75],a[228:231],a[128:131],v[72:75]
T a[216:217],v15
T a[218:219],v15 offset:2048
M v[68:71],a[228:231],a[124:127],v[68:71]
T a[220:221],v16
T a[222:223],v16 offset:2048
M v[64:67],a[228:231],a[120:123],v[64:67]
T a[224:225],v15 offset:4096
T a[226:227],v15 offset:6144
M v[52:55],a[232:235],a[132:135],v[52:55]
T a[228:229],v16 offset:4096
T a[230:231],v16 offset:6144
M v[56:59],a[232:235],a[136:139],v[56:59]
AW a145,v41
M v[60:63],a[232:235],a[140:143],v[60:63]
T a[232:233],v15 offset:8192
T a[234:235],v15 offset:10240
M v[72:75],a[236:239],a[140:143],v[72:75]
L v108,s[16:19],s35 offen offset:2048 lds
M v[68:71],a[236:239],a[136:139],v[68:71]
M v[64:67],a[236:239],a[132:135],v[64:67]
AW a146,v42
s_waitcnt lgkmcnt(4)
M v[52:55],a[216:219],v[112:115],v[52:55]
T a[236:237],v16 offset:8192
s_add_u32 m0,s28,0x6000
M v[56:59],a[216:219],v[116:119],v[56:59]
T a[238:239],v16 offset:10240
M v[60:63],a[216:219],v[120:123],v[60:63]
s_add_u32 s35,s32,0x7800
M v[72:75],a[220:223],v[120:123],v[72:75]
T a[216:217],v15 offset:12288
M v[68:71],a[220:223],v[116:119],v[68:71]
T a[218:219],v15 offset:14336
AW a147,v43
M v[64:67],a[220:223],v[112:115],v[64:67]
M v[52:55],a[224:227],v[124:127],v[52:55]
T a[220:221],v16 offset:12288
L v106,s[16:19],s32 offen lds
M v[56:59],a[224:227],v[128:131],v[56:59]
T a[222:223],v16 offset:14336
M v[60:63],a[224:227],v[132:135],v[60:63]
s_waitcnt lgkmcnt(4)
M v[72:75],a[228:231],v[132:135],v[72:75]
T a[224:225],v15 offset:16384
AW a148,v44
M v[68:71],a[228:231],v[128:131],v[68:71]
T a[226:227],v15 offset:18432
L v107,s[16:19],s32 offen offset:1024 lds
M v[64:67],a[228:231],v[124:127],v[64:67]
M v[52:55],a[232:235],v[136:139],v[52:55]
T a[228:229],v16 offset:16384
M v[56:59],a[232:235],v[140:143],v[56:59]
T a[230:231],v16 offset:18432
AW a149,v45
M v[60:63],a[232:235],v[144:147],v[60:63]
L v108,s[16:19],s32 offen offset:2048 lds
M v[72:75],a[236:239],v[144:147],v[72:75]
T a[232:233],v15 offset:20480
M v[68:71],a[236:239],v[140:143],v[68:71]
T a[234:235],v15 offset:22528
s_add_u32 m0,m0,0xc00
M v[64:67],a[236:239],v[136:139],v[64:67]
s_waitcnt lgkmcnt(4)
M v[52:55],a[216:219],v[148:151],v[52:55]
T a[236:237],v16 offset:20480
AW a150,v46
M v[56:59],a[216:219],v[152:155],v[56:59]
T a[238:239],v16 offset:22528
M v[60:63],a[216:219],v[156:159],v[60:63]
s_add_u32 s32,s32,0xfffc4000
M v[72:75],a[220:223],v[156:159],v[72:75]
M v[68:71],a[220:223],v[152:155],v[68:71]
AW a151,v47
M v[64:67],a[220:223],v[148:151],v[64:67]
L v106,s[16:19],s35 offen lds
M v[52:55],a[224:227],v[160:163],v[52:55]
L v107,s[16:19],s35 offen offset:1024 lds
M v[56:59],a[224:227],v[164:167],v[56:59]
AW a152,v48
M v[60:63],a[224:227],v[168:171],v[60:63]
s_waitcnt vmcnt(11) lgkmcnt(0)
s_barrier
M v[72:75],a[228:231],v[168:171],v[72:75]
T a[216:217],v15 offset:24576
T a[218:219],v15 offset:26624
M v[68:71],a[228:231],v[164:167],v[68:71]
T a[220:221],v16 offset:24576
T a[222:223],v16 offset:26624
M v[64:67],a[228:231],v[160:163],v[64:67]
T a[224:225],v15 offset:28672
T a[226:227],v15 offset:30720
M v[52:55],a[232:235],v[172:175],v[52:55]
T a[228:229],v16 offset:28672
T a[230:231],v16 offset:30720
M v[56:59],a[232:235],v[176:179],v[56:59]
M v[60:63],a[232:235],v[180:183],v[60:63]
T a[232:233],v15 offset:32768
T a[234:235],v15 offset:34816
M v[72:75],a[236:239],v[180:183],v[72:75]
L v108,s[16:19],s35 offen offset:2048 lds
M v[68:71],a[236:239],v[176:179],v[68:71]
AW a153,v49
M v[64:67],a[236:239],v[172:175],v[64:67]
s_waitcnt lgkmcnt(4)
M v[52:55],a[216:219],v[184:187],v[52:55]
T a[236:237],v16 offset:32768
s_add_u32 m0,s28,0xc000
M v[56:59],a[216:219],v[188:191],v[56:59]
T a[238:239],v16 offset:34816
M v[60:63],a[216:219],v[192:195],v[60:63]
AW a154,v50
M v[72:75],a[220:223],v[192:195],v[72:75]
T a[216:217],v15 offset:36864
s_add_u32 s35,s32,0x7800
M v[68:71],a[220:223],v[188:191],v[68:71]
T a[218:219],v15 offset:38912
M v[64:67],a[220:223],v[184:187],v[64:67]
M v[52:55],a[224:227],v[196:199],v[52:55]
T a[220:221],v16 offset:36864
AW a155,v51
M v[56:59],a[224:227],v[200:203],v[56:59]
T a[222:223],v16 offset:38912
L v106,s[16:19],s32 offen lds
M v[60:63],a[224:227],v[204:207],v[60:63]
s_waitcnt lgkmcnt(4)
M v[72:75],a[228:231],v[204:207],v[72:75]
T a[224:225],v15 offset:40960
M v[68:71],a[228:231],v[200:203],v[68:71]
T a[226:227],v15 offset:43008
M v[64:67],a[228:231],v[196:199],v[64:67]
s_mov_b32 s47,s44
L v107,s[16:19],s32 offen offset:1024 lds
M v[52:55],a[232:235],v[208:211],v[52:55]
T a[228:229],v16 offset:40960
M v[56:59],a[232:235],v[212:215],v[56:59]
T a[230:231],v16 offset:43008
M v[60:63],a[232:235],v[216:219],v[60:63]
L v108,s[16:19],s32 offen offset:2048 lds
M v[72:75],a[236:239],v[216:219],v[72:75]
T a[232:233],v15 offset:45056
M v[68:71],a[236:239],v[212:215],v[68:71]
T a[234:235],v15 offset:47104
s_add_u32 s44,s44,0x3000
M v[64:67],a[236:239],v[208:211],v[64:67]
s_waitcnt lgkmcnt(4)
M v[52:55],a[216:219],v[220:223],v[52:55]
T a[236:237],v16 offset:45056
s_add_u32 m0,m0,0xc00
M v[56:59],a[216:219],v[224:227],v[56:59]
T a[238:239],v16 offset:47104
M v[60:63],a[216:219],v[228:231],v[60:63]
M v[72:75],a[220:223],v[228:231],v[72:75]
s_add_u32 s32,s32,0x78000
M v[68:71],a[220:223],v[224:227],v[68:71]
L v106,s[16:19],s35 offen lds
M v[64:67],a[220:223],v[220:223],v[64:67]
M v[52:55],a[224:227],v[232:235],v[52:55]
s_cmp_eq_u32 s44,s46
s_cselect_b32 s44,s45,s44
M v[56:59],a[224:227],v[236:239],v[56:59]
L v107,s[16:19],s35 offen offset:1024 lds
M v[60:63],a[224:227],v[240:243],v[60:63]
s_waitcnt vmcnt(11) lgkmcnt(0)
s_barrier
M v[72:75],a[228:231],v[240:243],v[72:75]
T a[216:217],v13
T a[218:219],v13 offset:2048
M v[68:71],a[228:231],v[236:239],v[68:71]
T a[220:221],v14
T a[222:223],v14 offset:2048
M v[64:67],a[228:231],v[232:235],v[64:67]
T a[224:225],v13 offset:4096
T a[226:227],v13 offset:6144
M v[52:55],a[232:235],v[244:247],v[52:55]
T a[228:229],v14 offset:4096
T a[230:231],v14 offset:6144
M v[56:59],a[232:235],v[248:251],v[56:59]
M v[60:63],a[232:235],v[252:255],v[60:63]
T a[232:233],v13 offset:8192
T a[234:235],v13 offset:10240
M v[72:75],a[236:239],v[252:255],v[72:75]
L v108,s[16:19],s35 offen offset:2048 lds
M v[68:71],a[236:239],v[248:251],v[68:71]
M v[64:67],a[236:239],v[244:247],v[64:67]
s_waitcnt lgkmcnt(4)
M v[76:79],a[216:219],a[0:3],0
T a[236:237],v14 offset:8192
s_add_u32 m0,s28,0x12000
M v[80:83],a[216:219],a[4:7],0
T a[238:239],v14 offset:10240
M v[84:87],a[216:219],a[8:11],0
s_add_u32 s35,s32,0x7800
M v[96:99],a[220:223],a[8:11],0
T a[216:217],v13 offset:12288
C v40,v52,v53
M v[92:95],a[220:223],a[4:7],0
T a[218:219],v13 offset:14336
M v[88:91],a[220:223],a[0:3],0
L v106,s[16:19],s32 offen lds
M v[76:79],a[224:227],a[12:15],v[76:79]
T a[220:221],v14 offset:12288
M v[80:83],a[224:227],a[16:19],v[80:83]
T a[222:223],v14 offset:14336
L v107,s[16:19],s32 offen offset:1024 lds
M v[84:87],a[224:227],a[20:23],v[84:87]
C v41,v54,v55
s_waitcnt lgkmcnt(4)
M v[96:99],a[228:231],a[20:23],v[96:99]
T a[224:225],v13 offset:16384
M v[92:95],a[228:231],a[16:19],v[92:95]
T a[226:227],v13 offset:18432
M v[88:91],a[228:231],a[12:15],v[88:91]
L v108,s[16:19],s32 offen offset:2048 lds
M v[76:79],a[232:235],a[24:27],v[76:79]
T a[228:229],v14 offset:16384
M v[80:83],a[232:235],a[28:31],v[80:83]
T a[230:231],v14 offset:18432
C v42,v64,v65
M v[84:87],a[232:235],a[32:35],v[84:87]
s_add_u32 m0,m0,0xc00
M v[96:99],a[236:239],a[32:35],v[96:99]
T a[232:233],v13 offset:20480
M v[92:95],a[236:239],a[28:31],v[92:95]
T a[234:235],v13 offset:22528
s_add_u32 s32,s32,0xfff4c080
M v[88:91],a[236:239],a[24:27],v[88:91]
s_waitcnt lgkmcnt(4)
M v[76:79],a[216:219],a[36:39],v[76:79]
T a[236:237],v14 offset:20480
C v43,v66,v67
M v[80:83],a[216:219],a[40:43],v[80:83]
T a[238:239],v14 offset:22528
M v[84:87],a[216:219],a[44:47],v[84:87]
L v106,s[16:19],s35 offen lds
M v[96:99],a[220:223],a[44:47],v[96:99]
L v107,s[16:19],s35 offen offset:1024 lds
M v[92:95],a[220:223],a[40:43],v[92:95]
C v44,v56,v57
M v[88:91],a[220:223],a[36:39],v[88:91]
L v108,s[16:19],s35 offen offset:2048 lds
M v[76:79],a[224:227],a[48:51],v[76:79]
M v[80:83],a[224:227],a[52:55],v[80:83]
C v45,v58,v59
M v[84:87],a[224:227],a[56:59],v[84:87]
s_waitcnt vmcnt(12) lgkmcnt(0)
s_barrier
M v[96:99],a[228:231],a[56:59],v[96:99]
T a[216:217],v13 offset:24576
T a[218:219],v13 offset:26624
M v[92:95],a[228:231],a[52:55],v[92:95]
T a[220:221],v14 offset:24576
T a[222:223],v14 offset:26624
M v[88:91],a[228:231],a[48:51],v[88:91]
T a[224:225],v13 offset:28672
T a[226:227],v13 offset:30720
M v[76:79],a[232:235],a[60:63],v[76:79]
T a[228:229],v14 offset:28672
T a[230:231],v14 offset:30720
M v[80:83],a[232:235],a[64:67],v[80:83]
M v[84:87],a[232:235],a[68:71],v[84:87]
T a[232:233],v13 offset:32768
T a[234:235],v13 offset:34816
M v[96:99],a[236:239],a[68:71],v[96:99]
s_cmp_eq_u32 s32,s43
s_cselect_b32 s32,s42,s32
M v[92:95],a[236:239],a[64:67],v[92:95]
C v46,v68,v69
M v[88:91],a[236:239],a[60:63],v[88:91]
s_waitcnt lgkmcnt(4)
M v[76:79],a[216:219],a[72:75],v[76:79]
T a[236:237],v14 offset:32768
s_add_u32 m0,s28,0
M v[80:83],a[216:219],a[76:79],v[80:83]
T a[238:239],v14 offset:34816
M v[84:87],a[216:219],a[80:83],v[84:87]
C v47,v70,v71
M v[96:99],a[220:223],a[80:83],v[96:99]
T a[216:217],v13 offset:36864
s_add_u32 s35,s32,0x7800
M v[92:95],a[220:223],a[76:79],v[92:95]
T a[218:219],v13 offset:38912
M v[88:91],a[220:223],a[72:75],v[88:91]
M v[76:79],a[224:227],a[84:87],v[76:79]
T a[220:221],v14 offset:36864
L v106,s[16:19],s32 offen lds
M v[80:83],a[224:227],a[88:91],v[80:83]
T a[222:223],v14 offset:38912
C v48,v60,v61
M v[84:87],a[224:227],a[92:95],v[84:87]
s_waitcnt lgkmcnt(4)
M v[96:99],a[228:231],a[92:95],v[96:99]
T a[224:225],v13 offset:40960
M v[92:95],a[228:231],a[88:91],v[92:95]
T a[226:227],v13 offset:43008
L v107,s[16:19],s32 offen offset:1024 lds
M v[88:91],a[228:231],a[84:87],v[88:91]
M v[76:79],a[232:235],a[96:99],v[76:79]
T a[228:229],v14 offset:40960
C v49,v62,v63
M v[80:83],a[232:235],a[100:103],v[80:83]
T a[230:231],v14 offset:43008
M v[84:87],a[232:235],a[104:107],v[84:87]
L v108,s[16:19],s32 offen offset:2048 lds
M v[96:99],a[236:239],a[104:107],v[96:99]
T a[232:233],v13 offset:45056
M v[92:95],a[236:239],a[100:103],v[92:95]
T a[234:235],v13 offset:47104
s_add_u32 m0,m0,0xc00
M v[88:91],a[236:239],a[96:99],v[88:91]
C v50,v72,v73
s_waitcnt lgkmcnt(4)
M v[76:79],a[216:219],a[108:111],v[76:79]
T a[236:237],v14 offset:45056
M v[80:83],a[216:219],a[112:115],v[80:83]
T a[238:239],v14 offset:47104
M v[84:87],a[216:219],a[116:119],v[84:87]
s_add_u32 s32,s32,0x78000
M v[96:99],a[220:223],a[116:119],v[96:99]
C v51,v74,v75
M v[92:95],a[220:223],a[112:115],v[92:95]
M v[88:91],a[220:223],a[108:111],v[88:91]
L v106,s[16:19],s35 offen lds
M v[76:79],a[224:227],a[120:123],v[76:79]
AW a156,v40
M v[80:83],a[224:227],a[124:127],v[80:83]
L v107,s[16:19],s35 offen offset:1024 lds
M v[84:87],a[224:227],a[128:131],v[84:87]
s_waitcnt vmcnt(11) lgkmcnt(0)
s_barrier
M v[96:99],a[228:231],a[128:131],v[96:99]
T a[216:217],v15
T a[218:219],v15 offset:2048
M v[92:95],a[228:231],a[124:127],v[92:95]
T a[220:221],v16
T a[222:223],v16 offset:2048
M v[88:91],a[228:231],a[120:123],v[88:91]
T a[224:225],v15 offset:4096
T a[226:227],v15 offset:6144
M v[76:79],a[232:235],a[132:135],v[76:79]
T a[228:229],v16 offset:4096
T a[230:231],v16 offset:6144
M v[80:83],a[232:235],a[136:139],v[80:83]
M v[84:87],a[232:235],a[140:143],v[84:87]
T a[232:233],v15 offset:8192
T a[234:235],v15 offset:10240
M v[96:99],a[236:239],a[140:143],v[96:99]
AW a157,v41
L v108,s[16:19],s35 offen offset:2048 lds
M v[92:95],a[236:239],a[136:139],v[92:95]
M v[88:91],a[236:239],a[132:135],v[88:91]
s_waitcnt lgkmcnt(4)
M v[76:79],a[216:219],v[112:115],v[76:79]
T a[236:237],v16 offset:8192
s_add_u32 m0,s28,0x6000
M v[80:83],a[216:219],v[116:119],v[80:83]
T a[238:239],v16 offset:10240
M v[84:87],a[216:219],v[120:123],v[84:87]
AW a158,v42
M v[96:99],a[220:223],v[120:123],v[96:99]
T a[216:217],v15 offset:12288
s_add_u32 s35,s32,0x7800
M v[92:95],a[220:223],v[116:119],v[92:95]
T a[218:219],v15 offset:14336
M v[88:91],a[220:223],v[112:115],v[88:91]
M v[76:79],a[224:227],v[124:127],v[76:79]
T a[220:221],v16 offset:12288
AW a159,v43
M v[80:83],a[224:227],v[128:131],v[80:83]
T a[222:223],v16 offset:14336
L v106,s[16:19],s32 offen lds
M v[84:87],a[224:227],v[132:135],v[84:87]
s_waitcnt lgkmcnt(4)
M v[96:99],a[228:231],v[132:135],v[96:99]
T a[224:225],v15 offset:16384
M v[92:95],a[228:231],v[128:131],v[92:95]
T a[226:227],v15 offset:18432
L v107,s[16:19],s32 offen offset:1024 lds
M v[88:91],a[228:231],v[124:127],v[88:91]
AW a160,v44
M v[76:79],a[232:235],v[136:139],v[76:79]
T a[228:229],v16 offset:16384
M v[80:83],a[232:235],v[140:143],v[80:83]
T a[230:231],v16 offset:18432
M v[84:87],a[232:235],v[144:147],v[84:87]
L v108,s[16:19],s32 offen offset:2048 lds
M v[96:99],a[236:239],v[144:147],v[96:99]
T a[232:233],v15 offset:20480
M v[92:95],a[236:239],v[140:143],v[92:95]
T a[234:235],v15 offset:22528
AW a161,v45
M v[88:91],a[236:239],v[136:139],v[88:91]
s_add_u32 m0,m0,0xc00
s_waitcnt lgkmcnt(4)
M v[76:79],a[216:219],v[148:151],v[76:79]
T a[236:237],v16 offset:20480
M v[80:83],a[216:219],v[152:155],v[80:83]
T a[238:239],v16 offset:22528
M v[84:87],a[216:219],v[156:159],v[84:87]
s_add_u32 s32,s32,0xfffc4000
M v[96:99],a[220:223],v[156:159],v[96:99]
AW a162,v46
M v[92:95],a[220:223],v[152:155],v[92:95]
M v[88:91],a[220:223],v[148:151],v[88:91]
L v106,s[16:19],s35 offen lds
M v[76:79],a[224:227],v[160:163],v[76:79]
AW a163,v47
M v[80:83],a[224:227],v[164:167],v[80:83]
L v107,s[16:19],s35 offen offset:1024 lds
M v[84:87],a[224:227],v[168:171],v[84:87]
s_waitcnt vmcnt(11) lgkmcnt(0)
s_barrier
M v[96:99],a[228:231],v[168:171],v[96:99]
T a[216:217],v15 offset:24576
T a[218:219],v15 offset:26624
M v[92:95],a[228:231],v[164:167],v[92:95]
T a[220:221],v16 offset:24576
T a[222:223],v16 offset:26624
M v[88:91],a[228:231],v[160:163],v[88:91]
T a[224:225],v15 offset:28672
T a[226:227],v15 offset:30720
M v[76:79],a[232:235],v[172:175],v[76:79]
T a[228:229],v16 offset:28672
T a[230:231],v16 offset:30720
M v[80:83],a[232:235],v[176:179],v[80:83]
M v[84:87],a[232:235],v[180:183],v[84:87]
T a[232:233],v15 offset:32768
T a[234:235],v15 offset:34816
M v[96:99],a[236:239],v[180:183],v[96:99]
AW a164,v48
L v108,s[16:19],s35 offen offset:2048 lds
M v[92:95],a[236:239],v[176:179],v[92:95]
M v[88:91],a[236:239],v[172:175],v[88:91]
s_waitcnt lgkmcnt(4)
M v[76:79],a[216:219],v[184:187],v[76:79]
T a[236:237],v16 offset:32768
s_add_u32 m0,s28,0xc000
M v[80:83],a[216:219],v[188:191],v[80:83]
T a[238:239],v16 offset:34816
AW a165,v49
M v[84:87],a[216:219],v[192:195],v[84:87]
M v[96:99],a[220:223],v[192:195],v[96:99]
T a[216:217],v15 offset:36864
s_add_u32 s35,s32,0x7800
M v[92:95],a[220:223],v[188:191],v[92:95]
T a[218:219],v15 offset:38912
M v[88:91],a[220:223],v[184:187],v[88:91]
AW a166,v50
M v[76:79],a[224:227],v[196:199],v[76:79]
T a[220:221],v16 offset:36864
M v[80:83],a[224:227],v[200:203],v[80:83]
T a[222:223],v16 offset:38912
L v106,s[16:19],s32 offen lds
M v[84:87],a[224:227],v[204:207],v[84:87]
s_waitcnt lgkmcnt(4)
M v[96:99],a[228:231],v[204:207],v[96:99]
T a[224:225],v15 offset:40960
M v[92:95],a[228:231],v[200:203],v[92:95]
T a[226:227],v15 offset:43008
M v[88:91],a[228:231],v[196:199],v[88:91]
AW a167,v51
L v107,s[16:19],s32 offen offset:1024 lds
M v[76:79],a[232:235],v[208:211],v[76:79]
T a[228:229],v16 offset:40960
M v[80:83],a[232:235],v[212:215],v[80:83]
T a[230:231],v16 offset:43008
M v[84:87],a[232:235],v[216:219],v[84:87]
L v108,s[16:19],s32 offen offset:2048 lds
M v[96:99],a[236:239],v[216:219],v[96:99]
T a[232:233],v15 offset:45056
s_add_u32 s44,s44,0x3000
M v[92:95],a[236:239],v[212:215],v[92:95]
T a[234:235],v15 offset:47104
M v[88:91],a[236:239],v[208:211],v[88:91]
s_waitcnt lgkmcnt(4)
M v[76:79],a[216:219],v[220:223],v[76:79]
T a[236:237],v16 offset:45056
s_add_u32 m0,m0,0xc00
M v[80:83],a[216:219],v[224:227],v[80:83]
T a[238:239],v16 offset:47104
M v[84:87],a[216:219],v[228:231],v[84:87]
M v[96:99],a[220:223],v[228:231],v[96:99]
s_add_u32 s32,s32,0x78000
M v[92:95],a[220:223],v[224:227],v[92:95]
L v106,s[16:19],s35 offen lds
M v[88:91],a[220:223],v[220:223],v[88:91]
s_cmp_eq_u32 s44,s46
s_cselect_b32 s44,s45,s44
M v[76:79],a[224:227],v[232:235],v[76:79]
M v[80:83],a[224:227],v[236:239],v[80:83]
L v107,s[16:19],s35 offen offset:1024 lds
M v[84:87],a[224:227],v[240:243],v[84:87]
s_waitcnt vmcnt(11) lgkmcnt(0)
s_barrier
M v[96:99],a[228:231],v[240:243],v[96:99]
T a[216:217],v13
T a[218:219],v13 offset:2048
M v[92:95],a[228:231],v[236:239],v[92:95]
T a[220:221],v14
T a[222:223],v14 offset:2048
M v[88:91],a[228:231],v[232:235],v[88:91]
T a[224:225],v13 offset:4096
T a[226:227],v13 offset:6144
M v[76:79],a[232:235],v[244:247],v[76:79]
T a[228:229],v14 offset:4096
T a[230:231],v14 offset:6144
M v[80:83],a[232:235],v[248:251],v[80:83]
M v[84:87],a[232:235],v[252:255],v[84:87]
T a[232:233],v13 offset:8192
T a[234:235],v13 offset:10240
M v[96:99],a[236:239],v[252:255],v[96:99]
L v108,s[16:19],s35 offen offset:2048 lds
M v[92:95],a[236:239],v[248:251],v[92:95]
M v[88:91],a[236:239],v[244:247],v[88:91]
s_waitcnt lgkmcnt(4)
M v[52:55],a[216:219],a[0:3],0
T a[236:237],v14 offset:8192
s_add_u32 m0,s28,0x12000
M v[56:59],a[216:219],a[4:7],0
T a[238:239],v14 offset:10240
M v[60:63],a[216:219],a[8:11],0
s_add_u32 s35,s32,0x7800
M v[72:75],a[220:223],a[8:11],0
T a[216:217],v13 offset:12288
C v40,v76,v77
M v[68:71],a[220:223],a[4:7],0
T a[218:219],v13 offset:14336
M v[64:67],a[220:223],a[0:3],0
L v106,s[16:19],s32 offen lds
M v[52:55],a[224:227],a[12:15],v[52:55]
T a[220:221],v14 offset:12288
M v[56:59],a[224:227],a[16:19],v[56:59]
T a[222:223],v14 offset:14336
L v107,s[16:19],s32 offen offset:1024 lds
M v[60:63],a[224:227],a[20:23],v[60:63]
C v41,v78,v79
s_waitcnt lgkmcnt(4)
M v[72:75],a[228:231],a[20:23],v[72:75]
T a[224:225],v13 offset:16384
M v[68:71],a[228:231],a[16:19],v[68:71]
T a[226:227],v13 offset:18432
M v[64:67],a[228:231],a[12:15],v[64:67]
L v108,s[16:19],s32 offen offset:2048 lds
M v[52:55],a[232:235],a[24:27],v[52:55]
T a[228:229],v14 offset:16384
M v[56:59],a[232:235],a[28:31],v[56:59]
T a[230:231],v14 offset:18432
C v42,v88,v89
M v[60:63],a[232:235],a[32:35],v[60:63]
s_add_u32 m0,m0,0xc00
M v[72:75],a[236:239],a[32:35],v[72:75]
T a[232:233],v13 offset:20480
M v[68:71],a[236:239],a[28:31],v[68:71]
T a[234:235],v13 offset:22528
s_add_u32 s32,s32,0xfff4c080
M v[64:67],a[236:239],a[24:27],v[64:67]
s_waitcnt lgkmcnt(4)
M v[52:55],a[216:219],a[36:39],v[52:55]
T a[236:237],v14 offset:20480
C v43,v90,v91
M v[56:59],a[216:219],a[40:43],v[56:59]
T a[238:239],v14 offset:22528
M v[60:63],a[216:219],a[44:47],v[60:63]
L v106,s[16:19],s35 offen lds
M v[72:75],a[220:223],a[44:47],v[72:75]
L v107,s[16:19],s35 offen offset:1024 lds
M v[68:71],a[220:223],a[40:43],v[68:71]
C v44,v80,v81
M v[64:67],a[220:223],a[36:39],v[64:67]
L v108,s[16:19],s35 offen offset:2048 lds
M v[52:55],a[224:227],a[48:51],v[52:55]
M v[56:59],a[224:227],a[52:55],v[56:59]
C v45,v82,v83
M v[60:63],a[224:227],a[56:59],v[60:63]
s_waitcnt vmcnt(12) lgkmcnt(0)
s_barrier
M v[72:75],a[228:231],a[56:59],v[72:75]
T a[216:217],v13 offset:24576
T a[218:219],v13 offset:26624
M v[68:71],a[228:231],a[52:55],v[68:71]
T a[220:221],v14 offset:24576
T a[222:223],v14 offset:26624
M v[64:67],a[228:231],a[48:51],v[64:67]
T a[224:225],v13 offset:28672
T a[226:227],v13 offset:30720
M v[52:55],a[232:235],a[60:63],v[52:55]
T a[228:229],v14 offset:28672
T a[230:231],v14 offset:30720
M v[56:59],a[232:235],a[64:67],v[56:59]
M v[60:63],a[232:235],a[68:71],v[60:63]
T a[232:233],v13 offset:32768
T a[234:235],v13 offset:34816
M v[72:75],a[236:239],a[68:71],v[72:75]
s_cmp_eq_u32 s32,s43
s_cselect_b32 s32,s42,s32
M v[68:71],a[236:239],a[64:67],v[68:71]
C v46,v92,v93
M v[64:67],a[236:239],a[60:63],v[64:67]
s_waitcnt lgkmcnt(4)
M v[52:55],a[216:219],a[72:75],v[52:55]
T a[236:237],v14 offset:32768
s_add_u32 m0,s28,0
M v[56:59],a[216:219],a[76:79],v[56:59]
T a[238:239],v14 offset:34816
M v[60:63],a[216:219],a[80:83],v[60:63]
C v47,v94,v95
M v[72:75],a[220:223],a[80:83],v[72:75]
T a[216:217],v13 offset:36864
s_add_u32 s35,s32,0x7800
M v[68:71],a[220:223],a[76:79],v[68:71]
T a[218:219],v13 offset:38912
M v[64:67],a[220:223],a[72:75],v[64:67]
M v[52:55],a[224:227],a[84:87],v[52:55]
T a[220:221],v14 offset:36864
L v106,s[16:19],s32 offen lds
M v[56:59],a[224:227],a[88:91],v[56:59]
T a[222:223],v14 offset:38912
C v48,v84,v85
M v[60:63],a[224:227],a[92:95],v[60:63]
s_waitcnt lgkmcnt(4)
M v[72:75],a[228:231],a[92:95],v[72:75]
T a[224:225],v13 offset:40960
M v[68:71],a[228:231],a[88:91],v[68:71]
T a[226:227],v13 offset:43008
L v107,s[16:19],s32 offen offset:1024 lds
M v[64:67],a[228:231],a[84:87],v[64:67]
M v[52:55],a[232:235],a[96:99],v[52:55]
T a[228:229],v14 offset:40960
C v49,v86,v87
M v[56:59],a[232:235],a[100:103],v[56:59]
T a[230:231],v14 offset:43008
M v[60:63],a[232:235],a[104:107],v[60:63]
L v108,s[16:19],s32 offen offset:2048 lds
M v[72:75],a[236:239],a[104:107],v[72:75]
T a[232:233],v13 offset:45056
M v[68:71],a[236:239],a[100:103],v[68:71]
T a[234:235],v13 offset:47104
s_add_u32 m0,m0,0xc00
M v[64:67],a[236:239],a[96:99],v[64:67]
C v50,v96,v97
s_waitcnt lgkmcnt(4)
M v[52:55],a[216:219],a[108:111],v[52:55]
T a[236:237],v14 offset:45056
M v[56:59],a[216:219],a[112:115],v[56:59]
T a[238:239],v14 offset:47104
M v[60:63],a[216:219],a[116:119],v[60:63]
s_add_u32 s32,s32,0x78000
M v[72:75],a[220:223],a[116:119],v[72:75]
C v51,v98,v99
M v[68:71],a[220:223],a[112:115],v[68:71]
M v[64:67],a[220:223],a[108:111],v[64:67]
L v106,s[16:19],s35 offen lds
M v[52:55],a[224:227],a[120:123],v[52:55]
AW a168,v40
M v[56:59],a[224:227],a[124:127],v[56:59]
L v107,s[16:19],s35 offen offset:1024 lds
M v[60:63],a[224:227],a[128:131],v[60:63]
s_waitcnt vmcnt(11) lgkmcnt(0)
s_barrier
M v[72:75],a[228:231],a[128:131],v[72:75]
T a[216:217],v15
T a[218:219],v15 offset:2048
M v[68:71],a[228:231],a[124:127],v[68:71]
T a[220:221],v16
T a[222:223],v16 offset:2048
M v[64:67],a[228:231],a[120:123],v[64:67]
T a[224:225],v15 offset:4096
T a[226:227],v15 offset:6144
M v[52:55],a[232:235],a[132:135],v[52:55]
T a[228:229],v16 offset:4096
T a[230:231],v16 offset:6144
M v[56:59],a[232:235],a[136:139],v[56:59]
M v[60:63],a[232:235],a[140:143],v[60:63]
T a[232:233],v15 offset:8192
T a[234:235],v15 offset:10240
M v[72:75],a[236:239],a[140:143],v[72:75]
AW a169,v41
L v108,s[16:19],s35 offen offset:2048 lds
M v[68:71],a[236:239],a[136:139],v[68:71]
M v[64:67],a[236:239],a[132:135],v[64:67]
s_waitcnt lgkmcnt(4)
M v[52:55],a[216:219],v[112:115],v[52:55]
T a[236:237],v16 offset:8192
s_add_u32 m0,s28,0x6000
M v[56:59],a[216:219],v[116:119],v[56:59]
T a[238:239],v16 offset:10240
M v[60:63],a[216:219],v[120:123],v[60:63]
AW a170,v42
M v[72:75],a[220:223],v[120:123],v[72:75]
T a[216:217],v15 offset:12288
s_add_u32 s35,s32,0x7800
M v[68:71],a[220:223],v[116:119],v[68:71]
T a[218:219],v15 offset:14336
M v[64:67],a[220:223],v[112:115],v[64:67]
M v[52:55],a[224:227],v[124:127],v[52:55]
T a[220:221],v16 offset:12288
AW a171,v43
M v[56:59],a[224:227],v[128:131],v[56:59]
T a[222:223],v16 offset:14336
L v106,s[16:19],s32 offen lds
M v[60:63],a[224:227],v[132:135],v[60:63]
s_waitcnt lgkmcnt(4)
M v[72:75],a[228:231],v[132:135],v[72:75]
T a[224:225],v15 offset:16384
M v[68:71],a[228:231],v[128:131],v[68:71]
T a[226:227],v15 offset:18432
L v107,s[16:19],s32 offen offset:1024 lds
M v[64:67],a[228:231],v[124:127],v[64:67]
AW a172,v44
M v[52:55],a[232:235],v[136:139],v[52:55]
T a[228:229],v16 offset:16384
M v[56:59],a[232:235],v[140:143],v[56:59]
T a[230:231],v16 offset:18432
M v[60:63],a[232:235],v[144:147],v[60:63]
L v108,s[16:19],s32 offen offset:2048 lds
M v[72:75],a[236:239],v[144:147],v[72:75]
T a[232:233],v15 offset:20480
M v[68:71],a[236:239],v[140:143],v[68:71]
T a[234:235],v15 offset:22528
AW a173,v45
M v[64:67],a[236:239],v[136:139],v[64:67]
s_add_u32 m0,m0,0xc00
s_waitcnt lgkmcnt(4)
M v[52:55],a[216:219],v[148:151],v[52:55]
T a[236:237],v16 offset:20480
M v[56:59],a[216:219],v[152:155],v[56:59]
T a[238:239],v16 offset:22528
M v[60:63],a[216:219],v[156:159],v[60:63]
s_add_u32 s32,s32,0xfffc4000
M v[72:75],a[220:223],v[156:159],v[72:75]
AW a174,v46
M v[68:71],a[220:223],v[152:155],v[68:71]
M v[64:67],a[220:223],v[148:151],v[64:67]
L v106,s[16:19],s35 offen lds
M v[52:55],a[224:227],v[160:163],v[52:55]
AW a175,v47
M v[56:59],a[224:227],v[164:167],v[56:59]
L v107,s[16:19],s35 offen offset:1024 lds
M v[60:63],a[224:227],v[168:171],v[60:63]
s_waitcnt vmcnt(11) lgkmcnt(0)
s_barrier
M v[72:75],a[228:231],v[168:171],v[72:75]
T a[216:217],v15 offset:24576
T a[218:219],v15 offset:26624
M v[68:71],a[228:231],v[164:167],v[68:71]
T a[220:221],v16 offset:24576
T a[222:223],v16 offset:26624
M v[64:67],a[228:231],v[160:163],v[64:67]
T a[224:225],v15 offset:28672
T a[226:227],v15 offset:30720
M v[52:55],a[232:235],v[172:175],v[52:55]
T a[228:229],v16 offset:28672
T a[230:231],v16 offset:30720
M v[56:59],a[232:235],v[176:179],v[56:59]
M v[60:63],a[232:235],v[180:183],v[60:63]
T a[232:233],v15 offset:32768
T a[234:235],v15 offset:34816
M v[72:75],a[236:239],v[180:183],v[72:75]
AW a176,v48
L v108,s[16:19],s35 offen offset:2048 lds
M v[68:71],a[236:239],v[176:179],v[68:71]
M v[64:67],a[236:239],v[172:175],v[64:67]
s_waitcnt lgkmcnt(4)
M v[52:55],a[216:219],v[184:187],v[52:55]
T a[236:237],v16 offset:32768
s_add_u32 m0,s28,0xc000
M v[56:59],a[216:219],v[188:191],v[56:59]
T a[238:239],v16 offset:34816
AW a177,v49
M v[60:63],a[216:219],v[192:195],v[60:63]
M v[72:75],a[220:223],v[192:195],v[72:75]
T a[216:217],v15 offset:36864
s_add_u32 s35,s32,0x7800
M v[68:71],a[220:223],v[188:191],v[68:71]
T a[218:219],v15 offset:38912
M v[64:67],a[220:223],v[184:187],v[64:67]
AW a178,v50
M v[52:55],a[224:227],v[196:199],v[52:55]
T a[220:221],v16 offset:36864
M v[56:59],a[224:227],v[200:203],v[56:59]
T a[222:223],v16 offset:38912
L v106,s[16:19],s32 offen lds
M v[60:63],a[224:227],v[204:207],v[60:63]
s_waitcnt lgkmcnt(4)
M v[72:75],a[228:231],v[204:207],v[72:75]
T a[224:225],v15 offset:40960
M v[68:71],a[228:231],v[200:203],v[68:71]
T a[226:227],v15 offset:43008
M v[64:67],a[228:231],v[196:199],v[64:67]
AW a179,v51
L v107,s[16:19],s32 offen offset:1024 lds
M v[52:55],a[232:235],v[208:211],v[52:55]
T a[228:229],v16 offset:40960
M v[56:59],a[232:235],v[212:215],v[56:59]
T a[230:231],v16 offset:43008
M v[60:63],a[232:235],v[216:219],v[60:63]
L v108,s[16:19],s32 offen offset:2048 lds
M v[72:75],a[236:239],v[216:219],v[72:75]
T a[232:233],v15 offset:45056
s_add_u32 s44,s44,0x3000
M v[68:71],a[236:239],v[212:215],v[68:71]
T a[234:235],v15 offset:47104
M v[64:67],a[236:239],v[208:211],v[64:67]
s_waitcnt lgkmcnt(4)
M v[52:55],a[216:219],v[220:223],v[52:55]
T a[236:237],v16 offset:45056
s_add_u32 m0,m0,0xc00
M v[56:59],a[216:219],v[224:227],v[56:59]
T a[238:239],v16 offset:47104
M v[60:63],a[216:219],v[228:231],v[60:63]
M v[72:75],a[220:223],v[228:231],v[72:75]
s_add_u32 s32,s32,0x78000
M v[68:71],a[220:223],v[224:227],v[68:71]
L v106,s[16:19],s35 offen lds
M v[64:67],a[220:223],v[220:223],v[64:67]
s_cmp_eq_u32 s44,s46
s_cselect_b32 s44,s45,s44
M v[52:55],a[224:227],v[232:235],v[52:55]
M v[56:59],a[224:227],v[236:239],v[56:59]
L v107,s[16:19],s35 offen offset:1024 lds
M v[60:63],a[224:227],v[240:243],v[60:63]
s_waitcnt vmcnt(11) lgkmcnt(0)
s_barrier
M v[72:75],a[228:231],v[240:243],v[72:75]
T a[216:217],v13
T a[218:219],v13 offset:2048
M v[68:71],a[228:231],v[236:239],v[68:71]
T a[220:221],v14
T a[222:223],v14 offset:2048
M v[64:67],a[228:231],v[232:235],v[64:67]
T a[224:225],v13 offset:4096
T a[226:227],v13 offset:6144
M v[52:55],a[232:235],v[244:247],v[52:55]
T a[228:229],v14 offset:4096
T a[230:231],v14 offset:6144
M v[56:59],a[232:235],v[248:251],v[56:59]
M v[60:63],a[232:235],v[252:255],v[60:63]
T a[232:233],v13 offset:8192
T a[234:235],v13 offset:10240
M v[72:75],a[236:239],v[252:255],v[72:75]
L v108,s[16:19],s35 offen offset:2048 lds
M v[68:71],a[236:239],v[248:251],v[68:71]
M v[64:67],a[236:239],v[244:247],v[64:67]
s_waitcnt lgkmcnt(4)
M v[76:79],a[216:219],a[0:3],0
T a[236:237],v14 offset:8192
s_add_u32 m0,s28,0x12000
M v[80:83],a[216:219],a[4:7],0
T a[238:239],v14 offset:10240
M v[84:87],a[216:219],a[8:11],0
s_add_u32 s35,s32,0x7800
M v[96:99],a[220:223],a[8:11],0
T a[216:217],v13 offset:12288
C v40,v52,v53
M v[92:95],a[220:223],a[4:7],0
T a[218:219],v13 offset:14336
M v[88:91],a[220:223],a[0:3],0
L v106,s[16:19],s32 offen lds
M v[76:79],a[224:227],a[12:15],v[76:79]
T a[220:221],v14 offset:12288
M v[80:83],a[224:227],a[16:19],v[80:83]
T a[222:223],v14 offset:14336
L v107,s[16:19],s32 offen offset:1024 lds
M v[84:87],a[224:227],a[20:23],v[84:87]
C v41,v54,v55
s_waitcnt lgkmcnt(4)
M v[96:99],a[228:231],a[20:23],v[96:99]
T a[224:225],v13 offset:16384
M v[92:95],a[228:231],a[16:19],v[92:95]
T a[226:227],v13 offset:18432
M v[88:91],a[228:231],a[12:15],v[88:91]
L v108,s[16:19],s32 offen offset:2048 lds
M v[76:79],a[232:235],a[24:27],v[76:79]
T a[228:229],v14 offset:16384
M v[80:83],a[232:235],a[28:31],v[80:83]
T a[230:231],v14 offset:18432
C v42,v64,v65
M v[84:87],a[232:235],a[32:35],v[84:87]
s_add_u32 m0,m0,0xc00
M v[96:99],a[236:239],a[32:35],v[96:99]
T a[232:233],v13 offset:20480
M v[92:95],a[236:239],a[28:31],v[92:95]
T a[234:235],v13 offset:22528
s_add_u32 s32,s32,0xfff4c080
M v[88:91],a[236:239],a[24:27],v[88:91]
s_waitcnt lgkmcnt(4)
M v[76:79],a[216:219],a[36:39],v[76:79]
T a[236:237],v14 offset:20480
C v43,v66,v67
M v[80:83],a[216:219],a[40:43],v[80:83]
T a[238:239],v14 offset:22528
M v[84:87],a[216:219],a[44:47],v[84:87]
L v106,s[16:19],s35 offen lds
M v[96:99],a[220:223],a[44:47],v[96:99]
L v107,s[16:19],s35 offen offset:1024 lds
M v[92:95],a[220:223],a[40:43],v[92:95]
C v44,v56,v57
M v[88:91],a[220:223],a[36:39],v[88:91]
L v108,s[16:19],s35 offen offset:2048 lds
M v[76:79],a[224:227],a[48:51],v[76:79]
M v[80:83],a[224:227],a[52:55],v[80:83]
C v45,v58,v59
M v[84:87],a[224:227],a[56:59],v[84:87]
s_waitcnt vmcnt(12) lgkmcnt(0)
s_barrier
M v[96:99],a[228:231],a[56:59],v[96:99]
T a[216:217],v13 offset:24576
T a[218:219],v13 offset:26624
M v[92:95],a[228:231],a[52:55],v[92:95]
T a[220:221],v14 offset:24576
T a[222:223],v14 offset:26624
M v[88:91],a[228:231],a[48:51],v[88:91]
T a[224:225],v13 offset:28672
T a[226:227],v13 offset:30720
M v[76:79],a[232:235],a[60:63],v[76:79]
T a[228:229],v14 offset:28672
T a[230:231],v14 offset:30720
M v[80:83],a[232:235],a[64:67],v[80:83]
M v[84:87],a[232:235],a[68:71],v[84:87]
T a[232:233],v13 offset:32768
T a[234:235],v13 offset:34816
M v[96:99],a[236:239],a[68:71],v[96:99]
s_cmp_eq_u32 s32,s43
s_cselect_b32 s32,s42,s32
M v[92:95],a[236:239],a[64:67],v[92:95]
C v46,v68,v69
M v[88:91],a[236:239],a[60:63],v[88:91]
s_waitcnt lgkmcnt(4)
M v[76:79],a[216:219],a[72:75],v[76:79]
T a[236:237],v14 offset:32768
s_add_u32 m0,s28,0
M v[80:83],a[216:219],a[76:79],v[80:83]
T a[238:239],v14 offset:34816
M v[84:87],a[216:219],a[80:83],v[84:87]
C v47,v70,v71
M v[96:99],a[220:223],a[80:83],v[96:99]
T a[216:217],v13 offset:36864
s_add_u32 s35,s32,0x7800
M v[92:95],a[220:223],a[76:79],v[92:95]
T a[218:219],v13 offset:38912
M v[88:91],a[220:223],a[72:75],v[88:91]
M v[76:79],a[224:227],a[84:87],v[76:79]
T a[220:221],v14 offset:36864
L v106,s[16:19],s32 offen lds
M v[80:83],a[224:227],a[88:91],v[80:83]
T a[222:223],v14 offset:38912
C v48,v60,v61
M v[84:87],a[224:227],a[92:95],v[84:87]
s_waitcnt lgkmcnt(4)
M v[96:99],a[228:231],a[92:95],v[96:99]
T a[224:225],v13 offset:40960
M v[92:95],a[228:231],a[88:91],v[92:95]
T a[226:227],v13 offset:43008
L v107,s[16:19],s32 offen offset:1024 lds
M v[88:91],a[228:231],a[84:87],v[88:91]
M v[76:79],a[232:235],a[96:99],v[76:79]
T a[228:229],v14 offset:40960
C v49,v62,v63
M v[80:83],a[232:235],a[100:103],v[80:83]
T a[230:231],v14 offset:43008
M v[84:87],a[232:235],a[104:107],v[84:87]
L v108,s[16:19],s32 offen offset:2048 lds
M v[96:99],a[236:239],a[104:107],v[96:99]
T a[232:233],v13 offset:45056
M v[92:95],a[236:239],a[100:103],v[92:95]
T a[234:235],v13 offset:47104
s_add_u32 m0,m0,0xc00
M v[88:91],a[236:239],a[96:99],v[88:91]
C v50,v72,v73
s_waitcnt lgkmcnt(4)
M v[76:79],a[216:219],a[108:111],v[76:79]
T a[236:237],v14 offset:45056
M v[80:83],a[216:219],a[112:115],v[80:83]
T a[238:239],v14 offset:47104
M v[84:87],a[216:219],a[116:119],v[84:87]
s_add_u32 s32,s32,0x78000
M v[96:99],a[220:223],a[116:119],v[96:99]
C v51,v74,v75
M v[92:95],a[220:223],a[112:115],v[92:95]
M v[88:91],a[220:223],a[108:111],v[88:91]
L v106,s[16:19],s35 offen lds
M v[76:79],a[224:227],a[120:123],v[76:79]
AW a180,v40
M v[80:83],a[224:227],a[124:127],v[80:83]
L v107,s[16:19],s35 offen offset:1024 lds
M v[84:87],a[224:227],a[128:131],v[84:87]
s_waitcnt vmcnt(11) lgkmcnt(0)
s_barrier
M v[96:99],a[228:231],a[128:131],v[96:99]
T a[216:217],v15
T a[218:219],v15 offset:2048
M v[92:95],a[228:231],a[124:127],v[92:95]
T a[220:221],v16
T a[222:223],v16 offset:2048
M v[88:91],a[228:231],a[120:123],v[88:91]
T a[224:225],v15 offset:4096
T a[226:227],v15 offset:6144
M v[76:79],a[232:235],a[132:135],v[76:79]
T a[228:229],v16 offset:4096
T a[230:231],v16 offset:6144
M v[80:83],a[232:235],a[136:139],v[80:83]
M v[84:87],a[232:235],a[140:143],v[84:87]
T a[232:233],v15 offset:8192
T a[234:235],v15 offset:10240
M v[96:99],a[236:239],a[140:143],v[96:99]
AW a181,v41
L v108,s[16:19],s35 offen offset:2048 lds
M v[92:95],a[236:239],a[136:139],v[92:95]
M v[88:91],a[236:239],a[132:135],v[88:91]
s_waitcnt lgkmcnt(4)
M v[76:79],a[216:219],v[112:115],v[76:79]
T a[236:237],v16 offset:8192
s_add_u32 m0,s28,0x6000
M v[80:83],a[216:219],v[116:119],v[80:83]
T a[238:239],v16 offset:10240
M v[84:87],a[216:219],v[120:123],v[84:87]
AW a182,v42
M v[96:99],a[220:223],v[120:123],v[96:99]
T a[216:217],v15 offset:12288
s_add_u32 s35,s32,0x7800
M v[92:95],a[220:223],v[116:119],v[92:95]
T a[218:219],v15 offset:14336
M v[88:91],a[220:223],v[112:115],v[88:91]
M v[76:79],a[224:227],v[124:127],v[76:79]
T a[220:221],v16 offset:12288
AW a183,v43
M v[80:83],a[224:227],v[128:131],v[80:83]
T a[222:223],v16 offset:14336
L v106,s[16:19],s32 offen lds
M v[84:87],a[224:227],v[132:135],v[84:87]
s_waitcnt lgkmcnt(4)
M v[96:99],a[228:231],v[132:135],v[96:99]
T a[224:225],v15 offset:16384
M v[92:95],a[228:231],v[128:131],v[92:95]
T a[226:227],v15 offset:18432
L v107,s[16:19],s32 offen offset:1024 lds
M v[88:91],a[228:231],v[124:127],v[88:91]
AW a184,v44
M v[76:79],a[232:235],v[136:139],v[76:79]
T a[228:229],v16 offset:16384
M v[80:83],a[232:235],v[140:143],v[80:83]
T a[230:231],v16 offset:18432
M v[84:87],a[232:235],v[144:147],v[84:87]
L v108,s[16:19],s32 offen offset:2048 lds
M v[96:99],a[236:239],v[144:147],v[96:99]
T a[232:233],v15 offset:20480
M v[92:95],a[236:239],v[140:143],v[92:95]
T a[234:235],v15 offset:22528
AW a185,v45
M v[88:91],a[236:239],v[136:139],v[88:91]
s_add_u32 m0,m0,0xc00
s_waitcnt lgkmcnt(4)
M v[76:79],a[216:219],v[148:151],v[76:79]
T a[236:237],v16 offset:20480
M v[80:83],a[216:219],v[152:155],v[80:83]
T a[238:239],v16 offset:22528
M v[84:87],a[216:219],v[156:159],v[84:87]
s_add_u32 s32,s32,0xfffc4000
M v[96:99],a[220:223],v[156:159],v[96:99]
AW a186,v46
M v[92:95],a[220:223],v[152:155],v[92:95]
M v[88:91],a[220:223],v[148:151],v[88:91]
L v106,s[16:19],s35 offen lds
M v[76:79],a[224:227],v[160:163],v[76:79]
AW a187,v47
M v[80:83],a[224:227],v[164:167],v[80:83]
L v107,s[16:19],s35 offen offset:1024 lds
M v[84:87],a[224:227],v[168:171],v[84:87]
s_waitcnt vmcnt(11) lgkmcnt(0)
s_barrier
M v[96:99],a[228:231],v[168:171],v[96:99]
T a[216:217],v15 offset:24576
T a[218:219],v15 offset:26624
M v[92:95],a[228:231],v[164:167],v[92:95]
T a[220:221],v16 offset:24576
T a[222:223],v16 offset:26624
M v[88:91],a[228:231],v[160:163],v[88:91]
T a[224:225],v15 offset:28672
T a[226:227],v15 offset:30720
M v[76:79],a[232:235],v[172:175],v[76:79]
T a[228:229],v16 offset:28672
T a[230:231],v16 offset:30720
M v[80:83],a[232:235],v[176:179],v[80:83]
M v[84:87],a[232:235],v[180:183],v[84:87]
T a[232:233],v15 offset:32768
T a[234:235],v15 offset:34816
M v[96:99],a[236:239],v[180:183],v[96:99]
AW a188,v48
L v108,s[16:19],s35 offen offset:2048 lds
M v[92:95],a[236:239],v[176:179],v[92:95]
M v[88:91],a[236:239],v[172:175],v[88:91]
s_waitcnt lgkmcnt(4)
M v[76:79],a[216:219],v[184:187],v[76:79]
T a[236:237],v16 offset:32768
s_add_u32 m0,s28,0xc000
M v[80:83],a[216:219],v[188:191],v[80:83]
T a[238:239],v16 offset:34816
AW a189,v49
M v[84:87],a[216:219],v[192:195],v[84:87]
M v[96:99],a[220:223],v[192:195],v[96:99]
T a[216:217],v15 offset:36864
s_add_u32 s35,s32,0x7800
M v[92:95],a[220:223],v[188:191],v[92:95]
T a[218:219],v15 offset:38912
M v[88:91],a[220:223],v[184:187],v[88:91]
AW a190,v50
M v[76:79],a[224:227],v[196:199],v[76:79]
T a[220:221],v16 offset:36864
M v[80:83],a[224:227],v[200:203],v[80:83]
T a[222:223],v16 offset:38912
L v106,s[16:19],s32 offen lds
M v[84:87],a[224:227],v[204:207],v[84:87]
s_waitcnt lgkmcnt(4)
M v[96:99],a[228:231],v[204:207],v[96:99]
T a[224:225],v15 offset:40960
M v[92:95],a[228:231],v[200:203],v[92:95]
T a[226:227],v15 offset:43008
M v[88:91],a[228:231],v[196:199],v[88:91]
AW a191,v51
L v107,s[16:19],s32 offen offset:1024 lds
M v[76:79],a[232:235],v[208:211],v[76:79]
T a[228:229],v16 offset:40960
M v[80:83],a[232:235],v[212:215],v[80:83]
T a[230:231],v16 offset:43008
M v[84:87],a[232:235],v[216:219],v[84:87]
L v108,s[16:19],s32 offen offset:2048 lds
M v[96:99],a[236:239],v[216:219],v[96:99]
T a[232:233],v15 offset:45056
s_add_u32 s44,s44,0x3000
M v[92:95],a[236:239],v[212:215],v[92:95]
T a[234:235],v15 offset:47104
M v[88:91],a[236:239],v[208:211],v[88:91]
s_waitcnt lgkmcnt(4)
M v[76:79],a[216:219],v[220:223],v[76:79]
T a[236:237],v16 offset:45056
s_add_u32 m0,m0,0xc00
M v[80:83],a[216:219],v[224:227],v[80:83]
T a[238:239],v16 offset:47104
M v[84:87],a[216:219],v[228:231],v[84:87]
M v[96:99],a[220:223],v[228:231],v[96:99]
s_add_u32 s32,s32,0x78000
M v[92:95],a[220:223],v[224:227],v[92:95]
L v106,s[16:19],s35 offen lds
M v[88:91],a[220:223],v[220:223],v[88:91]
s_cmp_eq_u32 s44,s46
s_cselect_b32 s44,s45,s44
M v[76:79],a[224:227],v[232:235],v[76:79]
M v[80:83],a[224:227],v[236:239],v[80:83]
L v107,s[16:19],s35 offen offset:1024 lds
M v[84:87],a[224:227],v[240:243],v[84:87]
s_waitcnt vmcnt(11) lgkmcnt(0)
s_barrier
M v[96:99],a[228:231],v[240:243],v[96:99]
T a[216:217],v13
T a[218:219],v13 offset:2048
M v[92:95],a[228:231],v[236:239],v[92:95]
T a[220:221],v14
T a[222:223],v14 offset:2048
M v[88:91],a[228:231],v[232:235],v[88:91]
T a[224:225],v13 offset:4096
T a[226:227],v13 offset:6144
M v[76:79],a[232:235],v[244:247],v[76:79]
T a[228:229],v14 offset:4096
T a[230:231],v14 offset:6144
M v[80:83],a[232:235],v[248:251],v[80:83]
M v[84:87],a[232:235],v[252:255],v[84:87]
T a[232:233],v13 offset:8192
T a[234:235],v13 offset:10240
M v[96:99],a[236:239],v[252:255],v[96:99]
L v108,s[16:19],s35 offen offset:2048 lds
M v[92:95],a[236:239],v[248:251],v[92:95]
M v[88:91],a[236:239],v[244:247],v[88:91]
s_waitcnt lgkmcnt(4)
M v[52:55],a[216:219],a[0:3],0
T a[236:237],v14 offset:8192
s_add_u32 m0,s28,0x12000
M v[56:59],a[216:219],a[4:7],0
T a[238:239],v14 offset:10240
M v[60:63],a[216:219],a[8:11],0
s_add_u32 s35,s32,0x7800
M v[72:75],a[220:223],a[8:11],0
T a[216:217],v13 offset:12288
C v40,v76,v77
M v[68:71],a[220:223],a[4:7],0
T a[218:219],v13 offset:14336
M v[64:67],a[220:223],a[0:3],0
L v106,s[16:19],s32 offen lds
M v[52:55],a[224:227],a[12:15],v[52:55]
T a[220:221],v14 offset:12288
M v[56:59],a[224:227],a[16:19],v[56:59]
T a[222:223],v14 offset:14336
L v107,s[16:19],s32 offen offset:1024 lds
M v[60:63],a[224:227],a[20:23],v[60:63]
C v41,v78,v79
s_waitcnt lgkmcnt(4)
M v[72:75],a[228:231],a[20:23],v[72:75]
T a[224:225],v13 offset:16384
M v[68:71],a[228:231],a[16:19],v[68:71]
T a[226:227],v13 offset:18432
M v[64:67],a[228:231],a[12:15],v[64:67]
L v108,s[16:19],s32 offen offset:2048 lds
M v[52:55],a[232:235],a[24:27],v[52:55]
T a[228:229],v14 offset:16384
M v[56:59],a[232:235],a[28:31],v[56:59]
T a[230:231],v14 offset:18432
C v42,v88,v89
M v[60:63],a[232:235],a[32:35],v[60:63]
s_add_u32 m0,m0,0xc00
M v[72:75],a[236:239],a[32:35],v[72:75]
T a[232:233],v13 offset:20480
M v[68:71],a[236:239],a[28:31],v[68:71]
T a[234:235],v13 offset:22528
s_add_u32 s32,s32,0xfff4c080
M v[64:67],a[236:239],a[24:27],v[64:67]
s_waitcnt lgkmcnt(4)
M v[52:55],a[216:219],a[36:39],v[52:55]
T a[236:237],v14 offset:20480
C v43,v90,v91
M v[56:59],a[216:219],a[40:43],v[56:59]
T a[238:239],v14 offset:22528
M v[60:63],a[216:219],a[44:47],v[60:63]
L v106,s[16:19],s35 offen lds
M v[72:75],a[220:223],a[44:47],v[72:75]
L v107,s[16:19],s35 offen offset:1024 lds
M v[68:71],a[220:223],a[40:43],v[68:71]
C v44,v80,v81
M v[64:67],a[220:223],a[36:39],v[64:67]
L v108,s[16:19],s35 offen offset:2048 lds
M v[52:55],a[224:227],a[48:51],v[52:55]
M v[56:59],a[224:227],a[52:55],v[56:59]
C v45,v82,v83
M v[60:63],a[224:227],a[56:59],v[60:63]
s_waitcnt vmcnt(12) lgkmcnt(0)
s_barrier
M v[72:75],a[228:231],a[56:59],v[72:75]
T a[216:217],v13 offset:24576
T a[218:219],v13 offset:26624
M v[68:71],a[228:231],a[52:55],v[68:71]
T a[220:221],v14 offset:24576
T a[222:223],v14 offset:26624
M v[64:67],a[228:231],a[48:51],v[64:67]
T a[224:225],v13 offset:28672
T a[226:227],v13 offset:30720
M v[52:55],a[232:235],a[60:63],v[52:55]
T a[228:229],v14 offset:28672
T a[230:231],v14 offset:30720
M v[56:59],a[232:235],a[64:67],v[56:59]
M v[60:63],a[232:235],a[68:71],v[60:63]
T a[232:233],v13 offset:32768
T a[234:235],v13 offset:34816
M v[72:75],a[236:239],a[68:71],v[72:75]
s_cmp_eq_u32 s32,s43
s_cselect_b32 s32,s42,s32
M v[68:71],a[236:239],a[64:67],v[68:71]
C v46,v92,v93
M v[64:67],a[236:239],a[60:63],v[64:67]
s_waitcnt lgkmcnt(4)
M v[52:55],a[216:219],a[72:75],v[52:55]
T a[236:237],v14 offset:32768
s_add_u32 m0,s28,0
M v[56:59],a[216:219],a[76:79],v[56:59]
T a[238:239],v14 offset:34816
M v[60:63],a[216:219],a[80:83],v[60:63]
C v47,v94,v95
M v[72:75],a[220:223],a[80:83],v[72:75]
T a[216:217],v13 offset:36864
s_add_u32 s35,s32,0x7800
M v[68:71],a[220:223],a[76:79],v[68:71]
T a[218:219],v13 offset:38912
M v[64:67],a[220:223],a[72:75],v[64:67]
M v[52:55],a[224:227],a[84:87],v[52:55]
T a[220:221],v14 offset:36864
L v106,s[16:19],s32 offen lds
M v[56:59],a[224:227],a[88:91],v[56:59]
T a[222:223],v14 offset:38912
C v48,v84,v85
M v[60:63],a[224:227],a[92:95],v[60:63]
s_waitcnt lgkmcnt(4)
M v[72:75],a[228:231],a[92:95],v[72:75]
T a[224:225],v13 offset:40960
M v[68:71],a[228:231],a[88:91],v[68:71]
T a[226:227],v13 offset:43008
L v107,s[16:19],s32 offen offset:1024 lds
M v[64:67],a[228:231],a[84:87],v[64:67]
M v[52:55],a[232:235],a[96:99],v[52:55]
T a[228:229],v14 offset:40960
C v49,v86,v87
M v[56:59],a[232:235],a[100:103],v[56:59]
T a[230:231],v14 offset:43008
M v[60:63],a[232:235],a[104:107],v[60:63]
L v108,s[16:19],s32 offen offset:2048 lds
M v[72:75],a[236:239],a[104:107],v[72:75]
T a[232:233],v13 offset:45056
M v[68:71],a[236:239],a[100:103],v[68:71]
T a[234:235],v13 offset:47104
s_add_u32 m0,m0,0xc00
M v[64:67],a[236:239],a[96:99],v[64:67]
C v50,v96,v97
s_waitcnt lgkmcnt(4)
M v[52:55],a[216:219],a[108:111],v[52:55]
T a[236:237],v14 offset:45056
M v[56:59],a[216:219],a[112:115],v[56:59]
T a[238:239],v14 offset:47104
M v[60:63],a[216:219],a[116:119],v[60:63]
s_add_u32 s32,s32,0x78000
M v[72:75],a[220:223],a[116:119],v[72:75]
C v51,v98,v99
M v[68:71],a[220:223],a[112:115],v[68:71]
M v[64:67],a[220:223],a[108:111],v[64:67]
L v106,s[16:19],s35 offen lds
M v[52:55],a[224:227],a[120:123],v[52:55]
AW a192,v40
M v[56:59],a[224:227],a[124:127],v[56:59]
L v107,s[16:19],s35 offen offset:1024 lds
M v[60:63],a[224:227],a[128:131],v[60:63]
s_waitcnt vmcnt(11) lgkmcnt(0)
s_barrier
M v[72:75],a[228:231],a[128:131],v[72:75]
T a[216:217],v15
T a[218:219],v15 offset:2048
M v[68:71],a[228:231],a[124:127],v[68:71]
T a[220:221],v16
T a[222:223],v16 offset:2048
M v[64:67],a[228:231],a[120:123],v[64:67]
T a[224:225],v15 offset:4096
T a[226:227],v15 offset:6144
M v[52:55],a[232:235],a[132:135],v[52:55]
T a[228:229],v16 offset:4096
T a[230:231],v16 offset:6144
M v[56:59],a[232:235],a[136:139],v[56:59]
M v[60:63],a[232:235],a[140:143],v[60:63]
T a[232:233],v15 offset:8192
T a[234:235],v15 offset:10240
M v[72:75],a[236:239],a[140:143],v[72:75]
AW a193,v41
L v108,s[16:19],s35 offen offset:2048 lds
M v[68:71],a[236:239],a[136:139],v[68:71]
M v[64:67],a[236:239],a[132:135],v[64:67]
s_waitcnt lgkmcnt(4)
M v[52:55],a[216:219],v[112:115],v[52:55]
T a[236:237],v16 offset:8192
s_add_u32 m0,s28,0x6000
M v[56:59],a[216:219],v[116:119],v[56:59]
T a[238:239],v16 offset:10240
M v[60:63],a[216:219],v[120:123],v[60:63]
AW a194,v42
M v[72:75],a[220:223],v[120:123],v[72:75]
T a[216:217],v15 offset:12288
s_add_u32 s35,s32,0x7800
M v[68:71],a[220:223],v[116:119],v[68:71]
T a[218:219],v15 offset:14336
M v[64:67],a[220:223],v[112:115],v[64:67]
M v[52:55],a[224:227],v[124:127],v[52:55]
T a[220:221],v16 offset:12288
AW a195,v43
M v[56:59],a[224:227],v[128:131],v[56:59]
T a[222:223],v16 offset:14336
L v106,s[16:19],s32 offen lds
M v[60:63],a[224:227],v[132:135],v[60:63]
s_waitcnt lgkmcnt(4)
M v[72:75],a[228:231],v[132:135],v[72:75]
T a[224:225],v15 offset:16384
M v[68:71],a[228:231],v[128:131],v[68:71]
T a[226:227],v15 offset:18432
L v107,s[16:19],s32 offen offset:1024 lds
M v[64:67],a[228:231],v[124:127],v[64:67]
AW a196,v44
M v[52:55],a[232:235],v[136:139],v[52:55]
T a[228:229],v16 offset:16384
M v[56:59],a[232:235],v[140:143],v[56:59]
T a[230:231],v16 offset:18432
M v[60:63],a[232:235],v[144:147],v[60:63]
L v108,s[16:19],s32 offen offset:2048 lds
M v[72:75],a[236:239],v[144:147],v[72:75]
T a[232:233],v15 offset:20480
M v[68:71],a[236:239],v[140:143],v[68:71]
T a[234:235],v15 offset:22528
AW a197,v45
M v[64:67],a[236:239],v[136:139],v[64:67]
s_add_u32 m0,m0,0xc00
s_waitcnt lgkmcnt(4)
M v[52:55],a[216:219],v[148:151],v[52:55]
T a[236:237],v16 offset:20480
M v[56:59],a[216:219],v[152:155],v[56:59]
T a[238:239],v16 offset:22528
M v[60:63],a[216:219],v[156:159],v[60:63]
s_add_u32 s32,s32,0xfffc4000
M v[72:75],a[220:223],v[156:159],v[72:75]
AW a198,v46
M v[68:71],a[220:223],v[152:155],v[68:71]
M v[64:67],a[220:223],v[148:151],v[64:67]
L v106,s[16:19],s35 offen lds
M v[52:55],a[224:227],v[160:163],v[52:55]
AW a199,v47
M v[56:59],a[224:227],v[164:167],v[56:59]
L v107,s[16:19],s35 offen offset:1024 lds
M v[60:63],a[224:227],v[168:171],v[60:63]
s_waitcnt vmcnt(11) lgkmcnt(0)
s_barrier
M v[72:75],a[228:231],v[168:171],v[72:75]
T a[216:217],v15 offset:24576
T a[218:219],v15 offset:26624
M v[68:71],a[228:231],v[164:167],v[68:71]
T a[220:221],v16 offset:24576
T a[222:223],v16 offset:26624
M v[64:67],a[228:231],v[160:163],v[64:67]
T a[224:225],v15 offset:28672
T a[226:227],v15 offset:30720
M v[52:55],a[232:235],v[172:175],v[52:55]
T a[228:229],v16 offset:28672
T a[230:231],v16 offset:30720
M v[56:59],a[232:235],v[176:179],v[56:59]
M v[60:63],a[232:235],v[180:183],v[60:63]
T a[232:233],v15 offset:32768
T a[234:235],v15 offset:34816
M v[72:75],a[236:239],v[180:183],v[72:75]
AW a200,v48
L v108,s[16:19],s35 offen offset:2048 lds
M v[68:71],a[236:239],v[176:179],v[68:71]
M v[64:67],a[236:239],v[172:175],v[64:67]
s_waitcnt lgkmcnt(4)
M v[52:55],a[216:219],v[184:187],v[52:55]
T a[236:237],v16 offset:32768
s_add_u32 m0,s28,0xc000
M v[56:59],a[216:219],v[188:191],v[56:59]
T a[238:239],v16 offset:34816
AW a201,v49
M v[60:63],a[216:219],v[192:195],v[60:63]
M v[72:75],a[220:223],v[192:195],v[72:75]
T a[216:217],v15 offset:36864
s_add_u32 s35,s32,0x7800
M v[68:71],a[220:223],v[188:191],v[68:71]
T a[218:219],v15 offset:38912
M v[64:67],a[220:223],v[184:187],v[64:67]
AW a202,v50
M v[52:55],a[224:227],v[196:199],v[52:55]
T a[220:221],v16 offset:36864
M v[56:59],a[224:227],v[200:203],v[56:59]
T a[222:223],v16 offset:38912
L v106,s[16:19],s32 offen lds
M v[60:63],a[224:227],v[204:207],v[60:63]
s_waitcnt lgkmcnt(4)
M v[72:75],a[228:231],v[204:207],v[72:75]
T a[224:225],v15 offset:40960
M v[68:71],a[228:231],v[200:203],v[68:71]
T a[226:227],v15 offset:43008
M v[64:67],a[228:231],v[196:199],v[64:67]
AW a203,v51
L v107,s[16:19],s32 offen offset:1024 lds
M v[52:55],a[232:235],v[208:211],v[52:55]
T a[228:229],v16 offset:40960
M v[56:59],a[232:235],v[212:215],v[56:59]
T a[230:231],v16 offset:43008
M v[60:63],a[232:235],v[216:219],v[60:63]
L v108,s[16:19],s32 offen offset:2048 lds
M v[72:75],a[236:239],v[216:219],v[72:75]
T a[232:233],v15 offset:45056
s_add_u32 s44,s44,0x3000
M v[68:71],a[236:239],v[212:215],v[68:71]
T a[234:235],v15 offset:47104
M v[64:67],a[236:239],v[208:211],v[64:67]
s_waitcnt lgkmcnt(4)
M v[52:55],a[216:219],v[220:223],v[52:55]
T a[236:237],v16 offset:45056
s_add_u32 m0,m0,0xc00
M v[56:59],a[216:219],v[224:227],v[56:59]
T a[238:239],v16 offset:47104
M v[60:63],a[216:219],v[228:231],v[60:63]
M v[72:75],a[220:223],v[228:231],v[72:75]
s_add_u32 s32,s32,0x78000
M v[68:71],a[220:223],v[224:227],v[68:71]
L v106,s[16:19],s35 offen lds
M v[64:67],a[220:223],v[220:223],v[64:67]
s_cmp_eq_u32 s44,s46
s_cselect_b32 s44,s45,s44
M v[52:55],a[224:227],v[232:235],v[52:55]
M v[56:59],a[224:227],v[236:239],v[56:59]
L v107,s[16:19],s35 offen offset:1024 lds
M v[60:63],a[224:227],v[240:243],v[60:63]
s_waitcnt vmcnt(11) lgkmcnt(0)
s_barrier
M v[72:75],a[228:231],v[240:243],v[72:75]
T a[216:217],v13
T a[218:219],v13 offset:2048
M v[68:71],a[228:231],v[236:239],v[68:71]
T a[220:221],v14
T a[222:223],v14 offset:2048
M v[64:67],a[228:231],v[232:235],v[64:67]
T a[224:225],v13 offset:4096
T a[226:227],v13 offset:6144
M v[52:55],a[232:235],v[244:247],v[52:55]
T a[228:229],v14 offset:4096
T a[230:231],v14 offset:6144
M v[56:59],a[232:235],v[248:251],v[56:59]
M v[60:63],a[232:235],v[252:255],v[60:63]
T a[232:233],v13 offset:8192
T a[234:235],v13 offset:10240
M v[72:75],a[236:239],v[252:255],v[72:75]
L v108,s[16:19],s35 offen offset:2048 lds
M v[68:71],a[236:239],v[248:251],v[68:71]
M v[64:67],a[236:239],v[244:247],v[64:67]
s_waitcnt lgkmcnt(4)
M v[76:79],a[216:219],a[0:3],0
T a[236:237],v14 offset:8192
s_add_u32 m0,s28,0x12000
M v[80:83],a[216:219],a[4:7],0
T a[238:239],v14 offset:10240
M v[84:87],a[216:219],a[8:11],0
s_add_u32 s35,s32,0x7800
M v[96:99],a[220:223],a[8:11],0
T a[216:217],v13 offset:12288
C v40,v52,v53
M v[92:95],a[220:223],a[4:7],0
T a[218:219],v13 offset:14336
M v[88:91],a[220:223],a[0:3],0
L v106,s[16:19],s32 offen lds
M v[76:79],a[224:227],a[12:15],v[76:79]
T a[220:221],v14 offset:12288
M v[80:83],a[224:227],a[16:19],v[80:83]
T a[222:223],v14 offset:14336
L v107,s[16:19],s32 offen offset:1024 lds
M v[84:87],a[224:227],a[20:23],v[84:87]
C v41,v54,v55
s_waitcnt lgkmcnt(4)
M v[96:99],a[228:231],a[20:23],v[96:99]
T a[224:225],v13 offset:16384
M v[92:95],a[228:231],a[16:19],v[92:95]
T a[226:227],v13 offset:18432
M v[88:91],a[228:231],a[12:15],v[88:91]
L v108,s[16:19],s32 offen offset:2048 lds
M v[76:79],a[232:235],a[24:27],v[76:79]
T a[228:229],v14 offset:16384
M v[80:83],a[232:235],a[28:31],v[80:83]
T a[230:231],v14 offset:18432
C v42,v64,v65
M v[84:87],a[232:235],a[32:35],v[84:87]
s_add_u32 m0,m0,0xc00
M v[96:99],a[236:239],a[32:35],v[96:99]
T a[232:233],v13 offset:20480
M v[92:95],a[236:239],a[28:31],v[92:95]
T a[234:235],v13 offset:22528
s_add_u32 s32,s32,0xfff4c080
M v[88:91],a[236:239],a[24:27],v[88:91]
s_waitcnt lgkmcnt(4)
M v[76:79],a[216:219],a[36:39],v[76:79]
T a[236:237],v14 offset:20480
C v43,v66,v67
M v[80:83],a[216:219],a[40:43],v[80:83]
T a[238:239],v14 offset:22528
M v[84:87],a[216:219],a[44:47],v[84:87]
L v106,s[16:19],s35 offen lds
M v[96:99],a[220:223],a[44:47],v[96:99]
L v107,s[16:19],s35 offen offset:1024 lds
M v[92:95],a[220:223],a[40:43],v[92:95]
C v44,v56,v57
M v[88:91],a[220:223],a[36:39],v[88:91]
L v108,s[16:19],s35 offen offset:2048 lds
M v[76:79],a[224:227],a[48:51],v[76:79]
M v[80:83],a[224:227],a[52:55],v[80:83]
C v45,v58,v59
M v[84:87],a[224:227],a[56:59],v[84:87]
s_waitcnt vmcnt(12) lgkmcnt(0)
s_barrier
M v[96:99],a[228:231],a[56:59],v[96:99]
T a[216:217],v13 offset:24576
T a[218:219],v13 offset:26624
M v[92:95],a[228:231],a[52:55],v[92:95]
T a[220:221],v14 offset:24576
T a[222:223],v14 offset:26624
M v[88:91],a[228:231],a[48:51],v[88:91]
T a[224:225],v13 offset:28672
T a[226:227],v13 offset:30720
M v[76:79],a[232:235],a[60:63],v[76:79]
T a[228:229],v14 offset:28672
T a[230:231],v14 offset:30720
M v[80:83],a[232:235],a[64:67],v[80:83]
M v[84:87],a[232:235],a[68:71],v[84:87]
T a[232:233],v13 offset:32768
T a[234:235],v13 offset:34816
M v[96:99],a[236:239],a[68:71],v[96:99]
s_cmp_eq_u32 s32,s43
s_cselect_b32 s32,s42,s32
M v[92:95],a[236:239],a[64:67],v[92:95]
C v46,v68,v69
M v[88:91],a[236:239],a[60:63],v[88:91]
s_waitcnt lgkmcnt(4)
M v[76:79],a[216:219],a[72:75],v[76:79]
T a[236:237],v14 offset:32768
s_add_u32 m0,s28,0
M v[80:83],a[216:219],a[76:79],v[80:83]
T a[238:239],v14 offset:34816
M v[84:87],a[216:219],a[80:83],v[84:87]
C v47,v70,v71
M v[96:99],a[220:223],a[80:83],v[96:99]
T a[216:217],v13 offset:36864
s_add_u32 s35,s32,0x7800
M v[92:95],a[220:223],a[76:79],v[92:95]
T a[218:219],v13 offset:38912
M v[88:91],a[220:223],a[72:75],v[88:91]
M v[76:79],a[224:227],a[84:87],v[76:79]
T a[220:221],v14 offset:36864
L v106,s[16:19],s32 offen lds
M v[80:83],a[224:227],a[88:91],v[80:83]
T a[222:223],v14 offset:38912
C v48,v60,v61
M v[84:87],a[224:227],a[92:95],v[84:87]
s_waitcnt lgkmcnt(4)
M v[96:99],a[228:231],a[92:95],v[96:99]
T a[224:225],v13 offset:40960
M v[92:95],a[228:231],a[88:91],v[92:95]
T a[226:227],v13 offset:43008
L v107,s[16:19],s32 offen offset:1024 lds
M v[88:91],a[228:231],a[84:87],v[88:91]
M v[76:79],a[232:235],a[96:99],v[76:79]
T a[228:229],v14 offset:40960
C v49,v62,v63
M v[80:83],a[232:235],a[100:103],v[80:83]
T a[230:231],v14 offset:43008
M v[84:87],a[232:235],a[104:107],v[84:87]
L v108,s[16:19],s32 offen offset:2048 lds
M v[96:99],a[236:239],a[104:107],v[96:99]
T a[232:233],v13 offset:45056
M v[92:95],a[236:239],a[100:103],v[92:95]
T a[234:235],v13 offset:47104
s_add_u32 m0,m0,0xc00
M v[88:91],a[236:239],a[96:99],v[88:91]
C v50,v72,v73
s_waitcnt lgkmcnt(4)
M v[76:79],a[216:219],a[108:111],v[76:79]
T a[236:237],v14 offset:45056
M v[80:83],a[216:219],a[112:115],v[80:83]
T a[238:239],v14 offset:47104
M v[84:87],a[216:219],a[116:119],v[84:87]
s_add_u32 s32,s32,0x78000
M v[96:99],a[220:223],a[116:119],v[96:99]
C v51,v74,v75
M v[92:95],a[220:223],a[112:115],v[92:95]
M v[88:91],a[220:223],a[108:111],v[88:91]
L v106,s[16:19],s35 offen lds
M v[76:79],a[224:227],a[120:123],v[76:79]
AW a204,v40
M v[80:83],a[224:227],a[124:127],v[80:83]
L v107,s[16:19],s35 offen offset:1024 lds
M v[84:87],a[224:227],a[128:131],v[84:87]
s_waitcnt vmcnt(11) lgkmcnt(0)
s_barrier
M v[96:99],a[228:231],a[128:131],v[96:99]
T a[216:217],v15
T a[218:219],v15 offset:2048
M v[92:95],a[228:231],a[124:127],v[92:95]
T a[220:221],v16
T a[222:223],v16 offset:2048
M v[88:91],a[228:231],a[120:123],v[88:91]
T a[224:225],v15 offset:4096
T a[226:227],v15 offset:6144
M v[76:79],a[232:235],a[132:135],v[76:79]
T a[228:229],v16 offset:4096
T a[230:231],v16 offset:6144
M v[80:83],a[232:235],a[136:139],v[80:83]
M v[84:87],a[232:235],a[140:143],v[84:87]
T a[232:233],v15 offset:8192
T a[234:235],v15 offset:10240
M v[96:99],a[236:239],a[140:143],v[96:99]
AW a205,v41
L v108,s[16:19],s35 offen offset:2048 lds
M v[92:95],a[236:239],a[136:139],v[92:95]
M v[88:91],a[236:239],a[132:135],v[88:91]
s_waitcnt lgkmcnt(4)
M v[76:79],a[216:219],v[112:115],v[76:79]
T a[236:237],v16 offset:8192
s_add_u32 m0,s28,0x6000
M v[80:83],a[216:219],v[116:119],v[80:83]
T a[238:239],v16 offset:10240
M v[84:87],a[216:219],v[120:123],v[84:87]
AW a206,v42
M v[96:99],a[220:223],v[120:123],v[96:99]
T a[216:217],v15 offset:12288
s_add_u32 s35,s32,0x7800
M v[92:95],a[220:223],v[116:119],v[92:95]
T a[218:219],v15 offset:14336
M v[88:91],a[220:223],v[112:115],v[88:91]
M v[76:79],a[224:227],v[124:127],v[76:79]
T a[220:221],v16 offset:12288
AW a207,v43
M v[80:83],a[224:227],v[128:131],v[80:83]
T a[222:223],v16 offset:14336
L v106,s[16:19],s32 offen lds
M v[84:87],a[224:227],v[132:135],v[84:87]
s_waitcnt lgkmcnt(4)
M v[96:99],a[228:231],v[132:135],v[96:99]
T a[224:225],v15 offset:16384
M v[92:95],a[228:231],v[128:131],v[92:95]
T a[226:227],v15 offset:18432
L v107,s[16:19],s32 offen offset:1024 lds
M v[88:91],a[228:231],v[124:127],v[88:91]
AW a208,v44
M v[76:79],a[232:235],v[136:139],v[76:79]
T a[228:229],v16 offset:16384
M v[80:83],a[232:235],v[140:143],v[80:83]
T a[230:231],v16 offset:18432
M v[84:87],a[232:235],v[144:147],v[84:87]
L v108,s[16:19],s32 offen offset:2048 lds
M v[96:99],a[236:239],v[144:147],v[96:99]
T a[232:233],v15 offset:20480
M v[92:95],a[236:239],v[140:143],v[92:95]
T a[234:235],v15 offset:22528
AW a209,v45
M v[88:91],a[236:239],v[136:139],v[88:91]
s_add_u32 m0,m0,0xc00
s_waitcnt lgkmcnt(4)
M v[76:79],a[216:219],v[148:151],v[76:79]
T a[236:237],v16 offset:20480
M v[80:83],a[216:219],v[152:155],v[80:83]
T a[238:239],v16 offset:22528
M v[84:87],a[216:219],v[156:159],v[84:87]
s_add_u32 s32,s32,0xfffc4000
M v[96:99],a[220:223],v[156:159],v[96:99]
AW a210,v46
M v[92:95],a[220:223],v[152:155],v[92:95]
M v[88:91],a[220:223],v[148:151],v[88:91]
L v106,s[16:19],s35 offen lds
M v[76:79],a[224:227],v[160:163],v[76:79]
AW a211,v47
M v[80:83],a[224:227],v[164:167],v[80:83]
L v107,s[16:19],s35 offen offset:1024 lds
M v[84:87],a[224:227],v[168:171],v[84:87]
s_waitcnt vmcnt(11) lgkmcnt(0)
s_barrier
M v[96:99],a[228:231],v[168:171],v[96:99]
T a[216:217],v15 offset:24576
T a[218:219],v15 offset:26624
M v[92:95],a[228:231],v[164:167],v[92:95]
T a[220:221],v16 offset:24576
T a[222:223],v16 offset:26624
M v[88:91],a[228:231],v[160:163],v[88:91]
T a[224:225],v15 offset:28672
T a[226:227],v15 offset:30720
M v[76:79],a[232:235],v[172:175],v[76:79]
T a[228:229],v16 offset:28672
T a[230:231],v16 offset:30720
M v[80:83],a[232:235],v[176:179],v[80:83]
M v[84:87],a[232:235],v[180:183],v[84:87]
T a[232:233],v15 offset:32768
T a[234:235],v15 offset:34816
M v[96:99],a[236:239],v[180:183],v[96:99]
AW a212,v48
L v108,s[16:19],s35 offen offset:2048 lds
M v[92:95],a[236:239],v[176:179],v[92:95]
M v[88:91],a[236:239],v[172:175],v[88:91]
s_waitcnt lgkmcnt(4)
M v[76:79],a[216:219],v[184:187],v[76:79]
T a[236:237],v16 offset:32768
s_add_u32 m0,s28,0xc000
M v[80:83],a[216:219],v[188:191],v[80:83]
T a[238:239],v16 offset:34816
AW a213,v49
M v[84:87],a[216:219],v[192:195],v[84:87]
M v[96:99],a[220:223],v[192:195],v[96:99]
T a[216:217],v15 offset:36864
s_add_u32 s35,s32,0x7800
M v[92:95],a[220:223],v[188:191],v[92:95]
T a[218:219],v15 offset:38912
M v[88:91],a[220:223],v[184:187],v[88:91]
AW a214,v50
M v[76:79],a[224:227],v[196:199],v[76:79]
T a[220:221],v16 offset:36864
M v[80:83],a[224:227],v[200:203],v[80:83]
T a[222:223],v16 offset:38912
L v106,s[16:19],s32 offen lds
M v[84:87],a[224:227],v[204:207],v[84:87]
s_waitcnt lgkmcnt(4)
M v[96:99],a[228:231],v[204:207],v[96:99]
T a[224:225],v15 offset:40960
M v[92:95],a[228:231],v[200:203],v[92:95]
T a[226:227],v15 offset:43008
M v[88:91],a[228:231],v[196:199],v[88:91]
AW a215,v51
L v107,s[16:19],s32 offen offset:1024 lds
M v[76:79],a[232:235],v[208:211],v[76:79]
T a[228:229],v16 offset:40960
M v[80:83],a[232:235],v[212:215],v[80:83]
T a[230:231],v16 offset:43008
M v[84:87],a[232:235],v[216:219],v[84:87]
L v108,s[16:19],s32 offen offset:2048 lds
M v[96:99],a[236:239],v[216:219],v[96:99]
T a[232:233],v15 offset:45056
s_add_u32 s44,s44,0x3000
M v[92:95],a[236:239],v[212:215],v[92:95]
T a[234:235],v15 offset:47104
M v[88:91],a[236:239],v[208:211],v[88:91]
s_waitcnt lgkmcnt(4)
M v[76:79],a[216:219],v[220:223],v[76:79]
T a[236:237],v16 offset:45056
s_add_u32 m0,m0,0xc00
M v[80:83],a[216:219],v[224:227],v[80:83]
T a[238:239],v16 offset:47104
M v[84:87],a[216:219],v[228:231],v[84:87]
M v[96:99],a[220:223],v[228:231],v[96:99]
s_add_u32 s32,s32,0x78000
M v[92:95],a[220:223],v[224:227],v[92:95]
L v106,s[16:19],s35 offen lds
M v[88:91],a[220:223],v[220:223],v[88:91]
s_cmp_eq_u32 s44,s46
s_cselect_b32 s44,s45,s44
M v[76:79],a[224:227],v[232:235],v[76:79]
M v[80:83],a[224:227],v[236:239],v[80:83]
L v107,s[16:19],s35 offen offset:1024 lds
M v[84:87],a[224:227],v[240:243],v[84:87]
s_waitcnt vmcnt(11) lgkmcnt(0)
s_barrier
M v[96:99],a[228:231],v[240:243],v[96:99]
T a[216:217],v13
T a[218:219],v13 offset:2048
M v[92:95],a[228:231],v[236:239],v[92:95]
T a[220:221],v14
T a[222:223],v14 offset:2048
M v[88:91],a[228:231],v[232:235],v[88:91]
T a[224:225],v13 offset:4096
T a[226:227],v13 offset:6144
M v[76:79],a[232:235],v[244:247],v[76:79]
T a[228:229],v14 offset:4096
T a[230:231],v14 offset:6144
M v[80:83],a[232:235],v[248:251],v[80:83]
M v[84:87],a[232:235],v[252:255],v[84:87]
T a[232:233],v13 offset:8192
T a[234:235],v13 offset:10240
M v[96:99],a[236:239],v[252:255],v[96:99]
L v108,s[16:19],s35 offen offset:2048 lds
M v[92:95],a[236:239],v[248:251],v[92:95]
M v[88:91],a[236:239],v[244:247],v[88:91]
s_waitcnt lgkmcnt(4)
M v[52:55],a[216:219],a[0:3],0
T a[236:237],v14 offset:8192
s_add_u32 m0,s28,0x12000
M v[56:59],a[216:219],a[4:7],0
T a[238:239],v14 offset:10240
M v[60:63],a[216:219],a[8:11],0
s_add_u32 s35,s32,0x7800
M v[72:75],a[220:223],a[8:11],0
T a[216:217],v13 offset:12288
C v40,v76,v77
M v[68:71],a[220:223],a[4:7],0
T a[218:219],v13 offset:14336
M v[64:67],a[220:223],a[0:3],0
L v106,s[16:19],s32 offen lds
M v[52:55],a[224:227],a[12:15],v[52:55]
T a[220:221],v14 offset:12288
M v[56:59],a[224:227],a[16:19],v[56:59]
T a[222:223],v14 offset:14336
C v41,v78,v79
M v[60:63],a[224:227],a[20:23],v[60:63]
L v107,s[16:19],s32 offen offset:1024 lds
s_waitcnt lgkmcnt(4)
M v[72:75],a[228:231],a[20:23],v[72:75]
T a[224:225],v13 offset:16384
M v[68:71],a[228:231],a[16:19],v[68:71]
T a[226:227],v13 offset:18432
M v[64:67],a[228:231],a[12:15],v[64:67]
C v42,v88,v89
L v108,s[16:19],s32 offen offset:2048 lds
M v[52:55],a[232:235],a[24:27],v[52:55]
T a[228:229],v14 offset:16384
M v[56:59],a[232:235],a[28:31],v[56:59]
T a[230:231],v14 offset:18432
M v[60:63],a[232:235],a[32:35],v[60:63]
s_add_u32 m0,m0,0xc00
M v[72:75],a[236:239],a[32:35],v[72:75]
T a[232:233],v13 offset:20480
M v[68:71],a[236:239],a[28:31],v[68:71]
T a[234:235],v13 offset:22528
C v43,v90,v91
M v[64:67],a[236:239],a[24:27],v[64:67]
s_add_u32 s32,s32,0xfff4c080
s_waitcnt lgkmcnt(4)
M v[52:55],a[216:219],a[36:39],v[52:55]
T a[236:237],v14 offset:20480
M v[56:59],a[216:219],a[40:43],v[56:59]
T a[238:239],v14 offset:22528
M v[60:63],a[216:219],a[44:47],v[60:63]
buffer_store_dwordx4 v[40:43],v0,s[24:27],s44 offen sc1
L v106,s[16:19],s35 offen lds
M v[72:75],a[220:223],a[44:47],v[72:75]
M v[68:71],a[220:223],a[40:43],v[68:71]
L v107,s[16:19],s35 offen offset:1024 lds
M v[64:67],a[220:223],a[36:39],v[64:67]
C v44,v80,v81
M v[52:55],a[224:227],a[48:51],v[52:55]
L v108,s[16:19],s35 offen offset:2048 lds
M v[56:59],a[224:227],a[52:55],v[56:59]
M v[60:63],a[224:227],a[56:59],v[60:63]
s_waitcnt vmcnt(13) lgkmcnt(0)
s_barrier
M v[72:75],a[228:231],a[56:59],v[72:75]
T a[216:217],v13 offset:24576
T a[218:219],v13 offset:26624
M v[68:71],a[228:231],a[52:55],v[68:71]
T a[220:221],v14 offset:24576
T a[222:223],v14 offset:26624
M v[64:67],a[228:231],a[48:51],v[64:67]
T a[224:225],v13 offset:28672
T a[226:227],v13 offset:30720
M v[52:55],a[232:235],a[60:63],v[52:55]
T a[228:229],v14 offset:28672
T a[230:231],v14 offset:30720
M v[56:59],a[232:235],a[64:67],v[56:59]
C v45,v82,v83
M v[60:63],a[232:235],a[68:71],v[60:63]
T a[232:233],v13 offset:32768
T a[234:235],v13 offset:34816
M v[72:75],a[236:239],a[68:71],v[72:75]
s_cmp_eq_u32 s32,s43
s_cselect_b32 s32,s42,s32
M v[68:71],a[236:239],a[64:67],v[68:71]
M v[64:67],a[236:239],a[60:63],v[64:67]
C v46,v92,v93
s_waitcnt lgkmcnt(4)
M v[52:55],a[216:219],a[72:75],v[52:55]
T a[236:237],v14 offset:32768
s_add_u32 m0,s28,0
M v[56:59],a[216:219],a[76:79],v[56:59]
T a[238:239],v14 offset:34816
M v[60:63],a[216:219],a[80:83],v[60:63]
s_add_u32 s35,s32,0x7800
M v[72:75],a[220:223],a[80:83],v[72:75]
T a[216:217],v13 offset:36864
C v47,v94,v95
M v[68:71],a[220:223],a[76:79],v[68:71]
T a[218:219],v13 offset:38912
M v[64:67],a[220:223],a[72:75],v[64:67]
L v106,s[16:19],s32 offen lds
M v[52:55],a[224:227],a[84:87],v[52:55]
T a[220:221],v14 offset:36864
M v[56:59],a[224:227],a[88:91],v[56:59]
T a[222:223],v14 offset:38912
buffer_store_dwordx4 v[44:47],v0,s[24:27],s44 offen offset:1024 sc1
M v[60:63],a[224:227],a[92:95],v[60:63]
s_waitcnt lgkmcnt(4)
M v[72:75],a[228:231],a[92:95],v[72:75]
T a[224:225],v13 offset:40960
M v[68:71],a[228:231],a[88:91],v[68:71]
T a[226:227],v13 offset:43008
L v107,s[16:19],s32 offen offset:1024 lds
M v[64:67],a[228:231],a[84:87],v[64:67]
M v[52:55],a[232:235],a[96:99],v[52:55]
T a[228:229],v14 offset:40960
C v48,v84,v85
M v[56:59],a[232:235],a[100:103],v[56:59]
T a[230:231],v14 offset:43008
L v108,s[16:19],s32 offen offset:2048 lds
M v[60:63],a[232:235],a[104:107],v[60:63]
M v[72:75],a[236:239],a[104:107],v[72:75]
T a[232:233],v13 offset:45056
M v[68:71],a[236:239],a[100:103],v[68:71]
T a[234:235],v13 offset:47104
C v49,v86,v87
M v[64:67],a[236:239],a[96:99],v[64:67]
s_add_u32 m0,m0,0xc00
s_waitcnt lgkmcnt(4)
M v[52:55],a[216:219],a[108:111],v[52:55]
T a[236:237],v14 offset:45056
M v[56:59],a[216:219],a[112:115],v[56:59]
T a[238:239],v14 offset:47104
M v[60:63],a[216:219],a[116:119],v[60:63]
s_add_u32 s32,s32,0x78000
M v[72:75],a[220:223],a[116:119],v[72:75]
C v50,v96,v97
M v[68:71],a[220:223],a[112:115],v[68:71]
L v106,s[16:19],s35 offen lds
M v[64:67],a[220:223],a[108:111],v[64:67]
C v51,v98,v99
M v[52:55],a[224:227],a[120:123],v[52:55]
L v107,s[16:19],s35 offen offset:1024 lds
M v[56:59],a[224:227],a[124:127],v[56:59]
M v[60:63],a[224:227],a[128:131],v[60:63]
s_waitcnt vmcnt(13) lgkmcnt(0)
s_barrier
M v[72:75],a[228:231],a[128:131],v[72:75]
T a[216:217],v15
T a[218:219],v15 offset:2048
M v[68:71],a[228:231],a[124:127],v[68:71]
T a[220:221],v16
T a[222:223],v16 offset:2048
M v[64:67],a[228:231],a[120:123],v[64:67]
T a[224:225],v15 offset:4096
T a[226:227],v15 offset:6144
M v[52:55],a[232:235],a[132:135],v[52:55]
T a[228:229],v16 offset:4096
T a[230:231],v16 offset:6144
M v[56:59],a[232:235],a[136:139],v[56:59]
buffer_store_dwordx4 v[48:51],v0,s[24:27],s44 offen offset:2048 sc1
M v[60:63],a[232:235],a[140:143],v[60:63]
T a[232:233],v15 offset:8192
T a[234:235],v15 offset:10240
M v[72:75],a[236:239],a[140:143],v[72:75]
L v108,s[16:19],s35 offen offset:2048 lds
M v[68:71],a[236:239],a[136:139],v[68:71]
M v[64:67],a[236:239],a[132:135],v[64:67]
s_add_u32 s44,s44,0x3000
s_waitcnt lgkmcnt(4)
M v[52:55],a[216:219],v[112:115],v[52:55]
T a[236:237],v16 offset:8192
s_add_u32 m0,s28,0x6000
M v[56:59],a[216:219],v[116:119],v[56:59]
T a[238:239],v16 offset:10240
M v[60:63],a[216:219],v[120:123],v[60:63]
s_add_u32 s35,s32,0x7800
M v[72:75],a[220:223],v[120:123],v[72:75]
T a[216:217],v15 offset:12288
M v[68:71],a[220:223],v[116:119],v[68:71]
T a[218:219],v15 offset:14336
M v[64:67],a[220:223],v[112:115],v[64:67]
L v106,s[16:19],s32 offen lds
M v[52:55],a[224:227],v[124:127],v[52:55]
T a[220:221],v16 offset:12288
M v[56:59],a[224:227],v[128:131],v[56:59]
T a[222:223],v16 offset:14336
M v[60:63],a[224:227],v[132:135],v[60:63]
s_waitcnt lgkmcnt(4)
M v[72:75],a[228:231],v[132:135],v[72:75]
T a[224:225],v15 offset:16384
L v107,s[16:19],s32 offen offset:1024 lds
M v[68:71],a[228:231],v[128:131],v[68:71]
T a[226:227],v15 offset:18432
M v[64:67],a[228:231],v[124:127],v[64:67]
s_cmp_eq_u32 s44,s46
s_cselect_b32 s44,s45,s44
M v[52:55],a[232:235],v[136:139],v[52:55]
T a[228:229],v16 offset:16384
buffer_store_dwordx4 a[144:147],v0,s[24:27],s47 offen sc1
M v[56:59],a[232:235],v[140:143],v[56:59]
T a[230:231],v16 offset:18432
M v[60:63],a[232:235],v[144:147],v[60:63]
L v108,s[16:19],s32 offen offset:2048 lds
M v[72:75],a[236:239],v[144:147],v[72:75]
T a[232:233],v15 offset:20480
M v[68:71],a[236:239],v[140:143],v[68:71]
T a[234:235],v15 offset:22528
M v[64:67],a[236:239],v[136:139],v[64:67]
buffer_store_dwordx4 a[148:151],v0,s[24:27],s47 offen offset:1024 sc1
s_waitcnt lgkmcnt(4)
M v[52:55],a[216:219],v[148:151],v[52:55]
T a[236:237],v16 offset:20480
s_add_u32 m0,m0,0xc00
M v[56:59],a[216:219],v[152:155],v[56:59]
T a[238:239],v16 offset:22528
M v[60:63],a[216:219],v[156:159],v[60:63]
M v[72:75],a[220:223],v[156:159],v[72:75]
buffer_store_dwordx4 a[152:155],v0,s[24:27],s47 offen offset:2048 sc1
s_add_u32 s32,s32,0xfffc4000
M v[68:71],a[220:223],v[152:155],v[68:71]
M v[64:67],a[220:223],v[148:151],v[64:67]
L v106,s[16:19],s35 offen lds
M v[52:55],a[224:227],v[160:163],v[52:55]
s_add_u32 s47,s47,0x3000
M v[56:59],a[224:227],v[164:167],v[56:59]
L v107,s[16:19],s35 offen offset:1024 lds
M v[60:63],a[224:227],v[168:171],v[60:63]
s_waitcnt vmcnt(16) lgkmcnt(0)
s_barrier
M v[72:75],a[228:231],v[168:171],v[72:75]
T a[216:217],v15 offset:24576
T a[218:219],v15 offset:26624
M v[68:71],a[228:231],v[164:167],v[68:71]
T a[220:221],v16 offset:24576
T a[222:223],v16 offset:26624
M v[64:67],a[228:231],v[160:163],v[64:67]
T a[224:225],v15 offset:28672
T a[226:227],v15 offset:30720
M v[52:55],a[232:235],v[172:175],v[52:55]
T a[228:229],v16 offset:28672
T a[230:231],v16 offset:30720
M v[56:59],a[232:235],v[176:179],v[56:59]
M v[60:63],a[232:235],v[180:183],v[60:63]
T a[232:233],v15 offset:32768
T a[234:235],v15 offset:34816
M v[72:75],a[236:239],v[180:183],v[72:75]
L v108,s[16:19],s35 offen offset:2048 lds
M v[68:71],a[236:239],v[176:179],v[68:71]
M v[64:67],a[236:239],v[172:175],v[64:67]
s_waitcnt lgkmcnt(4)
M v[52:55],a[216:219],v[184:187],v[52:55]
T a[236:237],v16 offset:32768
s_add_u32 m0,s28,0xc000
M v[56:59],a[216:219],v[188:191],v[56:59]
T a[238:239],v16 offset:34816
M v[60:63],a[216:219],v[192:195],v[60:63]
s_cmp_eq_u32 s47,s46
s_cselect_b32 s47,s45,s47
M v[72:75],a[220:223],v[192:195],v[72:75]
T a[216:217],v15 offset:36864
M v[68:71],a[220:223],v[188:191],v[68:71]
T a[218:219],v15 offset:38912
buffer_store_dwordx4 a[156:159],v0,s[24:27],s47 offen sc1
M v[64:67],a[220:223],v[184:187],v[64:67]
s_add_u32 s35,s32,0x7800
M v[52:55],a[224:227],v[196:199],v[52:55]
T a[220:221],v16 offset:36864
M v[56:59],a[224:227],v[200:203],v[56:59]
T a[222:223],v16 offset:38912
L v106,s[16:19],s32 offen lds
M v[60:63],a[224:227],v[204:207],v[60:63]
buffer_store_dwordx4 a[160:163],v0,s[24:27],s47 offen offset:1024 sc1
s_waitcnt lgkmcnt(4)
M v[72:75],a[228:231],v[204:207],v[72:75]
T a[224:225],v15 offset:40960
M v[68:71],a[228:231],v[200:203],v[68:71]
T a[226:227],v15 offset:43008
M v[64:67],a[228:231],v[196:199],v[64:67]
L v107,s[16:19],s32 offen offset:1024 lds
M v[52:55],a[232:235],v[208:211],v[52:55]
T a[228:229],v16 offset:40960
M v[56:59],a[232:235],v[212:215],v[56:59]
T a[230:231],v16 offset:43008
buffer_store_dwordx4 a[164:167],v0,s[24:27],s47 offen offset:2048 sc1
M v[60:63],a[232:235],v[216:219],v[60:63]
L v108,s[16:19],s32 offen offset:2048 lds
M v[72:75],a[236:239],v[216:219],v[72:75]
T a[232:233],v15 offset:45056
M v[68:71],a[236:239],v[212:215],v[68:71]
T a[234:235],v15 offset:47104
M v[64:67],a[236:239],v[208:211],v[64:67]
s_add_u32 s47,s47,0x3000
s_waitcnt lgkmcnt(4)
M v[52:55],a[216:219],v[220:223],v[52:55]
T a[236:237],v16 offset:45056
M v[56:59],a[216:219],v[224:227],v[56:59]
T a[238:239],v16 offset:47104
s_add_u32 m0,m0,0xc00
M v[60:63],a[216:219],v[228:231],v[60:63]
M v[72:75],a[220:223],v[228:231],v[72:75]
s_add_u32 s32,s32,0x78000
M v[68:71],a[220:223],v[224:227],v[68:71]
M v[64:67],a[220:223],v[220:223],v[64:67]
L v106,s[16:19],s35 offen lds
M v[52:55],a[224:227],v[232:235],v[52:55]
s_cmp_eq_u32 s47,s46
s_cselect_b32 s47,s45,s47
M v[56:59],a[224:227],v[236:239],v[56:59]
L v107,s[16:19],s35 offen offset:1024 lds
M v[60:63],a[224:227],v[240:243],v[60:63]
s_waitcnt vmcnt(17) lgkmcnt(0)
s_barrier
M v[72:75],a[228:231],v[240:243],v[72:75]
T a[216:217],v13
T a[218:219],v13 offset:2048
M v[68:71],a[228:231],v[236:239],v[68:71]
T a[220:221],v14
T a[222:223],v14 offset:2048
M v[64:67],a[228:231],v[232:235],v[64:67]
T a[224:225],v13 offset:4096
T a[226:227],v13 offset:6144
M v[52:55],a[232:235],v[244:247],v[52:55]
T a[228:229],v14 offset:4096
T a[230:231],v14 offset:6144
M v[56:59],a[232:235],v[248:251],v[56:59]
M v[60:63],a[232:235],v[252:255],v[60:63]
T a[232:233],v13 offset:8192
T a[234:235],v13 offset:10240
M v[72:75],a[236:239],v[252:255],v[72:75]
L v108,s[16:19],s35 offen offset:2048 lds
M v[68:71],a[236:239],v[248:251],v[68:71]
M v[64:67],a[236:239],v[244:247],v[64:67]
s_waitcnt lgkmcnt(4)
M v[76:79],a[216:219],a[0:3],0
T a[236:237],v14 offset:8192
s_add_u32 m0,s28,0x12000
M v[80:83],a[216:219],a[4:7],0
T a[238:239],v14 offset:10240
M v[84:87],a[216:219],a[8:11],0
s_add_u32 s35,s32,0x7800
M v[96:99],a[220:223],a[8:11],0
T a[216:217],v13 offset:12288
C v40,v52,v53
M v[92:95],a[220:223],a[4:7],0
T a[218:219],v13 offset:14336
M v[88:91],a[220:223],a[0:3],0
L v106,s[16:19],s32 offen lds
M v[76:79],a[224:227],a[12:15],v[76:79]
T a[220:221],v14 offset:12288
M v[80:83],a[224:227],a[16:19],v[80:83]
T a[222:223],v14 offset:14336
C v41,v54,v55
M v[84:87],a[224:227],a[20:23],v[84:87]
L v107,s[16:19],s32 offen offset:1024 lds
s_waitcnt lgkmcnt(4)
M v[96:99],a[228:231],a[20:23],v[96:99]
T a[224:225],v13 offset:16384
M v[92:95],a[228:231],a[16:19],v[92:95]
T a[226:227],v13 offset:18432
M v[88:91],a[228:231],a[12:15],v[88:91]
C v42,v64,v65
L v108,s[16:19],s32 offen offset:2048 lds
M v[76:79],a[232:235],a[24:27],v[76:79]
T a[228:229],v14 offset:16384
M v[80:83],a[232:235],a[28:31],v[80:83]
T a[230:231],v14 offset:18432
M v[84:87],a[232:235],a[32:35],v[84:87]
s_add_u32 m0,m0,0xc00
M v[96:99],a[236:239],a[32:35],v[96:99]
T a[232:233],v13 offset:20480
M v[92:95],a[236:239],a[28:31],v[92:95]
T a[234:235],v13 offset:22528
C v43,v66,v67
M v[88:91],a[236:239],a[24:27],v[88:91]
s_add_u32 s32,s32,0xfff4c080
s_waitcnt lgkmcnt(4)
M v[76:79],a[216:219],a[36:39],v[76:79]
T a[236:237],v14 offset:20480
M v[80:83],a[216:219],a[40:43],v[80:83]
T a[238:239],v14 offset:22528
M v[84:87],a[216:219],a[44:47],v[84:87]
buffer_store_dwordx4 v[40:43],v0,s[24:27],s44 offen sc1
L v106,s[16:19],s35 offen lds
M v[96:99],a[220:223],a[44:47],v[96:99]
M v[92:95],a[220:223],a[40:43],v[92:95]
L v107,s[16:19],s35 offen offset:1024 lds
M v[88:91],a[220:223],a[36:39],v[88:91]
C v44,v56,v57
M v[76:79],a[224:227],a[48:51],v[76:79]
L v108,s[16:19],s35 offen offset:2048 lds
M v[80:83],a[224:227],a[52:55],v[80:83]
M v[84:87],a[224:227],a[56:59],v[84:87]
s_waitcnt vmcnt(16) lgkmcnt(0)
s_barrier
M v[96:99],a[228:231],a[56:59],v[96:99]
T a[216:217],v13 offset:24576
T a[218:219],v13 offset:26624
M v[92:95],a[228:231],a[52:55],v[92:95]
T a[220:221],v14 offset:24576
T a[222:223],v14 offset:26624
M v[88:91],a[228:231],a[48:51],v[88:91]
T a[224:225],v13 offset:28672
T a[226:227],v13 offset:30720
M v[76:79],a[232:235],a[60:63],v[76:79]
T a[228:229],v14 offset:28672
T a[230:231],v14 offset:30720
M v[80:83],a[232:235],a[64:67],v[80:83]
C v45,v58,v59
M v[84:87],a[232:235],a[68:71],v[84:87]
T a[232:233],v13 offset:32768
T a[234:235],v13 offset:34816
M v[96:99],a[236:239],a[68:71],v[96:99]
s_cmp_eq_u32 s32,s43
s_cselect_b32 s32,s42,s32
M v[92:95],a[236:239],a[64:67],v[92:95]
M v[88:91],a[236:239],a[60:63],v[88:91]
C v46,v68,v69
s_waitcnt lgkmcnt(4)
M v[76:79],a[216:219],a[72:75],v[76:79]
T a[236:237],v14 offset:32768
s_add_u32 m0,s28,0
M v[80:83],a[216:219],a[76:79],v[80:83]
T a[238:239],v14 offset:34816
M v[84:87],a[216:219],a[80:83],v[84:87]
s_add_u32 s35,s32,0x7800
M v[96:99],a[220:223],a[80:83],v[96:99]
T a[216:217],v13 offset:36864
C v47,v70,v71
M v[92:95],a[220:223],a[76:79],v[92:95]
T a[218:219],v13 offset:38912
M v[88:91],a[220:223],a[72:75],v[88:91]
L v106,s[16:19],s32 offen lds
M v[76:79],a[224:227],a[84:87],v[76:79]
T a[220:221],v14 offset:36864
M v[80:83],a[224:227],a[88:91],v[80:83]
T a[222:223],v14 offset:38912
buffer_store_dwordx4 v[44:47],v0,s[24:27],s44 offen offset:1024 sc1
M v[84:87],a[224:227],a[92:95],v[84:87]
s_waitcnt lgkmcnt(4)
M v[96:99],a[228:231],a[92:95],v[96:99]
T a[224:225],v13 offset:40960
M v[92:95],a[228:231],a[88:91],v[92:95]
T a[226:227],v13 offset:43008
L v107,s[16:19],s32 offen offset:1024 lds
M v[88:91],a[228:231],a[84:87],v[88:91]
M v[76:79],a[232:235],a[96:99],v[76:79]
T a[228:229],v14 offset:40960
C v48,v60,v61
M v[80:83],a[232:235],a[100:103],v[80:83]
T a[230:231],v14 offset:43008
L v108,s[16:19],s32 offen offset:2048 lds
M v[84:87],a[232:235],a[104:107],v[84:87]
M v[96:99],a[236:239],a[104:107],v[96:99]
T a[232:233],v13 offset:45056
M v[92:95],a[236:239],a[100:103],v[92:95]
T a[234:235],v13 offset:47104
C v49,v62,v63
M v[88:91],a[236:239],a[96:99],v[88:91]
s_add_u32 m0,m0,0xc00
s_waitcnt lgkmcnt(4)
M v[76:79],a[216:219],a[108:111],v[76:79]
T a[236:237],v14 offset:45056
M v[80:83],a[216:219],a[112:115],v[80:83]
T a[238:239],v14 offset:47104
M v[84:87],a[216:219],a[116:119],v[84:87]
s_add_u32 s32,s32,0x78000
M v[96:99],a[220:223],a[116:119],v[96:99]
C v50,v72,v73
M v[92:95],a[220:223],a[112:115],v[92:95]
L v106,s[16:19],s35 offen lds
M v[88:91],a[220:223],a[108:111],v[88:91]
C v51,v74,v75
M v[76:79],a[224:227],a[120:123],v[76:79]
L v107,s[16:19],s35 offen offset:1024 lds
M v[80:83],a[224:227],a[124:127],v[80:83]
M v[84:87],a[224:227],a[128:131],v[84:87]
s_waitcnt vmcnt(13) lgkmcnt(0)
s_barrier
M v[96:99],a[228:231],a[128:131],v[96:99]
T a[216:217],v15
T a[218:219],v15 offset:2048
M v[92:95],a[228:231],a[124:127],v[92:95]
T a[220:221],v16
T a[222:223],v16 offset:2048
M v[88:91],a[228:231],a[120:123],v[88:91]
T a[224:225],v15 offset:4096
T a[226:227],v15 offset:6144
M v[76:79],a[232:235],a[132:135],v[76:79]
T a[228:229],v16 offset:4096
T a[230:231],v16 offset:6144
M v[80:83],a[232:235],a[136:139],v[80:83]
buffer_store_dwordx4 v[48:51],v0,s[24:27],s44 offen offset:2048 sc1
M v[84:87],a[232:235],a[140:143],v[84:87]
T a[232:233],v15 offset:8192
T a[234:235],v15 offset:10240
M v[96:99],a[236:239],a[140:143],v[96:99]
L v108,s[16:19],s35 offen offset:2048 lds
M v[92:95],a[236:239],a[136:139],v[92:95]
M v[88:91],a[236:239],a[132:135],v[88:91]
s_add_u32 s44,s44,0x3000
s_waitcnt lgkmcnt(4)
M v[76:79],a[216:219],v[112:115],v[76:79]
T a[236:237],v16 offset:8192
s_add_u32 m0,s28,0x6000
M v[80:83],a[216:219],v[116:119],v[80:83]
T a[238:239],v16 offset:10240
M v[84:87],a[216:219],v[120:123],v[84:87]
s_add_u32 s35,s32,0x7800
M v[96:99],a[220:223],v[120:123],v[96:99]
T a[216:217],v15 offset:12288
M v[92:95],a[220:223],v[116:119],v[92:95]
T a[218:219],v15 offset:14336
M v[88:91],a[220:223],v[112:115],v[88:91]
L v106,s[16:19],s32 offen lds
M v[76:79],a[224:227],v[124:127],v[76:79]
T a[220:221],v16 offset:12288
M v[80:83],a[224:227],v[128:131],v[80:83]
T a[222:223],v16 offset:14336
M v[84:87],a[224:227],v[132:135],v[84:87]
s_waitcnt lgkmcnt(4)
M v[96:99],a[228:231],v[132:135],v[96:99]
T a[224:225],v15 offset:16384
L v107,s[16:19],s32 offen offset:1024 lds
M v[92:95],a[228:231],v[128:131],v[92:95]
T a[226:227],v15 offset:18432
M v[88:91],a[228:231],v[124:127],v[88:91]
s_cmp_eq_u32 s44,s46
s_cselect_b32 s44,s45,s44
M v[76:79],a[232:235],v[136:139],v[76:79]
T a[228:229],v16 offset:16384
buffer_store_dwordx4 a[168:171],v0,s[24:27],s47 offen sc1
M v[80:83],a[232:235],v[140:143],v[80:83]
T a[230:231],v16 offset:18432
M v[84:87],a[232:235],v[144:147],v[84:87]
L v108,s[16:19],s32 offen offset:2048 lds
M v[96:99],a[236:239],v[144:147],v[96:99]
T a[232:233],v15 offset:20480
M v[92:95],a[236:239],v[140:143],v[92:95]
T a[234:235],v15 offset:22528
M v[88:91],a[236:239],v[136:139],v[88:91]
buffer_store_dwordx4 a[172:175],v0,s[24:27],s47 offen offset:1024 sc1
s_waitcnt lgkmcnt(4)
M v[76:79],a[216:219],v[148:151],v[76:79]
T a[236:237],v16 offset:20480
s_add_u32 m0,m0,0xc00
M v[80:83],a[216:219],v[152:155],v[80:83]
T a[238:239],v16 offset:22528
M v[84:87],a[216:219],v[156:159],v[84:87]
M v[96:99],a[220:223],v[156:159],v[96:99]
buffer_store_dwordx4 a[176:179],v0,s[24:27],s47 offen offset:2048 sc1
s_add_u32 s32,s32,0xfffc4000
M v[92:95],a[220:223],v[152:155],v[92:95]
M v[88:91],a[220:223],v[148:151],v[88:91]
L v106,s[16:19],s35 offen lds
M v[76:79],a[224:227],v[160:163],v[76:79]
s_add_u32 s47,s47,0x3000
M v[80:83],a[224:227],v[164:167],v[80:83]
L v107,s[16:19],s35 offen offset:1024 lds
M v[84:87],a[224:227],v[168:171],v[84:87]
s_waitcnt vmcnt(16) lgkmcnt(0)
s_barrier
M v[96:99],a[228:231],v[168:171],v[96:99]
T a[216:217],v15 offset:24576
T a[218:219],v15 offset:26624
M v[92:95],a[228:231],v[164:167],v[92:95]
T a[220:221],v16 offset:24576
T a[222:223],v16 offset:26624
M v[88:91],a[228:231],v[160:163],v[88:91]
T a[224:225],v15 offset:28672
T a[226:227],v15 offset:30720
M v[76:79],a[232:235],v[172:175],v[76:79]
T a[228:229],v16 offset:28672
T a[230:231],v16 offset:30720
M v[80:83],a[232:235],v[176:179],v[80:83]
M v[84:87],a[232:235],v[180:183],v[84:87]
T a[232:233],v15 offset:32768
T a[234:235],v15 offset:34816
M v[96:99],a[236:239],v[180:183],v[96:99]
L v108,s[16:19],s35 offen offset:2048 lds
M v[92:95],a[236:239],v[176:179],v[92:95]
M v[88:91],a[236:239],v[172:175],v[88:91]
s_waitcnt lgkmcnt(4)
M v[76:79],a[216:219],v[184:187],v[76:79]
T a[236:237],v16 offset:32768
s_add_u32 m0,s28,0xc000
M v[80:83],a[216:219],v[188:191],v[80:83]
T a[238:239],v16 offset:34816
M v[84:87],a[216:219],v[192:195],v[84:87]
s_cmp_eq_u32 s47,s46
s_cselect_b32 s47,s45,s47
M v[96:99],a[220:223],v[192:195],v[96:99]
T a[216:217],v15 offset:36864
M v[92:95],a[220:223],v[188:191],v[92:95]
T a[218:219],v15 offset:38912
buffer_store_dwordx4 a[180:183],v0,s[24:27],s47 offen sc1
M v[88:91],a[220:223],v[184:187],v[88:91]
s_add_u32 s35,s32,0x7800
M v[76:79],a[224:227],v[196:199],v[76:79]
T a[220:221],v16 offset:36864
M v[80:83],a[224:227],v[200:203],v[80:83]
T a[222:223],v16 offset:38912
L v106,s[16:19],s32 offen lds
M v[84:87],a[224:227],v[204:207],v[84:87]
buffer_store_dwordx4 a[184:187],v0,s[24:27],s47 offen offset:1024 sc1
s_waitcnt lgkmcnt(4)
M v[96:99],a[228:231],v[204:207],v[96:99]
T a[224:225],v15 offset:40960
M v[92:95],a[228:231],v[200:203],v[92:95]
T a[226:227],v15 offset:43008
M v[88:91],a[228:231],v[196:199],v[88:91]
L v107,s[16:19],s32 offen offset:1024 lds
M v[76:79],a[232:235],v[208:211],v[76:79]
T a[228:229],v16 offset:40960
M v[80:83],a[232:235],v[212:215],v[80:83]
T a[230:231],v16 offset:43008
buffer_store_dwordx4 a[188:191],v0,s[24:27],s47 offen offset:2048 sc1
M v[84:87],a[232:235],v[216:219],v[84:87]
L v108,s[16:19],s32 offen offset:2048 lds
M v[96:99],a[236:239],v[216:219],v[96:99]
T a[232:233],v15 offset:45056
M v[92:95],a[236:239],v[212:215],v[92:95]
T a[234:235],v15 offset:47104
M v[88:91],a[236:239],v[208:211],v[88:91]
s_add_u32 s47,s47,0x3000
s_waitcnt lgkmcnt(4)
M v[76:79],a[216:219],v[220:223],v[76:79]
T a[236:237],v16 offset:45056
M v[80:83],a[216:219],v[224:227],v[80:83]
T a[238:239],v16 offset:47104
s_add_u32 m0,m0,0xc00
M v[84:87],a[216:219],v[228:231],v[84:87]
M v[96:99],a[220:223],v[228:231],v[96:99]
s_add_u32 s32,s32,0x78000
M v[92:95],a[220:223],v[224:227],v[92:95]
M v[88:91],a[220:223],v[220:223],v[88:91]
L v106,s[16:19],s35 offen lds
M v[76:79],a[224:227],v[232:235],v[76:79]
s_cmp_eq_u32 s47,s46
s_cselect_b32 s47,s45,s47
M v[80:83],a[224:227],v[236:239],v[80:83]
L v107,s[16:19],s35 offen offset:1024 lds
M v[84:87],a[224:227],v[240:243],v[84:87]
s_waitcnt vmcnt(17) lgkmcnt(0)
s_barrier
M v[96:99],a[228:231],v[240:243],v[96:99]
T a[216:217],v13
T a[218:219],v13 offset:2048
M v[92:95],a[228:231],v[236:239],v[92:95]
T a[220:221],v14
T a[222:223],v14 offset:2048
M v[88:91],a[228:231],v[232:235],v[88:91]
T a[224:225],v13 offset:4096
T a[226:227],v13 offset:6144
M v[76:79],a[232:235],v[244:247],v[76:79]
T a[228:229],v14 offset:4096
T a[230:231],v14 offset:6144
M v[80:83],a[232:235],v[248:251],v[80:83]
M v[84:87],a[232:235],v[252:255],v[84:87]
T a[232:233],v13 offset:8192
T a[234:235],v13 offset:10240
M v[96:99],a[236:239],v[252:255],v[96:99]
L v108,s[16:19],s35 offen offset:2048 lds
M v[92:95],a[236:239],v[248:251],v[92:95]
M v[88:91],a[236:239],v[244:247],v[88:91]
s_waitcnt lgkmcnt(4)
M v[52:55],a[216:219],a[0:3],0
T a[236:237],v14 offset:8192
s_add_u32 m0,s28,0x12000
M v[56:59],a[216:219],a[4:7],0
T a[238:239],v14 offset:10240
M v[60:63],a[216:219],a[8:11],0
s_add_u32 s35,s32,0x7800
M v[72:75],a[220:223],a[8:11],0
T a[216:217],v13 offset:12288
C v40,v76,v77
M v[68:71],a[220:223],a[4:7],0
T a[218:219],v13 offset:14336
M v[64:67],a[220:223],a[0:3],0
L v106,s[16:19],s32 offen lds
M v[52:55],a[224:227],a[12:15],v[52:55]
T a[220:221],v14 offset:12288
M v[56:59],a[224:227],a[16:19],v[56:59]
T a[222:223],v14 offset:14336
C v41,v78,v79
M v[60:63],a[224:227],a[20:23],v[60:63]
L v107,s[16:19],s32 offen offset:1024 lds
s_waitcnt lgkmcnt(4)
M v[72:75],a[228:231],a[20:23],v[72:75]
T a[224:225],v13 offset:16384
M v[68:71],a[228:231],a[16:19],v[68:71]
T a[226:227],v13 offset:18432
M v[64:67],a[228:231],a[12:15],v[64:67]
L v108,s[16:19],s32 offen offset:2048 lds
M v[52:55],a[232:235],a[24:27],v[52:55]
T a[228:229],v14 offset:16384
C v42,v88,v89
M v[56:59],a[232:235],a[28:31],v[56:59]
T a[230:231],v14 offset:18432
M v[60:63],a[232:235],a[32:35],v[60:63]
s_add_u32 m0,m0,0xc00
M v[72:75],a[236:239],a[32:35],v[72:75]
T a[232:233],v13 offset:20480
M v[68:71],a[236:239],a[28:31],v[68:71]
T a[234:235],v13 offset:22528
s_add_u32 s32,s32,0xfff4c080
M v[64:67],a[236:239],a[24:27],v[64:67]
C v43,v90,v91
s_waitcnt lgkmcnt(4)
M v[52:55],a[216:219],a[36:39],v[52:55]
T a[236:237],v14 offset:20480
M v[56:59],a[216:219],a[40:43],v[56:59]
T a[238:239],v14 offset:22528
M v[60:63],a[216:219],a[44:47],v[60:63]
L v106,s[16:19],s35 offen lds
M v[72:75],a[220:223],a[44:47],v[72:75]
buffer_store_dwordx4 v[40:43],v0,s[24:27],s44 offen sc1
M v[68:71],a[220:223],a[40:43],v[68:71]
L v107,s[16:19],s35 offen offset:1024 lds
M v[64:67],a[220:223],a[36:39],v[64:67]
L v108,s[16:19],s35 offen offset:2048 lds
M v[52:55],a[224:227],a[48:51],v[52:55]
C v44,v80,v81
M v[56:59],a[224:227],a[52:55],v[56:59]
M v[60:63],a[224:227],a[56:59],v[60:63]
s_waitcnt vmcnt(16) lgkmcnt(0)
s_barrier
M v[72:75],a[228:231],a[56:59],v[72:75]
T a[216:217],v13 offset:24576
T a[218:219],v13 offset:26624
M v[68:71],a[228:231],a[52:55],v[68:71]
T a[220:221],v14 offset:24576
T a[222:223],v14 offset:26624
M v[64:67],a[228:231],a[48:51],v[64:67]
T a[224:225],v13 offset:28672
T a[226:227],v13 offset:30720
M v[52:55],a[232:235],a[60:63],v[52:55]
T a[228:229],v14 offset:28672
T a[230:231],v14 offset:30720
M v[56:59],a[232:235],a[64:67],v[56:59]
M v[60:63],a[232:235],a[68:71],v[60:63]
T a[232:233],v13 offset:32768
T a[234:235],v13 offset:34816
M v[72:75],a[236:239],a[68:71],v[72:75]
C v45,v82,v83
M v[68:71],a[236:239],a[64:67],v[68:71]
s_cmp_eq_u32 s32,s43
s_cselect_b32 s32,s42,s32
M v[64:67],a[236:239],a[60:63],v[64:67]
s_waitcnt lgkmcnt(4)
M v[52:55],a[216:219],a[72:75],v[52:55]
T a[236:237],v14 offset:32768
M v[56:59],a[216:219],a[76:79],v[56:59]
T a[238:239],v14 offset:34816
C v46,v92,v93
M v[60:63],a[216:219],a[80:83],v[60:63]
M v[72:75],a[220:223],a[80:83],v[72:75]
T a[216:217],v13 offset:36864
M v[68:71],a[220:223],a[76:79],v[68:71]
T a[218:219],v13 offset:38912
M v[64:67],a[220:223],a[72:75],v[64:67]
C v47,v94,v95
M v[52:55],a[224:227],a[84:87],v[52:55]
T a[220:221],v14 offset:36864
M v[56:59],a[224:227],a[88:91],v[56:59]
T a[222:223],v14 offset:38912
M v[60:63],a[224:227],a[92:95],v[60:63]
s_waitcnt lgkmcnt(4)
M v[72:75],a[228:231],a[92:95],v[72:75]
T a[224:225],v13 offset:40960
M v[68:71],a[228:231],a[88:91],v[68:71]
T a[226:227],v13 offset:43008
M v[64:67],a[228:231],a[84:87],v[64:67]
buffer_store_dwordx4 v[44:47],v0,s[24:27],s44 offen offset:1024 sc1
M v[52:55],a[232:235],a[96:99],v[52:55]
T a[228:229],v14 offset:40960
M v[56:59],a[232:235],a[100:103],v[56:59]
T a[230:231],v14 offset:43008
M v[60:63],a[232:235],a[104:107],v[60:63]
M v[72:75],a[236:239],a[104:107],v[72:75]
T a[232:233],v13 offset:45056
C v48,v84,v85
M v[68:71],a[236:239],a[100:103],v[68:71]
T a[234:235],v13 offset:47104
M v[64:67],a[236:239],a[96:99],v[64:67]
s_waitcnt lgkmcnt(4)
M v[52:55],a[216:219],a[108:111],v[52:55]
T a[236:237],v14 offset:45056
M v[56:59],a[216:219],a[112:115],v[56:59]
T a[238:239],v14 offset:47104
M v[60:63],a[216:219],a[116:119],v[60:63]
C v49,v86,v87
M v[72:75],a[220:223],a[116:119],v[72:75]
M v[68:71],a[220:223],a[112:115],v[68:71]
M v[64:67],a[220:223],a[108:111],v[64:67]
C v50,v96,v97
M v[52:55],a[224:227],a[120:123],v[52:55]
M v[56:59],a[224:227],a[124:127],v[56:59]
M v[60:63],a[224:227],a[128:131],v[60:63]
s_waitcnt vmcnt(8) lgkmcnt(0)
s_barrier
M v[72:75],a[228:231],a[128:131],v[72:75]
T a[216:217],v15
T a[218:219],v15 offset:2048
M v[68:71],a[228:231],a[124:127],v[68:71]
T a[220:221],v16
T a[222:223],v16 offset:2048
M v[64:67],a[228:231],a[120:123],v[64:67]
T a[224:225],v15 offset:4096
T a[226:227],v15 offset:6144
M v[52:55],a[232:235],a[132:135],v[52:55]
T a[228:229],v16 offset:4096
T a[230:231],v16 offset:6144
M v[56:59],a[232:235],a[136:139],v[56:59]
C v51,v98,v99
M v[60:63],a[232:235],a[140:143],v[60:63]
T a[232:233],v15 offset:8192
T a[234:235],v15 offset:10240
M v[72:75],a[236:239],a[140:143],v[72:75]
M v[68:71],a[236:239],a[136:139],v[68:71]
M v[64:67],a[236:239],a[132:135],v[64:67]
buffer_store_dwordx4 v[48:51],v0,s[24:27],s44 offen offset:2048 sc1
s_waitcnt lgkmcnt(4)
M v[52:55],a[216:219],v[112:115],v[52:55]
T a[236:237],v16 offset:8192
M v[56:59],a[216:219],v[116:119],v[56:59]
T a[238:239],v16 offset:10240
M v[60:63],a[216:219],v[120:123],v[60:63]
M v[72:75],a[220:223],v[120:123],v[72:75]
T a[216:217],v15 offset:12288
M v[68:71],a[220:223],v[116:119],v[68:71]
T a[218:219],v15 offset:14336
s_add_u32 s44,s44,0x3000
M v[64:67],a[220:223],v[112:115],v[64:67]
M v[52:55],a[224:227],v[124:127],v[52:55]
T a[220:221],v16 offset:12288
M v[56:59],a[224:227],v[128:131],v[56:59]
T a[222:223],v16 offset:14336
M v[60:63],a[224:227],v[132:135],v[60:63]
s_waitcnt lgkmcnt(4)
M v[72:75],a[228:231],v[132:135],v[72:75]
T a[224:225],v15 offset:16384
M v[68:71],a[228:231],v[128:131],v[68:71]
T a[226:227],v15 offset:18432
M v[64:67],a[228:231],v[124:127],v[64:67]
M v[52:55],a[232:235],v[136:139],v[52:55]
T a[228:229],v16 offset:16384
M v[56:59],a[232:235],v[140:143],v[56:59]
T a[230:231],v16 offset:18432
M v[60:63],a[232:235],v[144:147],v[60:63]
s_cmp_eq_u32 s44,s46
s_cselect_b32 s44,s45,s44
M v[72:75],a[236:239],v[144:147],v[72:75]
T a[232:233],v15 offset:20480
M v[68:71],a[236:239],v[140:143],v[68:71]
T a[234:235],v15 offset:22528
M v[64:67],a[236:239],v[136:139],v[64:67]
s_waitcnt lgkmcnt(4)
M v[52:55],a[216:219],v[148:151],v[52:55]
T a[236:237],v16 offset:20480
buffer_store_dwordx4 a[192:195],v0,s[24:27],s47 offen sc1
M v[56:59],a[216:219],v[152:155],v[56:59]
T a[238:239],v16 offset:22528
M v[60:63],a[216:219],v[156:159],v[60:63]
M v[72:75],a[220:223],v[156:159],v[72:75]
M v[68:71],a[220:223],v[152:155],v[68:71]
buffer_store_dwordx4 a[196:199],v0,s[24:27],s47 offen offset:1024 sc1
M v[64:67],a[220:223],v[148:151],v[64:67]
M v[52:55],a[224:227],v[160:163],v[52:55]
M v[56:59],a[224:227],v[164:167],v[56:59]
buffer_store_dwordx4 a[200:203],v0,s[24:27],s47 offen offset:2048 sc1
M v[60:63],a[224:227],v[168:171],v[60:63]
s_waitcnt vmcnt(5) lgkmcnt(0)
s_barrier
M v[72:75],a[228:231],v[168:171],v[72:75]
T a[216:217],v15 offset:24576
T a[218:219],v15 offset:26624
M v[68:71],a[228:231],v[164:167],v[68:71]
T a[220:221],v16 offset:24576
T a[222:223],v16 offset:26624
M v[64:67],a[228:231],v[160:163],v[64:67]
T a[224:225],v15 offset:28672
T a[226:227],v15 offset:30720
M v[52:55],a[232:235],v[172:175],v[52:55]
T a[228:229],v16 offset:28672
T a[230:231],v16 offset:30720
M v[56:59],a[232:235],v[176:179],v[56:59]
M v[60:63],a[232:235],v[180:183],v[60:63]
T a[232:233],v15 offset:32768
T a[234:235],v15 offset:34816
M v[72:75],a[236:239],v[180:183],v[72:75]
M v[68:71],a[236:239],v[176:179],v[68:71]
s_add_u32 s47,s47,0x3000
M v[64:67],a[236:239],v[172:175],v[64:67]
s_waitcnt lgkmcnt(4)
M v[52:55],a[216:219],v[184:187],v[52:55]
T a[236:237],v16 offset:32768
M v[56:59],a[216:219],v[188:191],v[56:59]
T a[238:239],v16 offset:34816
M v[60:63],a[216:219],v[192:195],v[60:63]
M v[72:75],a[220:223],v[192:195],v[72:75]
T a[216:217],v15 offset:36864
M v[68:71],a[220:223],v[188:191],v[68:71]
T a[218:219],v15 offset:38912
M v[64:67],a[220:223],v[184:187],v[64:67]
M v[52:55],a[224:227],v[196:199],v[52:55]
T a[220:221],v16 offset:36864
M v[56:59],a[224:227],v[200:203],v[56:59]
T a[222:223],v16 offset:38912
M v[60:63],a[224:227],v[204:207],v[60:63]
buffer_load_dword v39,v110,s[24:27],0 offen sc1
s_waitcnt lgkmcnt(4)
M v[72:75],a[228:231],v[204:207],v[72:75]
T a[224:225],v15 offset:40960
M v[68:71],a[228:231],v[200:203],v[68:71]
T a[226:227],v15 offset:43008
M v[64:67],a[228:231],v[196:199],v[64:67]
s_cmp_eq_u32 s47,s46
s_cselect_b32 s47,s45,s47
M v[52:55],a[232:235],v[208:211],v[52:55]
T a[228:229],v16 offset:40960
buffer_store_dwordx4 a[204:207],v0,s[24:27],s47 offen sc1
M v[56:59],a[232:235],v[212:215],v[56:59]
T a[230:231],v16 offset:43008
M v[60:63],a[232:235],v[216:219],v[60:63]
M v[72:75],a[236:239],v[216:219],v[72:75]
T a[232:233],v15 offset:45056
M v[68:71],a[236:239],v[212:215],v[68:71]
T a[234:235],v15 offset:47104
buffer_store_dwordx4 a[208:211],v0,s[24:27],s47 offen offset:1024 sc1
M v[64:67],a[236:239],v[208:211],v[64:67]
s_waitcnt lgkmcnt(4)
M v[52:55],a[216:219],v[220:223],v[52:55]
T a[236:237],v16 offset:45056
M v[56:59],a[216:219],v[224:227],v[56:59]
T a[238:239],v16 offset:47104
M v[60:63],a[216:219],v[228:231],v[60:63]
M v[72:75],a[220:223],v[228:231],v[72:75]
buffer_store_dwordx4 a[212:215],v0,s[24:27],s47 offen offset:2048 sc1
M v[68:71],a[220:223],v[224:227],v[68:71]
M v[64:67],a[220:223],v[220:223],v[64:67]
M v[52:55],a[224:227],v[232:235],v[52:55]
s_add_u32 s47,s47,0x3000
M v[56:59],a[224:227],v[236:239],v[56:59]
M v[60:63],a[224:227],v[240:243],v[60:63]
s_waitcnt lgkmcnt(0)
M v[72:75],a[228:231],v[240:243],v[72:75]
M v[68:71],a[228:231],v[236:239],v[68:71]
M v[64:67],a[228:231],v[232:235],v[64:67]
M v[52:55],a[232:235],v[244:247],v[52:55]
s_cmp_eq_u32 s47,s46
s_cselect_b32 s47,s45,s47
s_load_dwordx4 s[60:63],s[0:1],80
M v[56:59],a[232:235],v[248:251],v[56:59]
M v[60:63],a[232:235],v[252:255],v[60:63]
M v[72:75],a[236:239],v[252:255],v[72:75]
M v[68:71],a[236:239],v[248:251],v[68:71]
M v[64:67],a[236:239],v[244:247],v[64:67]
C v40,v52,v53
C v41,v54,v55
s_nop 5
C v42,v64,v65
C v43,v66,v67
buffer_store_dwordx4 v[40:43],v0,s[24:27],s44 offen sc1
C v44,v56,v57
C v45,v58,v59
C v46,v68,v69
C v47,v70,v71
buffer_store_dwordx4 v[44:47],v0,s[24:27],s44 offen offset:1024 sc1
C v48,v60,v61
C v49,v62,v63
C v50,v72,v73
C v51,v74,v75
buffer_store_dwordx4 v[48:51],v0,s[24:27],s44 offen offset:2048 sc1
s_add_u32 s44,s44,0x3000
s_cmp_eq_u32 s44,s46
s_cselect_b32 s44,s45,s44
s_waitcnt vmcnt(6)
L_r1:
v_cmp_ne_u32 vcc,v39,v109
s_bfe_u32 s28,s2,0x10002
s_lshr_b32 s29,s2,4
s_lshl_b32 s30,s29,4
s_lshl_b32 s33,s28,2
s_add_u32 s30,s30,s33
s_mul_i32 s30,s30,122880
s_mov_b32 s35,s51
s_mov_b32 s36,s50
s_mov_b32 s32,0
s_mov_b32 s37,0
s_lshl_b32 s47,1,s51
s_andn2_b32 s34,vcc_lo,s47
s_and_b32 s48,s34,0xff
s_mov_b32 s34,0
s_sub_u32 s49,0,s48
s_and_b32 s49,s49,s48
s_or_b32 s34,s34,s49
s_xor_b32 s48,s48,s49
L_r1_setup:
s_mul_i32 s33,s35,15
s_add_u32 s38,s36,0
s_add_u32 s38,s38,s33
s_lshl_b32 s42,s38,10
s_add_u32 s42,s42,s30
s_add_u32 s39,s36,4
s_add_u32 s39,s39,s33
s_lshl_b32 s43,s39,10
s_add_u32 s43,s43,s30
s_add_u32 s40,s36,8
s_add_u32 s40,s40,s33
s_lshl_b32 s44,s40,10
s_add_u32 s44,s44,s30
s_add_u32 s41,s36,12
s_min_u32 s41,s41,14
s_add_u32 s41,s41,s33
s_lshl_b32 s45,s41,10
s_add_u32 s45,s45,s30
s_mov_b32 s31,0
s_mov_b32 s33,0
s_mov_b32 s46,0
L_r1_issue:
s_bitcmp1_b32 s34,0
s_cbranch_scc0 L_r1_s0
s_add_u32 s55,s42,0
L v[112:115],v0,s[24:27],s55 offen sc1
s_add_u32 s55,s43,0
L v[144:147],v0,s[24:27],s55 offen sc1
s_add_u32 s55,s44,0
L v[176:179],v0,s[24:27],s55 offen sc1
s_add_u32 s55,s45,0
L v[208:211],v0,s[24:27],s55 offen sc1
L_r1_s0:
s_bitcmp1_b32 s34,1
s_cbranch_scc0 L_r1_s1
s_add_u32 s55,s42,983040
L v[116:119],v0,s[24:27],s55 offen sc1
s_add_u32 s55,s43,983040
L v[148:151],v0,s[24:27],s55 offen sc1
s_add_u32 s55,s44,983040
L v[180:183],v0,s[24:27],s55 offen sc1
s_add_u32 s55,s45,983040
L v[212:215],v0,s[24:27],s55 offen sc1
L_r1_s1:
s_bitcmp1_b32 s34,2
s_cbranch_scc0 L_r1_s2
s_add_u32 s55,s42,122880
L v[120:123],v0,s[24:27],s55 offen sc1
s_add_u32 s55,s43,122880
L v[152:155],v0,s[24:27],s55 offen sc1
s_add_u32 s55,s44,122880
L v[184:187],v0,s[24:27],s55 offen sc1
s_add_u32 s55,s45,122880
L v[216:219],v0,s[24:27],s55 offen sc1
L_r1_s2:
s_bitcmp1_b32 s34,3
s_cbranch_scc0 L_r1_s3
s_add_u32 s55,s42,1105920
L v[124:127],v0,s[24:27],s55 offen sc1
s_add_u32 s55,s43,1105920
L v[156:159],v0,s[24:27],s55 offen sc1
s_add_u32 s55,s44,1105920
L v[188:191],v0,s[24:27],s55 offen sc1
s_add_u32 s55,s45,1105920
L v[220:223],v0,s[24:27],s55 offen sc1
L_r1_s3:
s_bitcmp1_b32 s34,4
s_cbranch_scc0 L_r1_s4
s_add_u32 s55,s42,245760
L v[128:131],v0,s[24:27],s55 offen sc1
s_add_u32 s55,s43,245760
L v[160:163],v0,s[24:27],s55 offen sc1
s_add_u32 s55,s44,245760
L v[192:195],v0,s[24:27],s55 offen sc1
s_add_u32 s55,s45,245760
L v[224:227],v0,s[24:27],s55 offen sc1
L_r1_s4:
s_bitcmp1_b32 s34,5
s_cbranch_scc0 L_r1_s5
s_add_u32 s55,s42,1228800
L v[132:135],v0,s[24:27],s55 offen sc1
s_add_u32 s55,s43,1228800
L v[164:167],v0,s[24:27],s55 offen sc1
s_add_u32 s55,s44,1228800
L v[196:199],v0,s[24:27],s55 offen sc1
s_add_u32 s55,s45,1228800
L v[228:231],v0,s[24:27],s55 offen sc1
L_r1_s5:
s_bitcmp1_b32 s34,6
s_cbranch_scc0 L_r1_s6
s_add_u32 s55,s42,368640
L v[136:139],v0,s[24:27],s55 offen sc1
s_add_u32 s55,s43,368640
L v[168:171],v0,s[24:27],s55 offen sc1
s_add_u32 s55,s44,368640
L v[200:203],v0,s[24:27],s55 offen sc1
s_add_u32 s55,s45,368640
L v[232:235],v0,s[24:27],s55 offen sc1
L_r1_s6:
s_bitcmp1_b32 s34,7
s_cbranch_scc0 L_r1_s7
s_add_u32 s55,s42,1351680
L v[140:143],v0,s[24:27],s55 offen sc1
s_add_u32 s55,s43,1351680
L v[172:175],v0,s[24:27],s55 offen sc1
s_add_u32 s55,s44,1351680
L v[204:207],v0,s[24:27],s55 offen sc1
s_add_u32 s55,s45,1351680
L v[236:239],v0,s[24:27],s55 offen sc1
L_r1_s7:
s_or_b32 s54,s47,s33
s_cbranch_scc1 L_r1_nset
v_lshrrev_b32 v3,4,v0
v_and_b32 v2,15,v3
v_mul_u32_u24 v2,2560,v2
v_lshrrev_b32 v3,4,v3
v_lshl_add_u32 v2,v3,4,v2
s_mul_hi_u32 s54,s38,0x15555556
s_mul_i32 s55,s54,12
s_sub_u32 s55,s38,s55
s_mul_hi_u32 s56,s55,0x55555556
s_mul_i32 s57,s56,3
s_sub_u32 s57,s55,s57
s_and_b32 s12,s56,1
s_mul_i32 s12,s12,48
s_lshl_b32 s57,s57,4
s_add_u32 s12,s12,s57
s_mul_i32 s57,s29,96
s_add_u32 s12,s12,s57
s_mul_i32 s12,s12,2560
s_mul_i32 s57,s28,1280
s_add_u32 s12,s12,s57
s_lshl_b32 s57,s54,7
s_add_u32 s12,s12,s57
s_lshr_b32 s57,s56,1
s_lshl_b32 s57,s57,6
s_add_u32 s12,s12,s57
s_mul_hi_u32 s54,s39,0x15555556
s_mul_i32 s55,s54,12
s_sub_u32 s55,s39,s55
s_mul_hi_u32 s56,s55,0x55555556
s_mul_i32 s57,s56,3
s_sub_u32 s57,s55,s57
s_and_b32 s13,s56,1
s_mul_i32 s13,s13,48
s_lshl_b32 s57,s57,4
s_add_u32 s13,s13,s57
s_mul_i32 s57,s29,96
s_add_u32 s13,s13,s57
s_mul_i32 s13,s13,2560
s_mul_i32 s57,s28,1280
s_add_u32 s13,s13,s57
s_lshl_b32 s57,s54,7
s_add_u32 s13,s13,s57
s_lshr_b32 s57,s56,1
s_lshl_b32 s57,s57,6
s_add_u32 s13,s13,s57
s_mul_hi_u32 s54,s40,0x15555556
s_mul_i32 s55,s54,12
s_sub_u32 s55,s40,s55
s_mul_hi_u32 s56,s55,0x55555556
s_mul_i32 s57,s56,3
s_sub_u32 s57,s55,s57
s_and_b32 s14,s56,1
s_mul_i32 s14,s14,48
s_lshl_b32 s57,s57,4
s_add_u32 s14,s14,s57
s_mul_i32 s57,s29,96
s_add_u32 s14,s14,s57
s_mul_i32 s14,s14,2560
s_mul_i32 s57,s28,1280
s_add_u32 s14,s14,s57
s_lshl_b32 s57,s54,7
s_add_u32 s14,s14,s57
s_lshr_b32 s57,s56,1
s_lshl_b32 s57,s57,6
s_add_u32 s14,s14,s57
s_mul_hi_u32 s54,s41,0x15555556
s_mul_i32 s55,s54,12
s_sub_u32 s55,s41,s55
s_mul_hi_u32 s56,s55,0x55555556
s_mul_i32 s57,s56,3
s_sub_u32 s57,s55,s57
s_and_b32 s15,s56,1
s_mul_i32 s15,s15,48
s_lshl_b32 s57,s57,4
s_add_u32 s15,s15,s57
s_mul_i32 s57,s29,96
s_add_u32 s15,s15,s57
s_mul_i32 s15,s15,2560
s_mul_i32 s57,s28,1280
s_add_u32 s15,s15,s57
s_lshl_b32 s57,s54,7
s_add_u32 s15,s15,s57
s_lshr_b32 s57,s56,1
s_lshl_b32 s57,s57,6
s_add_u32 s15,s15,s57
v_mov_b32 v64,0
v_mov_b32 v65,0
v_mov_b32 v66,0
v_mov_b32 v67,0
v_mov_b32 v68,0
v_mov_b32 v69,0
v_mov_b32 v70,0
v_mov_b32 v71,0
v_mov_b32 v72,0
v_mov_b32 v73,0
v_mov_b32 v74,0
v_mov_b32 v75,0
v_mov_b32 v76,0
v_mov_b32 v77,0
v_mov_b32 v78,0
v_mov_b32 v79,0
v_mov_b32 v80,0
v_mov_b32 v81,0
v_mov_b32 v82,0
v_mov_b32 v83,0
v_mov_b32 v84,0
v_mov_b32 v85,0
v_mov_b32 v86,0
v_mov_b32 v87,0
v_mov_b32 v88,0
v_mov_b32 v89,0
v_mov_b32 v90,0
v_mov_b32 v91,0
v_mov_b32 v92,0
v_mov_b32 v93,0
v_mov_b32 v94,0
v_mov_b32 v95,0
s_mov_b32 s33,1
L_r1_nset:
s_or_b32 s31,s31,s34
s_or_b32 s46,s46,s34
s_cmp_eq_u32 s47,0
s_cbranch_scc1 L_r1_norm
s_lshl_b32 s54,s28,4
s_add_u32 s54,s54,s29
s_lshl_b32 s54,s54,2
v_mov_b32 v6,s54
s_waitcnt lgkmcnt(0)
s_mov_b32 s4,s60
s_mov_b32 s5,s61
s_mov_b32 s6,3932160
s_mov_b32 s7,0x20000
s_mov_b32 s8,s62
s_mov_b32 s9,s63
s_mov_b32 s10,256
s_mov_b32 s11,0x20000
s_bcnt1_i32_b32 s54,s34
s_cmp_lt_u32 s54,1
s_cbranch_scc1 L_r1_w0
s_waitcnt vmcnt(4)
s_branch L_r1_bar
L_r1_w0:
s_waitcnt vmcnt(0)
L_r1_bar:
s_barrier
s_or_b32 s34,s47,s48
s_mov_b32 s49,s47
s_mov_b32 s47,0
s_cmp_lg_u32 s50,0
s_cbranch_scc1 L_r1_issue
s_mov_b32 exec_lo,s49
s_mov_b32 exec_hi,0
v_add_u32 v8,1,v109
buffer_store_dword v8,v110,s[24:27],0 offen sc1
v_mov_b32 v7,1
buffer_atomic_add v7,v6,s[8:11],0 offen sc0
s_mov_b64 exec,-1
s_branch L_r1_issue
L_r1_norm:
s_cmp_eq_u32 s31,0xff
s_cbranch_scc1 L_r1_wait
L_r1_poll:
buffer_load_dword v39,v110,s[24:27],0 offen sc1
s_add_u32 s33,s33,1
L_r1_wait:
s_waitcnt vmcnt(0)
s_bitcmp1_b32 s46,0
s_cbranch_scc0 L_r1_a0
M v[64:67],a[242:245],v[112:115],v[64:67]
M v[68:71],a[240:243],v[112:115],v[68:71]
M v[72:75],a[242:245],v[144:147],v[72:75]
M v[76:79],a[240:243],v[144:147],v[76:79]
M v[80:83],a[242:245],v[176:179],v[80:83]
M v[84:87],a[240:243],v[176:179],v[84:87]
M v[88:91],a[242:245],v[208:211],v[88:91]
M v[92:95],a[240:243],v[208:211],v[92:95]
L_r1_a0:
s_bitcmp1_b32 s46,1
s_cbranch_scc0 L_r1_a1
M v[64:67],a[242:245],v[116:119],v[64:67]
M v[68:71],a[240:243],v[116:119],v[68:71]
M v[72:75],a[242:245],v[148:151],v[72:75]
M v[76:79],a[240:243],v[148:151],v[76:79]
M v[80:83],a[242:245],v[180:183],v[80:83]
M v[84:87],a[240:243],v[180:183],v[84:87]
M v[88:91],a[242:245],v[212:215],v[88:91]
M v[92:95],a[240:243],v[212:215],v[92:95]
L_r1_a1:
s_bitcmp1_b32 s46,2
s_cbranch_scc0 L_r1_a2
M v[64:67],a[242:245],v[120:123],v[64:67]
M v[68:71],a[240:243],v[120:123],v[68:71]
M v[72:75],a[242:245],v[152:155],v[72:75]
M v[76:79],a[240:243],v[152:155],v[76:79]
M v[80:83],a[242:245],v[184:187],v[80:83]
M v[84:87],a[240:243],v[184:187],v[84:87]
M v[88:91],a[242:245],v[216:219],v[88:91]
M v[92:95],a[240:243],v[216:219],v[92:95]
L_r1_a2:
s_bitcmp1_b32 s46,3
s_cbranch_scc0 L_r1_a3
M v[64:67],a[242:245],v[124:127],v[64:67]
M v[68:71],a[240:243],v[124:127],v[68:71]
M v[72:75],a[242:245],v[156:159],v[72:75]
M v[76:79],a[240:243],v[156:159],v[76:79]
M v[80:83],a[242:245],v[188:191],v[80:83]
M v[84:87],a[240:243],v[188:191],v[84:87]
M v[88:91],a[242:245],v[220:223],v[88:91]
M v[92:95],a[240:243],v[220:223],v[92:95]
L_r1_a3:
s_bitcmp1_b32 s46,4
s_cbranch_scc0 L_r1_a4
M v[64:67],a[242:245],v[128:131],v[64:67]
M v[68:71],a[240:243],v[128:131],v[68:71]
M v[72:75],a[242:245],v[160:163],v[72:75]
M v[76:79],a[240:243],v[160:163],v[76:79]
M v[80:83],a[242:245],v[192:195],v[80:83]
M v[84:87],a[240:243],v[192:195],v[84:87]
M v[88:91],a[242:245],v[224:227],v[88:91]
M v[92:95],a[240:243],v[224:227],v[92:95]
L_r1_a4:
s_bitcmp1_b32 s46,5
s_cbranch_scc0 L_r1_a5
M v[64:67],a[242:245],v[132:135],v[64:67]
M v[68:71],a[240:243],v[132:135],v[68:71]
M v[72:75],a[242:245],v[164:167],v[72:75]
M v[76:79],a[240:243],v[164:167],v[76:79]
M v[80:83],a[242:245],v[196:199],v[80:83]
M v[84:87],a[240:243],v[196:199],v[84:87]
M v[88:91],a[242:245],v[228:231],v[88:91]
M v[92:95],a[240:243],v[228:231],v[92:95]
L_r1_a5:
s_bitcmp1_b32 s46,6
s_cbranch_scc0 L_r1_a6
M v[64:67],a[242:245],v[136:139],v[64:67]
M v[68:71],a[240:243],v[136:139],v[68:71]
M v[72:75],a[242:245],v[168:171],v[72:75]
M v[76:79],a[240:243],v[168:171],v[76:79]
M v[80:83],a[242:245],v[200:203],v[80:83]
M v[84:87],a[240:243],v[200:203],v[84:87]
M v[88:91],a[242:245],v[232:235],v[88:91]
M v[92:95],a[240:243],v[232:235],v[92:95]
L_r1_a6:
s_bitcmp1_b32 s46,7
s_cbranch_scc0 L_r1_a7
M v[64:67],a[242:245],v[140:143],v[64:67]
M v[68:71],a[240:243],v[140:143],v[68:71]
M v[72:75],a[242:245],v[172:175],v[72:75]
M v[76:79],a[240:243],v[172:175],v[76:79]
M v[80:83],a[242:245],v[204:207],v[80:83]
M v[84:87],a[240:243],v[204:207],v[84:87]
M v[88:91],a[242:245],v[236:239],v[88:91]
M v[92:95],a[240:243],v[236:239],v[92:95]
L_r1_a7:
s_mov_b32 s46,0
s_cmp_eq_u32 s31,0xff
s_cbranch_scc1 L_r1_sum
v_cmp_ne_u32 vcc,v39,v109
s_nop 4
s_andn2_b32 s34,vcc_lo,s31
s_and_b32 s34,s34,0xff
s_cbranch_scc1 L_r1_issue
s_and_b32 s54,s33,31
s_cbranch_scc1 L_r1_poll
s_mov_b64 exec,1
s_cmp_lt_u32 s33,3000
s_cbranch_scc1 L_r1_cnt
s_lshl_b32 s34,1,s51
v_mov_b32 v8,s34
buffer_atomic_or v8,v6,s[8:11],0 offen offset:128 sc0
s_waitcnt vmcnt(0)
L_r1_cnt:
v_mov_b32 v8,0
buffer_atomic_add v8,v6,s[8:11],0 offen sc0
s_waitcnt vmcnt(0)
v_readfirstlane_b32 s54,v8
s_mov_b64 exec,-1
s_andn2_b32 s34,0xff,s31
s_nop 2
s_cmp_eq_u32 s54,8
s_cbranch_scc1 L_r1_issue
s_cmp_lt_u32 s33,3000
s_cbranch_scc1 L_r1_poll
s_branch L_r1_next
L_r1_sum:
s_or_b32 s54,s50,s32
s_cbranch_scc1 L_r1_sum2
s_mov_b64 exec,1
v_mov_b32 v9,0
buffer_atomic_or v9,v6,s[8:11],0 offen offset:128 sc0
s_mov_b64 exec,-1
L_r1_sum2:
s_nop 7
C v48,v64,v65
C v49,v66,v67
C v50,v68,v69
C v51,v70,v71
C v52,v72,v73
C v53,v74,v75
C v54,v76,v77
C v55,v78,v79
C v56,v80,v81
C v57,v82,v83
C v58,v84,v85
C v59,v86,v87
C v60,v88,v89
C v61,v90,v91
C v62,v92,v93
C v63,v94,v95
v_permlane32_swap_b32 v48,v50
v_permlane32_swap_b32 v49,v51
v_permlane32_swap_b32 v52,v54
v_permlane32_swap_b32 v53,v55
v_permlane32_swap_b32 v56,v58
v_permlane32_swap_b32 v57,v59
v_permlane32_swap_b32 v60,v62
v_permlane32_swap_b32 v61,v63
v_permlane16_swap_b32 v48,v50
v_permlane16_swap_b32 v49,v51
v_permlane16_swap_b32 v52,v54
v_permlane16_swap_b32 v53,v55
v_permlane16_swap_b32 v56,v58
v_permlane16_swap_b32 v57,v59
v_permlane16_swap_b32 v60,v62
v_permlane16_swap_b32 v61,v63
s_nop 1
buffer_store_dwordx4 v[48:51],v2,s[4:7],s12 offen sc1
buffer_store_dwordx4 v[52:55],v2,s[4:7],s13 offen sc1
buffer_store_dwordx4 v[56:59],v2,s[4:7],s14 offen sc1
buffer_store_dwordx4 v[60:63],v2,s[4:7],s15 offen sc1
L_r1_next:
s_cmp_lg_u32 s50,0
s_cbranch_scc1 L_r1_done
s_cmp_lg_u32 s32,0
s_cbranch_scc1 L_r1_more
s_waitcnt vmcnt(0)
v_readlane_b32 s32,v7,s51
v_readlane_b32 s37,v9,0
s_nop 3
s_cmp_eq_u32 s32,7
s_cbranch_scc0 L_r1_done
s_mov_b32 s36,3
L_r1_more:
s_add_u32 s36,s36,1
s_and_b32 s36,s36,3
s_cbranch_scc1 L_r1_go
s_cmp_eq_u32 s37,0
s_cbranch_scc1 L_r1_done
s_ff1_i32_b32 s35,s37
s_bitset0_b32 s37,s35
L_r1_go:
s_mov_b32 s34,0xff
s_nop 7
s_branch L_r1_setup
L_r1_done:
s_endpgm
C1_29_r:
s_call_b64 s[52:53],L_rare1_1
s_branch C1_29_b
C1_31_r:
s_call_b64 s[52:53],L_rare1_0
s_branch C1_31_b
C1_33_r:
s_call_b64 s[52:53],L_rare1_1
s_branch C1_33_b
C1_35_r:
s_call_b64 s[52:53],L_rare1_0
s_branch C1_35_b
C1_37_r:
s_call_b64 s[52:53],L_rare1_1
s_branch C1_37_b
C1_41_r:
s_call_b64 s[52:53],L_rare1_1
s_branch C1_41_b
C1_43_r:
s_call_b64 s[52:53],L_rare1_0
s_branch C1_43_b
C1_45_r:
s_call_b64 s[52:53],L_rare1_1
s_branch C1_45_b
C1_47_r:
s_call_b64 s[52:53],L_rare1_0
s_branch C1_47_b
C1_49_r:
s_call_b64 s[52:53],L_rare1_1
s_branch C1_49_b
L_rare1_0:
s_nop 7
v_max3_f32 v29,v52,v53,v54
v_max3_f32 v30,v56,v57,v58
v_max3_f32 v31,v60,v61,v62
v_max3_f32 v29,v29,v55,v64
v_max3_f32 v30,v30,v59,v68
v_max3_f32 v31,v31,v63,v72
v_max3_f32 v29,v29,v65,v66
v_max3_f32 v30,v30,v69,v70
v_max3_f32 v31,v31,v73,v74
v_max_f32 v29,v29,v67
v_max_f32 v30,v30,v71
v_max_f32 v31,v31,v75
v_mov_b32 v25,v29
v_mov_b32 v26,v30
v_mov_b32 v27,v31
v_permlane32_swap_b32 v29,v25
v_permlane32_swap_b32 v30,v26
v_permlane32_swap_b32 v31,v27
v_max_f32 v29,v29,v25
v_max_f32 v30,v30,v26
v_max_f32 v31,v31,v27
v_mov_b32 v25,v29
v_mov_b32 v26,v30
v_mov_b32 v27,v31
v_permlane16_swap_b32 v29,v25
v_permlane16_swap_b32 v30,v26
v_permlane16_swap_b32 v31,v27
v_max_f32 v29,v29,v25
v_max_f32 v30,v30,v26
v_max_f32 v31,v31,v27
v_max_f32 v29,0,v29
v_max_f32 v30,0,v30
v_max_f32 v31,0,v31
v_add_f32 v19,v19,v29
v_add_f32 v20,v20,v30
v_add_f32 v21,v21,v31
v_sub_f32 v32,0,v29
v_sub_f32 v33,0,v30
v_sub_f32 v34,0,v31
v_exp_f32 v32,v32
v_exp_f32 v33,v33
v_exp_f32 v34,v34
v_sub_f32 v52,v52,v29
v_sub_f32 v56,v56,v30
v_sub_f32 v60,v60,v31
v_sub_f32 v53,v53,v29
v_sub_f32 v57,v57,v30
v_sub_f32 v61,v61,v31
v_sub_f32 v54,v54,v29
v_sub_f32 v58,v58,v30
v_sub_f32 v62,v62,v31
v_sub_f32 v55,v55,v29
v_sub_f32 v59,v59,v30
v_sub_f32 v63,v63,v31
v_sub_f32 v64,v64,v29
v_sub_f32 v68,v68,v30
v_sub_f32 v72,v72,v31
v_sub_f32 v65,v65,v29
v_sub_f32 v69,v69,v30
v_sub_f32 v73,v73,v31
v_sub_f32 v66,v66,v29
v_sub_f32 v70,v70,v30
v_sub_f32 v74,v74,v31
v_sub_f32 v67,v67,v29
v_sub_f32 v71,v71,v30
v_sub_f32 v75,v75,v31
v_mul_f32 v22,v22,v32
v_mul_f32 v23,v23,v33
v_mul_f32 v24,v24,v34
v_mul_f32 v112,v112,v32
v_mul_f32 v116,v116,v33
v_mul_f32 v120,v120,v34
v_mul_f32 v113,v113,v32
v_mul_f32 v117,v117,v33
v_mul_f32 v121,v121,v34
v_mul_f32 v114,v114,v32
v_mul_f32 v118,v118,v33
v_mul_f32 v122,v122,v34
v_mul_f32 v115,v115,v32
v_mul_f32 v119,v119,v33
v_mul_f32 v123,v123,v34
v_mul_f32 v124,v124,v32
v_mul_f32 v128,v128,v33
v_mul_f32 v132,v132,v34
v_mul_f32 v125,v125,v32
v_mul_f32 v129,v129,v33
v_mul_f32 v133,v133,v34
v_mul_f32 v126,v126,v32
v_mul_f32 v130,v130,v33
v_mul_f32 v134,v134,v34
v_mul_f32 v127,v127,v32
v_mul_f32 v131,v131,v33
v_mul_f32 v135,v135,v34
v_mul_f32 v136,v136,v32
v_mul_f32 v140,v140,v33
v_mul_f32 v144,v144,v34
v_mul_f32 v137,v137,v32
v_mul_f32 v141,v141,v33
v_mul_f32 v145,v145,v34
v_mul_f32 v138,v138,v32
v_mul_f32 v142,v142,v33
v_mul_f32 v146,v146,v34
v_mul_f32 v139,v139,v32
v_mul_f32 v143,v143,v33
v_mul_f32 v147,v147,v34
v_mul_f32 v148,v148,v32
v_mul_f32 v152,v152,v33
v_mul_f32 v156,v156,v34
v_mul_f32 v149,v149,v32
v_mul_f32 v153,v153,v33
v_mul_f32 v157,v157,v34
v_mul_f32 v150,v150,v32
v_mul_f32 v154,v154,v33
v_mul_f32 v158,v158,v34
v_mul_f32 v151,v151,v32
v_mul_f32 v155,v155,v33
v_mul_f32 v159,v159,v34
v_mul_f32 v160,v160,v32
v_mul_f32 v164,v164,v33
v_mul_f32 v168,v168,v34
v_mul_f32 v161,v161,v32
v_mul_f32 v165,v165,v33
v_mul_f32 v169,v169,v34
v_mul_f32 v162,v162,v32
v_mul_f32 v166,v166,v33
v_mul_f32 v170,v170,v34
v_mul_f32 v163,v163,v32
v_mul_f32 v167,v167,v33
v_mul_f32 v171,v171,v34
v_mul_f32 v172,v172,v32
v_mul_f32 v176,v176,v33
v_mul_f32 v180,v180,v34
v_mul_f32 v173,v173,v32
v_mul_f32 v177,v177,v33
v_mul_f32 v181,v181,v34
v_mul_f32 v174,v174,v32
v_mul_f32 v178,v178,v33
v_mul_f32 v182,v182,v34
v_mul_f32 v175,v175,v32
v_mul_f32 v179,v179,v33
v_mul_f32 v183,v183,v34
v_mul_f32 v184,v184,v32
v_mul_f32 v188,v188,v33
v_mul_f32 v192,v192,v34
v_mul_f32 v185,v185,v32
v_mul_f32 v189,v189,v33
v_mul_f32 v193,v193,v34
v_mul_f32 v186,v186,v32
v_mul_f32 v190,v190,v33
v_mul_f32 v194,v194,v34
v_mul_f32 v187,v187,v32
v_mul_f32 v191,v191,v33
v_mul_f32 v195,v195,v34
v_mul_f32 v196,v196,v32
v_mul_f32 v200,v200,v33
v_mul_f32 v204,v204,v34
v_mul_f32 v197,v197,v32
v_mul_f32 v201,v201,v33
v_mul_f32 v205,v205,v34
v_mul_f32 v198,v198,v32
v_mul_f32 v202,v202,v33
v_mul_f32 v206,v206,v34
v_mul_f32 v199,v199,v32
v_mul_f32 v203,v203,v33
v_mul_f32 v207,v207,v34
v_mul_f32 v208,v208,v32
v_mul_f32 v212,v212,v33
v_mul_f32 v216,v216,v34
v_mul_f32 v209,v209,v32
v_mul_f32 v213,v213,v33
v_mul_f32 v217,v217,v34
v_mul_f32 v210,v210,v32
v_mul_f32 v214,v214,v33
v_mul_f32 v218,v218,v34
v_mul_f32 v211,v211,v32
v_mul_f32 v215,v215,v33
v_mul_f32 v219,v219,v34
v_mul_f32 v220,v220,v32
v_mul_f32 v224,v224,v33
v_mul_f32 v228,v228,v34
v_mul_f32 v221,v221,v32
v_mul_f32 v225,v225,v33
v_mul_f32 v229,v229,v34
v_mul_f32 v222,v222,v32
v_mul_f32 v226,v226,v33
v_mul_f32 v230,v230,v34
v_mul_f32 v223,v223,v32
v_mul_f32 v227,v227,v33
v_mul_f32 v231,v231,v34
v_mul_f32 v232,v232,v32
v_mul_f32 v236,v236,v33
v_mul_f32 v240,v240,v34
v_mul_f32 v233,v233,v32
v_mul_f32 v237,v237,v33
v_mul_f32 v241,v241,v34
v_mul_f32 v234,v234,v32
v_mul_f32 v238,v238,v33
v_mul_f32 v242,v242,v34
v_mul_f32 v235,v235,v32
v_mul_f32 v239,v239,v33
v_mul_f32 v243,v243,v34
v_mul_f32 v244,v244,v32
v_mul_f32 v248,v248,v33
v_mul_f32 v252,v252,v34
v_mul_f32 v245,v245,v32
v_mul_f32 v249,v249,v33
v_mul_f32 v253,v253,v34
v_mul_f32 v246,v246,v32
v_mul_f32 v250,v250,v33
v_mul_f32 v254,v254,v34
v_mul_f32 v247,v247,v32
v_mul_f32 v251,v251,v33
v_mul_f32 v255,v255,v34
s_nop 3
s_setpc_b64 s[52:53]
L_rare1_1:
s_nop 7
v_max3_f32 v29,v76,v77,v78
v_max3_f32 v30,v80,v81,v82
v_max3_f32 v31,v84,v85,v86
v_max3_f32 v29,v29,v79,v88
v_max3_f32 v30,v30,v83,v92
v_max3_f32 v31,v31,v87,v96
v_max3_f32 v29,v29,v89,v90
v_max3_f32 v30,v30,v93,v94
v_max3_f32 v31,v31,v97,v98
v_max_f32 v29,v29,v91
v_max_f32 v30,v30,v95
v_max_f32 v31,v31,v99
v_mov_b32 v25,v29
v_mov_b32 v26,v30
v_mov_b32 v27,v31
v_permlane32_swap_b32 v29,v25
v_permlane32_swap_b32 v30,v26
v_permlane32_swap_b32 v31,v27
v_max_f32 v29,v29,v25
v_max_f32 v30,v30,v26
v_max_f32 v31,v31,v27
v_mov_b32 v25,v29
v_mov_b32 v26,v30
v_mov_b32 v27,v31
v_permlane16_swap_b32 v29,v25
v_permlane16_swap_b32 v30,v26
v_permlane16_swap_b32 v31,v27
v_max_f32 v29,v29,v25
v_max_f32 v30,v30,v26
v_max_f32 v31,v31,v27
v_max_f32 v29,0,v29
v_max_f32 v30,0,v30
v_max_f32 v31,0,v31
v_add_f32 v19,v19,v29
v_add_f32 v20,v20,v30
v_add_f32 v21,v21,v31
v_sub_f32 v32,0,v29
v_sub_f32 v33,0,v30
v_sub_f32 v34,0,v31
v_exp_f32 v32,v32
v_exp_f32 v33,v33
v_exp_f32 v34,v34
v_sub_f32 v76,v76,v29
v_sub_f32 v80,v80,v30
v_sub_f32 v84,v84,v31
v_sub_f32 v77,v77,v29
v_sub_f32 v81,v81,v30
v_sub_f32 v85,v85,v31
v_sub_f32 v78,v78,v29
v_sub_f32 v82,v82,v30
v_sub_f32 v86,v86,v31
v_sub_f32 v79,v79,v29
v_sub_f32 v83,v83,v30
v_sub_f32 v87,v87,v31
v_sub_f32 v88,v88,v29
v_sub_f32 v92,v92,v30
v_sub_f32 v96,v96,v31
v_sub_f32 v89,v89,v29
v_sub_f32 v93,v93,v30
v_sub_f32 v97,v97,v31
v_sub_f32 v90,v90,v29
v_sub_f32 v94,v94,v30
v_sub_f32 v98,v98,v31
v_sub_f32 v91,v91,v29
v_sub_f32 v95,v95,v30
v_sub_f32 v99,v99,v31
v_mul_f32 v22,v22,v32
v_mul_f32 v23,v23,v33
v_mul_f32 v24,v24,v34
v_mul_f32 v112,v112,v32
v_mul_f32 v116,v116,v33
v_mul_f32 v120,v120,v34
v_mul_f32 v113,v113,v32
v_mul_f32 v117,v117,v33
v_mul_f32 v121,v121,v34
v_mul_f32 v114,v114,v32
v_mul_f32 v118,v118,v33
v_mul_f32 v122,v122,v34
v_mul_f32 v115,v115,v32
v_mul_f32 v119,v119,v33
v_mul_f32 v123,v123,v34
v_mul_f32 v124,v124,v32
v_mul_f32 v128,v128,v33
v_mul_f32 v132,v132,v34
v_mul_f32 v125,v125,v32
v_mul_f32 v129,v129,v33
v_mul_f32 v133,v133,v34
v_mul_f32 v126,v126,v32
v_mul_f32 v130,v130,v33
v_mul_f32 v134,v134,v34
v_mul_f32 v127,v127,v32
v_mul_f32 v131,v131,v33
v_mul_f32 v135,v135,v34
v_mul_f32 v136,v136,v32
v_mul_f32 v140,v140,v33
v_mul_f32 v144,v144,v34
v_mul_f32 v137,v137,v32
v_mul_f32 v141,v141,v33
v_mul_f32 v145,v145,v34
v_mul_f32 v138,v138,v32
v_mul_f32 v142,v142,v33
v_mul_f32 v146,v146,v34
v_mul_f32 v139,v139,v32
v_mul_f32 v143,v143,v33
v_mul_f32 v147,v147,v34
v_mul_f32 v148,v148,v32
v_mul_f32 v152,v152,v33
v_mul_f32 v156,v156,v34
v_mul_f32 v149,v149,v32
v_mul_f32 v153,v153,v33
v_mul_f32 v157,v157,v34
v_mul_f32 v150,v150,v32
v_mul_f32 v154,v154,v33
v_mul_f32 v158,v158,v34
v_mul_f32 v151,v151,v32
v_mul_f32 v155,v155,v33
v_mul_f32 v159,v159,v34
v_mul_f32 v160,v160,v32
v_mul_f32 v164,v164,v33
v_mul_f32 v168,v168,v34
v_mul_f32 v161,v161,v32
v_mul_f32 v165,v165,v33
v_mul_f32 v169,v169,v34
v_mul_f32 v162,v162,v32
v_mul_f32 v166,v166,v33
v_mul_f32 v170,v170,v34
v_mul_f32 v163,v163,v32
v_mul_f32 v167,v167,v33
v_mul_f32 v171,v171,v34
v_mul_f32 v172,v172,v32
v_mul_f32 v176,v176,v33
v_mul_f32 v180,v180,v34
v_mul_f32 v173,v173,v32
v_mul_f32 v177,v177,v33
v_mul_f32 v181,v181,v34
v_mul_f32 v174,v174,v32
v_mul_f32 v178,v178,v33
v_mul_f32 v182,v182,v34
v_mul_f32 v175,v175,v32
v_mul_f32 v179,v179,v33
v_mul_f32 v183,v183,v34
v_mul_f32 v184,v184,v32
v_mul_f32 v188,v188,v33
v_mul_f32 v192,v192,v34
v_mul_f32 v185,v185,v32
v_mul_f32 v189,v189,v33
v_mul_f32 v193,v193,v34
v_mul_f32 v186,v186,v32
v_mul_f32 v190,v190,v33
v_mul_f32 v194,v194,v34
v_mul_f32 v187,v187,v32
v_mul_f32 v191,v191,v33
v_mul_f32 v195,v195,v34
v_mul_f32 v196,v196,v32
v_mul_f32 v200,v200,v33
v_mul_f32 v204,v204,v34
v_mul_f32 v197,v197,v32
v_mul_f32 v201,v201,v33
v_mul_f32 v205,v205,v34
v_mul_f32 v198,v198,v32
v_mul_f32 v202,v202,v33
v_mul_f32 v206,v206,v34
v_mul_f32 v199,v199,v32
v_mul_f32 v203,v203,v33
v_mul_f32 v207,v207,v34
v_mul_f32 v208,v208,v32
v_mul_f32 v212,v212,v33
v_mul_f32 v216,v216,v34
v_mul_f32 v209,v209,v32
v_mul_f32 v213,v213,v33
v_mul_f32 v217,v217,v34
v_mul_f32 v210,v210,v32
v_mul_f32 v214,v214,v33
v_mul_f32 v218,v218,v34
v_mul_f32 v211,v211,v32
v_mul_f32 v215,v215,v33
v_mul_f32 v219,v219,v34
v_mul_f32 v220,v220,v32
v_mul_f32 v224,v224,v33
v_mul_f32 v228,v228,v34
v_mul_f32 v221,v221,v32
v_mul_f32 v225,v225,v33
v_mul_f32 v229,v229,v34
v_mul_f32 v222,v222,v32
v_mul_f32 v226,v226,v33
v_mul_f32 v230,v230,v34
v_mul_f32 v223,v223,v32
v_mul_f32 v227,v227,v33
v_mul_f32 v231,v231,v34
v_mul_f32 v232,v232,v32
v_mul_f32 v236,v236,v33
v_mul_f32 v240,v240,v34
v_mul_f32 v233,v233,v32
v_mul_f32 v237,v237,v33
v_mul_f32 v241,v241,v34
v_mul_f32 v234,v234,v32
v_mul_f32 v238,v238,v33
v_mul_f32 v242,v242,v34
v_mul_f32 v235,v235,v32
v_mul_f32 v239,v239,v33
v_mul_f32 v243,v243,v34
v_mul_f32 v244,v244,v32
v_mul_f32 v248,v248,v33
v_mul_f32 v252,v252,v34
v_mul_f32 v245,v245,v32
v_mul_f32 v249,v249,v33
v_mul_f32 v253,v253,v34
v_mul_f32 v246,v246,v32
v_mul_f32 v250,v250,v33
v_mul_f32 v254,v254,v34
v_mul_f32 v247,v247,v32
v_mul_f32 v251,v251,v33
v_mul_f32 v255,v255,v34
s_nop 3
s_setpc_b64 s[52:53]
L_code_end:
.section .rodata,"a"
.p2align 6
.amdhsa_kernel concat_heads__mha_block_cached__gqa_block_cached__near_ridge_kernel
  .amdhsa_next_free_vgpr 512
  .amdhsa_next_free_sgpr 102
  .amdhsa_accum_offset 256
  .amdhsa_group_segment_fixed_size 0
  .amdhsa_kernarg_size 104
  .amdhsa_user_sgpr_count 2
  .amdhsa_user_sgpr_kernarg_segment_ptr 1
  .amdhsa_system_sgpr_workgroup_id_x 1
.end_amdhsa_kernel
```
